```python
import torch

def _softmax(x, axis=-1):
    return torch.softmax(x, dim=axis)
def _gelu(x):
    return torch.nn.functional.gelu(x, approximate="tanh")
def _silu(x):
    return torch.nn.functional.silu(x)
def _sigmoid(x):
    return torch.sigmoid(x)
def _layernorm(x, axis=-1, eps=1e-5):
    m = x.mean(dim=axis, keepdim=True)
    v = x.var(dim=axis, keepdim=True, unbiased=False)
    return (x - m) / torch.sqrt(v + eps)
def _scatter_add(tgt, idx, src, axis=0):
    return tgt.clone().index_add_(axis, idx, src)
def _segment_sum(src, seg, n):
    out = torch.zeros((n,) + src.shape[1:], dtype=src.dtype)
    return out.index_add_(0, seg, src)
def _pad(x, pw):
    flat = tuple(v for pair in reversed(pw) for v in pair)
    return torch.nn.functional.pad(x, flat)

kernel_name = 'recurrent_scan__sliding_block_cached__mixer_s_mlp__prompt'

def setup_inputs():

    _w = (lambda a: (lambda t: t.to(torch.bfloat16) if t.is_floating_point() else t)(torch.as_tensor(a)))
    def _A_setup():
        B, Sq, D = 1, 2048, 1024
        Hq, Hkv, Sk, Dh = 32, 4, 2048, 128
        assert Hq % Hkv == 0, (Hq, Hkv)
        return {
            "x": _w((lambda *s: torch.randn(*s, dtype=torch.bfloat16) * 0.05)(B, Sq, D)),
            "k_cache": _w((lambda *s: torch.randn(*s, dtype=torch.bfloat16) * 0.8)(B, Hkv, Sk, Dh)),
            "v_cache": _w((lambda *s: torch.randn(*s, dtype=torch.bfloat16) * 0.8)(B, Hkv, Sk, Dh)),
            "wq": _w((lambda *s: torch.randn(*s, dtype=torch.bfloat16) * 0.8)(D, Hq * Dh) * (D ** -0.5)),
            "wo": _w((lambda *s: torch.randn(*s, dtype=torch.bfloat16) * 0.8)(Hq * Dh, D) * ((Hq * Dh) ** -0.5)),
        }
    _A_in = _A_setup()

    def _B_setup():
        B, S, D, F = 1, 2048, 1024, 3584
        return {
            "x":  _w((lambda *s: torch.randn(*s, dtype=torch.bfloat16) * 0.05)(B, S, D)),
            "w1": _w((lambda *s: torch.randn(*s, dtype=torch.bfloat16) * 3.2)(D, D) * (D ** -0.5)),
            "w2": _w((lambda *s: torch.randn(*s, dtype=torch.bfloat16) * 3.2)(D, D) * (D ** -0.5)),
            "w3": _w((lambda *s: torch.randn(*s, dtype=torch.bfloat16) * 3.2)(D, F) * (D ** -0.5)),
            "w4": _w((lambda *s: torch.randn(*s, dtype=torch.bfloat16) * 1.6)(F, D) * (F ** -0.5)),
        }
    _B_in = _B_setup()

    return {
        "A_x": _A_in["x"],
        "A_k_cache": _A_in["k_cache"],
        "A_v_cache": _A_in["v_cache"],
        "A_wq": _A_in["wq"],
        "A_wo": _A_in["wo"],
        "B_x": _B_in["x"],
        "B_w1": _B_in["w1"],
        "B_w2": _B_in["w2"],
        "B_w3": _B_in["w3"],
        "B_w4": _B_in["w4"],
    }

def reference(A_x, A_k_cache, A_v_cache, A_wq, A_wo, B_x, B_w1, B_w2, B_w3, B_w4):
    def _A_ref(x, k_cache, v_cache, wq, wo):
        B, Sq, D = x.shape
        Hq, Dh = 32, 128
        Hkv, Sk = k_cache.shape[1], k_cache.shape[2]
        W = min(4096, max(256, Sk // 4))
        rep = Hq // Hkv
        q = (lambda x, *d: x.permute(*d))((x @ wq).reshape(B, Sq, Hq, Dh), 0, 2, 1, 3)
        k = (lambda x, n, axis: torch.repeat_interleave(x, n, dim=axis))(k_cache[:, :, Sk - W:, :], rep, axis=1)
        v = (lambda x, n, axis: torch.repeat_interleave(x, n, dim=axis))(v_cache[:, :, Sk - W:, :], rep, axis=1)
        scores = torch.einsum("bhqd,bhkd->bhqk", q, k) * (Dh ** -0.5)
        p = _softmax(scores, axis=-1)
        o = torch.einsum("bhqk,bhkd->bhqd", p, v)
        return (lambda x, *d: x.permute(*d))(o, 0, 2, 1, 3).reshape(B, Sq, Hq * Dh) @ wo

    def _B_ref(x, w1, w2, w3, w4):
        B, S, D = x.shape
        h = _gelu(_layernorm(x, axis=-1) @ w1)
        c = D // 4
        g0 = _pad(h[:, :, 0*c:1*c], ((0, 0), (1, 0), (0, 0)))[:, :S, :]
        g1 = _pad(h[:, :, 1*c:2*c], ((0, 0), (0, 1), (0, 0)))[:, 1:, :]
        g2 = _pad(h[:, :, 2*c:3*c], ((0, 0), (2, 0), (0, 0)))[:, :S, :]
        g3 = _pad(h[:, :, 3*c:   ], ((0, 0), (0, 2), (0, 0)))[:, 2:, :]
        hs = torch.concatenate([g0, g1, g2, g3], axis=-1) @ w2
        x1 = x + hs
        h2 = _gelu(_layernorm(x1, axis=-1) @ w3) @ w4
        return x1 + h2

    x = A_x
    xn = _layernorm(x, axis=-1)
    s = _A_ref(xn, A_k_cache, A_v_cache, A_wq, A_wo)
    g = _silu(_B_ref(xn, B_w1, B_w2, B_w3, B_w4))
    return x + s * g
```

```asm
; @launch grid=(256,1,1) block=(256,1,1) lds=163840
.amdgcn_target "amdgcn-amd-amdhsa--gfx950"

.macro MA d, a, b
v_mfma_f32_16x16x32_bf16 v[\d:\d+3], a[\a:\a+3], a[\b:\b+3], v[\d:\d+3]
.endm
.macro MZ d, a, b
v_mfma_f32_16x16x32_bf16 v[\d:\d+3], a[\a:\a+3], a[\b:\b+3], 0
.endm
.macro TR d, v, o
ds_read_b64_tr_b16 a[\d:\d+1], v\v offset:\o
.endm
.macro XL d, v, r, s, o
buffer_load_dwordx4 a[\d:\d+3], v\v, s[\r:\r+3], s\s offen offset:\o sc1
.endm
.macro DM v, r, s, o
buffer_load_dwordx4 v\v, s[\r:\r+3], s\s offen offset:\o lds
.endm
.macro WL n
s_waitcnt lgkmcnt(\n)
.endm
.macro WV n
s_waitcnt vmcnt(\n)
.endm

.text
.globl recurrent_scan__sliding_block_cached__mixer_s_mlp__prompt_kernel
.p2align 8
.type recurrent_scan__sliding_block_cached__mixer_s_mlp__prompt_kernel,@function
recurrent_scan__sliding_block_cached__mixer_s_mlp__prompt_kernel:
s_cmp_ge_u32 s2, 256
s_cbranch_scc0 main_go
s_endpgm
main_go:
s_load_dwordx16 s[64:79], s[0:1], 0
s_load_dwordx8 s[80:87], s[0:1], 64
s_load_dwordx2 s[88:89], s[0:1], 96
v_lshrrev_b32 v1, 6, v0
s_nop 0
v_readfirstlane_b32 s44, v1
WL 0
s_mov_b32 s36, s64
s_mov_b32 s37, s65
s_mov_b32 s38, 4194304
s_mov_b32 s39, 0x20000
s_mov_b32 s20, s66
s_mov_b32 s21, s67
s_mov_b32 s22, 2097152
s_mov_b32 s23, 0x20000
s_mov_b32 s24, s68
s_mov_b32 s25, s69
s_mov_b32 s26, 2097152
s_mov_b32 s27, 0x20000
s_mov_b32 s16, s70
s_mov_b32 s17, s71
s_mov_b32 s18, 8388608
s_mov_b32 s19, 0x20000
s_mov_b32 s28, s80
s_mov_b32 s29, s81
s_mov_b32 s30, 7340032
s_mov_b32 s31, 0x20000
s_mov_b32 s40, s84
s_mov_b32 s41, s85
s_mov_b32 s42, 4194304
s_mov_b32 s43, 0x20000
s_mov_b32 s8, s86
s_mov_b32 s9, s87
s_mov_b32 s10, 256
s_mov_b32 s11, 0x20000
s_mov_b32 s4, s88
s_mov_b32 s5, s89
s_mov_b32 s6, 67108864
s_mov_b32 s7, 0x20000
s_lshl_b32 s48, s44, 12
s_lshl_b32 s49, s44, 13
s_bitcmp1_b32 s2, 3
s_cbranch_scc1 t2_entry
t1_entry:
v_and_b32 v0, 63, v0
v_and_b32 v48, 7, v0
v_lshlrev_b32 v49, 11, v48
v_bfe_u32 v50, v0, 3, 1
v_lshl_add_u32 v49, v50, 6, v49
v_bfe_u32 v50, v0, 4, 1
v_lshl_add_u32 v49, v50, 5, v49
v_lshrrev_b32 v50, 5, v0
v_lshl_add_u32 v49, v50, 4, v49
s_lshl_b32 s60, s2, 14
s_lshl_b32 s61, s44, 9
s_add_u32 s60, s60, s61
buffer_load_dwordx4 v[128:131], v49, s[36:39], s60 offen offset:0
buffer_load_dwordx4 v[132:135], v49, s[36:39], s60 offen offset:128
buffer_load_dwordx4 v[136:139], v49, s[36:39], s60 offen offset:256
buffer_load_dwordx4 v[140:143], v49, s[36:39], s60 offen offset:384
s_and_b32 s45, s2, 3
s_lshr_b32 s46, s2, 3
s_lshr_b32 s62, s2, 4
s_lshl_b32 s62, s62, 0
s_and_b32 s63, s46, 0
s_add_u32 s99, s62, s63
s_lshr_b32 s62, s99, 2
s_lshl_b32 s62, s62, 3
s_and_b32 s63, s99, 3
s_add_u32 s46, s62, s63
s_and_b32 s62, s2, 4
s_add_u32 s46, s46, s62
s_and_b32 s62, s45, 1
s_lshr_b32 s63, s45, 1
s_and_b32 s64, s46, 7
s_lshl_b32 s54, s62, 3
s_add_u32 s54, s54, s64
s_lshr_b32 s64, s46, 3
s_and_b32 s64, s64, 3
s_lshl_b32 s55, s63, 2
s_add_u32 s55, s55, s64
s_lshr_b32 s64, s46, 3
s_lshl_b32 s58, s62, 2
s_add_u32 s58, s58, s64
s_mov_b32 s56, s58
s_and_b32 s64, s46, 7
s_lshl_b32 s59, s63, 3
s_add_u32 s59, s59, s64
s_add_u32 s57, s59, 0
s_lshl_b32 s94, s55, 2
s_lshl_b32 s96, s63, 2
s_and_b32 s64, s46, 3
s_add_u32 s96, s96, s64
s_bfe_u32 s97, s46, 0x10002
s_mov_b32 s12, s76
s_mov_b32 s13, s77
s_mov_b32 s14, 2097152
s_mov_b32 s15, 0x20000
s_mov_b32 s32, s72
s_mov_b32 s33, s73
s_mov_b32 s34, 8388608
s_mov_b32 s35, 0x20000
s_mov_b32 s40, s82
s_mov_b32 s41, s83
s_mov_b32 s42, 7340032
s_mov_b32 s36, s78
s_mov_b32 s37, s79
s_mov_b32 s38, 2097152
s_lshr_b32 s72, s44, 1
s_and_b32 s73, s44, 1
s_lshr_b32 s78, s54, 0
s_lshl_b32 s78, s78, 11
s_add_u32 s78, s78, 22020096
s_lshr_b32 s79, s54, 1
s_lshl_b32 s79, s79, 11
s_add_u32 s79, s79, 22020096
s_lshr_b32 s80, s58, 0
s_lshl_b32 s80, s80, 11
s_add_u32 s80, s80, 22020096
v_and_b32 v5, 7, v0
v_lshlrev_b32 v5, 4, v5
v_lshrrev_b32 v19, 3, v0
v_lshl_add_u32 v5, v19, 9, v5
v_lshrrev_b32 v19, 4, v0
v_lshrrev_b32 v48, 2, v0
v_lshlrev_b32 v1, 8, v48
v_and_b32 v49, 7, v48
v_lshl_add_u32 v1, v49, 5, v1
v_and_b32 v49, 3, v0
v_lshl_add_u32 v1, v49, 3, v1
s_lshl_b32 s62, s72, 14
v_add_u32 v2, s62, v1
v_and_b32 v48, 31, v0
v_lshlrev_b32 v3, 8, v48
v_lshrrev_b32 v50, 5, v0
v_and_b32 v48, 15, v0
v_xor_b32 v48, v50, v48
v_lshl_add_u32 v3, v48, 4, v3
v_bfe_u32 v48, v0, 2, 2
v_lshl_add_u32 v4, v50, 2, v48
v_lshlrev_b32 v4, 8, v4
v_lshl_add_u32 v4, v48, 6, v4
v_and_b32 v48, 1, v19
v_lshl_add_u32 v4, v48, 5, v4
v_lshl_add_u32 v4, v49, 3, v4
v_and_b32 v48, 15, v0
v_lshlrev_b32 v49, 1, v19
v_xor_b32 v20, v48, v49
v_lshlrev_b32 v20, 4, v20
v_lshlrev_b32 v49, 2, v19
v_xor_b32 v16, v48, v49
v_lshlrev_b32 v16, 4, v16
v_lshl_add_u32 v16, v19, 8, v16
v_and_b32 v48, 1, v19
v_lshrrev_b32 v49, 1, v19
v_lshl_add_u32 v48, v48, 1, v49
v_and_b32 v49, 15, v0
v_xor_b32 v48, v48, v49
v_lshlrev_b32 v3, 8, v49
v_lshl_add_u32 v3, v48, 4, v3
v_lshl_add_u32 v16, v19, 8, v20
v_xor_b32 v4, 128, v16
s_mul_i32 s62, s72, 8448
v_add_u32 v6, s62, v5
s_mul_i32 s62, s72, 7936
s_add_u32 s62, s62, 256
v_add_u32 v7, s62, v5
v_add_u32 v48, s44, v0
v_min_u32 v48, 1, v48
v_lshlrev_b32 v18, 31, v48
v_mov_b32 v21, 1
s_xor_b32 s62, s44, 3
s_min_u32 s62, s62, 1
s_lshl_b32 s63, s62, 31
v_mov_b32 v22, s63
s_sub_u32 s74, s62, 1
s_mov_b32 s75, s74
s_mov_b32 s76, 22020096
s_lshl_b32 s82, s46, 2
s_add_u32 s82, s82, s45
s_lshl_b32 s82, s82, 2
s_add_u32 s82, s82, s44
v_lshlrev_b32 v64, 7, v0
v_lshrrev_b32 v60, 4, v0
v_lshl_add_u32 v60, v60, 29, v64
s_getpc_b64 s[84:85]
t1_entry_pc:
s_sub_u32 s84, s84, t1_entry_pc-t1_entry
s_subb_u32 s85, s85, 0
s_mov_b32 s86, t1_end-t1_entry
s_mov_b32 s87, 0x20000
s_lshl_b32 s77, s99, 2
s_add_u32 s77, s77, s44
s_lshl_b32 s77, s77, 11
buffer_load_dword v61, v60, s[84:87], s77 offen
s_mul_i32 s81, s82, 2048
buffer_load_dword v61, v60, s[12:15], s81 offen
s_add_u32 s81, s81, 1048576
buffer_load_dword v61, v60, s[12:15], s81 offen
s_add_u32 s81, s81, 1048576
s_lshl_b32 s50, s54, 1
s_add_u32 s50, s50, s73
s_mul_i32 s50, s50, 131072
s_add_u32 s50, s50, 0
s_mul_i32 s52, s44, 65536
s_mul_i32 s62, s55, 256
s_add_u32 s52, s52, s62
s_mov_b32 s62, 2048
v_mad_u32_u24 v8, v19, s62, v20
v_xor_b32 v9, 128, v8
v_add_u32 v10, 14336, v8
v_add_u32 v11, 21504, v9
v_add_u32 v9, 7168, v9
v_xor_b32 v24, 0, v2
v_xor_b32 v25, 32, v2
v_xor_b32 v26, 64, v2
v_xor_b32 v27, 96, v2
v_xor_b32 v28, 128, v2
v_xor_b32 v29, 160, v2
v_xor_b32 v30, 192, v2
v_xor_b32 v31, 224, v2
v_xor_b32 v32, 65536, v2
v_xor_b32 v33, 65568, v2
v_xor_b32 v34, 65600, v2
v_xor_b32 v35, 65632, v2
v_xor_b32 v36, 65664, v2
v_xor_b32 v37, 65696, v2
v_xor_b32 v38, 65728, v2
v_xor_b32 v39, 65760, v2
v_and_b32 v72, 7, v0
v_lshlrev_b32 v74, 3, v72
s_lshl_b32 s62, s44, 6
s_add_u32 s62, s62, 131072
v_add_u32 v75, s62, v74
v_lshl_add_u32 v74, v19, 6, v74
v_add_u32 v74, 131072, v74
v_lshlrev_b32 v76, 4, v72
v_lshl_add_u32 v76, v19, 10, v76
v_bfe_u32 v77, v0, 3, 1
v_lshl_add_u32 v76, v77, 12, v76
s_lshr_b32 s60, s2, 3
s_lshl_b32 s60, s60, 17
s_bfe_u32 s62, s2, 0x20001
s_lshl_b32 s62, s62, 7
s_add_u32 s60, s60, s62
s_and_b32 s62, s2, 1
s_lshl_b32 s62, s62, 9
s_add_u32 s60, s60, s62
s_lshl_b32 s62, s44, 15
s_add_u32 s60, s60, s62
s_lshl_b32 s61, s2, 5
s_add_u32 s61, s61, 21495808
v_lshrrev_b32 v77, 3, v0
v_add_u32 v77, s44, v77
v_lshlrev_b32 v77, 26, v77
v_lshl_add_u32 v77, v72, 2, v77
s_and_b32 s64, s2, 0xf0
s_lshl_b32 s63, s2, 8
s_add_u32 s63, s63, 22020096
v_mov_b32 v73, 0
buffer_store_dword v73, v18, s[4:7], s63 offen sc1
s_mov_b32 s62, 0x3f803f80
v_mov_b32 v50, 0
v_mov_b32 v51, 0
v_mov_b32 v52, 0
v_mov_b32 v53, 0
WV 7
v_dot2_f32_bf16 v50, v128, s62, v50
v_dot2_f32_bf16 v52, v128, v128, v52
v_dot2_f32_bf16 v51, v129, s62, v51
v_dot2_f32_bf16 v53, v129, v129, v53
v_dot2_f32_bf16 v50, v130, s62, v50
v_dot2_f32_bf16 v52, v130, v130, v52
v_dot2_f32_bf16 v51, v131, s62, v51
v_dot2_f32_bf16 v53, v131, v131, v53
WV 6
v_dot2_f32_bf16 v50, v132, s62, v50
v_dot2_f32_bf16 v52, v132, v132, v52
v_dot2_f32_bf16 v51, v133, s62, v51
v_dot2_f32_bf16 v53, v133, v133, v53
v_dot2_f32_bf16 v50, v134, s62, v50
v_dot2_f32_bf16 v52, v134, v134, v52
v_dot2_f32_bf16 v51, v135, s62, v51
v_dot2_f32_bf16 v53, v135, v135, v53
WV 5
v_dot2_f32_bf16 v50, v136, s62, v50
v_dot2_f32_bf16 v52, v136, v136, v52
v_dot2_f32_bf16 v51, v137, s62, v51
v_dot2_f32_bf16 v53, v137, v137, v53
v_dot2_f32_bf16 v50, v138, s62, v50
v_dot2_f32_bf16 v52, v138, v138, v52
v_dot2_f32_bf16 v51, v139, s62, v51
v_dot2_f32_bf16 v53, v139, v139, v53
WV 4
v_dot2_f32_bf16 v50, v140, s62, v50
v_dot2_f32_bf16 v52, v140, v140, v52
v_dot2_f32_bf16 v51, v141, s62, v51
v_dot2_f32_bf16 v53, v141, v141, v53
v_dot2_f32_bf16 v50, v142, s62, v50
v_dot2_f32_bf16 v52, v142, v142, v52
v_dot2_f32_bf16 v51, v143, s62, v51
v_dot2_f32_bf16 v53, v143, v143, v53
s_nop 2
v_add_f32 v50, v50, v51
v_add_f32 v51, v52, v53
v_permlane16_swap_b32 v128, v130
v_permlane16_swap_b32 v129, v131
v_add_f32_dpp v50, v50, v50 row_ror:8 row_mask:0xf bank_mask:0xf
v_add_f32_dpp v51, v51, v51 row_ror:8 row_mask:0xf bank_mask:0xf
v_permlane16_swap_b32 v132, v134
v_permlane16_swap_b32 v133, v135
v_mov_b32 v72, v50
v_mov_b32 v73, v51
v_permlane16_swap_b32 v136, v138
v_permlane16_swap_b32 v137, v139
v_permlane16_swap_b32 v50, v72
v_permlane16_swap_b32 v51, v73
v_add_f32 v50, v50, v72
v_add_f32 v51, v51, v73
v_mov_b32 v72, v50
v_mov_b32 v73, v51
v_permlane16_swap_b32 v140, v142
v_permlane16_swap_b32 v141, v143
v_permlane32_swap_b32 v50, v72
v_permlane32_swap_b32 v51, v73
v_add_f32 v50, v50, v72
v_add_f32 v51, v51, v73
ds_write_b64 v75, v[50:51]
v_lshlrev_b32 v144, 16, v128
v_and_b32 v145, 0xffff0000, v128
v_lshlrev_b32 v146, 16, v129
v_and_b32 v147, 0xffff0000, v129
v_lshlrev_b32 v148, 16, v130
v_and_b32 v149, 0xffff0000, v130
v_lshlrev_b32 v150, 16, v131
v_and_b32 v151, 0xffff0000, v131
v_lshlrev_b32 v152, 16, v132
v_and_b32 v153, 0xffff0000, v132
v_lshlrev_b32 v154, 16, v133
v_and_b32 v155, 0xffff0000, v133
WL 0
s_barrier
ds_read_b64 v[50:51], v74
v_lshlrev_b32 v156, 16, v134
v_and_b32 v157, 0xffff0000, v134
v_lshlrev_b32 v158, 16, v135
v_and_b32 v159, 0xffff0000, v135
v_lshlrev_b32 v160, 16, v136
v_and_b32 v161, 0xffff0000, v136
v_lshlrev_b32 v162, 16, v137
v_and_b32 v163, 0xffff0000, v137
v_lshlrev_b32 v164, 16, v138
v_and_b32 v165, 0xffff0000, v138
v_lshlrev_b32 v166, 16, v139
v_and_b32 v167, 0xffff0000, v139
v_lshlrev_b32 v168, 16, v140
v_and_b32 v169, 0xffff0000, v140
v_lshlrev_b32 v170, 16, v141
v_and_b32 v171, 0xffff0000, v141
WL 0
v_mov_b32 v72, v50
v_mov_b32 v73, v51
v_lshlrev_b32 v172, 16, v142
v_and_b32 v173, 0xffff0000, v142
v_permlane16_swap_b32 v50, v72
v_permlane16_swap_b32 v51, v73
v_add_f32 v50, v50, v72
v_add_f32 v51, v51, v73
v_mov_b32 v72, v50
v_mov_b32 v73, v51
v_lshlrev_b32 v174, 16, v143
v_and_b32 v175, 0xffff0000, v143
v_permlane32_swap_b32 v50, v72
v_permlane32_swap_b32 v51, v73
v_add_f32 v50, v50, v72
v_add_f32 v51, v51, v73
v_mul_f32 v50, 0x3a800000, v50
v_mul_f32 v51, 0x3a800000, v51
v_fma_f32 v51, -v50, v50, v51
v_max_f32 v51, 0, v51
v_cvt_pk_bf16_f32 v52, v51, v51
v_lshlrev_b32 v52, 16, v52
v_add_f32 v52, 0x3727c5ac, v52
v_cvt_pk_bf16_f32 v52, v52, v52
v_lshlrev_b32 v52, 16, v52
v_sqrt_f32 v52, v52
s_nop 0
v_cvt_pk_bf16_f32 v52, v52, v52
v_lshlrev_b32 v52, 16, v52
v_rcp_f32 v52, v52
s_nop 0
v_mul_f32 v54, -v50, v52
v_pk_fma_f32 v[144:145], v[144:145], v[52:53], v[54:55] op_sel_hi:[1,0,0]
v_pk_fma_f32 v[146:147], v[146:147], v[52:53], v[54:55] op_sel_hi:[1,0,0]
v_pk_fma_f32 v[148:149], v[148:149], v[52:53], v[54:55] op_sel_hi:[1,0,0]
v_pk_fma_f32 v[150:151], v[150:151], v[52:53], v[54:55] op_sel_hi:[1,0,0]
v_cvt_pk_bf16_f32 v128, v144, v145
v_cvt_pk_bf16_f32 v129, v146, v147
v_cvt_pk_bf16_f32 v130, v148, v149
v_cvt_pk_bf16_f32 v131, v150, v151
buffer_store_dwordx4 v[128:131], v76, s[4:7], s60 offen sc1
s_add_u32 s60, s60, 8192
v_pk_fma_f32 v[152:153], v[152:153], v[52:53], v[54:55] op_sel_hi:[1,0,0]
v_pk_fma_f32 v[154:155], v[154:155], v[52:53], v[54:55] op_sel_hi:[1,0,0]
v_pk_fma_f32 v[156:157], v[156:157], v[52:53], v[54:55] op_sel_hi:[1,0,0]
v_pk_fma_f32 v[158:159], v[158:159], v[52:53], v[54:55] op_sel_hi:[1,0,0]
v_cvt_pk_bf16_f32 v132, v152, v153
v_cvt_pk_bf16_f32 v133, v154, v155
v_cvt_pk_bf16_f32 v134, v156, v157
v_cvt_pk_bf16_f32 v135, v158, v159
buffer_store_dwordx4 v[132:135], v76, s[4:7], s60 offen sc1
s_add_u32 s60, s60, 8192
v_pk_fma_f32 v[160:161], v[160:161], v[52:53], v[54:55] op_sel_hi:[1,0,0]
v_pk_fma_f32 v[162:163], v[162:163], v[52:53], v[54:55] op_sel_hi:[1,0,0]
v_pk_fma_f32 v[164:165], v[164:165], v[52:53], v[54:55] op_sel_hi:[1,0,0]
v_pk_fma_f32 v[166:167], v[166:167], v[52:53], v[54:55] op_sel_hi:[1,0,0]
v_cvt_pk_bf16_f32 v136, v160, v161
v_cvt_pk_bf16_f32 v137, v162, v163
v_cvt_pk_bf16_f32 v138, v164, v165
v_cvt_pk_bf16_f32 v139, v166, v167
buffer_store_dwordx4 v[136:139], v76, s[4:7], s60 offen sc1
s_add_u32 s60, s60, 8192
v_pk_fma_f32 v[168:169], v[168:169], v[52:53], v[54:55] op_sel_hi:[1,0,0]
v_pk_fma_f32 v[170:171], v[170:171], v[52:53], v[54:55] op_sel_hi:[1,0,0]
v_pk_fma_f32 v[172:173], v[172:173], v[52:53], v[54:55] op_sel_hi:[1,0,0]
v_pk_fma_f32 v[174:175], v[174:175], v[52:53], v[54:55] op_sel_hi:[1,0,0]
v_cvt_pk_bf16_f32 v140, v168, v169
v_cvt_pk_bf16_f32 v141, v170, v171
v_cvt_pk_bf16_f32 v142, v172, v173
v_cvt_pk_bf16_f32 v143, v174, v175
buffer_store_dwordx4 v[140:143], v76, s[4:7], s60 offen sc1
s_add_u32 s60, s60, 8192
v_mul_f32 v51, v51, v52
v_mul_f32 v51, v51, v52
v_cvt_pk_bf16_f32 v51, v51, v51
v_lshlrev_b32 v51, 16, v51
v_add_f32 v51, 0x3727c5ac, v51
v_cvt_pk_bf16_f32 v51, v51, v51
v_lshlrev_b32 v51, 16, v51
v_sqrt_f32 v51, v51
s_nop 0
v_cvt_pk_bf16_f32 v51, v51, v51
v_lshlrev_b32 v51, 16, v51
v_rcp_f32 v51, v51
s_nop 0
buffer_store_dword v51, v77, s[4:7], s61 offen sc1
WV 0
s_barrier
buffer_atomic_add v21, v18, s[8:11], s64 offen offset:0
s_add_u32 m0, s49, 0
s_nop 0
DM 8,12,52,0
DM 9,12,52,1024
DM 10,12,52,2048
DM 11,12,52,3072
s_add_u32 s52, s52, 32768
s_add_u32 m0, s49, 4096
s_nop 0
DM 8,12,52,0
DM 9,12,52,1024
DM 10,12,52,2048
DM 11,12,52,3072
s_add_u32 s52, s52, 229376
s_add_u32 m0, s49, 32768
s_nop 0
DM 8,12,52,0
DM 9,12,52,1024
DM 10,12,52,2048
DM 11,12,52,3072
s_add_u32 s52, s52, 32768
s_add_u32 m0, s49, 36864
s_nop 0
DM 8,12,52,0
DM 9,12,52,1024
DM 10,12,52,2048
DM 11,12,52,3072
s_add_u32 s52, s52, 229376
s_add_u32 m0, s49, 65536
s_nop 0
DM 8,12,52,0
DM 9,12,52,1024
DM 10,12,52,2048
DM 11,12,52,3072
s_add_u32 s52, s52, 32768
s_add_u32 m0, s49, 69632
s_nop 0
DM 8,12,52,0
DM 9,12,52,1024
DM 10,12,52,2048
DM 11,12,52,3072
s_add_u32 s52, s52, 229376
s_add_u32 m0, s49, 98304
s_nop 0
DM 8,12,52,0
DM 9,12,52,1024
DM 10,12,52,2048
DM 11,12,52,3072
s_add_u32 s52, s52, 32768
s_add_u32 m0, s49, 102400
s_nop 0
DM 8,12,52,0
DM 9,12,52,1024
DM 10,12,52,2048
DM 11,12,52,3072
s_add_u32 s52, s52, 229376
s_lshl_b32 s63, s54, 4
buffer_load_dword v17, v22, s[8:11], s63 offen offset:0 sc1
WV 0
v_cmp_gt_u32 s[68:69], 16, v17
s_nop 0
s_and_b64 s[68:69], s[68:69], s[74:75]
s_cbranch_scc1 t1_slow1
t1_back2:
s_barrier
XL 0,6,4,50,0
XL 4,6,4,50,128
XL 8,7,4,50,0
XL 12,7,4,50,128
s_add_u32 s50, s50, 4096
XL 16,6,4,50,0
XL 20,6,4,50,128
XL 24,7,4,50,0
XL 28,7,4,50,128
s_add_u32 s50, s50, 12288
XL 32,6,4,50,0
XL 36,6,4,50,128
XL 40,7,4,50,0
XL 44,7,4,50,128
s_add_u32 s50, s50, 4096
XL 48,6,4,50,0
XL 52,6,4,50,128
XL 56,7,4,50,0
XL 60,7,4,50,128
s_add_u32 s50, s50, 12288
XL 64,6,4,50,0
XL 68,6,4,50,128
XL 72,7,4,50,0
XL 76,7,4,50,128
s_add_u32 s50, s50, 4096
XL 80,6,4,50,0
XL 84,6,4,50,128
XL 88,7,4,50,0
XL 92,7,4,50,128
s_add_u32 s50, s50, 12288
s_barrier
TR 192,24,0
TR 194,24,4096
TR 196,24,8192
TR 198,24,12288
TR 200,25,0
TR 202,25,4096
TR 204,25,8192
TR 206,25,12288
s_waitcnt vmcnt(16) lgkmcnt(4)
MZ 128,192,0
TR 208,26,0
MA 128,196,16
TR 210,26,4096
MZ 160,196,20
XL 96,6,4,50,0
MA 160,192,4
MZ 192,192,8
TR 212,26,8192
MA 192,196,24
TR 214,26,12288
MZ 224,196,28
MA 224,192,12
WL 4
MZ 228,200,12
TR 216,27,0
MA 228,204,28
TR 218,27,4096
MZ 196,204,24
XL 100,6,4,50,128
MA 196,200,8
MZ 164,200,4
TR 220,27,8192
MA 164,204,20
TR 222,27,12288
MZ 132,204,16
MA 132,200,0
WL 4
MZ 136,208,0
TR 192,28,0
MA 136,212,16
TR 194,28,4096
MZ 168,212,20
XL 104,7,4,50,0
MA 168,208,4
MZ 200,208,8
TR 196,28,8192
MA 200,212,24
TR 198,28,12288
MZ 232,212,28
MA 232,208,12
WL 4
MZ 236,216,12
TR 200,29,0
MA 236,220,28
TR 202,29,4096
MZ 204,220,24
XL 108,7,4,50,128
MA 204,216,8
s_add_u32 s50, s50, 4096
MZ 172,216,4
TR 204,29,8192
MA 172,220,20
TR 206,29,12288
MZ 140,220,16
MA 140,216,0
WL 4
MZ 144,192,0
TR 208,30,0
MA 144,196,16
TR 210,30,4096
MZ 176,196,20
XL 112,6,4,50,0
MA 176,192,4
s_lshl_b32 s51, s56, 2
MZ 208,192,8
TR 212,30,8192
MA 208,196,24
TR 214,30,12288
MZ 240,196,28
MA 240,192,12
s_add_u32 s51, s51, s44
WL 4
MZ 244,200,12
TR 216,31,0
MA 244,204,28
TR 218,31,4096
MZ 212,204,24
XL 116,6,4,50,128
MA 212,200,8
s_mul_i32 s51, s51, 131072
MZ 180,200,4
TR 220,31,8192
MA 180,204,20
TR 222,31,12288
MZ 148,204,16
MA 148,200,0
s_add_u32 s51, s51, 0
WL 4
MZ 152,208,0
MA 152,212,16
MZ 184,212,20
XL 120,7,4,50,0
MA 184,208,4
s_mul_i32 s53, s44, 131072
WL 0
s_barrier
MZ 216,208,8
TR 192,24,32768
MA 216,212,24
TR 194,24,36864
MZ 248,212,28
TR 196,24,40960
MA 248,208,12
TR 198,24,45056
s_mul_i32 s62, s57, 256
MZ 252,216,12
TR 200,25,32768
MA 252,220,28
TR 202,25,36864
MZ 220,220,24
XL 124,7,4,50,128
MA 220,216,8
s_add_u32 s50, s50, 12288
s_add_u32 s53, s53, s62
MZ 188,216,4
TR 204,25,40960
MA 188,220,20
TR 206,25,45056
MZ 156,220,16
MA 156,216,0
v_min_u32 v23, 15, v0
s_waitcnt vmcnt(16) lgkmcnt(4)
MA 128,192,32
TR 208,26,32768
MA 128,196,48
s_add_u32 m0, s49, 0
TR 210,26,36864
MA 160,196,52
DM 8,12,52,0
MA 160,192,36
v_and_b32 v23, 15, v23
MA 192,192,40
TR 212,26,40960
MA 192,196,56
TR 214,26,45056
MA 224,196,60
DM 9,12,52,1024
MA 224,192,44
v_lshl_add_u32 v23, v23, 4, v22
WL 4
MA 228,200,44
TR 216,27,32768
MA 228,204,60
TR 218,27,36864
MA 196,204,56
DM 10,12,52,2048
MA 196,200,40
s_mov_b32 s62, 8192
MA 164,200,36
TR 220,27,40960
MA 164,204,52
TR 222,27,45056
MA 132,204,48
DM 11,12,52,3072
MA 132,200,32
s_add_u32 s52, s52, 32768
v_mad_u32_u24 v12, v19, s62, v20
WL 4
MA 136,208,32
TR 192,28,32768
MA 136,212,48
s_add_u32 m0, s49, 4096
TR 194,28,36864
MA 168,212,52
DM 8,12,52,0
MA 168,208,36
v_xor_b32 v13, 128, v12
MA 200,208,40
TR 196,28,40960
MA 200,212,56
TR 198,28,45056
MA 232,212,60
DM 9,12,52,1024
MA 232,208,44
v_add_u32 v14, 63488, v12
WL 4
MA 236,216,44
TR 200,29,32768
MA 236,220,60
TR 202,29,36864
MA 204,220,56
DM 10,12,52,2048
MA 204,216,40
v_add_u32 v15, 95232, v13
MA 172,216,36
TR 204,29,40960
MA 172,220,52
TR 206,29,45056
MA 140,220,48
DM 11,12,52,3072
MA 140,216,32
s_add_u32 s52, s52, 229376
v_add_u32 v13, 31744, v13
WL 4
MA 144,192,32
TR 208,30,32768
MA 144,196,48
TR 210,30,36864
MA 176,196,52
XL 0,6,4,50,0
MA 176,192,36
MA 208,192,40
TR 212,30,40960
MA 208,196,56
TR 214,30,45056
MA 240,196,60
XL 4,6,4,50,128
MA 240,192,44
WL 4
MA 244,200,44
TR 216,31,32768
MA 244,204,60
TR 218,31,36864
MA 212,204,56
XL 8,7,4,50,0
MA 212,200,40
MA 180,200,36
TR 220,31,40960
MA 180,204,52
TR 222,31,45056
MA 148,204,48
XL 12,7,4,50,128
MA 148,200,32
s_add_u32 s50, s50, 4096
WL 4
MA 152,208,32
MA 152,212,48
MA 184,212,52
XL 16,6,4,50,0
MA 184,208,36
WL 0
s_barrier
MA 216,208,40
TR 192,32,0
MA 216,212,56
TR 194,32,4096
MA 248,212,60
XL 20,6,4,50,128
TR 196,32,8192
MA 248,208,44
TR 198,32,12288
MA 252,216,44
TR 200,33,0
MA 252,220,60
TR 202,33,4096
MA 220,220,56
XL 24,7,4,50,0
MA 220,216,40
MA 188,216,36
TR 204,33,8192
MA 188,220,52
TR 206,33,12288
MA 156,220,48
XL 28,7,4,50,128
MA 156,216,32
s_add_u32 s50, s50, 12288
s_waitcnt vmcnt(24) lgkmcnt(4)
MA 128,192,64
TR 208,34,0
MA 128,196,80
s_add_u32 m0, s49, 32768
TR 210,34,4096
MA 160,196,84
DM 8,12,52,0
MA 160,192,68
MA 192,192,72
TR 212,34,8192
MA 192,196,88
TR 214,34,12288
MA 224,196,92
DM 9,12,52,1024
MA 224,192,76
WL 4
MA 228,200,76
TR 216,35,0
MA 228,204,92
TR 218,35,4096
MA 196,204,88
DM 10,12,52,2048
MA 196,200,72
MA 164,200,68
TR 220,35,8192
MA 164,204,84
TR 222,35,12288
MA 132,204,80
DM 11,12,52,3072
MA 132,200,64
s_add_u32 s52, s52, 32768
WL 4
MA 136,208,64
TR 192,36,0
MA 136,212,80
s_add_u32 m0, s49, 36864
TR 194,36,4096
MA 168,212,84
DM 8,12,52,0
MA 168,208,68
MA 200,208,72
TR 196,36,8192
MA 200,212,88
TR 198,36,12288
MA 232,212,92
DM 9,12,52,1024
MA 232,208,76
WL 4
MA 236,216,76
TR 200,37,0
MA 236,220,92
TR 202,37,4096
MA 204,220,88
DM 10,12,52,2048
MA 204,216,72
MA 172,216,68
TR 204,37,8192
MA 172,220,84
TR 206,37,12288
MA 140,220,80
DM 11,12,52,3072
MA 140,216,64
s_add_u32 s52, s52, 229376
WL 4
MA 144,192,64
TR 208,38,0
MA 144,196,80
TR 210,38,4096
MA 176,196,84
XL 32,6,4,50,0
MA 176,192,68
MA 208,192,72
TR 212,38,8192
MA 208,196,88
TR 214,38,12288
MA 240,196,92
XL 36,6,4,50,128
MA 240,192,76
buffer_load_dword v17, v23, s[8:11], 0 offen offset:0 sc1
WL 4
MA 244,200,76
TR 216,39,0
MA 244,204,92
TR 218,39,4096
MA 212,204,88
XL 40,7,4,50,0
MA 212,200,72
MA 180,200,68
TR 220,39,8192
MA 180,204,84
TR 222,39,12288
MA 148,204,80
XL 44,7,4,50,128
MA 148,200,64
s_add_u32 s50, s50, 4096
WL 4
MA 152,208,64
MA 152,212,80
MA 184,212,84
XL 48,6,4,50,0
MA 184,208,68
WL 0
s_barrier
MA 216,208,72
TR 192,32,32768
MA 216,212,88
TR 194,32,36864
MA 248,212,92
XL 52,6,4,50,128
TR 196,32,40960
MA 248,208,76
TR 198,32,45056
MA 252,216,76
TR 200,33,32768
MA 252,220,92
TR 202,33,36864
MA 220,220,88
XL 56,7,4,50,0
MA 220,216,72
MA 188,216,68
TR 204,33,40960
MA 188,220,84
TR 206,33,45056
MA 156,220,80
XL 60,7,4,50,128
MA 156,216,64
s_add_u32 s50, s50, 12288
s_waitcnt vmcnt(33) lgkmcnt(4)
MA 128,192,96
TR 208,34,32768
MA 128,196,112
s_add_u32 m0, s49, 65536
TR 210,34,36864
MA 160,196,116
DM 8,12,52,0
MA 160,192,100
s_lshl_b32 s60, s54, 9
MA 192,192,104
TR 212,34,40960
MA 192,196,120
TR 214,34,45056
MA 224,196,124
DM 9,12,52,1024
MA 224,192,108
s_lshl_b32 s65, s73, 8
WL 4
MA 228,200,108
TR 216,35,32768
MA 228,204,124
TR 218,35,36864
MA 196,204,120
DM 10,12,52,2048
MA 196,200,104
s_add_u32 s60, s60, s65
MA 164,200,100
TR 220,35,40960
MA 164,204,116
TR 222,35,45056
MA 132,204,112
DM 11,12,52,3072
MA 132,200,96
s_add_u32 s52, s52, 32768
s_lshl_b32 s65, s72, 7
buffer_load_dword v61, v60, s[84:87], s77 offen
WL 4
MA 136,208,96
TR 192,36,32768
MA 136,212,112
s_add_u32 m0, s49, 69632
TR 194,36,36864
MA 168,212,116
DM 8,12,52,0
MA 168,208,100
s_add_u32 s60, s60, s65
MA 200,208,104
TR 196,36,40960
MA 200,212,120
TR 198,36,45056
MA 232,212,124
DM 9,12,52,1024
MA 232,208,108
s_add_u32 s60, s60, 21495808
WL 4
MA 236,216,108
TR 200,37,32768
MA 236,220,124
TR 202,37,36864
MA 204,220,120
DM 10,12,52,2048
MA 204,216,104
v_and_b32 v56, 15, v0
MA 172,216,100
TR 204,37,40960
MA 172,220,116
TR 206,37,45056
MA 140,220,112
DM 11,12,52,3072
MA 140,216,96
s_add_u32 s52, s52, 229376
v_lshlrev_b32 v56, 2, v56
WL 4
MA 144,192,96
TR 208,38,32768
MA 144,196,112
TR 210,38,36864
MA 176,196,116
XL 64,6,4,50,0
MA 176,192,100
buffer_load_dword v54, v56, s[4:7], s60 offen sc1
MA 208,192,104
TR 212,38,40960
MA 208,196,120
TR 214,38,45056
MA 240,196,124
XL 68,6,4,50,128
MA 240,192,108
buffer_load_dword v55, v56, s[4:7], s60 offen offset:64 sc1
WL 4
MA 244,200,108
TR 216,39,32768
MA 244,204,124
TR 218,39,36864
MA 212,204,120
XL 72,7,4,50,0
MA 212,200,104
MA 180,200,100
TR 220,39,40960
MA 180,204,116
TR 222,39,45056
MA 148,204,112
XL 76,7,4,50,128
MA 148,200,96
s_add_u32 s50, s50, 4096
WL 4
MA 152,208,96
MA 152,212,112
MA 184,212,116
XL 80,6,4,50,0
MA 184,208,100
WV 22
v_cmp_gt_u32 s[68:69], 16, v17
s_nop 0
s_and_b64 s[68:69], s[68:69], s[74:75]
s_cbranch_scc1 t1_slow3
t1_back4:
WL 0
s_barrier
MA 216,208,104
TR 192,24,0
MA 216,212,120
TR 194,24,4096
MA 248,212,124
XL 84,6,4,50,128
TR 196,24,8192
MA 248,208,108
TR 198,24,12288
MA 252,216,108
TR 200,25,0
MA 252,220,124
TR 202,25,4096
MA 220,220,120
XL 88,7,4,50,0
MA 220,216,104
MA 188,216,100
TR 204,25,8192
MA 188,220,116
TR 206,25,12288
MA 156,220,112
XL 92,7,4,50,128
MA 156,216,96
s_add_u32 s50, s50, 12288
WL 4
MA 128,192,0
TR 208,26,0
MA 128,196,16
s_add_u32 m0, s49, 98304
TR 210,26,4096
MA 160,196,20
DM 8,12,52,0
MA 160,192,4
MA 192,192,8
TR 212,26,8192
MA 192,196,24
TR 214,26,12288
MA 224,196,28
DM 9,12,52,1024
MA 224,192,12
WL 4
MA 228,200,12
TR 216,27,0
MA 228,204,28
TR 218,27,4096
MA 196,204,24
DM 10,12,52,2048
MA 196,200,8
MA 164,200,4
TR 220,27,8192
MA 164,204,20
TR 222,27,12288
MA 132,204,16
DM 11,12,52,3072
MA 132,200,0
s_add_u32 s52, s52, 32768
WL 4
MA 136,208,0
TR 192,28,0
MA 136,212,16
s_add_u32 m0, s49, 102400
TR 194,28,4096
MA 168,212,20
DM 8,12,52,0
MA 168,208,4
MA 200,208,8
TR 196,28,8192
MA 200,212,24
TR 198,28,12288
MA 232,212,28
DM 9,12,52,1024
MA 232,208,12
WL 4
MA 236,216,12
TR 200,29,0
MA 236,220,28
TR 202,29,4096
MA 204,220,24
DM 10,12,52,2048
MA 204,216,8
MA 172,216,4
TR 204,29,8192
MA 172,220,20
TR 206,29,12288
MA 140,220,16
DM 11,12,52,3072
MA 140,216,0
s_add_u32 s52, s52, 229376
WL 4
MA 144,192,0
TR 208,30,0
MA 144,196,16
TR 210,30,4096
MA 176,196,20
XL 96,6,4,50,0
MA 176,192,4
MA 208,192,8
TR 212,30,8192
MA 208,196,24
TR 214,30,12288
MA 240,196,28
XL 100,6,4,50,128
MA 240,192,12
WL 4
MA 244,200,12
TR 216,31,0
MA 244,204,28
TR 218,31,4096
MA 212,204,24
XL 104,7,4,50,0
MA 212,200,8
MA 180,200,4
TR 220,31,8192
MA 180,204,20
TR 222,31,12288
MA 148,204,16
XL 108,7,4,50,128
MA 148,200,0
s_add_u32 s50, s50, 4096
WL 4
MA 152,208,0
MA 152,212,16
MA 184,212,20
XL 112,6,4,50,0
MA 184,208,4
WL 0
s_barrier
MA 216,208,8
TR 192,24,32768
MA 216,212,24
TR 194,24,36864
MA 248,212,28
XL 116,6,4,50,128
TR 196,24,40960
MA 248,208,12
TR 198,24,45056
MA 252,216,12
TR 200,25,32768
MA 252,220,28
TR 202,25,36864
MA 220,220,24
XL 120,7,4,50,0
MA 220,216,8
MA 188,216,4
TR 204,25,40960
MA 188,220,20
TR 206,25,45056
MA 156,220,16
XL 124,7,4,50,128
MA 156,216,0
s_add_u32 s50, s50, 12288
s_waitcnt vmcnt(35) lgkmcnt(4)
MA 128,192,32
TR 208,26,32768
MA 128,196,48
s_add_u32 m0, s48, 0
TR 210,26,36864
MA 160,196,52
DM 12,16,53,0
MA 160,192,36
MA 192,192,40
TR 212,26,40960
MA 192,196,56
TR 214,26,45056
MA 224,196,60
DM 13,16,53,1024
MA 224,192,44
WL 4
MA 228,200,44
TR 216,27,32768
MA 228,204,60
TR 218,27,36864
MA 196,204,56
DM 14,16,53,2048
MA 196,200,40
MA 164,200,36
TR 220,27,40960
MA 164,204,52
TR 222,27,45056
MA 132,204,48
MA 132,200,32
WL 4
MA 136,208,32
TR 192,28,32768
MA 136,212,48
TR 194,28,36864
MA 168,212,52
DM 15,16,53,3072
MA 168,208,36
s_add_u32 s53, s53, 524288
MA 200,208,40
TR 196,28,40960
MA 200,212,56
TR 198,28,45056
MA 232,212,60
XL 0,5,4,51,0
MA 232,208,44
WL 4
MA 236,216,44
TR 200,29,32768
MA 236,220,60
TR 202,29,36864
MA 204,220,56
XL 4,5,4,51,128
MA 204,216,40
MA 172,216,36
TR 204,29,40960
MA 172,220,52
TR 206,29,45056
MA 140,220,48
MA 140,216,32
WL 4
MA 144,192,32
TR 208,30,32768
MA 144,196,48
TR 210,30,36864
s_lshl_b32 s88, s48, 2
MA 176,196,52
XL 8,5,4,51,256
MA 176,192,36
MA 208,192,40
TR 212,30,40960
MA 208,196,56
TR 214,30,45056
s_add_u32 s88, s88, 98304
MA 240,196,60
XL 12,5,4,51,384
MA 240,192,44
s_add_u32 s51, s51, 4096
WL 4
MA 244,200,44
TR 216,31,32768
MA 244,204,60
TR 218,31,36864
v_lshl_add_u32 v52, v0, 4, s88
MA 212,204,56
XL 16,5,4,51,0
MA 212,200,40
MA 180,200,36
TR 220,31,40960
MA 180,204,52
TR 222,31,45056
s_xor_b32 s88, s48, 8192
MA 148,204,48
MA 148,200,32
WL 4
MA 152,208,32
s_lshr_b32 s62, s55, 1
s_lshr_b32 s63, s62, 1
MA 152,212,48
s_lshl_b32 s88, s88, 2
s_add_u32 s63, s63, 1
MA 184,212,52
XL 20,5,4,51,128
MA 184,208,36
s_and_b32 s62, s62, 1
s_waitcnt vmcnt(36) lgkmcnt(0)
s_barrier
MA 216,208,40
TR 192,32,0
s_mul_i32 s62, s62, -2
MA 216,212,56
TR 194,32,4096
s_add_u32 s88, s88, 98304
s_add_u32 s62, s62, 1
MA 248,212,60
XL 24,5,4,51,256
TR 196,32,8192
MA 248,208,44
TR 198,32,12288
s_mul_i32 s63, s63, s62
MA 252,216,44
TR 200,33,0
s_lshl_b32 s62, s54, 7
MA 252,220,60
TR 202,33,4096
v_lshl_add_u32 v53, v0, 4, s88
MA 220,220,56
XL 28,5,4,51,384
MA 220,216,40
s_add_u32 s51, s51, 4096
s_lshl_b32 s64, s73, 6
MA 188,216,36
TR 204,33,8192
s_add_u32 s62, s62, s64
MA 188,220,52
TR 206,33,12288
s_lshl_b32 s64, s72, 5
MA 156,220,48
s_add_u32 s62, s62, s64
MA 156,216,32
s_add_u32 s62, s62, s63
s_lshl_b32 s60, s55, 14
s_waitcnt vmcnt(28) lgkmcnt(4)
MA 128,192,64
TR 208,34,0
s_add_u32 s60, s60, 8388608
MA 128,196,80
s_add_u32 m0, s48, 32768
TR 210,34,4096
MA 160,196,84
DM 12,16,53,0
MA 160,192,68
s_movk_i32 s64, 0x800
MA 192,192,72
TR 212,34,8192
v_mov_b32 v58, 0x7f800000
MA 192,196,88
TR 214,34,12288
MA 224,196,92
DM 13,16,53,1024
MA 224,192,76
v_and_b32 v56, 15, v0
WL 4
MA 228,200,76
TR 216,35,0
MA 228,204,92
TR 218,35,4096
v_add_u32 v56, 0, v56
MA 196,204,88
DM 14,16,53,2048
MA 196,200,72
v_add_u32 v56, s62, v56
MA 164,200,68
TR 220,35,8192
MA 164,204,84
TR 222,35,12288
v_cmp_gt_u32 s[68:69], s64, v56
MA 132,204,80
MA 132,200,64
v_rcp_f32 v44, v54
WL 4
MA 136,208,64
TR 192,36,0
MA 136,212,80
TR 194,36,4096
MA 168,212,84
DM 15,16,53,3072
MA 168,208,68
s_add_u32 s53, s53, 524288
v_cndmask_b32 v54, 0, v54, s[68:69]
MA 200,208,72
TR 196,36,8192
MA 200,212,88
TR 198,36,12288
MA 232,212,92
XL 32,5,4,51,0
v_cndmask_b32 v44, v58, v44, s[68:69]
MA 232,208,76
WL 4
MA 236,216,76
TR 200,37,0
v_mul_f32 v40, 0xc0135761, v54
MA 236,220,92
TR 202,37,4096
MA 204,220,88
XL 36,5,4,51,128
MA 204,216,72
v_mul_f32 v42, 0xbdd2d3e8, v54
MA 172,216,68
TR 204,37,8192
MA 172,220,84
TR 206,37,12288
v_mul_f32 v54, v54, v54
MA 140,220,80
v_mul_f32 v42, v42, v54
MA 140,216,64
WL 4
MA 144,192,64
TR 208,38,0
v_and_b32 v56, 0x7ff, v56
MA 144,196,80
TR 210,38,4096
MA 176,196,84
XL 40,5,4,51,256
MA 176,192,68
v_xor_b32 v24, 0, v1
v_lshrrev_b32 v57, 6, v56
MA 208,192,72
TR 212,38,8192
MA 208,196,88
TR 214,38,12288
v_lshlrev_b32 v54, 17, v57
MA 240,196,92
XL 44,5,4,51,384
MA 240,192,76
s_add_u32 s51, s51, 4096
v_xor_b32 v25, 32, v1
WL 4
MA 244,200,76
TR 216,39,0
MA 244,204,92
TR 218,39,4096
v_bfe_u32 v57, v56, 4, 2
MA 212,204,88
XL 48,5,4,51,0
MA 212,200,72
v_xor_b32 v26, 64, v1
MA 180,200,68
TR 220,39,8192
v_lshl_add_u32 v54, v57, 7, v54
MA 180,204,84
TR 222,39,12288
MA 148,204,80
v_bfe_u32 v57, v56, 3, 1
MA 148,200,64
v_xor_b32 v27, 96, v1
WL 4
MA 152,208,64
v_lshl_add_u32 v54, v57, 9, v54
MA 152,212,80
v_and_b32 v57, 7, v56
MA 184,212,84
XL 52,5,4,51,128
MA 184,208,68
v_xor_b32 v28, 128, v1
s_waitcnt vmcnt(30) lgkmcnt(0)
s_barrier
MA 216,208,72
TR 192,32,32768
v_lshl_add_u32 v54, v57, 4, v54
MA 216,212,88
TR 194,32,36864
MA 248,212,92
XL 56,5,4,51,256
TR 196,32,40960
MA 248,208,76
TR 198,32,45056
v_xor_b32 v29, 160, v1
MA 252,216,76
TR 200,33,32768
v_lshl_add_u32 v54, v19, 10, v54
MA 252,220,92
TR 202,33,36864
MA 220,220,88
XL 60,5,4,51,384
MA 220,216,72
s_add_u32 s51, s51, 4096
v_xor_b32 v30, 192, v1
MA 188,216,68
TR 204,33,40960
v_and_b32 v56, 15, v0
MA 188,220,84
TR 206,33,45056
MA 156,220,80
v_add_u32 v56, 16, v56
MA 156,216,64
v_xor_b32 v31, 224, v1
s_waitcnt vmcnt(24) lgkmcnt(4)
MA 192,192,104
TR 208,34,32768
v_add_u32 v56, s62, v56
MA 192,196,120
s_add_u32 m0, s48, 65536
TR 210,34,36864
MA 224,196,124
DM 12,16,53,0
TR 212,34,40960
MA 224,192,108
TR 214,34,45056
v_cmp_gt_u32 s[68:69], s64, v56
WL 4
MA 228,200,108
TR 216,35,32768
MA 228,204,124
TR 218,35,36864
MA 196,204,120
DM 13,16,53,1024
TR 220,35,40960
MA 196,200,104
TR 222,35,45056
WL 4
MA 200,208,104
TR 224,36,32768
v_rcp_f32 v45, v55
MA 200,212,120
TR 226,36,36864
MA 232,212,124
DM 14,16,53,2048
TR 228,36,40960
MA 232,208,108
TR 230,36,45056
WL 4
MA 236,216,108
TR 232,37,32768
v_cndmask_b32 v55, 0, v55, s[68:69]
MA 236,220,124
TR 234,37,36864
MA 204,220,120
TR 236,37,40960
MA 204,216,104
TR 238,37,45056
buffer_load_dword v61, v60, s[84:87], s77 offen
v_cndmask_b32 v45, v58, v45, s[68:69]
WL 4
MA 208,224,104
TR 240,38,32768
MA 208,228,120
TR 242,38,36864
MA 240,228,124
DM 15,16,53,3072
TR 244,38,40960
v_mul_f32 v41, 0xc0135761, v55
MA 240,224,108
s_add_u32 s53, s53, 524288
TR 246,38,45056
WL 4
MA 244,232,108
TR 248,39,32768
MA 244,236,124
TR 250,39,36864
v_mul_f32 v43, 0xbdd2d3e8, v55
MA 212,236,120
XL 64,5,4,51,0
TR 252,39,40960
MA 212,232,104
TR 254,39,45056
WL 4
MA 216,240,104
v_mul_f32 v55, v55, v55
MA 216,244,120
v_mul_f32 v43, v43, v55
MA 248,244,124
XL 68,5,4,51,128
MA 248,240,108
WL 0
MA 252,248,108
v_and_b32 v56, 0x7ff, v56
MA 252,252,124
v_lshrrev_b32 v57, 6, v56
MA 220,252,120
v_lshlrev_b32 v55, 17, v57
MA 220,248,104
WV 27
s_barrier
MA 128,192,96
v_bfe_u32 v57, v56, 4, 2
MA 128,196,112
ds_write_b128 v52, v[192:195] offset:0
v_lshl_add_u32 v55, v57, 7, v55
MA 160,196,116
XL 72,5,4,51,256
MA 160,192,100
ds_write_b128 v52, v[196:199] offset:1024
MA 164,200,100
v_bfe_u32 v57, v56, 3, 1
MA 164,204,116
ds_write_b128 v52, v[200:203] offset:2048
MA 132,204,112
XL 76,5,4,51,384
MA 132,200,96
s_add_u32 s51, s51, 4096
ds_write_b128 v52, v[204:207] offset:3072
v_lshl_add_u32 v55, v57, 9, v55
MA 136,208,96
MA 136,212,112
ds_write_b128 v52, v[208:211] offset:4096
v_and_b32 v57, 7, v56
MA 168,212,116
XL 80,5,4,51,0
MA 168,208,100
ds_write_b128 v52, v[212:215] offset:5120
MA 172,216,100
TR 192,24,0
v_lshl_add_u32 v55, v57, 4, v55
MA 172,220,116
ds_write_b128 v52, v[216:219] offset:6144
MA 140,220,112
TR 194,24,4096
v_lshl_add_u32 v55, v19, 10, v55
MA 140,216,96
ds_write_b128 v52, v[220:223] offset:7168
MA 144,224,96
TR 196,24,8192
MA 144,228,112
ds_write_b128 v52, v[224:227] offset:8192
MA 176,228,116
XL 84,5,4,51,128
TR 198,24,12288
MA 176,224,100
ds_write_b128 v52, v[228:231] offset:9216
MA 180,232,100
TR 200,25,0
MA 180,236,116
ds_write_b128 v52, v[232:235] offset:10240
MA 148,236,112
XL 88,5,4,51,256
TR 202,25,4096
MA 148,232,96
ds_write_b128 v52, v[236:239] offset:11264
MA 152,240,96
TR 204,25,8192
MA 152,244,112
ds_write_b128 v52, v[240:243] offset:12288
MA 184,244,116
XL 92,5,4,51,384
TR 206,25,12288
MA 184,240,100
s_add_u32 s51, s51, 4096
ds_write_b128 v52, v[244:247] offset:13312
MA 188,248,100
MA 188,252,116
ds_write_b128 v52, v[248:251] offset:14336
MA 156,252,112
MA 156,248,96
ds_write_b128 v52, v[252:255] offset:15360
WL 0
s_barrier
ds_read_b128 v[192:195], v53 offset:0
ds_read_b128 v[196:199], v53 offset:1024
ds_read_b128 v[200:203], v53 offset:2048
ds_read_b128 v[204:207], v53 offset:3072
ds_read_b128 v[208:211], v53 offset:4096
ds_read_b128 v[212:215], v53 offset:5120
ds_read_b128 v[216:219], v53 offset:6144
ds_read_b128 v[220:223], v53 offset:7168
ds_read_b128 v[224:227], v53 offset:8192
ds_read_b128 v[228:231], v53 offset:9216
ds_read_b128 v[232:235], v53 offset:10240
ds_read_b128 v[236:239], v53 offset:11264
ds_read_b128 v[240:243], v53 offset:12288
ds_read_b128 v[244:247], v53 offset:13312
ds_read_b128 v[248:251], v53 offset:14336
ds_read_b128 v[252:255], v53 offset:15360
WL 15
v_pk_add_f32 v[64:65], v[128:129], v[192:193]
v_pk_add_f32 v[66:67], v[130:131], v[194:195]
WL 14
v_pk_add_f32 v[68:69], v[132:133], v[196:197]
v_pk_add_f32 v[70:71], v[134:135], v[198:199]
WL 13
v_pk_add_f32 v[72:73], v[136:137], v[200:201]
v_pk_add_f32 v[74:75], v[138:139], v[202:203]
WL 12
v_pk_add_f32 v[76:77], v[140:141], v[204:205]
v_pk_add_f32 v[78:79], v[142:143], v[206:207]
WL 11
v_pk_add_f32 v[80:81], v[144:145], v[208:209]
v_pk_add_f32 v[82:83], v[146:147], v[210:211]
WL 10
v_pk_add_f32 v[84:85], v[148:149], v[212:213]
v_pk_add_f32 v[86:87], v[150:151], v[214:215]
WL 9
v_pk_add_f32 v[88:89], v[152:153], v[216:217]
v_pk_add_f32 v[90:91], v[154:155], v[218:219]
WL 8
v_pk_add_f32 v[92:93], v[156:157], v[220:221]
v_pk_add_f32 v[94:95], v[158:159], v[222:223]
WL 7
v_pk_add_f32 v[96:97], v[160:161], v[224:225]
v_pk_add_f32 v[98:99], v[162:163], v[226:227]
WL 6
v_pk_add_f32 v[100:101], v[164:165], v[228:229]
v_pk_add_f32 v[102:103], v[166:167], v[230:231]
WL 5
v_pk_add_f32 v[104:105], v[168:169], v[232:233]
v_pk_add_f32 v[106:107], v[170:171], v[234:235]
WL 4
v_pk_add_f32 v[108:109], v[172:173], v[236:237]
v_pk_add_f32 v[110:111], v[174:175], v[238:239]
WL 3
v_pk_add_f32 v[112:113], v[176:177], v[240:241]
v_pk_add_f32 v[114:115], v[178:179], v[242:243]
WL 2
v_pk_add_f32 v[116:117], v[180:181], v[244:245]
v_pk_add_f32 v[118:119], v[182:183], v[246:247]
WL 1
v_pk_add_f32 v[120:121], v[184:185], v[248:249]
v_pk_add_f32 v[122:123], v[186:187], v[250:251]
WL 0
v_pk_add_f32 v[124:125], v[188:189], v[252:253]
v_pk_add_f32 v[126:127], v[190:191], v[254:255]
s_barrier
v_pk_mul_f32 v[128:129], v[64:65], v[64:65]
v_pk_mul_f32 v[130:131], v[66:67], v[66:67]
v_pk_mul_f32 v[132:133], v[68:69], v[68:69]
v_pk_mul_f32 v[134:135], v[70:71], v[70:71]
v_pk_fma_f32 v[128:129], v[128:129], v[42:43], v[40:41] op_sel:[0,0,0] op_sel_hi:[1,0,0]
v_pk_fma_f32 v[130:131], v[130:131], v[42:43], v[40:41] op_sel:[0,0,0] op_sel_hi:[1,0,0]
v_pk_fma_f32 v[132:133], v[132:133], v[42:43], v[40:41] op_sel:[0,0,0] op_sel_hi:[1,0,0]
v_pk_fma_f32 v[134:135], v[134:135], v[42:43], v[40:41] op_sel:[0,0,0] op_sel_hi:[1,0,0]
v_pk_mul_f32 v[128:129], v[128:129], v[64:65]
v_pk_mul_f32 v[130:131], v[130:131], v[66:67]
v_pk_mul_f32 v[132:133], v[132:133], v[68:69]
v_pk_mul_f32 v[134:135], v[134:135], v[70:71]
v_exp_f32 v128, v128
v_pk_mul_f32 v[144:145], v[96:97], v[96:97]
v_exp_f32 v129, v129
v_pk_mul_f32 v[146:147], v[98:99], v[98:99]
v_exp_f32 v130, v130
v_pk_mul_f32 v[148:149], v[100:101], v[100:101]
v_exp_f32 v131, v131
v_pk_mul_f32 v[150:151], v[102:103], v[102:103]
v_exp_f32 v132, v132
v_pk_fma_f32 v[144:145], v[144:145], v[42:43], v[40:41] op_sel:[0,1,1] op_sel_hi:[1,1,1]
v_exp_f32 v133, v133
v_pk_fma_f32 v[146:147], v[146:147], v[42:43], v[40:41] op_sel:[0,1,1] op_sel_hi:[1,1,1]
v_exp_f32 v134, v134
v_pk_fma_f32 v[148:149], v[148:149], v[42:43], v[40:41] op_sel:[0,1,1] op_sel_hi:[1,1,1]
v_exp_f32 v135, v135
v_pk_fma_f32 v[128:129], v[128:129], v[44:45], v[44:45] op_sel:[0,0,0] op_sel_hi:[1,0,0]
v_pk_fma_f32 v[130:131], v[130:131], v[44:45], v[44:45] op_sel:[0,0,0] op_sel_hi:[1,0,0]
v_pk_fma_f32 v[132:133], v[132:133], v[44:45], v[44:45] op_sel:[0,0,0] op_sel_hi:[1,0,0]
v_pk_fma_f32 v[134:135], v[134:135], v[44:45], v[44:45] op_sel:[0,0,0] op_sel_hi:[1,0,0]
v_rcp_f32 v128, v128
v_pk_fma_f32 v[150:151], v[150:151], v[42:43], v[40:41] op_sel:[0,1,1] op_sel_hi:[1,1,1]
v_rcp_f32 v129, v129
v_pk_mul_f32 v[144:145], v[144:145], v[96:97]
v_rcp_f32 v130, v130
v_pk_mul_f32 v[146:147], v[146:147], v[98:99]
v_rcp_f32 v131, v131
v_pk_mul_f32 v[148:149], v[148:149], v[100:101]
v_rcp_f32 v132, v132
v_pk_mul_f32 v[150:151], v[150:151], v[102:103]
v_rcp_f32 v133, v133
v_rcp_f32 v134, v134
v_rcp_f32 v135, v135
v_pk_mul_f32 v[128:129], v[128:129], v[64:65]
v_exp_f32 v144, v144
v_pk_mul_f32 v[130:131], v[130:131], v[66:67]
v_exp_f32 v145, v145
v_pk_mul_f32 v[132:133], v[132:133], v[68:69]
v_exp_f32 v146, v146
v_pk_mul_f32 v[134:135], v[134:135], v[70:71]
v_exp_f32 v147, v147
v_cvt_pk_bf16_f32 v136, v128, v129
v_exp_f32 v148, v148
v_cvt_pk_bf16_f32 v137, v130, v131
v_exp_f32 v149, v149
v_cvt_pk_bf16_f32 v138, v132, v133
v_exp_f32 v150, v150
v_cvt_pk_bf16_f32 v139, v134, v135
v_exp_f32 v151, v151
buffer_store_dwordx4 v[136:139], v54, s[4:7], s60 offen sc1
v_pk_fma_f32 v[144:145], v[144:145], v[44:45], v[44:45] op_sel:[0,1,1] op_sel_hi:[1,1,1]
v_pk_fma_f32 v[146:147], v[146:147], v[44:45], v[44:45] op_sel:[0,1,1] op_sel_hi:[1,1,1]
v_pk_fma_f32 v[148:149], v[148:149], v[44:45], v[44:45] op_sel:[0,1,1] op_sel_hi:[1,1,1]
v_pk_fma_f32 v[150:151], v[150:151], v[44:45], v[44:45] op_sel:[0,1,1] op_sel_hi:[1,1,1]
v_rcp_f32 v144, v144
v_pk_mul_f32 v[128:129], v[72:73], v[72:73]
v_rcp_f32 v145, v145
v_pk_mul_f32 v[130:131], v[74:75], v[74:75]
v_rcp_f32 v146, v146
v_pk_mul_f32 v[132:133], v[76:77], v[76:77]
v_rcp_f32 v147, v147
v_pk_mul_f32 v[134:135], v[78:79], v[78:79]
v_rcp_f32 v148, v148
v_pk_fma_f32 v[128:129], v[128:129], v[42:43], v[40:41] op_sel:[0,0,0] op_sel_hi:[1,0,0]
v_rcp_f32 v149, v149
v_pk_fma_f32 v[130:131], v[130:131], v[42:43], v[40:41] op_sel:[0,0,0] op_sel_hi:[1,0,0]
v_rcp_f32 v150, v150
v_pk_fma_f32 v[132:133], v[132:133], v[42:43], v[40:41] op_sel:[0,0,0] op_sel_hi:[1,0,0]
v_rcp_f32 v151, v151
v_pk_mul_f32 v[144:145], v[144:145], v[96:97]
v_pk_mul_f32 v[146:147], v[146:147], v[98:99]
v_pk_mul_f32 v[148:149], v[148:149], v[100:101]
v_pk_mul_f32 v[150:151], v[150:151], v[102:103]
v_cvt_pk_bf16_f32 v152, v144, v145
v_cvt_pk_bf16_f32 v153, v146, v147
v_cvt_pk_bf16_f32 v154, v148, v149
v_cvt_pk_bf16_f32 v155, v150, v151
buffer_store_dwordx4 v[152:155], v55, s[4:7], s60 offen sc1
s_add_u32 s60, s60, 4096
v_pk_fma_f32 v[134:135], v[134:135], v[42:43], v[40:41] op_sel:[0,0,0] op_sel_hi:[1,0,0]
v_pk_mul_f32 v[128:129], v[128:129], v[72:73]
v_pk_mul_f32 v[130:131], v[130:131], v[74:75]
v_pk_mul_f32 v[132:133], v[132:133], v[76:77]
v_pk_mul_f32 v[134:135], v[134:135], v[78:79]
v_exp_f32 v128, v128
v_pk_mul_f32 v[144:145], v[104:105], v[104:105]
v_exp_f32 v129, v129
v_pk_mul_f32 v[146:147], v[106:107], v[106:107]
v_exp_f32 v130, v130
v_pk_mul_f32 v[148:149], v[108:109], v[108:109]
v_exp_f32 v131, v131
v_pk_mul_f32 v[150:151], v[110:111], v[110:111]
v_exp_f32 v132, v132
v_pk_fma_f32 v[144:145], v[144:145], v[42:43], v[40:41] op_sel:[0,1,1] op_sel_hi:[1,1,1]
v_exp_f32 v133, v133
v_pk_fma_f32 v[146:147], v[146:147], v[42:43], v[40:41] op_sel:[0,1,1] op_sel_hi:[1,1,1]
v_exp_f32 v134, v134
v_pk_fma_f32 v[148:149], v[148:149], v[42:43], v[40:41] op_sel:[0,1,1] op_sel_hi:[1,1,1]
v_exp_f32 v135, v135
v_pk_fma_f32 v[128:129], v[128:129], v[44:45], v[44:45] op_sel:[0,0,0] op_sel_hi:[1,0,0]
v_pk_fma_f32 v[130:131], v[130:131], v[44:45], v[44:45] op_sel:[0,0,0] op_sel_hi:[1,0,0]
v_pk_fma_f32 v[132:133], v[132:133], v[44:45], v[44:45] op_sel:[0,0,0] op_sel_hi:[1,0,0]
v_pk_fma_f32 v[134:135], v[134:135], v[44:45], v[44:45] op_sel:[0,0,0] op_sel_hi:[1,0,0]
v_rcp_f32 v128, v128
v_pk_fma_f32 v[150:151], v[150:151], v[42:43], v[40:41] op_sel:[0,1,1] op_sel_hi:[1,1,1]
v_rcp_f32 v129, v129
v_pk_mul_f32 v[144:145], v[144:145], v[104:105]
v_rcp_f32 v130, v130
v_pk_mul_f32 v[146:147], v[146:147], v[106:107]
v_rcp_f32 v131, v131
v_pk_mul_f32 v[148:149], v[148:149], v[108:109]
v_rcp_f32 v132, v132
v_pk_mul_f32 v[150:151], v[150:151], v[110:111]
v_rcp_f32 v133, v133
v_rcp_f32 v134, v134
v_rcp_f32 v135, v135
v_pk_mul_f32 v[128:129], v[128:129], v[72:73]
v_exp_f32 v144, v144
v_pk_mul_f32 v[130:131], v[130:131], v[74:75]
v_exp_f32 v145, v145
v_pk_mul_f32 v[132:133], v[132:133], v[76:77]
v_exp_f32 v146, v146
v_pk_mul_f32 v[134:135], v[134:135], v[78:79]
v_exp_f32 v147, v147
v_cvt_pk_bf16_f32 v136, v128, v129
v_exp_f32 v148, v148
v_cvt_pk_bf16_f32 v137, v130, v131
v_exp_f32 v149, v149
v_cvt_pk_bf16_f32 v138, v132, v133
v_exp_f32 v150, v150
v_cvt_pk_bf16_f32 v139, v134, v135
v_exp_f32 v151, v151
buffer_store_dwordx4 v[136:139], v54, s[4:7], s60 offen sc1
v_pk_fma_f32 v[144:145], v[144:145], v[44:45], v[44:45] op_sel:[0,1,1] op_sel_hi:[1,1,1]
v_pk_fma_f32 v[146:147], v[146:147], v[44:45], v[44:45] op_sel:[0,1,1] op_sel_hi:[1,1,1]
v_pk_fma_f32 v[148:149], v[148:149], v[44:45], v[44:45] op_sel:[0,1,1] op_sel_hi:[1,1,1]
v_pk_fma_f32 v[150:151], v[150:151], v[44:45], v[44:45] op_sel:[0,1,1] op_sel_hi:[1,1,1]
v_rcp_f32 v144, v144
v_pk_mul_f32 v[128:129], v[80:81], v[80:81]
v_rcp_f32 v145, v145
v_pk_mul_f32 v[130:131], v[82:83], v[82:83]
v_rcp_f32 v146, v146
v_pk_mul_f32 v[132:133], v[84:85], v[84:85]
v_rcp_f32 v147, v147
v_pk_mul_f32 v[134:135], v[86:87], v[86:87]
v_rcp_f32 v148, v148
v_pk_fma_f32 v[128:129], v[128:129], v[42:43], v[40:41] op_sel:[0,0,0] op_sel_hi:[1,0,0]
v_rcp_f32 v149, v149
v_pk_fma_f32 v[130:131], v[130:131], v[42:43], v[40:41] op_sel:[0,0,0] op_sel_hi:[1,0,0]
v_rcp_f32 v150, v150
v_pk_fma_f32 v[132:133], v[132:133], v[42:43], v[40:41] op_sel:[0,0,0] op_sel_hi:[1,0,0]
v_rcp_f32 v151, v151
v_pk_mul_f32 v[144:145], v[144:145], v[104:105]
v_pk_mul_f32 v[146:147], v[146:147], v[106:107]
v_pk_mul_f32 v[148:149], v[148:149], v[108:109]
v_pk_mul_f32 v[150:151], v[150:151], v[110:111]
v_cvt_pk_bf16_f32 v152, v144, v145
v_cvt_pk_bf16_f32 v153, v146, v147
v_cvt_pk_bf16_f32 v154, v148, v149
v_cvt_pk_bf16_f32 v155, v150, v151
buffer_store_dwordx4 v[152:155], v55, s[4:7], s60 offen sc1
s_add_u32 s60, s60, 4096
v_pk_fma_f32 v[134:135], v[134:135], v[42:43], v[40:41] op_sel:[0,0,0] op_sel_hi:[1,0,0]
v_pk_mul_f32 v[128:129], v[128:129], v[80:81]
v_pk_mul_f32 v[130:131], v[130:131], v[82:83]
v_pk_mul_f32 v[132:133], v[132:133], v[84:85]
v_pk_mul_f32 v[134:135], v[134:135], v[86:87]
v_exp_f32 v128, v128
v_pk_mul_f32 v[144:145], v[112:113], v[112:113]
v_exp_f32 v129, v129
v_pk_mul_f32 v[146:147], v[114:115], v[114:115]
v_exp_f32 v130, v130
v_pk_mul_f32 v[148:149], v[116:117], v[116:117]
v_exp_f32 v131, v131
v_pk_mul_f32 v[150:151], v[118:119], v[118:119]
v_exp_f32 v132, v132
v_pk_fma_f32 v[144:145], v[144:145], v[42:43], v[40:41] op_sel:[0,1,1] op_sel_hi:[1,1,1]
v_exp_f32 v133, v133
v_pk_fma_f32 v[146:147], v[146:147], v[42:43], v[40:41] op_sel:[0,1,1] op_sel_hi:[1,1,1]
v_exp_f32 v134, v134
v_pk_fma_f32 v[148:149], v[148:149], v[42:43], v[40:41] op_sel:[0,1,1] op_sel_hi:[1,1,1]
v_exp_f32 v135, v135
v_pk_fma_f32 v[128:129], v[128:129], v[44:45], v[44:45] op_sel:[0,0,0] op_sel_hi:[1,0,0]
v_pk_fma_f32 v[130:131], v[130:131], v[44:45], v[44:45] op_sel:[0,0,0] op_sel_hi:[1,0,0]
v_pk_fma_f32 v[132:133], v[132:133], v[44:45], v[44:45] op_sel:[0,0,0] op_sel_hi:[1,0,0]
v_pk_fma_f32 v[134:135], v[134:135], v[44:45], v[44:45] op_sel:[0,0,0] op_sel_hi:[1,0,0]
v_rcp_f32 v128, v128
v_pk_fma_f32 v[150:151], v[150:151], v[42:43], v[40:41] op_sel:[0,1,1] op_sel_hi:[1,1,1]
v_rcp_f32 v129, v129
v_pk_mul_f32 v[144:145], v[144:145], v[112:113]
v_rcp_f32 v130, v130
v_pk_mul_f32 v[146:147], v[146:147], v[114:115]
v_rcp_f32 v131, v131
v_pk_mul_f32 v[148:149], v[148:149], v[116:117]
v_rcp_f32 v132, v132
v_pk_mul_f32 v[150:151], v[150:151], v[118:119]
v_rcp_f32 v133, v133
v_rcp_f32 v134, v134
v_rcp_f32 v135, v135
v_pk_mul_f32 v[128:129], v[128:129], v[80:81]
v_exp_f32 v144, v144
v_pk_mul_f32 v[130:131], v[130:131], v[82:83]
v_exp_f32 v145, v145
v_pk_mul_f32 v[132:133], v[132:133], v[84:85]
v_exp_f32 v146, v146
v_pk_mul_f32 v[134:135], v[134:135], v[86:87]
v_exp_f32 v147, v147
v_cvt_pk_bf16_f32 v136, v128, v129
v_exp_f32 v148, v148
v_cvt_pk_bf16_f32 v137, v130, v131
v_exp_f32 v149, v149
v_cvt_pk_bf16_f32 v138, v132, v133
v_exp_f32 v150, v150
v_cvt_pk_bf16_f32 v139, v134, v135
v_exp_f32 v151, v151
buffer_store_dwordx4 v[136:139], v54, s[4:7], s60 offen sc1
v_pk_fma_f32 v[144:145], v[144:145], v[44:45], v[44:45] op_sel:[0,1,1] op_sel_hi:[1,1,1]
v_pk_fma_f32 v[146:147], v[146:147], v[44:45], v[44:45] op_sel:[0,1,1] op_sel_hi:[1,1,1]
v_pk_fma_f32 v[148:149], v[148:149], v[44:45], v[44:45] op_sel:[0,1,1] op_sel_hi:[1,1,1]
v_pk_fma_f32 v[150:151], v[150:151], v[44:45], v[44:45] op_sel:[0,1,1] op_sel_hi:[1,1,1]
v_rcp_f32 v144, v144
v_pk_mul_f32 v[128:129], v[88:89], v[88:89]
v_rcp_f32 v145, v145
v_pk_mul_f32 v[130:131], v[90:91], v[90:91]
v_rcp_f32 v146, v146
v_pk_mul_f32 v[132:133], v[92:93], v[92:93]
v_rcp_f32 v147, v147
v_pk_mul_f32 v[134:135], v[94:95], v[94:95]
v_rcp_f32 v148, v148
v_pk_fma_f32 v[128:129], v[128:129], v[42:43], v[40:41] op_sel:[0,0,0] op_sel_hi:[1,0,0]
v_rcp_f32 v149, v149
v_pk_fma_f32 v[130:131], v[130:131], v[42:43], v[40:41] op_sel:[0,0,0] op_sel_hi:[1,0,0]
v_rcp_f32 v150, v150
v_pk_fma_f32 v[132:133], v[132:133], v[42:43], v[40:41] op_sel:[0,0,0] op_sel_hi:[1,0,0]
v_rcp_f32 v151, v151
v_pk_mul_f32 v[144:145], v[144:145], v[112:113]
v_pk_mul_f32 v[146:147], v[146:147], v[114:115]
v_pk_mul_f32 v[148:149], v[148:149], v[116:117]
v_pk_mul_f32 v[150:151], v[150:151], v[118:119]
v_cvt_pk_bf16_f32 v152, v144, v145
v_cvt_pk_bf16_f32 v153, v146, v147
v_cvt_pk_bf16_f32 v154, v148, v149
v_cvt_pk_bf16_f32 v155, v150, v151
buffer_store_dwordx4 v[152:155], v55, s[4:7], s60 offen sc1
s_add_u32 s60, s60, 4096
v_pk_fma_f32 v[134:135], v[134:135], v[42:43], v[40:41] op_sel:[0,0,0] op_sel_hi:[1,0,0]
v_pk_mul_f32 v[128:129], v[128:129], v[88:89]
v_pk_mul_f32 v[130:131], v[130:131], v[90:91]
v_pk_mul_f32 v[132:133], v[132:133], v[92:93]
v_pk_mul_f32 v[134:135], v[134:135], v[94:95]
v_exp_f32 v128, v128
v_pk_mul_f32 v[144:145], v[120:121], v[120:121]
v_exp_f32 v129, v129
v_pk_mul_f32 v[146:147], v[122:123], v[122:123]
v_exp_f32 v130, v130
v_pk_mul_f32 v[148:149], v[124:125], v[124:125]
v_exp_f32 v131, v131
v_pk_mul_f32 v[150:151], v[126:127], v[126:127]
v_exp_f32 v132, v132
v_pk_fma_f32 v[144:145], v[144:145], v[42:43], v[40:41] op_sel:[0,1,1] op_sel_hi:[1,1,1]
v_exp_f32 v133, v133
v_pk_fma_f32 v[146:147], v[146:147], v[42:43], v[40:41] op_sel:[0,1,1] op_sel_hi:[1,1,1]
v_exp_f32 v134, v134
v_pk_fma_f32 v[148:149], v[148:149], v[42:43], v[40:41] op_sel:[0,1,1] op_sel_hi:[1,1,1]
v_exp_f32 v135, v135
v_pk_fma_f32 v[128:129], v[128:129], v[44:45], v[44:45] op_sel:[0,0,0] op_sel_hi:[1,0,0]
v_pk_fma_f32 v[130:131], v[130:131], v[44:45], v[44:45] op_sel:[0,0,0] op_sel_hi:[1,0,0]
v_pk_fma_f32 v[132:133], v[132:133], v[44:45], v[44:45] op_sel:[0,0,0] op_sel_hi:[1,0,0]
v_pk_fma_f32 v[134:135], v[134:135], v[44:45], v[44:45] op_sel:[0,0,0] op_sel_hi:[1,0,0]
v_rcp_f32 v128, v128
v_pk_fma_f32 v[150:151], v[150:151], v[42:43], v[40:41] op_sel:[0,1,1] op_sel_hi:[1,1,1]
v_rcp_f32 v129, v129
v_pk_mul_f32 v[144:145], v[144:145], v[120:121]
v_rcp_f32 v130, v130
v_pk_mul_f32 v[146:147], v[146:147], v[122:123]
v_rcp_f32 v131, v131
v_pk_mul_f32 v[148:149], v[148:149], v[124:125]
v_rcp_f32 v132, v132
v_pk_mul_f32 v[150:151], v[150:151], v[126:127]
v_rcp_f32 v133, v133
v_rcp_f32 v134, v134
v_rcp_f32 v135, v135
v_pk_mul_f32 v[128:129], v[128:129], v[88:89]
v_exp_f32 v144, v144
v_pk_mul_f32 v[130:131], v[130:131], v[90:91]
v_exp_f32 v145, v145
v_pk_mul_f32 v[132:133], v[132:133], v[92:93]
v_exp_f32 v146, v146
v_pk_mul_f32 v[134:135], v[134:135], v[94:95]
v_exp_f32 v147, v147
v_cvt_pk_bf16_f32 v136, v128, v129
v_exp_f32 v148, v148
v_cvt_pk_bf16_f32 v137, v130, v131
v_exp_f32 v149, v149
v_cvt_pk_bf16_f32 v138, v132, v133
v_exp_f32 v150, v150
v_cvt_pk_bf16_f32 v139, v134, v135
v_exp_f32 v151, v151
buffer_store_dwordx4 v[136:139], v54, s[4:7], s60 offen sc1
v_pk_fma_f32 v[144:145], v[144:145], v[44:45], v[44:45] op_sel:[0,1,1] op_sel_hi:[1,1,1]
v_pk_fma_f32 v[146:147], v[146:147], v[44:45], v[44:45] op_sel:[0,1,1] op_sel_hi:[1,1,1]
v_pk_fma_f32 v[148:149], v[148:149], v[44:45], v[44:45] op_sel:[0,1,1] op_sel_hi:[1,1,1]
v_pk_fma_f32 v[150:151], v[150:151], v[44:45], v[44:45] op_sel:[0,1,1] op_sel_hi:[1,1,1]
v_rcp_f32 v144, v144
v_rcp_f32 v145, v145
v_rcp_f32 v146, v146
v_rcp_f32 v147, v147
v_rcp_f32 v148, v148
v_rcp_f32 v149, v149
v_rcp_f32 v150, v150
v_rcp_f32 v151, v151
v_pk_mul_f32 v[144:145], v[144:145], v[120:121]
v_pk_mul_f32 v[146:147], v[146:147], v[122:123]
v_pk_mul_f32 v[148:149], v[148:149], v[124:125]
v_pk_mul_f32 v[150:151], v[150:151], v[126:127]
v_cvt_pk_bf16_f32 v152, v144, v145
v_cvt_pk_bf16_f32 v153, v146, v147
v_cvt_pk_bf16_f32 v154, v148, v149
v_cvt_pk_bf16_f32 v155, v150, v151
buffer_store_dwordx4 v[152:155], v55, s[4:7], s60 offen sc1
s_add_u32 s60, s60, 4096
WV 33
MZ 128,192,0
TR 208,26,0
MA 128,196,16
s_add_u32 m0, s48, 98304
TR 210,26,4096
MZ 160,196,20
DM 12,16,53,0
MA 160,192,4
v_xor_b32 v32, 65536, v1
MZ 192,192,8
TR 212,26,8192
MA 192,196,24
TR 214,26,12288
MZ 224,196,28
DM 13,16,53,1024
MA 224,192,12
v_xor_b32 v33, 65568, v1
MZ 228,200,12
TR 216,27,0
MA 228,204,28
TR 218,27,4096
MZ 196,204,24
DM 14,16,53,2048
MA 196,200,8
v_xor_b32 v34, 65600, v1
MZ 164,200,4
TR 220,27,8192
MA 164,204,20
TR 222,27,12288
MZ 132,204,16
MA 132,200,0
v_xor_b32 v35, 65632, v1
WL 4
MZ 136,208,0
TR 192,28,0
MA 136,212,16
TR 194,28,4096
MZ 168,212,20
DM 15,16,53,3072
MA 168,208,4
s_add_u32 s53, s53, 524288
v_xor_b32 v36, 65664, v1
MZ 200,208,8
TR 196,28,8192
MA 200,212,24
TR 198,28,12288
MZ 232,212,28
XL 96,5,4,51,0
MA 232,208,12
v_xor_b32 v37, 65696, v1
WL 4
MZ 236,216,12
TR 200,29,0
MA 236,220,28
TR 202,29,4096
MZ 204,220,24
XL 100,5,4,51,128
MA 204,216,8
v_xor_b32 v38, 65728, v1
MZ 172,216,4
TR 204,29,8192
MA 172,220,20
TR 206,29,12288
MZ 140,220,16
MA 140,216,0
v_xor_b32 v39, 65760, v1
WL 4
MZ 144,192,0
TR 208,30,0
MA 144,196,16
TR 210,30,4096
MZ 176,196,20
XL 104,5,4,51,256
MA 176,192,4
s_lshr_b32 s52, s57, 3
MZ 208,192,8
TR 212,30,8192
MA 208,196,24
TR 214,30,12288
MZ 240,196,28
XL 108,5,4,51,384
MA 240,192,12
s_add_u32 s51, s51, 4096
s_lshl_b32 s52, s52, 19
WL 4
MZ 244,200,12
TR 216,31,0
MA 244,204,28
TR 218,31,4096
MZ 212,204,24
XL 112,5,4,51,0
MA 212,200,8
s_add_u32 s52, s52, s48
MZ 180,200,4
TR 220,31,8192
MA 180,204,20
TR 222,31,12288
MZ 148,204,16
MA 148,200,0
s_add_u32 s52, s52, 393216
WL 4
MZ 152,208,0
MA 152,212,16
MZ 184,212,20
XL 116,5,4,51,128
MA 184,208,4
v_and_b32 v8, 15, v0
s_waitcnt vmcnt(10) lgkmcnt(0)
s_barrier
buffer_atomic_add v21, v18, s[4:7], s78 offen offset:0
MZ 216,208,8
TR 192,24,32768
MA 216,212,24
TR 194,24,36864
MZ 248,212,28
XL 120,5,4,51,256
TR 196,24,40960
MA 248,208,12
TR 198,24,45056
v_xor_b32 v8, v19, v8
MZ 252,216,12
TR 200,25,32768
MA 252,220,28
TR 202,25,36864
MZ 220,220,24
XL 124,5,4,51,384
MA 220,216,8
s_add_u32 s51, s51, 4096
v_lshlrev_b32 v8, 4, v8
MZ 188,216,4
TR 204,25,40960
MA 188,220,20
TR 206,25,45056
MZ 156,220,16
MA 156,216,0
v_lshl_add_u32 v8, v19, 8, v8
WL 4
MA 128,192,32
TR 208,26,32768
MA 128,196,48
s_add_u32 m0, s48, 0
TR 210,26,36864
MA 160,196,52
DM 12,16,53,0
MA 160,192,36
v_xor_b32 v9, 64, v8
MA 192,192,40
TR 212,26,40960
MA 192,196,56
TR 214,26,45056
MA 224,196,60
DM 13,16,53,1024
MA 224,192,44
v_xor_b32 v10, 128, v8
WL 4
MA 228,200,44
TR 216,27,32768
MA 228,204,60
TR 218,27,36864
MA 196,204,56
DM 14,16,53,2048
MA 196,200,40
v_xor_b32 v11, 192, v8
MA 164,200,36
TR 220,27,40960
MA 164,204,52
TR 222,27,45056
MA 132,204,48
MA 132,200,32
WL 4
MA 136,208,32
TR 192,28,32768
MA 136,212,48
TR 194,28,36864
MA 168,212,52
DM 15,16,53,3072
MA 168,208,36
s_add_u32 s53, s53, 524288
MA 200,208,40
TR 196,28,40960
MA 200,212,56
TR 198,28,45056
MA 232,212,60
XL 0,5,4,51,0
MA 232,208,44
WL 4
MA 236,216,44
TR 200,29,32768
MA 236,220,60
TR 202,29,36864
MA 204,220,56
XL 4,5,4,51,128
MA 204,216,40
MA 172,216,36
TR 204,29,40960
MA 172,220,52
TR 206,29,45056
MA 140,220,48
MA 140,216,32
WL 4
MA 144,192,32
TR 208,30,32768
MA 144,196,48
TR 210,30,36864
MA 176,196,52
XL 8,5,4,51,256
MA 176,192,36
MA 208,192,40
TR 212,30,40960
MA 208,196,56
TR 214,30,45056
MA 240,196,60
XL 12,5,4,51,384
MA 240,192,44
s_add_u32 s51, s51, 4096
WL 4
MA 244,200,44
TR 216,31,32768
MA 244,204,60
TR 218,31,36864
MA 212,204,56
XL 16,5,4,51,0
MA 212,200,40
MA 180,200,36
TR 220,31,40960
MA 180,204,52
TR 222,31,45056
MA 148,204,48
MA 148,200,32
WL 4
MA 152,208,32
MA 152,212,48
MA 184,212,52
XL 20,5,4,51,128
MA 184,208,36
WL 0
s_barrier
MA 216,208,40
TR 192,32,0
MA 216,212,56
TR 194,32,4096
MA 248,212,60
XL 24,5,4,51,256
TR 196,32,8192
MA 248,208,44
TR 198,32,12288
MA 252,216,44
TR 200,33,0
MA 252,220,60
TR 202,33,4096
MA 220,220,56
XL 28,5,4,51,384
MA 220,216,40
s_add_u32 s51, s51, 4096
MA 188,216,36
TR 204,33,8192
MA 188,220,52
TR 206,33,12288
MA 156,220,48
MA 156,216,32
WL 4
MA 128,192,64
TR 208,34,0
MA 128,196,80
s_add_u32 m0, s48, 32768
TR 210,34,4096
MA 160,196,84
DM 12,16,53,0
MA 160,192,68
s_lshr_b32 s81, s82, 6
MA 192,192,72
TR 212,34,8192
MA 192,196,88
TR 214,34,12288
MA 224,196,92
DM 13,16,53,1024
MA 224,192,76
s_add_u32 s81, s81, 0
WL 4
MA 228,200,76
TR 216,35,0
MA 228,204,92
TR 218,35,4096
MA 196,204,88
DM 14,16,53,2048
MA 196,200,72
s_lshl_b32 s81, s81, 19
MA 164,200,68
TR 220,35,8192
MA 164,204,84
TR 222,35,12288
MA 132,204,80
MA 132,200,64
s_and_b32 s65, s82, 63
WL 4
MA 136,208,64
TR 192,36,0
MA 136,212,80
TR 194,36,4096
MA 168,212,84
DM 15,16,53,3072
MA 168,208,68
s_add_u32 s53, s53, 524288
s_lshl_b32 s65, s65, 11
MA 200,208,72
TR 196,36,8192
MA 200,212,88
TR 198,36,12288
MA 232,212,92
XL 32,5,4,51,0
MA 232,208,76
s_add_u32 s81, s81, s65
WL 4
MA 236,216,76
TR 200,37,0
MA 236,220,92
TR 202,37,4096
MA 204,220,88
XL 36,5,4,51,128
MA 204,216,72
s_add_u32 s81, s81, 393216
MA 172,216,68
TR 204,37,8192
MA 172,220,84
TR 206,37,12288
MA 140,220,80
MA 140,216,64
s_lshr_b32 s65, s82, 7
WL 4
MA 144,192,64
TR 208,38,0
MA 144,196,80
TR 210,38,4096
MA 176,196,84
XL 40,5,4,51,256
MA 176,192,68
s_lshl_b32 s65, s65, 30
MA 208,192,72
TR 212,38,8192
MA 208,196,88
TR 214,38,12288
MA 240,196,92
XL 44,5,4,51,384
MA 240,192,76
s_add_u32 s51, s51, 4096
s_add_u32 s81, s81, s65
WL 4
MA 244,200,76
TR 216,39,0
MA 244,204,92
TR 218,39,4096
MA 212,204,88
XL 48,5,4,51,0
MA 212,200,72
buffer_load_dword v61, v60, s[20:23], s81 offen
MA 180,200,68
TR 220,39,8192
MA 180,204,84
TR 222,39,12288
MA 148,204,80
MA 148,200,64
buffer_load_dword v61, v60, s[24:27], s81 offen
WL 4
MA 152,208,64
MA 152,212,80
MA 184,212,84
XL 52,5,4,51,128
MA 184,208,68
s_waitcnt vmcnt(33) lgkmcnt(0)
s_barrier
MA 216,208,72
TR 192,32,32768
MA 216,212,88
TR 194,32,36864
MA 248,212,92
XL 56,5,4,51,256
TR 196,32,40960
MA 248,208,76
TR 198,32,45056
MA 252,216,76
TR 200,33,32768
MA 252,220,92
TR 202,33,36864
MA 220,220,88
XL 60,5,4,51,384
MA 220,216,72
s_add_u32 s51, s51, 4096
MA 188,216,68
TR 204,33,40960
MA 188,220,84
TR 206,33,45056
MA 156,220,80
MA 156,216,64
s_waitcnt vmcnt(26) lgkmcnt(4)
MA 128,192,96
TR 208,34,32768
MA 128,196,112
s_add_u32 m0, s48, 65536
TR 210,34,36864
MA 160,196,116
DM 12,16,53,0
MA 160,192,100
MA 192,192,104
TR 212,34,40960
MA 192,196,120
TR 214,34,45056
MA 224,196,124
DM 13,16,53,1024
MA 224,192,108
WL 4
MA 228,200,108
TR 216,35,32768
MA 228,204,124
TR 218,35,36864
MA 196,204,120
DM 14,16,53,2048
MA 196,200,104
MA 164,200,100
TR 220,35,40960
MA 164,204,116
TR 222,35,45056
MA 132,204,112
MA 132,200,96
buffer_load_dword v61, v60, s[84:87], s77 offen
WL 4
MA 136,208,96
TR 192,36,32768
MA 136,212,112
TR 194,36,36864
MA 168,212,116
DM 15,16,53,3072
MA 168,208,100
s_add_u32 s53, s53, 524288
MA 200,208,104
TR 196,36,40960
MA 200,212,120
TR 198,36,45056
MA 232,212,124
XL 64,5,4,51,0
MA 232,208,108
WL 4
MA 236,216,108
TR 200,37,32768
MA 236,220,124
TR 202,37,36864
MA 204,220,120
XL 68,5,4,51,128
MA 204,216,104
MA 172,216,100
TR 204,37,40960
MA 172,220,116
TR 206,37,45056
MA 140,220,112
MA 140,216,96
WL 4
MA 144,192,96
TR 208,38,32768
MA 144,196,112
TR 210,38,36864
MA 176,196,116
XL 72,5,4,51,256
MA 176,192,100
MA 208,192,104
TR 212,38,40960
MA 208,196,120
TR 214,38,45056
MA 240,196,124
XL 76,5,4,51,384
MA 240,192,108
s_add_u32 s51, s51, 4096
WL 4
MA 244,200,108
TR 216,39,32768
MA 244,204,124
TR 218,39,36864
MA 212,204,120
XL 80,5,4,51,0
MA 212,200,104
MA 180,200,100
TR 220,39,40960
MA 180,204,116
TR 222,39,45056
MA 148,204,112
MA 148,200,96
WL 4
MA 152,208,96
MA 152,212,112
MA 184,212,116
XL 84,5,4,51,128
MA 184,208,100
s_waitcnt vmcnt(33) lgkmcnt(0)
s_barrier
MA 216,208,104
TR 192,24,0
MA 216,212,120
TR 194,24,4096
MA 248,212,124
XL 88,5,4,51,256
TR 196,24,8192
MA 248,208,108
TR 198,24,12288
MA 252,216,108
TR 200,25,0
MA 252,220,124
TR 202,25,4096
MA 220,220,120
XL 92,5,4,51,384
MA 220,216,104
s_add_u32 s51, s51, 4096
MA 188,216,100
TR 204,25,8192
MA 188,220,116
TR 206,25,12288
MA 156,220,112
MA 156,216,96
s_mov_b32 s47, 1
t1_L9:
s_waitcnt vmcnt(25) lgkmcnt(4)
MA 128,192,0
TR 208,26,0
MA 128,196,16
s_add_u32 m0, s48, 98304
TR 210,26,4096
MA 160,196,20
DM 12,16,53,0
MA 160,192,4
MA 192,192,8
TR 212,26,8192
MA 192,196,24
TR 214,26,12288
MA 224,196,28
DM 13,16,53,1024
MA 224,192,12
WL 4
MA 228,200,12
TR 216,27,0
MA 228,204,28
TR 218,27,4096
MA 196,204,24
DM 14,16,53,2048
MA 196,200,8
MA 164,200,4
TR 220,27,8192
MA 164,204,20
TR 222,27,12288
MA 132,204,16
MA 132,200,0
WL 4
MA 136,208,0
TR 192,28,0
MA 136,212,16
TR 194,28,4096
MA 168,212,20
DM 15,16,53,3072
MA 168,208,4
s_add_u32 s53, s53, 524288
MA 200,208,8
TR 196,28,8192
MA 200,212,24
TR 198,28,12288
MA 232,212,28
XL 96,5,4,51,0
MA 232,208,12
WL 4
MA 236,216,12
TR 200,29,0
MA 236,220,28
TR 202,29,4096
MA 204,220,24
XL 100,5,4,51,128
MA 204,216,8
MA 172,216,4
TR 204,29,8192
MA 172,220,20
TR 206,29,12288
MA 140,220,16
MA 140,216,0
WL 4
MA 144,192,0
TR 208,30,0
MA 144,196,16
TR 210,30,4096
MA 176,196,20
XL 104,5,4,51,256
MA 176,192,4
MA 208,192,8
TR 212,30,8192
MA 208,196,24
TR 214,30,12288
MA 240,196,28
XL 108,5,4,51,384
MA 240,192,12
s_add_u32 s51, s51, 4096
WL 4
MA 244,200,12
TR 216,31,0
MA 244,204,28
TR 218,31,4096
MA 212,204,24
XL 112,5,4,51,0
MA 212,200,8
MA 180,200,4
TR 220,31,8192
MA 180,204,20
TR 222,31,12288
MA 148,204,16
MA 148,200,0
WL 4
MA 152,208,0
MA 152,212,16
MA 184,212,20
XL 116,5,4,51,128
MA 184,208,4
s_waitcnt vmcnt(31) lgkmcnt(0)
s_barrier
MA 216,208,8
TR 192,24,32768
MA 216,212,24
TR 194,24,36864
MA 248,212,28
XL 120,5,4,51,256
TR 196,24,40960
MA 248,208,12
TR 198,24,45056
MA 252,216,12
TR 200,25,32768
MA 252,220,28
TR 202,25,36864
MA 220,220,24
XL 124,5,4,51,384
MA 220,216,8
s_add_u32 s51, s51, 4096
MA 188,216,4
TR 204,25,40960
MA 188,220,20
TR 206,25,45056
MA 156,220,16
MA 156,216,0
s_waitcnt vmcnt(25) lgkmcnt(4)
MA 128,192,32
TR 208,26,32768
MA 128,196,48
s_add_u32 m0, s48, 0
TR 210,26,36864
MA 160,196,52
DM 12,16,53,0
MA 160,192,36
MA 192,192,40
TR 212,26,40960
MA 192,196,56
TR 214,26,45056
MA 224,196,60
DM 13,16,53,1024
MA 224,192,44
WL 4
MA 228,200,44
TR 216,27,32768
MA 228,204,60
TR 218,27,36864
MA 196,204,56
DM 14,16,53,2048
MA 196,200,40
MA 164,200,36
TR 220,27,40960
MA 164,204,52
TR 222,27,45056
MA 132,204,48
MA 132,200,32
WL 4
MA 136,208,32
TR 192,28,32768
MA 136,212,48
TR 194,28,36864
MA 168,212,52
DM 15,16,53,3072
MA 168,208,36
s_add_u32 s53, s53, 524288
MA 200,208,40
TR 196,28,40960
MA 200,212,56
TR 198,28,45056
MA 232,212,60
XL 0,5,4,51,0
MA 232,208,44
WL 4
MA 236,216,44
TR 200,29,32768
MA 236,220,60
TR 202,29,36864
MA 204,220,56
XL 4,5,4,51,128
MA 204,216,40
MA 172,216,36
TR 204,29,40960
MA 172,220,52
TR 206,29,45056
MA 140,220,48
MA 140,216,32
WL 4
MA 144,192,32
TR 208,30,32768
MA 144,196,48
TR 210,30,36864
MA 176,196,52
XL 8,5,4,51,256
MA 176,192,36
MA 208,192,40
TR 212,30,40960
MA 208,196,56
TR 214,30,45056
MA 240,196,60
XL 12,5,4,51,384
MA 240,192,44
s_add_u32 s51, s51, 4096
WL 4
MA 244,200,44
TR 216,31,32768
MA 244,204,60
TR 218,31,36864
MA 212,204,56
XL 16,5,4,51,0
MA 212,200,40
MA 180,200,36
TR 220,31,40960
MA 180,204,52
TR 222,31,45056
MA 148,204,48
MA 148,200,32
WL 4
MA 152,208,32
MA 152,212,48
MA 184,212,52
XL 20,5,4,51,128
MA 184,208,36
s_waitcnt vmcnt(30) lgkmcnt(0)
s_barrier
MA 216,208,40
TR 192,32,0
MA 216,212,56
TR 194,32,4096
MA 248,212,60
XL 24,5,4,51,256
TR 196,32,8192
MA 248,208,44
TR 198,32,12288
MA 252,216,44
TR 200,33,0
MA 252,220,60
TR 202,33,4096
MA 220,220,56
XL 28,5,4,51,384
MA 220,216,40
s_add_u32 s51, s51, 4096
MA 188,216,36
TR 204,33,8192
MA 188,220,52
TR 206,33,12288
MA 156,220,48
MA 156,216,32
s_waitcnt vmcnt(24) lgkmcnt(4)
MA 128,192,64
TR 208,34,0
MA 128,196,80
s_add_u32 m0, s48, 32768
TR 210,34,4096
MA 160,196,84
DM 12,16,53,0
MA 160,192,68
MA 192,192,72
TR 212,34,8192
MA 192,196,88
TR 214,34,12288
MA 224,196,92
DM 13,16,53,1024
MA 224,192,76
WL 4
MA 228,200,76
TR 216,35,0
MA 228,204,92
TR 218,35,4096
MA 196,204,88
DM 14,16,53,2048
MA 196,200,72
MA 164,200,68
TR 220,35,8192
MA 164,204,84
TR 222,35,12288
MA 132,204,80
MA 132,200,64
WL 4
MA 136,208,64
TR 192,36,0
MA 136,212,80
TR 194,36,4096
MA 168,212,84
DM 15,16,53,3072
MA 168,208,68
s_add_u32 s53, s53, 524288
MA 200,208,72
TR 196,36,8192
MA 200,212,88
TR 198,36,12288
MA 232,212,92
XL 32,5,4,51,0
MA 232,208,76
WL 4
MA 236,216,76
TR 200,37,0
MA 236,220,92
TR 202,37,4096
MA 204,220,88
XL 36,5,4,51,128
MA 204,216,72
MA 172,216,68
TR 204,37,8192
MA 172,220,84
TR 206,37,12288
MA 140,220,80
MA 140,216,64
WL 4
MA 144,192,64
TR 208,38,0
MA 144,196,80
TR 210,38,4096
MA 176,196,84
XL 40,5,4,51,256
MA 176,192,68
MA 208,192,72
TR 212,38,8192
MA 208,196,88
TR 214,38,12288
MA 240,196,92
XL 44,5,4,51,384
MA 240,192,76
s_add_u32 s51, s51, 4096
WL 4
MA 244,200,76
TR 216,39,0
MA 244,204,92
TR 218,39,4096
MA 212,204,88
XL 48,5,4,51,0
MA 212,200,72
MA 180,200,68
TR 220,39,8192
MA 180,204,84
TR 222,39,12288
MA 148,204,80
MA 148,200,64
WL 4
MA 152,208,64
MA 152,212,80
MA 184,212,84
XL 52,5,4,51,128
MA 184,208,68
s_waitcnt vmcnt(30) lgkmcnt(0)
s_barrier
MA 216,208,72
TR 192,32,32768
MA 216,212,88
TR 194,32,36864
MA 248,212,92
XL 56,5,4,51,256
TR 196,32,40960
MA 248,208,76
TR 198,32,45056
MA 252,216,76
TR 200,33,32768
MA 252,220,92
TR 202,33,36864
MA 220,220,88
XL 60,5,4,51,384
MA 220,216,72
s_add_u32 s51, s51, 4096
MA 188,216,68
TR 204,33,40960
MA 188,220,84
TR 206,33,45056
MA 156,220,80
MA 156,216,64
s_waitcnt vmcnt(24) lgkmcnt(4)
MA 128,192,96
TR 208,34,32768
MA 128,196,112
s_add_u32 m0, s48, 65536
TR 210,34,36864
MA 160,196,116
DM 12,16,53,0
MA 160,192,100
MA 192,192,104
TR 212,34,40960
MA 192,196,120
TR 214,34,45056
MA 224,196,124
DM 13,16,53,1024
MA 224,192,108
WL 4
MA 228,200,108
TR 216,35,32768
MA 228,204,124
TR 218,35,36864
MA 196,204,120
DM 14,16,53,2048
MA 196,200,104
MA 164,200,100
TR 220,35,40960
MA 164,204,116
TR 222,35,45056
MA 132,204,112
MA 132,200,96
buffer_load_dword v61, v60, s[84:87], s77 offen
WL 4
MA 136,208,96
TR 192,36,32768
MA 136,212,112
TR 194,36,36864
MA 168,212,116
DM 15,16,53,3072
MA 168,208,100
s_add_u32 s53, s53, 524288
MA 200,208,104
TR 196,36,40960
MA 200,212,120
TR 198,36,45056
MA 232,212,124
XL 64,5,4,51,0
MA 232,208,108
WL 4
MA 236,216,108
TR 200,37,32768
MA 236,220,124
TR 202,37,36864
MA 204,220,120
XL 68,5,4,51,128
MA 204,216,104
MA 172,216,100
TR 204,37,40960
MA 172,220,116
TR 206,37,45056
MA 140,220,112
MA 140,216,96
WL 4
MA 144,192,96
TR 208,38,32768
MA 144,196,112
TR 210,38,36864
MA 176,196,116
XL 72,5,4,51,256
MA 176,192,100
MA 208,192,104
TR 212,38,40960
MA 208,196,120
TR 214,38,45056
MA 240,196,124
XL 76,5,4,51,384
MA 240,192,108
s_add_u32 s51, s51, 4096
WL 4
MA 244,200,108
TR 216,39,32768
MA 244,204,124
TR 218,39,36864
MA 212,204,120
XL 80,5,4,51,0
MA 212,200,104
MA 180,200,100
TR 220,39,40960
MA 180,204,116
TR 222,39,45056
MA 148,204,112
MA 148,200,96
WL 4
MA 152,208,96
MA 152,212,112
MA 184,212,116
XL 84,5,4,51,128
MA 184,208,100
s_waitcnt vmcnt(31) lgkmcnt(0)
s_barrier
MA 216,208,104
TR 192,24,0
MA 216,212,120
TR 194,24,4096
MA 248,212,124
XL 88,5,4,51,256
TR 196,24,8192
MA 248,208,108
TR 198,24,12288
MA 252,216,108
TR 200,25,0
MA 252,220,124
TR 202,25,4096
MA 220,220,120
XL 92,5,4,51,384
MA 220,216,104
s_add_u32 s51, s51, 4096
MA 188,216,100
TR 204,25,8192
MA 188,220,116
TR 206,25,12288
MA 156,220,112
MA 156,216,96
s_sub_u32 s47, s47, 1
s_cbranch_scc0 t1_L9
s_waitcnt vmcnt(25) lgkmcnt(4)
MA 128,192,0
TR 208,26,0
MA 128,196,16
s_add_u32 m0, s48, 98304
TR 210,26,4096
MA 160,196,20
DM 12,16,53,0
MA 160,192,4
MA 192,192,8
TR 212,26,8192
MA 192,196,24
TR 214,26,12288
MA 224,196,28
DM 13,16,53,1024
MA 224,192,12
WL 4
MA 228,200,12
TR 216,27,0
MA 228,204,28
TR 218,27,4096
MA 196,204,24
DM 14,16,53,2048
MA 196,200,8
MA 164,200,4
TR 220,27,8192
MA 164,204,20
TR 222,27,12288
MA 132,204,16
MA 132,200,0
WL 4
MA 136,208,0
TR 192,28,0
MA 136,212,16
TR 194,28,4096
MA 168,212,20
DM 15,16,53,3072
MA 168,208,4
s_add_u32 s53, s53, 524288
MA 200,208,8
TR 196,28,8192
MA 200,212,24
TR 198,28,12288
MA 232,212,28
XL 96,5,4,51,0
MA 232,208,12
WL 4
MA 236,216,12
TR 200,29,0
MA 236,220,28
TR 202,29,4096
MA 204,220,24
XL 100,5,4,51,128
MA 204,216,8
MA 172,216,4
TR 204,29,8192
MA 172,220,20
TR 206,29,12288
MA 140,220,16
MA 140,216,0
WL 4
MA 144,192,0
TR 208,30,0
MA 144,196,16
TR 210,30,4096
MA 176,196,20
XL 104,5,4,51,256
MA 176,192,4
s_lshr_b32 s81, s82, 1
MA 208,192,8
TR 212,30,8192
MA 208,196,24
TR 214,30,12288
MA 240,196,28
XL 108,5,4,51,384
MA 240,192,12
s_add_u32 s51, s51, 4096
s_mul_i32 s81, s81, 7168
WL 4
MA 244,200,12
TR 216,31,0
MA 244,204,28
TR 218,31,4096
MA 212,204,24
XL 112,5,4,51,0
MA 212,200,8
s_and_b32 s65, s82, 1
MA 180,200,4
TR 220,31,8192
MA 180,204,20
TR 222,31,12288
MA 148,204,16
MA 148,200,0
s_mul_i32 s65, s65, 1536
WL 4
MA 152,208,0
MA 152,212,16
MA 184,212,20
XL 116,5,4,51,128
MA 184,208,4
s_add_u32 s81, s81, s65
s_waitcnt vmcnt(31) lgkmcnt(0)
s_barrier
MA 216,208,8
TR 192,24,32768
MA 216,212,24
TR 194,24,36864
MA 248,212,28
XL 120,5,4,51,256
TR 196,24,40960
MA 248,208,12
TR 198,24,45056
MA 252,216,12
TR 200,25,32768
MA 252,220,28
TR 202,25,36864
MA 220,220,24
XL 124,5,4,51,384
MA 220,216,8
s_add_u32 s51, s51, 4096
MA 188,216,4
TR 204,25,40960
MA 188,220,20
TR 206,25,45056
MA 156,220,16
MA 156,216,0
s_waitcnt vmcnt(25) lgkmcnt(4)
MA 128,192,32
TR 208,26,32768
MA 128,196,48
s_add_u32 m0, s48, 0
TR 210,26,36864
MA 160,196,52
DM 8,20,52,0
MA 160,192,36
MA 192,192,40
TR 212,26,40960
MA 192,196,56
TR 214,26,45056
MA 224,196,60
MA 224,192,44
WL 4
MA 228,200,44
TR 216,27,32768
MA 228,204,60
TR 218,27,36864
MA 196,204,56
DM 9,20,52,1024
MA 196,200,40
MA 164,200,36
TR 220,27,40960
MA 164,204,52
TR 222,27,45056
MA 132,204,48
MA 132,200,32
WL 4
MA 136,208,32
TR 192,28,32768
MA 136,212,48
TR 194,28,36864
MA 168,212,52
DM 10,20,52,2048
MA 168,208,36
MA 200,208,40
TR 196,28,40960
MA 200,212,56
TR 198,28,45056
MA 232,212,60
MA 232,208,44
WL 4
MA 236,216,44
TR 200,29,32768
MA 236,220,60
TR 202,29,36864
MA 204,220,56
DM 11,20,52,3072
MA 204,216,40
MA 172,216,36
TR 204,29,40960
MA 172,220,52
TR 206,29,45056
MA 140,220,48
MA 140,216,32
WL 4
MA 144,192,32
TR 208,30,32768
MA 144,196,48
s_add_u32 m0, s48, 16384
TR 210,30,36864
MA 176,196,52
DM 16,24,52,0
MA 176,192,36
MA 208,192,40
TR 212,30,40960
MA 208,196,56
TR 214,30,45056
MA 240,196,60
MA 240,192,44
WL 4
MA 244,200,44
TR 216,31,32768
MA 244,204,60
TR 218,31,36864
MA 212,204,56
DM 4,24,52,1024
MA 212,200,40
MA 180,200,36
TR 220,31,40960
MA 180,204,52
TR 222,31,45056
MA 148,204,48
MA 148,200,32
WL 4
MA 152,208,32
MA 152,212,48
MA 184,212,52
DM 16,24,52,2048
MA 184,208,36
s_waitcnt vmcnt(27) lgkmcnt(0)
s_barrier
MA 216,208,40
TR 192,32,0
MA 216,212,56
TR 194,32,4096
MA 248,212,60
TR 196,32,8192
MA 248,208,44
TR 198,32,12288
MA 252,216,44
TR 200,33,0
MA 252,220,60
TR 202,33,4096
MA 220,220,56
DM 4,24,52,3072
MA 220,216,40
s_add_u32 s52, s52, 16384
MA 188,216,36
TR 204,33,8192
MA 188,220,52
TR 206,33,12288
MA 156,220,48
MA 156,216,32
s_waitcnt vmcnt(20) lgkmcnt(4)
MA 128,192,64
TR 208,34,0
MA 128,196,80
s_add_u32 m0, s48, 32768
TR 210,34,4096
MA 160,196,84
DM 8,20,52,0
MA 160,192,68
MA 192,192,72
TR 212,34,8192
MA 192,196,88
TR 214,34,12288
MA 224,196,92
MA 224,192,76
WL 4
MA 228,200,76
TR 216,35,0
MA 228,204,92
TR 218,35,4096
MA 196,204,88
DM 9,20,52,1024
MA 196,200,72
MA 164,200,68
TR 220,35,8192
MA 164,204,84
TR 222,35,12288
MA 132,204,80
MA 132,200,64
WL 4
MA 136,208,64
TR 192,36,0
MA 136,212,80
TR 194,36,4096
MA 168,212,84
DM 10,20,52,2048
MA 168,208,68
MA 200,208,72
TR 196,36,8192
MA 200,212,88
TR 198,36,12288
MA 232,212,92
MA 232,208,76
WL 4
MA 236,216,76
TR 200,37,0
MA 236,220,92
TR 202,37,4096
MA 204,220,88
DM 11,20,52,3072
MA 204,216,72
MA 172,216,68
TR 204,37,8192
MA 172,220,84
TR 206,37,12288
MA 140,220,80
MA 140,216,64
WL 4
MA 144,192,64
TR 208,38,0
MA 144,196,80
s_add_u32 m0, s48, 49152
TR 210,38,4096
MA 176,196,84
DM 16,24,52,0
MA 176,192,68
v_xor_b32 v24, 0, v1
MA 208,192,72
TR 212,38,8192
MA 208,196,88
TR 214,38,12288
MA 240,196,92
MA 240,192,76
v_xor_b32 v25, 32, v1
WL 4
MA 244,200,76
TR 216,39,0
MA 244,204,92
TR 218,39,4096
MA 212,204,88
DM 4,24,52,1024
MA 212,200,72
v_xor_b32 v26, 64, v1
MA 180,200,68
TR 220,39,8192
MA 180,204,84
TR 222,39,12288
MA 148,204,80
MA 148,200,64
v_xor_b32 v27, 96, v1
WL 4
MA 152,208,64
MA 152,212,80
MA 184,212,84
DM 16,24,52,2048
MA 184,208,68
v_xor_b32 v28, 128, v1
s_waitcnt vmcnt(23) lgkmcnt(0)
s_barrier
MA 216,208,72
TR 192,32,32768
MA 216,212,88
TR 194,32,36864
MA 248,212,92
TR 196,32,40960
MA 248,208,76
TR 198,32,45056
v_xor_b32 v29, 160, v1
MA 252,216,76
TR 200,33,32768
MA 252,220,92
TR 202,33,36864
MA 220,220,88
DM 4,24,52,3072
MA 220,216,72
s_add_u32 s52, s52, 16384
v_xor_b32 v30, 192, v1
MA 188,216,68
TR 204,33,40960
MA 188,220,84
TR 206,33,45056
MA 156,220,80
MA 156,216,64
v_xor_b32 v31, 224, v1
s_waitcnt vmcnt(16) lgkmcnt(4)
MA 128,192,96
TR 208,34,32768
MA 128,196,112
s_add_u32 m0, s48, 65536
TR 210,34,36864
MA 160,196,116
DM 8,20,52,0
MA 160,192,100
v_xor_b32 v40, 0, v3
MA 192,192,104
TR 212,34,40960
MA 192,196,120
TR 214,34,45056
MA 224,196,124
MA 224,192,108
v_xor_b32 v41, 64, v3
WL 4
MA 228,200,108
TR 216,35,32768
MA 228,204,124
TR 218,35,36864
MA 196,204,120
DM 9,20,52,1024
MA 196,200,104
v_xor_b32 v42, 128, v3
MA 164,200,100
TR 220,35,40960
MA 164,204,116
TR 222,35,45056
MA 132,204,112
MA 132,200,96
v_xor_b32 v43, 192, v3
buffer_load_dword v61, v60, s[84:87], s77 offen
WL 4
MA 136,208,96
TR 192,36,32768
MA 136,212,112
TR 194,36,36864
MA 168,212,116
DM 10,20,52,2048
MA 168,208,100
MA 200,208,104
TR 196,36,40960
MA 200,212,120
TR 198,36,45056
MA 232,212,124
MA 232,208,108
WL 4
MA 236,216,108
TR 200,37,32768
MA 236,220,124
TR 202,37,36864
MA 204,220,120
DM 11,20,52,3072
MA 204,216,104
MA 172,216,100
TR 204,37,40960
MA 172,220,116
TR 206,37,45056
MA 140,220,112
MA 140,216,96
WL 4
MA 144,192,96
TR 208,38,32768
MA 144,196,112
s_add_u32 m0, s48, 81920
TR 210,38,36864
MA 176,196,116
DM 16,24,52,0
MA 176,192,100
MA 208,192,104
TR 212,38,40960
MA 208,196,120
TR 214,38,45056
MA 240,196,124
MA 240,192,108
WL 4
MA 244,200,108
TR 216,39,32768
MA 244,204,124
TR 218,39,36864
MA 212,204,120
DM 4,24,52,1024
MA 212,200,104
MA 180,200,100
TR 220,39,40960
MA 180,204,116
TR 222,39,45056
MA 148,204,112
MA 148,200,96
WL 4
MA 152,208,96
MA 152,212,112
MA 184,212,116
DM 16,24,52,2048
MA 184,208,100
s_waitcnt vmcnt(16) lgkmcnt(0)
s_barrier
MA 216,208,104
ds_read_b128 a[192:195], v40 offset:0
MA 216,212,120
ds_read_b128 a[196:199], v41 offset:0
MA 248,212,124
MA 248,208,108
MA 252,216,108
ds_read_b128 a[200:203], v42 offset:0
MA 252,220,124
ds_read_b128 a[204:207], v43 offset:0
MA 220,220,120
DM 4,24,52,3072
MA 220,216,104
s_add_u32 s52, s52, 16384
MA 188,216,100
MA 188,220,116
MA 156,220,112
MA 156,216,96
v_mov_b32 v48, 0x3e0293ee
v_pk_mul_f32 v[128:129], v[128:129], v[48:49] op_sel_hi:[1,0]
v_pk_mul_f32 v[130:131], v[130:131], v[48:49] op_sel_hi:[1,0]
v_pk_mul_f32 v[132:133], v[132:133], v[48:49] op_sel_hi:[1,0]
v_pk_mul_f32 v[134:135], v[134:135], v[48:49] op_sel_hi:[1,0]
v_cvt_pk_bf16_f32 v64, v128, v129
v_cvt_pk_bf16_f32 v65, v130, v131
v_cvt_pk_bf16_f32 v66, v132, v133
v_cvt_pk_bf16_f32 v67, v134, v135
v_pk_mul_f32 v[136:137], v[136:137], v[48:49] op_sel_hi:[1,0]
v_pk_mul_f32 v[138:139], v[138:139], v[48:49] op_sel_hi:[1,0]
v_pk_mul_f32 v[140:141], v[140:141], v[48:49] op_sel_hi:[1,0]
v_pk_mul_f32 v[142:143], v[142:143], v[48:49] op_sel_hi:[1,0]
v_cvt_pk_bf16_f32 v68, v136, v137
v_cvt_pk_bf16_f32 v69, v138, v139
v_cvt_pk_bf16_f32 v70, v140, v141
v_cvt_pk_bf16_f32 v71, v142, v143
v_permlane16_swap_b32 v64, v66
v_permlane16_swap_b32 v65, v67
v_permlane16_swap_b32 v68, v70
v_permlane16_swap_b32 v69, v71
v_pk_mul_f32 v[144:145], v[144:145], v[48:49] op_sel_hi:[1,0]
v_pk_mul_f32 v[146:147], v[146:147], v[48:49] op_sel_hi:[1,0]
v_pk_mul_f32 v[148:149], v[148:149], v[48:49] op_sel_hi:[1,0]
v_pk_mul_f32 v[150:151], v[150:151], v[48:49] op_sel_hi:[1,0]
v_cvt_pk_bf16_f32 v72, v144, v145
v_cvt_pk_bf16_f32 v73, v146, v147
v_cvt_pk_bf16_f32 v74, v148, v149
v_cvt_pk_bf16_f32 v75, v150, v151
v_pk_mul_f32 v[152:153], v[152:153], v[48:49] op_sel_hi:[1,0]
v_pk_mul_f32 v[154:155], v[154:155], v[48:49] op_sel_hi:[1,0]
v_pk_mul_f32 v[156:157], v[156:157], v[48:49] op_sel_hi:[1,0]
v_pk_mul_f32 v[158:159], v[158:159], v[48:49] op_sel_hi:[1,0]
v_cvt_pk_bf16_f32 v76, v152, v153
v_cvt_pk_bf16_f32 v77, v154, v155
v_cvt_pk_bf16_f32 v78, v156, v157
v_cvt_pk_bf16_f32 v79, v158, v159
v_permlane16_swap_b32 v72, v74
v_permlane16_swap_b32 v73, v75
v_permlane16_swap_b32 v76, v78
v_permlane16_swap_b32 v77, v79
v_pk_mul_f32 v[160:161], v[160:161], v[48:49] op_sel_hi:[1,0]
v_pk_mul_f32 v[162:163], v[162:163], v[48:49] op_sel_hi:[1,0]
v_pk_mul_f32 v[164:165], v[164:165], v[48:49] op_sel_hi:[1,0]
v_pk_mul_f32 v[166:167], v[166:167], v[48:49] op_sel_hi:[1,0]
v_cvt_pk_bf16_f32 v80, v160, v161
v_cvt_pk_bf16_f32 v81, v162, v163
v_cvt_pk_bf16_f32 v82, v164, v165
v_cvt_pk_bf16_f32 v83, v166, v167
v_pk_mul_f32 v[168:169], v[168:169], v[48:49] op_sel_hi:[1,0]
v_pk_mul_f32 v[170:171], v[170:171], v[48:49] op_sel_hi:[1,0]
v_pk_mul_f32 v[172:173], v[172:173], v[48:49] op_sel_hi:[1,0]
v_pk_mul_f32 v[174:175], v[174:175], v[48:49] op_sel_hi:[1,0]
v_cvt_pk_bf16_f32 v84, v168, v169
v_cvt_pk_bf16_f32 v85, v170, v171
v_cvt_pk_bf16_f32 v86, v172, v173
v_cvt_pk_bf16_f32 v87, v174, v175
v_permlane16_swap_b32 v80, v82
v_permlane16_swap_b32 v81, v83
v_permlane16_swap_b32 v84, v86
v_permlane16_swap_b32 v85, v87
v_pk_mul_f32 v[176:177], v[176:177], v[48:49] op_sel_hi:[1,0]
v_pk_mul_f32 v[178:179], v[178:179], v[48:49] op_sel_hi:[1,0]
v_pk_mul_f32 v[180:181], v[180:181], v[48:49] op_sel_hi:[1,0]
v_pk_mul_f32 v[182:183], v[182:183], v[48:49] op_sel_hi:[1,0]
v_cvt_pk_bf16_f32 v88, v176, v177
v_cvt_pk_bf16_f32 v89, v178, v179
v_cvt_pk_bf16_f32 v90, v180, v181
v_cvt_pk_bf16_f32 v91, v182, v183
v_pk_mul_f32 v[184:185], v[184:185], v[48:49] op_sel_hi:[1,0]
v_pk_mul_f32 v[186:187], v[186:187], v[48:49] op_sel_hi:[1,0]
v_pk_mul_f32 v[188:189], v[188:189], v[48:49] op_sel_hi:[1,0]
v_pk_mul_f32 v[190:191], v[190:191], v[48:49] op_sel_hi:[1,0]
v_cvt_pk_bf16_f32 v92, v184, v185
v_cvt_pk_bf16_f32 v93, v186, v187
v_cvt_pk_bf16_f32 v94, v188, v189
v_cvt_pk_bf16_f32 v95, v190, v191
v_permlane16_swap_b32 v88, v90
v_permlane16_swap_b32 v89, v91
v_permlane16_swap_b32 v92, v94
v_permlane16_swap_b32 v93, v95
v_pk_mul_f32 v[192:193], v[192:193], v[48:49] op_sel_hi:[1,0]
v_pk_mul_f32 v[194:195], v[194:195], v[48:49] op_sel_hi:[1,0]
v_pk_mul_f32 v[196:197], v[196:197], v[48:49] op_sel_hi:[1,0]
v_pk_mul_f32 v[198:199], v[198:199], v[48:49] op_sel_hi:[1,0]
v_cvt_pk_bf16_f32 v96, v192, v193
v_cvt_pk_bf16_f32 v97, v194, v195
v_cvt_pk_bf16_f32 v98, v196, v197
v_cvt_pk_bf16_f32 v99, v198, v199
v_pk_mul_f32 v[200:201], v[200:201], v[48:49] op_sel_hi:[1,0]
v_pk_mul_f32 v[202:203], v[202:203], v[48:49] op_sel_hi:[1,0]
v_pk_mul_f32 v[204:205], v[204:205], v[48:49] op_sel_hi:[1,0]
v_pk_mul_f32 v[206:207], v[206:207], v[48:49] op_sel_hi:[1,0]
v_cvt_pk_bf16_f32 v100, v200, v201
v_cvt_pk_bf16_f32 v101, v202, v203
v_cvt_pk_bf16_f32 v102, v204, v205
v_cvt_pk_bf16_f32 v103, v206, v207
v_permlane16_swap_b32 v96, v98
v_permlane16_swap_b32 v97, v99
v_permlane16_swap_b32 v100, v102
v_permlane16_swap_b32 v101, v103
v_pk_mul_f32 v[208:209], v[208:209], v[48:49] op_sel_hi:[1,0]
v_pk_mul_f32 v[210:211], v[210:211], v[48:49] op_sel_hi:[1,0]
v_pk_mul_f32 v[212:213], v[212:213], v[48:49] op_sel_hi:[1,0]
v_pk_mul_f32 v[214:215], v[214:215], v[48:49] op_sel_hi:[1,0]
v_cvt_pk_bf16_f32 v104, v208, v209
v_cvt_pk_bf16_f32 v105, v210, v211
v_cvt_pk_bf16_f32 v106, v212, v213
v_cvt_pk_bf16_f32 v107, v214, v215
v_pk_mul_f32 v[216:217], v[216:217], v[48:49] op_sel_hi:[1,0]
v_pk_mul_f32 v[218:219], v[218:219], v[48:49] op_sel_hi:[1,0]
v_pk_mul_f32 v[220:221], v[220:221], v[48:49] op_sel_hi:[1,0]
v_pk_mul_f32 v[222:223], v[222:223], v[48:49] op_sel_hi:[1,0]
v_cvt_pk_bf16_f32 v108, v216, v217
v_cvt_pk_bf16_f32 v109, v218, v219
v_cvt_pk_bf16_f32 v110, v220, v221
v_cvt_pk_bf16_f32 v111, v222, v223
v_permlane16_swap_b32 v104, v106
v_permlane16_swap_b32 v105, v107
v_permlane16_swap_b32 v108, v110
v_permlane16_swap_b32 v109, v111
v_pk_mul_f32 v[224:225], v[224:225], v[48:49] op_sel_hi:[1,0]
v_pk_mul_f32 v[226:227], v[226:227], v[48:49] op_sel_hi:[1,0]
v_pk_mul_f32 v[228:229], v[228:229], v[48:49] op_sel_hi:[1,0]
v_pk_mul_f32 v[230:231], v[230:231], v[48:49] op_sel_hi:[1,0]
v_cvt_pk_bf16_f32 v112, v224, v225
v_cvt_pk_bf16_f32 v113, v226, v227
v_cvt_pk_bf16_f32 v114, v228, v229
v_cvt_pk_bf16_f32 v115, v230, v231
v_pk_mul_f32 v[232:233], v[232:233], v[48:49] op_sel_hi:[1,0]
v_pk_mul_f32 v[234:235], v[234:235], v[48:49] op_sel_hi:[1,0]
v_pk_mul_f32 v[236:237], v[236:237], v[48:49] op_sel_hi:[1,0]
v_pk_mul_f32 v[238:239], v[238:239], v[48:49] op_sel_hi:[1,0]
v_cvt_pk_bf16_f32 v116, v232, v233
v_cvt_pk_bf16_f32 v117, v234, v235
v_cvt_pk_bf16_f32 v118, v236, v237
v_cvt_pk_bf16_f32 v119, v238, v239
v_permlane16_swap_b32 v112, v114
v_permlane16_swap_b32 v113, v115
v_permlane16_swap_b32 v116, v118
v_permlane16_swap_b32 v117, v119
v_pk_mul_f32 v[240:241], v[240:241], v[48:49] op_sel_hi:[1,0]
v_pk_mul_f32 v[242:243], v[242:243], v[48:49] op_sel_hi:[1,0]
v_pk_mul_f32 v[244:245], v[244:245], v[48:49] op_sel_hi:[1,0]
v_pk_mul_f32 v[246:247], v[246:247], v[48:49] op_sel_hi:[1,0]
v_cvt_pk_bf16_f32 v120, v240, v241
v_cvt_pk_bf16_f32 v121, v242, v243
v_cvt_pk_bf16_f32 v122, v244, v245
v_cvt_pk_bf16_f32 v123, v246, v247
v_pk_mul_f32 v[248:249], v[248:249], v[48:49] op_sel_hi:[1,0]
v_pk_mul_f32 v[250:251], v[250:251], v[48:49] op_sel_hi:[1,0]
v_pk_mul_f32 v[252:253], v[252:253], v[48:49] op_sel_hi:[1,0]
v_pk_mul_f32 v[254:255], v[254:255], v[48:49] op_sel_hi:[1,0]
v_cvt_pk_bf16_f32 v124, v248, v249
v_cvt_pk_bf16_f32 v125, v250, v251
v_cvt_pk_bf16_f32 v126, v252, v253
v_cvt_pk_bf16_f32 v127, v254, v255
v_permlane16_swap_b32 v120, v122
v_permlane16_swap_b32 v121, v123
v_permlane16_swap_b32 v124, v126
v_permlane16_swap_b32 v125, v127
v_mov_b32 v48, 0x3f803f80
v_accvgpr_write_b32 a240, v48
v_accvgpr_write_b32 a241, v48
v_accvgpr_write_b32 a242, v48
v_accvgpr_write_b32 a243, v48
WL 0
v_mfma_f32_16x16x32_bf16 v[128:131], a[192:195], v[64:67], 0
ds_read_b128 a[224:227], v40 offset:4096
v_mfma_f32_16x16x32_bf16 v[128:131], a[196:199], v[68:71], v[128:131]
ds_read_b128 a[228:231], v41 offset:4096
v_mfma_f32_16x16x32_bf16 v[128:131], a[200:203], v[72:75], v[128:131]
ds_read_b128 a[232:235], v42 offset:4096
s_add_u32 m0, s48, 98304
s_nop 0
DM 8,20,52,0
v_mfma_f32_16x16x32_bf16 v[128:131], a[204:207], v[76:79], v[128:131]
ds_read_b128 a[236:239], v43 offset:4096
v_mfma_f32_16x16x32_bf16 v[136:139], a[204:207], v[92:95], 0
v_mfma_f32_16x16x32_bf16 v[136:139], a[200:203], v[88:91], v[136:139]
v_xor_b32 v32, 65536, v1
v_xor_b32 v33, 65568, v1
v_mfma_f32_16x16x32_bf16 v[136:139], a[196:199], v[84:87], v[136:139]
DM 9,20,52,1024
v_mfma_f32_16x16x32_bf16 v[136:139], a[192:195], v[80:83], v[136:139]
v_mfma_f32_16x16x32_bf16 v[144:147], a[192:195], v[96:99], 0
v_mfma_f32_16x16x32_bf16 v[144:147], a[196:199], v[100:103], v[144:147]
v_xor_b32 v34, 65600, v1
v_xor_b32 v35, 65632, v1
v_mfma_f32_16x16x32_bf16 v[144:147], a[200:203], v[104:107], v[144:147]
DM 10,20,52,2048
v_mfma_f32_16x16x32_bf16 v[144:147], a[204:207], v[108:111], v[144:147]
v_mfma_f32_16x16x32_bf16 v[152:155], a[204:207], v[124:127], 0
v_mfma_f32_16x16x32_bf16 v[152:155], a[200:203], v[120:123], v[152:155]
v_xor_b32 v36, 65664, v1
v_xor_b32 v37, 65696, v1
v_mfma_f32_16x16x32_bf16 v[152:155], a[196:199], v[116:119], v[152:155]
DM 11,20,52,3072
v_mfma_f32_16x16x32_bf16 v[152:155], a[192:195], v[112:115], v[152:155]
WL 0
v_mfma_f32_16x16x32_bf16 v[132:135], a[224:227], v[64:67], 0
ds_read_b128 a[192:195], v40 offset:8192
v_mfma_f32_16x16x32_bf16 v[132:135], a[228:231], v[68:71], v[132:135]
ds_read_b128 a[196:199], v41 offset:8192
v_xor_b32 v38, 65728, v1
v_xor_b32 v39, 65760, v1
v_mfma_f32_16x16x32_bf16 v[132:135], a[232:235], v[72:75], v[132:135]
ds_read_b128 a[200:203], v42 offset:8192
s_add_u32 m0, s48, 114688
s_nop 0
DM 16,24,52,0
v_mfma_f32_16x16x32_bf16 v[132:135], a[236:239], v[76:79], v[132:135]
ds_read_b128 a[204:207], v43 offset:8192
v_mfma_f32_16x16x32_bf16 v[140:143], a[236:239], v[92:95], 0
v_mfma_f32_16x16x32_bf16 v[140:143], a[232:235], v[88:91], v[140:143]
v_xor_b32 v44, 65536, v3
v_xor_b32 v45, 65600, v3
v_mfma_f32_16x16x32_bf16 v[140:143], a[228:231], v[84:87], v[140:143]
DM 4,24,52,1024
v_mfma_f32_16x16x32_bf16 v[140:143], a[224:227], v[80:83], v[140:143]
v_mfma_f32_16x16x32_bf16 v[148:151], a[224:227], v[96:99], 0
v_mfma_f32_16x16x32_bf16 v[148:151], a[228:231], v[100:103], v[148:151]
v_xor_b32 v46, 65664, v3
v_xor_b32 v47, 65728, v3
v_mfma_f32_16x16x32_bf16 v[148:151], a[232:235], v[104:107], v[148:151]
DM 16,24,52,2048
v_mfma_f32_16x16x32_bf16 v[148:151], a[236:239], v[108:111], v[148:151]
v_mfma_f32_16x16x32_bf16 v[156:159], a[236:239], v[124:127], 0
v_mfma_f32_16x16x32_bf16 v[156:159], a[232:235], v[120:123], v[156:159]
v_mfma_f32_16x16x32_bf16 v[156:159], a[228:231], v[116:119], v[156:159]
DM 4,24,52,3072
s_add_u32 s52, s52, 16384
v_mfma_f32_16x16x32_bf16 v[156:159], a[224:227], v[112:115], v[156:159]
v_max3_f32 v52, v128, v129, v130
v_max3_f32 v53, v136, v137, v138
v_max3_f32 v54, v144, v145, v146
v_max3_f32 v55, v152, v153, v154
v_max3_f32 v52, v52, v131, v132
v_max3_f32 v53, v53, v139, v140
v_max3_f32 v54, v54, v147, v148
s_nop 0
v_max3_f32 v55, v55, v155, v156
v_max3_f32 v52, v52, v133, v134
v_max3_f32 v53, v53, v141, v142
v_max3_f32 v54, v54, v149, v150
v_max3_f32 v55, v55, v157, v158
v_max_f32 v52, v52, v135
v_max_f32 v53, v53, v143
v_max_f32 v54, v54, v151
v_max_f32 v55, v55, v159
v_mov_b32 v208, v52
v_mov_b32 v209, v53
v_mov_b32 v210, v54
v_mov_b32 v211, v55
v_permlane16_swap_b32 v52, v208
v_permlane16_swap_b32 v53, v209
v_permlane16_swap_b32 v54, v210
v_permlane16_swap_b32 v55, v211
v_max_f32 v52, v52, v208
v_max_f32 v53, v53, v209
v_max_f32 v54, v54, v210
v_max_f32 v55, v55, v211
v_mov_b32 v208, v52
v_mov_b32 v209, v53
v_mov_b32 v210, v54
v_mov_b32 v211, v55
v_permlane32_swap_b32 v52, v208
v_permlane32_swap_b32 v53, v209
v_permlane32_swap_b32 v54, v210
v_permlane32_swap_b32 v55, v211
v_max_f32 v52, v52, v208
v_max_f32 v53, v53, v209
v_max_f32 v54, v54, v210
v_max_f32 v55, v55, v211
v_sub_f32 v192, 0, v52
v_sub_f32 v196, 0, v53
v_sub_f32 v200, 0, v54
v_sub_f32 v204, 0, v55
v_sub_f32 v193, 0, v52
v_sub_f32 v197, 0, v53
v_sub_f32 v201, 0, v54
v_sub_f32 v205, 0, v55
v_sub_f32 v194, 0, v52
v_sub_f32 v198, 0, v53
v_sub_f32 v202, 0, v54
v_sub_f32 v206, 0, v55
v_sub_f32 v195, 0, v52
v_sub_f32 v199, 0, v53
v_sub_f32 v203, 0, v54
v_sub_f32 v207, 0, v55
WL 0
v_mfma_f32_16x16x32_bf16 v[160:163], a[192:195], v[64:67], v[192:195]
v_sub_f32 v128, v128, v52
v_sub_f32 v129, v129, v52
v_exp_f32 v128, v128
v_mfma_f32_16x16x32_bf16 v[160:163], a[196:199], v[68:71], v[160:163]
ds_read_b128 a[224:227], v40 offset:12288
v_exp_f32 v129, v129
v_sub_f32 v130, v130, v52
v_mfma_f32_16x16x32_bf16 v[160:163], a[200:203], v[72:75], v[160:163]
v_sub_f32 v131, v131, v52
v_exp_f32 v130, v130
v_exp_f32 v131, v131
v_mfma_f32_16x16x32_bf16 v[160:163], a[204:207], v[76:79], v[160:163]
ds_read_b128 a[228:231], v41 offset:12288
v_sub_f32 v136, v136, v53
v_sub_f32 v137, v137, v53
v_exp_f32 v136, v136
v_mfma_f32_16x16x32_bf16 v[168:171], a[204:207], v[92:95], v[196:199]
v_exp_f32 v137, v137
v_sub_f32 v138, v138, v53
v_sub_f32 v139, v139, v53
v_mfma_f32_16x16x32_bf16 v[168:171], a[200:203], v[88:91], v[168:171]
ds_read_b128 a[232:235], v42 offset:12288
v_exp_f32 v138, v138
v_exp_f32 v139, v139
v_mfma_f32_16x16x32_bf16 v[168:171], a[196:199], v[84:87], v[168:171]
v_sub_f32 v144, v144, v54
v_sub_f32 v145, v145, v54
v_exp_f32 v144, v144
v_cvt_pk_bf16_f32 v224, v128, v129
v_mfma_f32_16x16x32_bf16 v[168:171], a[192:195], v[80:83], v[168:171]
ds_read_b128 a[236:239], v43 offset:12288
v_exp_f32 v145, v145
v_sub_f32 v146, v146, v54
v_sub_f32 v147, v147, v54
v_mfma_f32_16x16x32_bf16 v[176:179], a[192:195], v[96:99], v[200:203]
v_exp_f32 v146, v146
v_exp_f32 v147, v147
v_sub_f32 v152, v152, v55
v_mfma_f32_16x16x32_bf16 v[176:179], a[196:199], v[100:103], v[176:179]
v_sub_f32 v153, v153, v55
v_exp_f32 v152, v152
v_exp_f32 v153, v153
v_mfma_f32_16x16x32_bf16 v[176:179], a[200:203], v[104:107], v[176:179]
v_sub_f32 v154, v154, v55
v_sub_f32 v155, v155, v55
v_exp_f32 v154, v154
v_exp_f32 v155, v155
v_mfma_f32_16x16x32_bf16 v[176:179], a[204:207], v[108:111], v[176:179]
v_sub_f32 v132, v132, v52
v_sub_f32 v133, v133, v52
v_exp_f32 v132, v132
v_cvt_pk_bf16_f32 v225, v130, v131
v_mfma_f32_16x16x32_bf16 v[184:187], a[204:207], v[124:127], v[204:207]
v_exp_f32 v133, v133
v_sub_f32 v134, v134, v52
v_sub_f32 v135, v135, v52
v_cvt_pk_bf16_f32 v228, v136, v137
v_mfma_f32_16x16x32_bf16 v[184:187], a[200:203], v[120:123], v[184:187]
v_exp_f32 v134, v134
v_exp_f32 v135, v135
v_sub_f32 v140, v140, v53
v_mfma_f32_16x16x32_bf16 v[184:187], a[196:199], v[116:119], v[184:187]
v_sub_f32 v141, v141, v53
v_exp_f32 v140, v140
v_exp_f32 v141, v141
v_mfma_f32_16x16x32_bf16 v[184:187], a[192:195], v[112:115], v[184:187]
v_sub_f32 v142, v142, v53
v_sub_f32 v143, v143, v53
v_exp_f32 v142, v142
v_cvt_pk_bf16_f32 v229, v138, v139
WL 0
v_mfma_f32_16x16x32_bf16 v[164:167], a[224:227], v[64:67], v[192:195]
v_exp_f32 v143, v143
v_sub_f32 v148, v148, v54
v_sub_f32 v149, v149, v54
v_cvt_pk_bf16_f32 v232, v144, v145
v_mfma_f32_16x16x32_bf16 v[164:167], a[228:231], v[68:71], v[164:167]
v_exp_f32 v148, v148
v_exp_f32 v149, v149
v_sub_f32 v150, v150, v54
v_mfma_f32_16x16x32_bf16 v[164:167], a[232:235], v[72:75], v[164:167]
v_sub_f32 v151, v151, v54
v_exp_f32 v150, v150
v_exp_f32 v151, v151
v_mfma_f32_16x16x32_bf16 v[164:167], a[236:239], v[76:79], v[164:167]
v_sub_f32 v156, v156, v55
v_sub_f32 v157, v157, v55
v_exp_f32 v156, v156
v_cvt_pk_bf16_f32 v233, v146, v147
v_mfma_f32_16x16x32_bf16 v[172:175], a[236:239], v[92:95], v[196:199]
TR 208,24,16384
v_exp_f32 v157, v157
v_sub_f32 v158, v158, v55
v_cvt_pk_bf16_f32 v236, v152, v153
v_mfma_f32_16x16x32_bf16 v[172:175], a[232:235], v[88:91], v[172:175]
TR 210,24,20480
v_cvt_pk_bf16_f32 v237, v154, v155
v_sub_f32 v159, v159, v55
v_cvt_pk_bf16_f32 v226, v132, v133
v_cvt_pk_bf16_f32 v227, v134, v135
v_mfma_f32_16x16x32_bf16 v[172:175], a[228:231], v[84:87], v[172:175]
v_exp_f32 v158, v158
v_cvt_pk_bf16_f32 v230, v140, v141
v_cvt_pk_bf16_f32 v231, v142, v143
v_cvt_pk_bf16_f32 v234, v148, v149
v_mfma_f32_16x16x32_bf16 v[172:175], a[224:227], v[80:83], v[172:175]
v_exp_f32 v159, v159
v_cvt_pk_bf16_f32 v235, v150, v151
v_cvt_pk_bf16_f32 v238, v156, v157
v_cvt_pk_bf16_f32 v239, v158, v159
v_mfma_f32_16x16x32_bf16 v[208:211], a[240:243], v[224:227], 0
TR 212,25,16384
v_mfma_f32_16x16x32_bf16 v[212:215], a[240:243], v[228:231], 0
TR 214,25,20480
v_mfma_f32_16x16x32_bf16 v[216:219], a[240:243], v[232:235], 0
buffer_load_dword v61, v60, s[28:31], s81 offen
v_mfma_f32_16x16x32_bf16 v[220:223], a[240:243], v[236:239], 0
s_add_u32 s81, s81, 1835008
v_mfma_f32_16x16x32_bf16 v[180:183], a[224:227], v[96:99], v[200:203]
TR 216,26,16384
v_mfma_f32_16x16x32_bf16 v[180:183], a[228:231], v[100:103], v[180:183]
TR 218,26,20480
v_mfma_f32_16x16x32_bf16 v[180:183], a[232:235], v[104:107], v[180:183]
v_mfma_f32_16x16x32_bf16 v[180:183], a[236:239], v[108:111], v[180:183]
v_mfma_f32_16x16x32_bf16 v[188:191], a[236:239], v[124:127], v[204:207]
v_mfma_f32_16x16x32_bf16 v[188:191], a[232:235], v[120:123], v[188:191]
v_mfma_f32_16x16x32_bf16 v[188:191], a[228:231], v[116:119], v[188:191]
v_mfma_f32_16x16x32_bf16 v[188:191], a[224:227], v[112:115], v[188:191]
WL 4
v_mfma_f32_16x16x32_bf16 a[0:3], a[208:211], v[224:227], 0
TR 220,27,16384
v_mov_b32 v48, v208
v_mov_b32 v49, v212
v_mfma_f32_16x16x32_bf16 a[32:35], a[208:211], v[228:231], 0
TR 222,27,20480
v_mov_b32 v50, v216
v_mov_b32 v51, v220
v_mfma_f32_16x16x32_bf16 a[64:67], a[208:211], v[232:235], 0
v_exp_f32 v160, v160
v_mfma_f32_16x16x32_bf16 a[96:99], a[208:211], v[236:239], 0
v_exp_f32 v161, v161
WL 4
v_mfma_f32_16x16x32_bf16 a[100:103], a[212:215], v[236:239], 0
TR 208,28,16384
v_mfma_f32_16x16x32_bf16 a[68:71], a[212:215], v[232:235], 0
TR 210,28,20480
v_mfma_f32_16x16x32_bf16 a[36:39], a[212:215], v[228:231], 0
v_exp_f32 v162, v162
v_mfma_f32_16x16x32_bf16 a[4:7], a[212:215], v[224:227], 0
v_exp_f32 v163, v163
WL 4
v_mfma_f32_16x16x32_bf16 a[8:11], a[216:219], v[224:227], 0
TR 212,29,16384
v_mfma_f32_16x16x32_bf16 a[40:43], a[216:219], v[228:231], 0
TR 214,29,20480
v_mfma_f32_16x16x32_bf16 a[72:75], a[216:219], v[232:235], 0
v_exp_f32 v168, v168
v_mfma_f32_16x16x32_bf16 a[104:107], a[216:219], v[236:239], 0
v_exp_f32 v169, v169
WL 4
v_mfma_f32_16x16x32_bf16 a[108:111], a[220:223], v[236:239], 0
TR 216,30,16384
v_mfma_f32_16x16x32_bf16 a[76:79], a[220:223], v[232:235], 0
TR 218,30,20480
v_mfma_f32_16x16x32_bf16 a[44:47], a[220:223], v[228:231], 0
v_exp_f32 v170, v170
v_mfma_f32_16x16x32_bf16 a[12:15], a[220:223], v[224:227], 0
v_exp_f32 v171, v171
WL 4
v_mfma_f32_16x16x32_bf16 a[16:19], a[208:211], v[224:227], 0
TR 220,31,16384
v_mfma_f32_16x16x32_bf16 a[48:51], a[208:211], v[228:231], 0
TR 222,31,20480
v_mfma_f32_16x16x32_bf16 a[80:83], a[208:211], v[232:235], 0
v_exp_f32 v176, v176
v_mfma_f32_16x16x32_bf16 a[112:115], a[208:211], v[236:239], 0
v_exp_f32 v177, v177
WV 18
s_barrier
WL 4
v_mfma_f32_16x16x32_bf16 a[116:119], a[212:215], v[236:239], 0
ds_read_b128 a[192:195], v40 offset:32768
v_mfma_f32_16x16x32_bf16 a[84:87], a[212:215], v[232:235], 0
v_exp_f32 v178, v178
v_mfma_f32_16x16x32_bf16 a[52:55], a[212:215], v[228:231], 0
ds_read_b128 a[196:199], v41 offset:32768
v_mfma_f32_16x16x32_bf16 a[20:23], a[212:215], v[224:227], 0
v_exp_f32 v179, v179
WL 4
v_mfma_f32_16x16x32_bf16 a[24:27], a[216:219], v[224:227], 0
ds_read_b128 a[200:203], v42 offset:32768
v_exp_f32 v184, v184
v_mfma_f32_16x16x32_bf16 a[56:59], a[216:219], v[228:231], 0
v_exp_f32 v185, v185
v_mfma_f32_16x16x32_bf16 a[88:91], a[216:219], v[232:235], 0
ds_read_b128 a[204:207], v43 offset:32768
v_mfma_f32_16x16x32_bf16 a[120:123], a[216:219], v[236:239], 0
v_exp_f32 v186, v186
WL 4
v_mfma_f32_16x16x32_bf16 a[124:127], a[220:223], v[236:239], 0
v_exp_f32 v187, v187
v_mfma_f32_16x16x32_bf16 a[92:95], a[220:223], v[232:235], 0
v_exp_f32 v164, v164
v_mfma_f32_16x16x32_bf16 a[60:63], a[220:223], v[228:231], 0
v_exp_f32 v165, v165
v_mfma_f32_16x16x32_bf16 a[28:31], a[220:223], v[224:227], 0
v_exp_f32 v166, v166
WL 0
v_mfma_f32_16x16x32_bf16 v[128:131], a[192:195], v[64:67], v[192:195]
v_exp_f32 v167, v167
v_mfma_f32_16x16x32_bf16 v[128:131], a[196:199], v[68:71], v[128:131]
ds_read_b128 a[224:227], v40 offset:36864
v_cvt_pk_bf16_f32 v224, v160, v161
v_mfma_f32_16x16x32_bf16 v[128:131], a[200:203], v[72:75], v[128:131]
v_exp_f32 v172, v172
v_mfma_f32_16x16x32_bf16 v[128:131], a[204:207], v[76:79], v[128:131]
ds_read_b128 a[228:231], v41 offset:36864
v_cvt_pk_bf16_f32 v225, v162, v163
v_mfma_f32_16x16x32_bf16 v[136:139], a[204:207], v[92:95], v[196:199]
v_exp_f32 v173, v173
v_mfma_f32_16x16x32_bf16 v[136:139], a[200:203], v[88:91], v[136:139]
ds_read_b128 a[232:235], v42 offset:36864
v_cvt_pk_bf16_f32 v228, v168, v169
v_mfma_f32_16x16x32_bf16 v[136:139], a[196:199], v[84:87], v[136:139]
v_exp_f32 v174, v174
v_mfma_f32_16x16x32_bf16 v[136:139], a[192:195], v[80:83], v[136:139]
ds_read_b128 a[236:239], v43 offset:36864
v_cvt_pk_bf16_f32 v229, v170, v171
v_mfma_f32_16x16x32_bf16 v[144:147], a[192:195], v[96:99], v[200:203]
v_exp_f32 v175, v175
v_mfma_f32_16x16x32_bf16 v[144:147], a[196:199], v[100:103], v[144:147]
v_exp_f32 v180, v180
v_mfma_f32_16x16x32_bf16 v[144:147], a[200:203], v[104:107], v[144:147]
v_exp_f32 v181, v181
v_mfma_f32_16x16x32_bf16 v[144:147], a[204:207], v[108:111], v[144:147]
v_exp_f32 v182, v182
v_mfma_f32_16x16x32_bf16 v[152:155], a[204:207], v[124:127], v[204:207]
v_exp_f32 v183, v183
v_mfma_f32_16x16x32_bf16 v[152:155], a[200:203], v[120:123], v[152:155]
v_cvt_pk_bf16_f32 v232, v176, v177
v_cvt_pk_bf16_f32 v233, v178, v179
v_mfma_f32_16x16x32_bf16 v[152:155], a[196:199], v[116:119], v[152:155]
v_exp_f32 v188, v188
v_mfma_f32_16x16x32_bf16 v[152:155], a[192:195], v[112:115], v[152:155]
v_cvt_pk_bf16_f32 v236, v184, v185
v_cvt_pk_bf16_f32 v237, v186, v187
WL 0
v_mfma_f32_16x16x32_bf16 v[132:135], a[224:227], v[64:67], v[192:195]
v_exp_f32 v189, v189
v_mfma_f32_16x16x32_bf16 v[132:135], a[228:231], v[68:71], v[132:135]
v_cvt_pk_bf16_f32 v226, v164, v165
v_cvt_pk_bf16_f32 v227, v166, v167
v_mfma_f32_16x16x32_bf16 v[132:135], a[232:235], v[72:75], v[132:135]
v_exp_f32 v190, v190
v_mfma_f32_16x16x32_bf16 v[132:135], a[236:239], v[76:79], v[132:135]
v_cvt_pk_bf16_f32 v230, v172, v173
v_cvt_pk_bf16_f32 v231, v174, v175
v_mfma_f32_16x16x32_bf16 v[140:143], a[236:239], v[92:95], v[196:199]
TR 208,24,24576
v_cvt_pk_bf16_f32 v234, v180, v181
v_mfma_f32_16x16x32_bf16 v[140:143], a[232:235], v[88:91], v[140:143]
TR 210,24,28672
v_cvt_pk_bf16_f32 v235, v182, v183
v_mfma_f32_16x16x32_bf16 v[140:143], a[228:231], v[84:87], v[140:143]
v_exp_f32 v191, v191
v_mfma_f32_16x16x32_bf16 v[140:143], a[224:227], v[80:83], v[140:143]
v_cvt_pk_bf16_f32 v238, v188, v189
v_cvt_pk_bf16_f32 v239, v190, v191
v_mfma_f32_16x16x32_bf16 v[208:211], a[240:243], v[224:227], 0
TR 212,25,24576
v_mfma_f32_16x16x32_bf16 v[212:215], a[240:243], v[228:231], 0
TR 214,25,28672
v_mfma_f32_16x16x32_bf16 v[216:219], a[240:243], v[232:235], 0
buffer_load_dword v61, v60, s[28:31], s81 offen
v_mfma_f32_16x16x32_bf16 v[220:223], a[240:243], v[236:239], 0
s_add_u32 s81, s81, 1835008
v_mfma_f32_16x16x32_bf16 v[148:151], a[224:227], v[96:99], v[200:203]
TR 216,26,24576
v_mfma_f32_16x16x32_bf16 v[148:151], a[228:231], v[100:103], v[148:151]
TR 218,26,28672
v_mfma_f32_16x16x32_bf16 v[148:151], a[232:235], v[104:107], v[148:151]
v_mfma_f32_16x16x32_bf16 v[148:151], a[236:239], v[108:111], v[148:151]
v_mfma_f32_16x16x32_bf16 v[156:159], a[236:239], v[124:127], v[204:207]
v_mfma_f32_16x16x32_bf16 v[156:159], a[232:235], v[120:123], v[156:159]
v_mfma_f32_16x16x32_bf16 v[156:159], a[228:231], v[116:119], v[156:159]
v_max3_f32 v56, v208, v212, v216
v_max_f32 v56, v56, v220
v_mfma_f32_16x16x32_bf16 v[156:159], a[224:227], v[112:115], v[156:159]
v_cmp_lt_f32 vcc, 0x49800000, v56
s_nop 0
s_cbranch_vccnz t1_c7
t1_r8:
WL 4
v_mfma_f32_16x16x32_bf16 a[0:3], a[208:211], v[224:227], a[0:3]
TR 220,27,24576
v_add_f32 v48, v48, v208
v_add_f32 v49, v49, v212
v_mfma_f32_16x16x32_bf16 a[32:35], a[208:211], v[228:231], a[32:35]
TR 222,27,28672
v_add_f32 v50, v50, v216
v_add_f32 v51, v51, v220
v_mfma_f32_16x16x32_bf16 a[64:67], a[208:211], v[232:235], a[64:67]
v_exp_f32 v128, v128
v_mfma_f32_16x16x32_bf16 a[96:99], a[208:211], v[236:239], a[96:99]
v_exp_f32 v129, v129
WL 4
v_mfma_f32_16x16x32_bf16 a[100:103], a[212:215], v[236:239], a[100:103]
TR 208,28,24576
v_mfma_f32_16x16x32_bf16 a[68:71], a[212:215], v[232:235], a[68:71]
TR 210,28,28672
v_mfma_f32_16x16x32_bf16 a[36:39], a[212:215], v[228:231], a[36:39]
v_exp_f32 v130, v130
v_mfma_f32_16x16x32_bf16 a[4:7], a[212:215], v[224:227], a[4:7]
v_exp_f32 v131, v131
WL 4
v_mfma_f32_16x16x32_bf16 a[8:11], a[216:219], v[224:227], a[8:11]
TR 212,29,24576
v_mfma_f32_16x16x32_bf16 a[40:43], a[216:219], v[228:231], a[40:43]
TR 214,29,28672
v_mfma_f32_16x16x32_bf16 a[72:75], a[216:219], v[232:235], a[72:75]
v_exp_f32 v136, v136
v_mfma_f32_16x16x32_bf16 a[104:107], a[216:219], v[236:239], a[104:107]
v_exp_f32 v137, v137
WL 4
v_mfma_f32_16x16x32_bf16 a[108:111], a[220:223], v[236:239], a[108:111]
TR 216,30,24576
v_mfma_f32_16x16x32_bf16 a[76:79], a[220:223], v[232:235], a[76:79]
TR 218,30,28672
v_mfma_f32_16x16x32_bf16 a[44:47], a[220:223], v[228:231], a[44:47]
v_exp_f32 v138, v138
v_mfma_f32_16x16x32_bf16 a[12:15], a[220:223], v[224:227], a[12:15]
v_exp_f32 v139, v139
WL 4
v_mfma_f32_16x16x32_bf16 a[16:19], a[208:211], v[224:227], a[16:19]
TR 220,31,24576
v_exp_f32 v144, v144
v_mfma_f32_16x16x32_bf16 a[48:51], a[208:211], v[228:231], a[48:51]
TR 222,31,28672
v_mfma_f32_16x16x32_bf16 a[80:83], a[208:211], v[232:235], a[80:83]
v_exp_f32 v145, v145
v_mfma_f32_16x16x32_bf16 a[112:115], a[208:211], v[236:239], a[112:115]
v_exp_f32 v146, v146
WL 4
v_mfma_f32_16x16x32_bf16 a[116:119], a[212:215], v[236:239], a[116:119]
ds_read_b128 a[192:195], v40 offset:40960
v_mfma_f32_16x16x32_bf16 a[84:87], a[212:215], v[232:235], a[84:87]
v_exp_f32 v147, v147
v_mfma_f32_16x16x32_bf16 a[52:55], a[212:215], v[228:231], a[52:55]
ds_read_b128 a[196:199], v41 offset:40960
v_mfma_f32_16x16x32_bf16 a[20:23], a[212:215], v[224:227], a[20:23]
v_exp_f32 v152, v152
WL 4
v_mfma_f32_16x16x32_bf16 a[24:27], a[216:219], v[224:227], a[24:27]
ds_read_b128 a[200:203], v42 offset:40960
v_mfma_f32_16x16x32_bf16 a[56:59], a[216:219], v[228:231], a[56:59]
v_exp_f32 v153, v153
v_mfma_f32_16x16x32_bf16 a[88:91], a[216:219], v[232:235], a[88:91]
ds_read_b128 a[204:207], v43 offset:40960
v_mfma_f32_16x16x32_bf16 a[120:123], a[216:219], v[236:239], a[120:123]
v_exp_f32 v154, v154
WL 4
v_mfma_f32_16x16x32_bf16 a[124:127], a[220:223], v[236:239], a[124:127]
v_exp_f32 v155, v155
v_mfma_f32_16x16x32_bf16 a[92:95], a[220:223], v[232:235], a[92:95]
v_exp_f32 v132, v132
v_mfma_f32_16x16x32_bf16 a[60:63], a[220:223], v[228:231], a[60:63]
v_exp_f32 v133, v133
v_mfma_f32_16x16x32_bf16 a[28:31], a[220:223], v[224:227], a[28:31]
v_exp_f32 v134, v134
v_cvt_pk_bf16_f32 v224, v128, v129
WL 0
v_mfma_f32_16x16x32_bf16 v[160:163], a[192:195], v[64:67], v[192:195]
v_exp_f32 v135, v135
v_mfma_f32_16x16x32_bf16 v[160:163], a[196:199], v[68:71], v[160:163]
ds_read_b128 a[224:227], v40 offset:45056
v_cvt_pk_bf16_f32 v225, v130, v131
v_mfma_f32_16x16x32_bf16 v[160:163], a[200:203], v[72:75], v[160:163]
v_exp_f32 v140, v140
v_mfma_f32_16x16x32_bf16 v[160:163], a[204:207], v[76:79], v[160:163]
ds_read_b128 a[228:231], v41 offset:45056
v_cvt_pk_bf16_f32 v228, v136, v137
v_mfma_f32_16x16x32_bf16 v[168:171], a[204:207], v[92:95], v[196:199]
v_exp_f32 v141, v141
v_mfma_f32_16x16x32_bf16 v[168:171], a[200:203], v[88:91], v[168:171]
ds_read_b128 a[232:235], v42 offset:45056
v_cvt_pk_bf16_f32 v229, v138, v139
v_mfma_f32_16x16x32_bf16 v[168:171], a[196:199], v[84:87], v[168:171]
v_exp_f32 v142, v142
v_mfma_f32_16x16x32_bf16 v[168:171], a[192:195], v[80:83], v[168:171]
ds_read_b128 a[236:239], v43 offset:45056
v_cvt_pk_bf16_f32 v232, v144, v145
v_mfma_f32_16x16x32_bf16 v[176:179], a[192:195], v[96:99], v[200:203]
v_exp_f32 v143, v143
v_mfma_f32_16x16x32_bf16 v[176:179], a[196:199], v[100:103], v[176:179]
v_exp_f32 v148, v148
v_mfma_f32_16x16x32_bf16 v[176:179], a[200:203], v[104:107], v[176:179]
v_exp_f32 v149, v149
v_mfma_f32_16x16x32_bf16 v[176:179], a[204:207], v[108:111], v[176:179]
buffer_load_dword v61, v60, s[84:87], s77 offen
v_mfma_f32_16x16x32_bf16 v[184:187], a[204:207], v[124:127], v[204:207]
v_exp_f32 v150, v150
v_mfma_f32_16x16x32_bf16 v[184:187], a[200:203], v[120:123], v[184:187]
v_exp_f32 v151, v151
v_cvt_pk_bf16_f32 v233, v146, v147
v_mfma_f32_16x16x32_bf16 v[184:187], a[196:199], v[116:119], v[184:187]
v_exp_f32 v156, v156
v_mfma_f32_16x16x32_bf16 v[184:187], a[192:195], v[112:115], v[184:187]
v_cvt_pk_bf16_f32 v236, v152, v153
v_cvt_pk_bf16_f32 v237, v154, v155
WL 0
v_mfma_f32_16x16x32_bf16 v[164:167], a[224:227], v[64:67], v[192:195]
v_exp_f32 v157, v157
v_mfma_f32_16x16x32_bf16 v[164:167], a[228:231], v[68:71], v[164:167]
v_cvt_pk_bf16_f32 v226, v132, v133
v_cvt_pk_bf16_f32 v227, v134, v135
v_mfma_f32_16x16x32_bf16 v[164:167], a[232:235], v[72:75], v[164:167]
v_exp_f32 v158, v158
v_mfma_f32_16x16x32_bf16 v[164:167], a[236:239], v[76:79], v[164:167]
v_cvt_pk_bf16_f32 v230, v140, v141
v_cvt_pk_bf16_f32 v231, v142, v143
v_mfma_f32_16x16x32_bf16 v[172:175], a[236:239], v[92:95], v[196:199]
TR 208,24,49152
v_cvt_pk_bf16_f32 v234, v148, v149
v_mfma_f32_16x16x32_bf16 v[172:175], a[232:235], v[88:91], v[172:175]
TR 210,24,53248
v_cvt_pk_bf16_f32 v235, v150, v151
v_mfma_f32_16x16x32_bf16 v[172:175], a[228:231], v[84:87], v[172:175]
v_exp_f32 v159, v159
v_mfma_f32_16x16x32_bf16 v[172:175], a[224:227], v[80:83], v[172:175]
v_cvt_pk_bf16_f32 v238, v156, v157
v_cvt_pk_bf16_f32 v239, v158, v159
v_mfma_f32_16x16x32_bf16 v[208:211], a[240:243], v[224:227], 0
TR 212,25,49152
v_mfma_f32_16x16x32_bf16 v[212:215], a[240:243], v[228:231], 0
TR 214,25,53248
v_mfma_f32_16x16x32_bf16 v[216:219], a[240:243], v[232:235], 0
buffer_load_dword v61, v60, s[28:31], s81 offen
v_mfma_f32_16x16x32_bf16 v[220:223], a[240:243], v[236:239], 0
s_add_u32 s81, s81, 1835008
v_mfma_f32_16x16x32_bf16 v[180:183], a[224:227], v[96:99], v[200:203]
TR 216,26,49152
v_mfma_f32_16x16x32_bf16 v[180:183], a[228:231], v[100:103], v[180:183]
TR 218,26,53248
v_mfma_f32_16x16x32_bf16 v[180:183], a[232:235], v[104:107], v[180:183]
v_mfma_f32_16x16x32_bf16 v[180:183], a[236:239], v[108:111], v[180:183]
v_mfma_f32_16x16x32_bf16 v[188:191], a[236:239], v[124:127], v[204:207]
v_mfma_f32_16x16x32_bf16 v[188:191], a[232:235], v[120:123], v[188:191]
v_mfma_f32_16x16x32_bf16 v[188:191], a[228:231], v[116:119], v[188:191]
v_max3_f32 v56, v208, v212, v216
v_max_f32 v56, v56, v220
v_mfma_f32_16x16x32_bf16 v[188:191], a[224:227], v[112:115], v[188:191]
v_cmp_lt_f32 vcc, 0x49800000, v56
s_nop 0
s_cbranch_vccnz t1_c9
t1_r10:
WL 4
v_mfma_f32_16x16x32_bf16 a[0:3], a[208:211], v[224:227], a[0:3]
TR 220,27,49152
v_add_f32 v48, v48, v208
v_add_f32 v49, v49, v212
v_mfma_f32_16x16x32_bf16 a[32:35], a[208:211], v[228:231], a[32:35]
TR 222,27,53248
v_add_f32 v50, v50, v216
v_add_f32 v51, v51, v220
v_mfma_f32_16x16x32_bf16 a[64:67], a[208:211], v[232:235], a[64:67]
v_exp_f32 v160, v160
v_mfma_f32_16x16x32_bf16 a[96:99], a[208:211], v[236:239], a[96:99]
v_exp_f32 v161, v161
WL 4
v_mfma_f32_16x16x32_bf16 a[100:103], a[212:215], v[236:239], a[100:103]
TR 208,28,49152
v_mfma_f32_16x16x32_bf16 a[68:71], a[212:215], v[232:235], a[68:71]
TR 210,28,53248
v_exp_f32 v162, v162
v_mfma_f32_16x16x32_bf16 a[36:39], a[212:215], v[228:231], a[36:39]
v_exp_f32 v163, v163
v_mfma_f32_16x16x32_bf16 a[4:7], a[212:215], v[224:227], a[4:7]
v_exp_f32 v168, v168
WL 4
v_mfma_f32_16x16x32_bf16 a[8:11], a[216:219], v[224:227], a[8:11]
TR 212,29,49152
v_exp_f32 v169, v169
v_mfma_f32_16x16x32_bf16 a[40:43], a[216:219], v[228:231], a[40:43]
TR 214,29,53248
v_mfma_f32_16x16x32_bf16 a[72:75], a[216:219], v[232:235], a[72:75]
v_exp_f32 v170, v170
v_mfma_f32_16x16x32_bf16 a[104:107], a[216:219], v[236:239], a[104:107]
v_exp_f32 v171, v171
WL 4
v_mfma_f32_16x16x32_bf16 a[108:111], a[220:223], v[236:239], a[108:111]
TR 216,30,49152
v_exp_f32 v176, v176
v_mfma_f32_16x16x32_bf16 a[76:79], a[220:223], v[232:235], a[76:79]
TR 218,30,53248
v_mfma_f32_16x16x32_bf16 a[44:47], a[220:223], v[228:231], a[44:47]
v_exp_f32 v177, v177
v_mfma_f32_16x16x32_bf16 a[12:15], a[220:223], v[224:227], a[12:15]
v_exp_f32 v178, v178
WL 4
v_mfma_f32_16x16x32_bf16 a[16:19], a[208:211], v[224:227], a[16:19]
TR 220,31,49152
v_exp_f32 v179, v179
v_mfma_f32_16x16x32_bf16 a[48:51], a[208:211], v[228:231], a[48:51]
TR 222,31,53248
v_mfma_f32_16x16x32_bf16 a[80:83], a[208:211], v[232:235], a[80:83]
v_exp_f32 v184, v184
v_mfma_f32_16x16x32_bf16 a[112:115], a[208:211], v[236:239], a[112:115]
v_exp_f32 v185, v185
WV 12
s_barrier
WL 4
v_mfma_f32_16x16x32_bf16 a[116:119], a[212:215], v[236:239], a[116:119]
ds_read_b128 a[192:195], v44 offset:0
v_exp_f32 v186, v186
v_mfma_f32_16x16x32_bf16 a[84:87], a[212:215], v[232:235], a[84:87]
v_exp_f32 v187, v187
v_mfma_f32_16x16x32_bf16 a[52:55], a[212:215], v[228:231], a[52:55]
ds_read_b128 a[196:199], v45 offset:0
s_add_u32 m0, s48, 0
v_mfma_f32_16x16x32_bf16 a[20:23], a[212:215], v[224:227], a[20:23]
DM 8,20,52,0
WL 4
v_mfma_f32_16x16x32_bf16 a[24:27], a[216:219], v[224:227], a[24:27]
ds_read_b128 a[200:203], v46 offset:0
v_exp_f32 v164, v164
v_mfma_f32_16x16x32_bf16 a[56:59], a[216:219], v[228:231], a[56:59]
v_exp_f32 v165, v165
v_mfma_f32_16x16x32_bf16 a[88:91], a[216:219], v[232:235], a[88:91]
ds_read_b128 a[204:207], v47 offset:0
v_mfma_f32_16x16x32_bf16 a[120:123], a[216:219], v[236:239], a[120:123]
DM 9,20,52,1024
WL 4
v_mfma_f32_16x16x32_bf16 a[124:127], a[220:223], v[236:239], a[124:127]
v_exp_f32 v166, v166
v_mfma_f32_16x16x32_bf16 a[92:95], a[220:223], v[232:235], a[92:95]
v_exp_f32 v167, v167
v_mfma_f32_16x16x32_bf16 a[60:63], a[220:223], v[228:231], a[60:63]
v_exp_f32 v172, v172
v_mfma_f32_16x16x32_bf16 a[28:31], a[220:223], v[224:227], a[28:31]
DM 10,20,52,2048
v_cvt_pk_bf16_f32 v224, v160, v161
WL 0
v_mfma_f32_16x16x32_bf16 v[128:131], a[192:195], v[64:67], v[192:195]
v_exp_f32 v173, v173
v_mfma_f32_16x16x32_bf16 v[128:131], a[196:199], v[68:71], v[128:131]
ds_read_b128 a[224:227], v44 offset:4096
v_cvt_pk_bf16_f32 v225, v162, v163
v_mfma_f32_16x16x32_bf16 v[128:131], a[200:203], v[72:75], v[128:131]
v_exp_f32 v174, v174
v_mfma_f32_16x16x32_bf16 v[128:131], a[204:207], v[76:79], v[128:131]
ds_read_b128 a[228:231], v45 offset:4096
DM 11,20,52,3072
v_mfma_f32_16x16x32_bf16 v[136:139], a[204:207], v[92:95], v[196:199]
v_exp_f32 v175, v175
v_cvt_pk_bf16_f32 v228, v168, v169
v_mfma_f32_16x16x32_bf16 v[136:139], a[200:203], v[88:91], v[136:139]
ds_read_b128 a[232:235], v46 offset:4096
v_cvt_pk_bf16_f32 v229, v170, v171
v_mfma_f32_16x16x32_bf16 v[136:139], a[196:199], v[84:87], v[136:139]
s_add_u32 m0, s48, 16384
v_exp_f32 v180, v180
v_mfma_f32_16x16x32_bf16 v[136:139], a[192:195], v[80:83], v[136:139]
ds_read_b128 a[236:239], v47 offset:4096
DM 16,24,52,0
v_mfma_f32_16x16x32_bf16 v[144:147], a[192:195], v[96:99], v[200:203]
v_exp_f32 v181, v181
v_mfma_f32_16x16x32_bf16 v[144:147], a[196:199], v[100:103], v[144:147]
v_exp_f32 v182, v182
v_mfma_f32_16x16x32_bf16 v[144:147], a[200:203], v[104:107], v[144:147]
v_exp_f32 v183, v183
v_mfma_f32_16x16x32_bf16 v[144:147], a[204:207], v[108:111], v[144:147]
DM 4,24,52,1024
v_mfma_f32_16x16x32_bf16 v[152:155], a[204:207], v[124:127], v[204:207]
v_cvt_pk_bf16_f32 v232, v176, v177
v_cvt_pk_bf16_f32 v233, v178, v179
v_cvt_pk_bf16_f32 v236, v184, v185
v_mfma_f32_16x16x32_bf16 v[152:155], a[200:203], v[120:123], v[152:155]
v_exp_f32 v188, v188
v_mfma_f32_16x16x32_bf16 v[152:155], a[196:199], v[116:119], v[152:155]
v_cvt_pk_bf16_f32 v237, v186, v187
v_cvt_pk_bf16_f32 v226, v164, v165
v_mfma_f32_16x16x32_bf16 v[152:155], a[192:195], v[112:115], v[152:155]
DM 16,24,52,2048
WL 0
v_mfma_f32_16x16x32_bf16 v[132:135], a[224:227], v[64:67], v[192:195]
v_exp_f32 v189, v189
v_mfma_f32_16x16x32_bf16 v[132:135], a[228:231], v[68:71], v[132:135]
v_cvt_pk_bf16_f32 v227, v166, v167
v_cvt_pk_bf16_f32 v230, v172, v173
v_mfma_f32_16x16x32_bf16 v[132:135], a[232:235], v[72:75], v[132:135]
v_exp_f32 v190, v190
v_mfma_f32_16x16x32_bf16 v[132:135], a[236:239], v[76:79], v[132:135]
DM 4,24,52,3072
s_add_u32 s52, s52, 16384
v_mfma_f32_16x16x32_bf16 v[140:143], a[236:239], v[92:95], v[196:199]
TR 208,24,57344
v_cvt_pk_bf16_f32 v231, v174, v175
v_cvt_pk_bf16_f32 v234, v180, v181
v_mfma_f32_16x16x32_bf16 v[140:143], a[232:235], v[88:91], v[140:143]
TR 210,24,61440
v_cvt_pk_bf16_f32 v235, v182, v183
v_mfma_f32_16x16x32_bf16 v[140:143], a[228:231], v[84:87], v[140:143]
v_exp_f32 v191, v191
v_mfma_f32_16x16x32_bf16 v[140:143], a[224:227], v[80:83], v[140:143]
v_cvt_pk_bf16_f32 v238, v188, v189
v_cvt_pk_bf16_f32 v239, v190, v191
v_mfma_f32_16x16x32_bf16 v[208:211], a[240:243], v[224:227], 0
TR 212,25,57344
v_mfma_f32_16x16x32_bf16 v[212:215], a[240:243], v[228:231], 0
TR 214,25,61440
v_mfma_f32_16x16x32_bf16 v[216:219], a[240:243], v[232:235], 0
buffer_load_dword v61, v60, s[28:31], s81 offen
v_mfma_f32_16x16x32_bf16 v[220:223], a[240:243], v[236:239], 0
s_add_u32 s81, s81, 1835008
v_mfma_f32_16x16x32_bf16 v[148:151], a[224:227], v[96:99], v[200:203]
TR 216,26,57344
v_mfma_f32_16x16x32_bf16 v[148:151], a[228:231], v[100:103], v[148:151]
TR 218,26,61440
v_mfma_f32_16x16x32_bf16 v[148:151], a[232:235], v[104:107], v[148:151]
v_mfma_f32_16x16x32_bf16 v[148:151], a[236:239], v[108:111], v[148:151]
v_mfma_f32_16x16x32_bf16 v[156:159], a[236:239], v[124:127], v[204:207]
v_mfma_f32_16x16x32_bf16 v[156:159], a[232:235], v[120:123], v[156:159]
v_mfma_f32_16x16x32_bf16 v[156:159], a[228:231], v[116:119], v[156:159]
v_max3_f32 v56, v208, v212, v216
v_max_f32 v56, v56, v220
v_mfma_f32_16x16x32_bf16 v[156:159], a[224:227], v[112:115], v[156:159]
v_cmp_lt_f32 vcc, 0x49800000, v56
s_nop 0
s_cbranch_vccnz t1_c11
t1_r12:
WL 4
v_mfma_f32_16x16x32_bf16 a[0:3], a[208:211], v[224:227], a[0:3]
TR 220,27,57344
v_add_f32 v48, v48, v208
v_add_f32 v49, v49, v212
v_mfma_f32_16x16x32_bf16 a[32:35], a[208:211], v[228:231], a[32:35]
TR 222,27,61440
v_add_f32 v50, v50, v216
v_add_f32 v51, v51, v220
v_mfma_f32_16x16x32_bf16 a[64:67], a[208:211], v[232:235], a[64:67]
v_exp_f32 v128, v128
v_mfma_f32_16x16x32_bf16 a[96:99], a[208:211], v[236:239], a[96:99]
v_exp_f32 v129, v129
WL 4
v_mfma_f32_16x16x32_bf16 a[100:103], a[212:215], v[236:239], a[100:103]
TR 208,28,57344
v_mfma_f32_16x16x32_bf16 a[68:71], a[212:215], v[232:235], a[68:71]
TR 210,28,61440
v_mfma_f32_16x16x32_bf16 a[36:39], a[212:215], v[228:231], a[36:39]
v_exp_f32 v130, v130
v_mfma_f32_16x16x32_bf16 a[4:7], a[212:215], v[224:227], a[4:7]
v_exp_f32 v131, v131
WL 4
v_mfma_f32_16x16x32_bf16 a[8:11], a[216:219], v[224:227], a[8:11]
TR 212,29,57344
v_mfma_f32_16x16x32_bf16 a[40:43], a[216:219], v[228:231], a[40:43]
TR 214,29,61440
v_mfma_f32_16x16x32_bf16 a[72:75], a[216:219], v[232:235], a[72:75]
v_exp_f32 v136, v136
v_mfma_f32_16x16x32_bf16 a[104:107], a[216:219], v[236:239], a[104:107]
v_exp_f32 v137, v137
WL 4
v_mfma_f32_16x16x32_bf16 a[108:111], a[220:223], v[236:239], a[108:111]
TR 216,30,57344
v_mfma_f32_16x16x32_bf16 a[76:79], a[220:223], v[232:235], a[76:79]
TR 218,30,61440
v_mfma_f32_16x16x32_bf16 a[44:47], a[220:223], v[228:231], a[44:47]
v_exp_f32 v138, v138
v_mfma_f32_16x16x32_bf16 a[12:15], a[220:223], v[224:227], a[12:15]
v_exp_f32 v139, v139
WL 4
v_mfma_f32_16x16x32_bf16 a[16:19], a[208:211], v[224:227], a[16:19]
TR 220,31,57344
v_mfma_f32_16x16x32_bf16 a[48:51], a[208:211], v[228:231], a[48:51]
TR 222,31,61440
v_exp_f32 v144, v144
v_mfma_f32_16x16x32_bf16 a[80:83], a[208:211], v[232:235], a[80:83]
v_exp_f32 v145, v145
v_mfma_f32_16x16x32_bf16 a[112:115], a[208:211], v[236:239], a[112:115]
v_exp_f32 v146, v146
WL 4
v_mfma_f32_16x16x32_bf16 a[116:119], a[212:215], v[236:239], a[116:119]
ds_read_b128 a[192:195], v44 offset:8192
v_mfma_f32_16x16x32_bf16 a[84:87], a[212:215], v[232:235], a[84:87]
v_exp_f32 v147, v147
v_mfma_f32_16x16x32_bf16 a[52:55], a[212:215], v[228:231], a[52:55]
ds_read_b128 a[196:199], v45 offset:8192
v_mfma_f32_16x16x32_bf16 a[20:23], a[212:215], v[224:227], a[20:23]
v_exp_f32 v152, v152
WL 4
v_mfma_f32_16x16x32_bf16 a[24:27], a[216:219], v[224:227], a[24:27]
ds_read_b128 a[200:203], v46 offset:8192
v_mfma_f32_16x16x32_bf16 a[56:59], a[216:219], v[228:231], a[56:59]
v_exp_f32 v153, v153
v_mfma_f32_16x16x32_bf16 a[88:91], a[216:219], v[232:235], a[88:91]
ds_read_b128 a[204:207], v47 offset:8192
v_mfma_f32_16x16x32_bf16 a[120:123], a[216:219], v[236:239], a[120:123]
v_exp_f32 v154, v154
WL 4
v_mfma_f32_16x16x32_bf16 a[124:127], a[220:223], v[236:239], a[124:127]
v_exp_f32 v155, v155
v_mfma_f32_16x16x32_bf16 a[92:95], a[220:223], v[232:235], a[92:95]
v_exp_f32 v132, v132
v_mfma_f32_16x16x32_bf16 a[60:63], a[220:223], v[228:231], a[60:63]
v_exp_f32 v133, v133
v_mfma_f32_16x16x32_bf16 a[28:31], a[220:223], v[224:227], a[28:31]
v_exp_f32 v134, v134
WL 0
v_mfma_f32_16x16x32_bf16 v[160:163], a[192:195], v[64:67], v[192:195]
v_exp_f32 v135, v135
v_mfma_f32_16x16x32_bf16 v[160:163], a[196:199], v[68:71], v[160:163]
ds_read_b128 a[224:227], v44 offset:12288
v_cvt_pk_bf16_f32 v224, v128, v129
v_mfma_f32_16x16x32_bf16 v[160:163], a[200:203], v[72:75], v[160:163]
v_exp_f32 v140, v140
v_mfma_f32_16x16x32_bf16 v[160:163], a[204:207], v[76:79], v[160:163]
ds_read_b128 a[228:231], v45 offset:12288
v_cvt_pk_bf16_f32 v225, v130, v131
v_mfma_f32_16x16x32_bf16 v[168:171], a[204:207], v[92:95], v[196:199]
v_exp_f32 v141, v141
v_mfma_f32_16x16x32_bf16 v[168:171], a[200:203], v[88:91], v[168:171]
ds_read_b128 a[232:235], v46 offset:12288
v_cvt_pk_bf16_f32 v228, v136, v137
v_mfma_f32_16x16x32_bf16 v[168:171], a[196:199], v[84:87], v[168:171]
v_exp_f32 v142, v142
v_mfma_f32_16x16x32_bf16 v[168:171], a[192:195], v[80:83], v[168:171]
ds_read_b128 a[236:239], v47 offset:12288
v_cvt_pk_bf16_f32 v229, v138, v139
v_mfma_f32_16x16x32_bf16 v[176:179], a[192:195], v[96:99], v[200:203]
v_exp_f32 v143, v143
v_mfma_f32_16x16x32_bf16 v[176:179], a[196:199], v[100:103], v[176:179]
v_exp_f32 v148, v148
v_cvt_pk_bf16_f32 v232, v144, v145
v_mfma_f32_16x16x32_bf16 v[176:179], a[200:203], v[104:107], v[176:179]
v_exp_f32 v149, v149
v_mfma_f32_16x16x32_bf16 v[176:179], a[204:207], v[108:111], v[176:179]
v_exp_f32 v150, v150
v_mfma_f32_16x16x32_bf16 v[184:187], a[204:207], v[124:127], v[204:207]
v_exp_f32 v151, v151
v_mfma_f32_16x16x32_bf16 v[184:187], a[200:203], v[120:123], v[184:187]
v_cvt_pk_bf16_f32 v233, v146, v147
v_cvt_pk_bf16_f32 v236, v152, v153
v_mfma_f32_16x16x32_bf16 v[184:187], a[196:199], v[116:119], v[184:187]
v_exp_f32 v156, v156
v_mfma_f32_16x16x32_bf16 v[184:187], a[192:195], v[112:115], v[184:187]
v_cvt_pk_bf16_f32 v237, v154, v155
v_cvt_pk_bf16_f32 v226, v132, v133
WL 0
v_mfma_f32_16x16x32_bf16 v[164:167], a[224:227], v[64:67], v[192:195]
v_exp_f32 v157, v157
v_mfma_f32_16x16x32_bf16 v[164:167], a[228:231], v[68:71], v[164:167]
v_cvt_pk_bf16_f32 v227, v134, v135
v_cvt_pk_bf16_f32 v230, v140, v141
v_mfma_f32_16x16x32_bf16 v[164:167], a[232:235], v[72:75], v[164:167]
v_exp_f32 v158, v158
v_mfma_f32_16x16x32_bf16 v[164:167], a[236:239], v[76:79], v[164:167]
v_cvt_pk_bf16_f32 v231, v142, v143
v_cvt_pk_bf16_f32 v234, v148, v149
v_mfma_f32_16x16x32_bf16 v[172:175], a[236:239], v[92:95], v[196:199]
TR 208,32,16384
v_cvt_pk_bf16_f32 v235, v150, v151
v_mfma_f32_16x16x32_bf16 v[172:175], a[232:235], v[88:91], v[172:175]
TR 210,32,20480
v_cvt_pk_bf16_f32 v238, v156, v157
v_mfma_f32_16x16x32_bf16 v[172:175], a[228:231], v[84:87], v[172:175]
v_exp_f32 v159, v159
v_mfma_f32_16x16x32_bf16 v[172:175], a[224:227], v[80:83], v[172:175]
s_mul_i32 s81, s82, 2048
v_cvt_pk_bf16_f32 v239, v158, v159
v_mfma_f32_16x16x32_bf16 v[208:211], a[240:243], v[224:227], 0
TR 212,33,16384
v_mfma_f32_16x16x32_bf16 v[212:215], a[240:243], v[228:231], 0
TR 214,33,20480
v_mfma_f32_16x16x32_bf16 v[216:219], a[240:243], v[232:235], 0
TR 216,34,16384
v_mfma_f32_16x16x32_bf16 v[220:223], a[240:243], v[236:239], 0
TR 218,34,20480
v_mfma_f32_16x16x32_bf16 v[180:183], a[224:227], v[96:99], v[200:203]
buffer_load_dword v61, v60, s[32:35], s81 offen
v_mfma_f32_16x16x32_bf16 v[180:183], a[228:231], v[100:103], v[180:183]
s_add_u32 s81, s81, 1048576
v_mfma_f32_16x16x32_bf16 v[180:183], a[232:235], v[104:107], v[180:183]
v_mfma_f32_16x16x32_bf16 v[180:183], a[236:239], v[108:111], v[180:183]
v_mfma_f32_16x16x32_bf16 v[188:191], a[236:239], v[124:127], v[204:207]
v_mfma_f32_16x16x32_bf16 v[188:191], a[232:235], v[120:123], v[188:191]
v_mfma_f32_16x16x32_bf16 v[188:191], a[228:231], v[116:119], v[188:191]
v_max3_f32 v56, v208, v212, v216
v_max_f32 v56, v56, v220
v_mfma_f32_16x16x32_bf16 v[188:191], a[224:227], v[112:115], v[188:191]
v_cmp_lt_f32 vcc, 0x49800000, v56
s_nop 0
s_cbranch_vccnz t1_c13
t1_r14:
WL 4
v_mfma_f32_16x16x32_bf16 a[0:3], a[208:211], v[224:227], a[0:3]
TR 220,35,16384
v_add_f32 v48, v48, v208
v_add_f32 v49, v49, v212
v_mfma_f32_16x16x32_bf16 a[32:35], a[208:211], v[228:231], a[32:35]
TR 222,35,20480
v_add_f32 v50, v50, v216
v_add_f32 v51, v51, v220
v_mfma_f32_16x16x32_bf16 a[64:67], a[208:211], v[232:235], a[64:67]
v_exp_f32 v160, v160
v_mfma_f32_16x16x32_bf16 a[96:99], a[208:211], v[236:239], a[96:99]
v_exp_f32 v161, v161
WL 4
v_mfma_f32_16x16x32_bf16 a[100:103], a[212:215], v[236:239], a[100:103]
TR 208,36,16384
v_mfma_f32_16x16x32_bf16 a[68:71], a[212:215], v[232:235], a[68:71]
TR 210,36,20480
v_exp_f32 v162, v162
v_mfma_f32_16x16x32_bf16 a[36:39], a[212:215], v[228:231], a[36:39]
v_exp_f32 v163, v163
v_mfma_f32_16x16x32_bf16 a[4:7], a[212:215], v[224:227], a[4:7]
v_exp_f32 v168, v168
WL 4
v_mfma_f32_16x16x32_bf16 a[8:11], a[216:219], v[224:227], a[8:11]
TR 212,37,16384
v_exp_f32 v169, v169
v_mfma_f32_16x16x32_bf16 a[40:43], a[216:219], v[228:231], a[40:43]
TR 214,37,20480
v_mfma_f32_16x16x32_bf16 a[72:75], a[216:219], v[232:235], a[72:75]
v_exp_f32 v170, v170
v_mfma_f32_16x16x32_bf16 a[104:107], a[216:219], v[236:239], a[104:107]
v_exp_f32 v171, v171
WL 4
v_mfma_f32_16x16x32_bf16 a[108:111], a[220:223], v[236:239], a[108:111]
TR 216,38,16384
v_exp_f32 v176, v176
v_mfma_f32_16x16x32_bf16 a[76:79], a[220:223], v[232:235], a[76:79]
TR 218,38,20480
v_mfma_f32_16x16x32_bf16 a[44:47], a[220:223], v[228:231], a[44:47]
v_exp_f32 v177, v177
v_mfma_f32_16x16x32_bf16 a[12:15], a[220:223], v[224:227], a[12:15]
v_exp_f32 v178, v178
WL 4
v_mfma_f32_16x16x32_bf16 a[16:19], a[208:211], v[224:227], a[16:19]
TR 220,39,16384
v_exp_f32 v179, v179
v_mfma_f32_16x16x32_bf16 a[48:51], a[208:211], v[228:231], a[48:51]
TR 222,39,20480
v_mfma_f32_16x16x32_bf16 a[80:83], a[208:211], v[232:235], a[80:83]
v_exp_f32 v184, v184
v_mfma_f32_16x16x32_bf16 a[112:115], a[208:211], v[236:239], a[112:115]
v_exp_f32 v185, v185
WV 14
s_barrier
WL 4
v_mfma_f32_16x16x32_bf16 a[116:119], a[212:215], v[236:239], a[116:119]
ds_read_b128 a[192:195], v44 offset:32768
v_exp_f32 v186, v186
v_mfma_f32_16x16x32_bf16 a[84:87], a[212:215], v[232:235], a[84:87]
v_exp_f32 v187, v187
v_mfma_f32_16x16x32_bf16 a[52:55], a[212:215], v[228:231], a[52:55]
ds_read_b128 a[196:199], v45 offset:32768
s_add_u32 m0, s48, 32768
v_mfma_f32_16x16x32_bf16 a[20:23], a[212:215], v[224:227], a[20:23]
DM 8,20,52,0
WL 4
v_mfma_f32_16x16x32_bf16 a[24:27], a[216:219], v[224:227], a[24:27]
ds_read_b128 a[200:203], v46 offset:32768
v_exp_f32 v164, v164
v_mfma_f32_16x16x32_bf16 a[56:59], a[216:219], v[228:231], a[56:59]
v_exp_f32 v165, v165
v_mfma_f32_16x16x32_bf16 a[88:91], a[216:219], v[232:235], a[88:91]
ds_read_b128 a[204:207], v47 offset:32768
v_mfma_f32_16x16x32_bf16 a[120:123], a[216:219], v[236:239], a[120:123]
DM 9,20,52,1024
WL 4
v_mfma_f32_16x16x32_bf16 a[124:127], a[220:223], v[236:239], a[124:127]
v_exp_f32 v166, v166
v_mfma_f32_16x16x32_bf16 a[92:95], a[220:223], v[232:235], a[92:95]
v_exp_f32 v167, v167
v_mfma_f32_16x16x32_bf16 a[60:63], a[220:223], v[228:231], a[60:63]
v_exp_f32 v172, v172
v_mfma_f32_16x16x32_bf16 a[28:31], a[220:223], v[224:227], a[28:31]
DM 10,20,52,2048
v_cvt_pk_bf16_f32 v224, v160, v161
WL 0
v_mfma_f32_16x16x32_bf16 v[128:131], a[192:195], v[64:67], v[192:195]
v_exp_f32 v173, v173
v_mfma_f32_16x16x32_bf16 v[128:131], a[196:199], v[68:71], v[128:131]
ds_read_b128 a[224:227], v44 offset:36864
v_cvt_pk_bf16_f32 v225, v162, v163
v_mfma_f32_16x16x32_bf16 v[128:131], a[200:203], v[72:75], v[128:131]
v_exp_f32 v174, v174
v_mfma_f32_16x16x32_bf16 v[128:131], a[204:207], v[76:79], v[128:131]
ds_read_b128 a[228:231], v45 offset:36864
DM 11,20,52,3072
v_mfma_f32_16x16x32_bf16 v[136:139], a[204:207], v[92:95], v[196:199]
v_exp_f32 v175, v175
v_cvt_pk_bf16_f32 v228, v168, v169
v_mfma_f32_16x16x32_bf16 v[136:139], a[200:203], v[88:91], v[136:139]
ds_read_b128 a[232:235], v46 offset:36864
v_cvt_pk_bf16_f32 v229, v170, v171
v_mfma_f32_16x16x32_bf16 v[136:139], a[196:199], v[84:87], v[136:139]
s_add_u32 m0, s48, 49152
v_exp_f32 v180, v180
v_mfma_f32_16x16x32_bf16 v[136:139], a[192:195], v[80:83], v[136:139]
ds_read_b128 a[236:239], v47 offset:36864
DM 16,24,52,0
v_mfma_f32_16x16x32_bf16 v[144:147], a[192:195], v[96:99], v[200:203]
v_exp_f32 v181, v181
v_mfma_f32_16x16x32_bf16 v[144:147], a[196:199], v[100:103], v[144:147]
v_exp_f32 v182, v182
v_mfma_f32_16x16x32_bf16 v[144:147], a[200:203], v[104:107], v[144:147]
v_exp_f32 v183, v183
v_mfma_f32_16x16x32_bf16 v[144:147], a[204:207], v[108:111], v[144:147]
DM 4,24,52,1024
v_mfma_f32_16x16x32_bf16 v[152:155], a[204:207], v[124:127], v[204:207]
v_cvt_pk_bf16_f32 v232, v176, v177
v_cvt_pk_bf16_f32 v233, v178, v179
v_cvt_pk_bf16_f32 v236, v184, v185
v_mfma_f32_16x16x32_bf16 v[152:155], a[200:203], v[120:123], v[152:155]
v_exp_f32 v188, v188
v_mfma_f32_16x16x32_bf16 v[152:155], a[196:199], v[116:119], v[152:155]
v_cvt_pk_bf16_f32 v237, v186, v187
v_cvt_pk_bf16_f32 v226, v164, v165
v_mfma_f32_16x16x32_bf16 v[152:155], a[192:195], v[112:115], v[152:155]
DM 16,24,52,2048
WL 0
v_mfma_f32_16x16x32_bf16 v[132:135], a[224:227], v[64:67], v[192:195]
v_exp_f32 v189, v189
v_mfma_f32_16x16x32_bf16 v[132:135], a[228:231], v[68:71], v[132:135]
v_cvt_pk_bf16_f32 v227, v166, v167
v_cvt_pk_bf16_f32 v230, v172, v173
v_mfma_f32_16x16x32_bf16 v[132:135], a[232:235], v[72:75], v[132:135]
v_exp_f32 v190, v190
v_mfma_f32_16x16x32_bf16 v[132:135], a[236:239], v[76:79], v[132:135]
DM 4,24,52,3072
s_add_u32 s52, s52, 16384
v_mfma_f32_16x16x32_bf16 v[140:143], a[236:239], v[92:95], v[196:199]
TR 208,32,24576
v_cvt_pk_bf16_f32 v231, v174, v175
v_cvt_pk_bf16_f32 v234, v180, v181
v_mfma_f32_16x16x32_bf16 v[140:143], a[232:235], v[88:91], v[140:143]
TR 210,32,28672
v_cvt_pk_bf16_f32 v235, v182, v183
v_mfma_f32_16x16x32_bf16 v[140:143], a[228:231], v[84:87], v[140:143]
v_exp_f32 v191, v191
v_mfma_f32_16x16x32_bf16 v[140:143], a[224:227], v[80:83], v[140:143]
v_cvt_pk_bf16_f32 v238, v188, v189
v_cvt_pk_bf16_f32 v239, v190, v191
v_mfma_f32_16x16x32_bf16 v[208:211], a[240:243], v[224:227], 0
TR 212,33,24576
v_mfma_f32_16x16x32_bf16 v[212:215], a[240:243], v[228:231], 0
TR 214,33,28672
v_mfma_f32_16x16x32_bf16 v[216:219], a[240:243], v[232:235], 0
TR 216,34,24576
v_mfma_f32_16x16x32_bf16 v[220:223], a[240:243], v[236:239], 0
TR 218,34,28672
v_mfma_f32_16x16x32_bf16 v[148:151], a[224:227], v[96:99], v[200:203]
buffer_load_dword v61, v60, s[32:35], s81 offen
v_mfma_f32_16x16x32_bf16 v[148:151], a[228:231], v[100:103], v[148:151]
s_add_u32 s81, s81, 1048576
v_mfma_f32_16x16x32_bf16 v[148:151], a[232:235], v[104:107], v[148:151]
v_mfma_f32_16x16x32_bf16 v[148:151], a[236:239], v[108:111], v[148:151]
v_mfma_f32_16x16x32_bf16 v[156:159], a[236:239], v[124:127], v[204:207]
v_mfma_f32_16x16x32_bf16 v[156:159], a[232:235], v[120:123], v[156:159]
v_mfma_f32_16x16x32_bf16 v[156:159], a[228:231], v[116:119], v[156:159]
v_max3_f32 v56, v208, v212, v216
v_max_f32 v56, v56, v220
v_mfma_f32_16x16x32_bf16 v[156:159], a[224:227], v[112:115], v[156:159]
v_cmp_lt_f32 vcc, 0x49800000, v56
s_nop 0
s_cbranch_vccnz t1_c15
t1_r16:
WL 4
v_mfma_f32_16x16x32_bf16 a[0:3], a[208:211], v[224:227], a[0:3]
TR 220,35,24576
v_add_f32 v48, v48, v208
v_add_f32 v49, v49, v212
v_mfma_f32_16x16x32_bf16 a[32:35], a[208:211], v[228:231], a[32:35]
TR 222,35,28672
v_add_f32 v50, v50, v216
v_add_f32 v51, v51, v220
v_mfma_f32_16x16x32_bf16 a[64:67], a[208:211], v[232:235], a[64:67]
v_exp_f32 v128, v128
v_mfma_f32_16x16x32_bf16 a[96:99], a[208:211], v[236:239], a[96:99]
v_exp_f32 v129, v129
WL 4
v_mfma_f32_16x16x32_bf16 a[100:103], a[212:215], v[236:239], a[100:103]
TR 208,36,24576
v_mfma_f32_16x16x32_bf16 a[68:71], a[212:215], v[232:235], a[68:71]
TR 210,36,28672
v_mfma_f32_16x16x32_bf16 a[36:39], a[212:215], v[228:231], a[36:39]
v_exp_f32 v130, v130
v_mfma_f32_16x16x32_bf16 a[4:7], a[212:215], v[224:227], a[4:7]
v_exp_f32 v131, v131
WL 4
v_mfma_f32_16x16x32_bf16 a[8:11], a[216:219], v[224:227], a[8:11]
TR 212,37,24576
v_mfma_f32_16x16x32_bf16 a[40:43], a[216:219], v[228:231], a[40:43]
TR 214,37,28672
v_mfma_f32_16x16x32_bf16 a[72:75], a[216:219], v[232:235], a[72:75]
v_exp_f32 v136, v136
v_mfma_f32_16x16x32_bf16 a[104:107], a[216:219], v[236:239], a[104:107]
v_exp_f32 v137, v137
WL 4
v_mfma_f32_16x16x32_bf16 a[108:111], a[220:223], v[236:239], a[108:111]
TR 216,38,24576
v_mfma_f32_16x16x32_bf16 a[76:79], a[220:223], v[232:235], a[76:79]
TR 218,38,28672
v_mfma_f32_16x16x32_bf16 a[44:47], a[220:223], v[228:231], a[44:47]
v_exp_f32 v138, v138
v_mfma_f32_16x16x32_bf16 a[12:15], a[220:223], v[224:227], a[12:15]
v_exp_f32 v139, v139
WL 4
v_mfma_f32_16x16x32_bf16 a[16:19], a[208:211], v[224:227], a[16:19]
TR 220,39,24576
v_exp_f32 v144, v144
v_mfma_f32_16x16x32_bf16 a[48:51], a[208:211], v[228:231], a[48:51]
TR 222,39,28672
v_mfma_f32_16x16x32_bf16 a[80:83], a[208:211], v[232:235], a[80:83]
v_exp_f32 v145, v145
v_mfma_f32_16x16x32_bf16 a[112:115], a[208:211], v[236:239], a[112:115]
v_exp_f32 v146, v146
WL 4
v_mfma_f32_16x16x32_bf16 a[116:119], a[212:215], v[236:239], a[116:119]
ds_read_b128 a[192:195], v44 offset:40960
v_mfma_f32_16x16x32_bf16 a[84:87], a[212:215], v[232:235], a[84:87]
v_exp_f32 v147, v147
v_mfma_f32_16x16x32_bf16 a[52:55], a[212:215], v[228:231], a[52:55]
ds_read_b128 a[196:199], v45 offset:40960
v_mfma_f32_16x16x32_bf16 a[20:23], a[212:215], v[224:227], a[20:23]
v_exp_f32 v152, v152
WL 4
v_mfma_f32_16x16x32_bf16 a[24:27], a[216:219], v[224:227], a[24:27]
ds_read_b128 a[200:203], v46 offset:40960
v_mfma_f32_16x16x32_bf16 a[56:59], a[216:219], v[228:231], a[56:59]
v_exp_f32 v153, v153
v_mfma_f32_16x16x32_bf16 a[88:91], a[216:219], v[232:235], a[88:91]
ds_read_b128 a[204:207], v47 offset:40960
v_mfma_f32_16x16x32_bf16 a[120:123], a[216:219], v[236:239], a[120:123]
v_exp_f32 v154, v154
WL 4
v_mfma_f32_16x16x32_bf16 a[124:127], a[220:223], v[236:239], a[124:127]
v_exp_f32 v155, v155
v_mfma_f32_16x16x32_bf16 a[92:95], a[220:223], v[232:235], a[92:95]
v_exp_f32 v132, v132
v_mfma_f32_16x16x32_bf16 a[60:63], a[220:223], v[228:231], a[60:63]
v_exp_f32 v133, v133
v_mfma_f32_16x16x32_bf16 a[28:31], a[220:223], v[224:227], a[28:31]
v_exp_f32 v134, v134
v_cvt_pk_bf16_f32 v224, v128, v129
WL 0
v_mfma_f32_16x16x32_bf16 v[160:163], a[192:195], v[64:67], v[192:195]
v_exp_f32 v135, v135
v_mfma_f32_16x16x32_bf16 v[160:163], a[196:199], v[68:71], v[160:163]
ds_read_b128 a[224:227], v44 offset:45056
v_cvt_pk_bf16_f32 v225, v130, v131
v_mfma_f32_16x16x32_bf16 v[160:163], a[200:203], v[72:75], v[160:163]
v_exp_f32 v140, v140
v_mfma_f32_16x16x32_bf16 v[160:163], a[204:207], v[76:79], v[160:163]
ds_read_b128 a[228:231], v45 offset:45056
v_cvt_pk_bf16_f32 v228, v136, v137
v_mfma_f32_16x16x32_bf16 v[168:171], a[204:207], v[92:95], v[196:199]
v_exp_f32 v141, v141
v_mfma_f32_16x16x32_bf16 v[168:171], a[200:203], v[88:91], v[168:171]
ds_read_b128 a[232:235], v46 offset:45056
v_cvt_pk_bf16_f32 v229, v138, v139
v_mfma_f32_16x16x32_bf16 v[168:171], a[196:199], v[84:87], v[168:171]
v_exp_f32 v142, v142
v_mfma_f32_16x16x32_bf16 v[168:171], a[192:195], v[80:83], v[168:171]
ds_read_b128 a[236:239], v47 offset:45056
v_cvt_pk_bf16_f32 v232, v144, v145
v_mfma_f32_16x16x32_bf16 v[176:179], a[192:195], v[96:99], v[200:203]
v_exp_f32 v143, v143
v_mfma_f32_16x16x32_bf16 v[176:179], a[196:199], v[100:103], v[176:179]
v_exp_f32 v148, v148
v_mfma_f32_16x16x32_bf16 v[176:179], a[200:203], v[104:107], v[176:179]
v_exp_f32 v149, v149
v_mfma_f32_16x16x32_bf16 v[176:179], a[204:207], v[108:111], v[176:179]
buffer_load_dword v61, v60, s[84:87], s77 offen
v_mfma_f32_16x16x32_bf16 v[184:187], a[204:207], v[124:127], v[204:207]
v_exp_f32 v150, v150
v_mfma_f32_16x16x32_bf16 v[184:187], a[200:203], v[120:123], v[184:187]
v_exp_f32 v151, v151
v_cvt_pk_bf16_f32 v233, v146, v147
v_mfma_f32_16x16x32_bf16 v[184:187], a[196:199], v[116:119], v[184:187]
v_exp_f32 v156, v156
v_mfma_f32_16x16x32_bf16 v[184:187], a[192:195], v[112:115], v[184:187]
v_cvt_pk_bf16_f32 v236, v152, v153
v_cvt_pk_bf16_f32 v237, v154, v155
WL 0
v_mfma_f32_16x16x32_bf16 v[164:167], a[224:227], v[64:67], v[192:195]
v_exp_f32 v157, v157
v_mfma_f32_16x16x32_bf16 v[164:167], a[228:231], v[68:71], v[164:167]
v_cvt_pk_bf16_f32 v226, v132, v133
v_cvt_pk_bf16_f32 v227, v134, v135
v_mfma_f32_16x16x32_bf16 v[164:167], a[232:235], v[72:75], v[164:167]
v_exp_f32 v158, v158
v_mfma_f32_16x16x32_bf16 v[164:167], a[236:239], v[76:79], v[164:167]
v_cvt_pk_bf16_f32 v230, v140, v141
v_cvt_pk_bf16_f32 v231, v142, v143
v_mfma_f32_16x16x32_bf16 v[172:175], a[236:239], v[92:95], v[196:199]
TR 208,32,49152
v_cvt_pk_bf16_f32 v234, v148, v149
v_mfma_f32_16x16x32_bf16 v[172:175], a[232:235], v[88:91], v[172:175]
TR 210,32,53248
v_cvt_pk_bf16_f32 v235, v150, v151
v_mfma_f32_16x16x32_bf16 v[172:175], a[228:231], v[84:87], v[172:175]
v_exp_f32 v159, v159
v_mfma_f32_16x16x32_bf16 v[172:175], a[224:227], v[80:83], v[172:175]
v_cvt_pk_bf16_f32 v238, v156, v157
v_cvt_pk_bf16_f32 v239, v158, v159
v_mfma_f32_16x16x32_bf16 v[208:211], a[240:243], v[224:227], 0
TR 212,33,49152
v_mfma_f32_16x16x32_bf16 v[212:215], a[240:243], v[228:231], 0
TR 214,33,53248
v_mfma_f32_16x16x32_bf16 v[216:219], a[240:243], v[232:235], 0
TR 216,34,49152
v_mfma_f32_16x16x32_bf16 v[220:223], a[240:243], v[236:239], 0
TR 218,34,53248
v_mfma_f32_16x16x32_bf16 v[180:183], a[224:227], v[96:99], v[200:203]
buffer_load_dword v61, v60, s[32:35], s81 offen
v_mfma_f32_16x16x32_bf16 v[180:183], a[228:231], v[100:103], v[180:183]
s_add_u32 s81, s81, 1048576
v_mfma_f32_16x16x32_bf16 v[180:183], a[232:235], v[104:107], v[180:183]
v_mfma_f32_16x16x32_bf16 v[180:183], a[236:239], v[108:111], v[180:183]
v_mfma_f32_16x16x32_bf16 v[188:191], a[236:239], v[124:127], v[204:207]
v_mfma_f32_16x16x32_bf16 v[188:191], a[232:235], v[120:123], v[188:191]
v_mfma_f32_16x16x32_bf16 v[188:191], a[228:231], v[116:119], v[188:191]
v_max3_f32 v56, v208, v212, v216
v_max_f32 v56, v56, v220
v_mfma_f32_16x16x32_bf16 v[188:191], a[224:227], v[112:115], v[188:191]
v_cmp_lt_f32 vcc, 0x49800000, v56
s_nop 0
s_cbranch_vccnz t1_c17
t1_r18:
WL 4
v_mfma_f32_16x16x32_bf16 a[0:3], a[208:211], v[224:227], a[0:3]
TR 220,35,49152
v_add_f32 v48, v48, v208
v_add_f32 v49, v49, v212
v_mfma_f32_16x16x32_bf16 a[32:35], a[208:211], v[228:231], a[32:35]
TR 222,35,53248
v_add_f32 v50, v50, v216
v_add_f32 v51, v51, v220
v_mfma_f32_16x16x32_bf16 a[64:67], a[208:211], v[232:235], a[64:67]
v_exp_f32 v160, v160
v_mfma_f32_16x16x32_bf16 a[96:99], a[208:211], v[236:239], a[96:99]
v_exp_f32 v161, v161
WL 4
v_mfma_f32_16x16x32_bf16 a[100:103], a[212:215], v[236:239], a[100:103]
TR 208,36,49152
v_mfma_f32_16x16x32_bf16 a[68:71], a[212:215], v[232:235], a[68:71]
TR 210,36,53248
v_exp_f32 v162, v162
v_mfma_f32_16x16x32_bf16 a[36:39], a[212:215], v[228:231], a[36:39]
v_exp_f32 v163, v163
v_mfma_f32_16x16x32_bf16 a[4:7], a[212:215], v[224:227], a[4:7]
v_exp_f32 v168, v168
WL 4
v_mfma_f32_16x16x32_bf16 a[8:11], a[216:219], v[224:227], a[8:11]
TR 212,37,49152
v_exp_f32 v169, v169
v_mfma_f32_16x16x32_bf16 a[40:43], a[216:219], v[228:231], a[40:43]
TR 214,37,53248
v_mfma_f32_16x16x32_bf16 a[72:75], a[216:219], v[232:235], a[72:75]
v_exp_f32 v170, v170
v_mfma_f32_16x16x32_bf16 a[104:107], a[216:219], v[236:239], a[104:107]
v_exp_f32 v171, v171
WL 4
v_mfma_f32_16x16x32_bf16 a[108:111], a[220:223], v[236:239], a[108:111]
TR 216,38,49152
v_exp_f32 v176, v176
v_mfma_f32_16x16x32_bf16 a[76:79], a[220:223], v[232:235], a[76:79]
TR 218,38,53248
v_mfma_f32_16x16x32_bf16 a[44:47], a[220:223], v[228:231], a[44:47]
v_exp_f32 v177, v177
v_mfma_f32_16x16x32_bf16 a[12:15], a[220:223], v[224:227], a[12:15]
v_exp_f32 v178, v178
WL 4
v_mfma_f32_16x16x32_bf16 a[16:19], a[208:211], v[224:227], a[16:19]
TR 220,39,49152
v_exp_f32 v179, v179
v_mfma_f32_16x16x32_bf16 a[48:51], a[208:211], v[228:231], a[48:51]
TR 222,39,53248
v_mfma_f32_16x16x32_bf16 a[80:83], a[208:211], v[232:235], a[80:83]
v_exp_f32 v184, v184
v_mfma_f32_16x16x32_bf16 a[112:115], a[208:211], v[236:239], a[112:115]
v_exp_f32 v185, v185
WV 13
s_barrier
WL 4
v_mfma_f32_16x16x32_bf16 a[116:119], a[212:215], v[236:239], a[116:119]
ds_read_b128 a[192:195], v40 offset:0
v_exp_f32 v186, v186
v_mfma_f32_16x16x32_bf16 a[84:87], a[212:215], v[232:235], a[84:87]
v_exp_f32 v187, v187
v_mfma_f32_16x16x32_bf16 a[52:55], a[212:215], v[228:231], a[52:55]
ds_read_b128 a[196:199], v41 offset:0
s_add_u32 m0, s48, 65536
v_mfma_f32_16x16x32_bf16 a[20:23], a[212:215], v[224:227], a[20:23]
DM 8,20,52,0
WL 4
v_mfma_f32_16x16x32_bf16 a[24:27], a[216:219], v[224:227], a[24:27]
ds_read_b128 a[200:203], v42 offset:0
v_exp_f32 v164, v164
v_mfma_f32_16x16x32_bf16 a[56:59], a[216:219], v[228:231], a[56:59]
v_exp_f32 v165, v165
v_mfma_f32_16x16x32_bf16 a[88:91], a[216:219], v[232:235], a[88:91]
ds_read_b128 a[204:207], v43 offset:0
v_mfma_f32_16x16x32_bf16 a[120:123], a[216:219], v[236:239], a[120:123]
DM 9,20,52,1024
WL 4
v_mfma_f32_16x16x32_bf16 a[124:127], a[220:223], v[236:239], a[124:127]
v_exp_f32 v166, v166
v_mfma_f32_16x16x32_bf16 a[92:95], a[220:223], v[232:235], a[92:95]
v_exp_f32 v167, v167
v_mfma_f32_16x16x32_bf16 a[60:63], a[220:223], v[228:231], a[60:63]
v_exp_f32 v172, v172
v_mfma_f32_16x16x32_bf16 a[28:31], a[220:223], v[224:227], a[28:31]
DM 10,20,52,2048
v_cvt_pk_bf16_f32 v224, v160, v161
WL 0
v_mfma_f32_16x16x32_bf16 v[128:131], a[192:195], v[64:67], v[192:195]
v_exp_f32 v173, v173
v_mfma_f32_16x16x32_bf16 v[128:131], a[196:199], v[68:71], v[128:131]
ds_read_b128 a[224:227], v40 offset:4096
v_cvt_pk_bf16_f32 v225, v162, v163
v_mfma_f32_16x16x32_bf16 v[128:131], a[200:203], v[72:75], v[128:131]
v_exp_f32 v174, v174
v_mfma_f32_16x16x32_bf16 v[128:131], a[204:207], v[76:79], v[128:131]
ds_read_b128 a[228:231], v41 offset:4096
DM 11,20,52,3072
v_mfma_f32_16x16x32_bf16 v[136:139], a[204:207], v[92:95], v[196:199]
v_exp_f32 v175, v175
v_cvt_pk_bf16_f32 v228, v168, v169
v_mfma_f32_16x16x32_bf16 v[136:139], a[200:203], v[88:91], v[136:139]
ds_read_b128 a[232:235], v42 offset:4096
v_cvt_pk_bf16_f32 v229, v170, v171
v_mfma_f32_16x16x32_bf16 v[136:139], a[196:199], v[84:87], v[136:139]
s_add_u32 m0, s48, 81920
v_exp_f32 v180, v180
v_mfma_f32_16x16x32_bf16 v[136:139], a[192:195], v[80:83], v[136:139]
ds_read_b128 a[236:239], v43 offset:4096
DM 16,24,52,0
v_mfma_f32_16x16x32_bf16 v[144:147], a[192:195], v[96:99], v[200:203]
v_exp_f32 v181, v181
v_mfma_f32_16x16x32_bf16 v[144:147], a[196:199], v[100:103], v[144:147]
v_exp_f32 v182, v182
v_mfma_f32_16x16x32_bf16 v[144:147], a[200:203], v[104:107], v[144:147]
v_exp_f32 v183, v183
v_mfma_f32_16x16x32_bf16 v[144:147], a[204:207], v[108:111], v[144:147]
DM 4,24,52,1024
v_mfma_f32_16x16x32_bf16 v[152:155], a[204:207], v[124:127], v[204:207]
v_cvt_pk_bf16_f32 v232, v176, v177
v_cvt_pk_bf16_f32 v233, v178, v179
v_cvt_pk_bf16_f32 v236, v184, v185
v_mfma_f32_16x16x32_bf16 v[152:155], a[200:203], v[120:123], v[152:155]
v_exp_f32 v188, v188
v_mfma_f32_16x16x32_bf16 v[152:155], a[196:199], v[116:119], v[152:155]
v_cvt_pk_bf16_f32 v237, v186, v187
v_cvt_pk_bf16_f32 v226, v164, v165
v_mfma_f32_16x16x32_bf16 v[152:155], a[192:195], v[112:115], v[152:155]
DM 16,24,52,2048
WL 0
v_mfma_f32_16x16x32_bf16 v[132:135], a[224:227], v[64:67], v[192:195]
v_exp_f32 v189, v189
v_mfma_f32_16x16x32_bf16 v[132:135], a[228:231], v[68:71], v[132:135]
v_cvt_pk_bf16_f32 v227, v166, v167
v_cvt_pk_bf16_f32 v230, v172, v173
v_mfma_f32_16x16x32_bf16 v[132:135], a[232:235], v[72:75], v[132:135]
v_exp_f32 v190, v190
v_mfma_f32_16x16x32_bf16 v[132:135], a[236:239], v[76:79], v[132:135]
DM 4,24,52,3072
s_add_u32 s52, s52, 16384
v_mfma_f32_16x16x32_bf16 v[140:143], a[236:239], v[92:95], v[196:199]
TR 208,32,57344
v_cvt_pk_bf16_f32 v231, v174, v175
v_cvt_pk_bf16_f32 v234, v180, v181
v_mfma_f32_16x16x32_bf16 v[140:143], a[232:235], v[88:91], v[140:143]
TR 210,32,61440
v_cvt_pk_bf16_f32 v235, v182, v183
v_mfma_f32_16x16x32_bf16 v[140:143], a[228:231], v[84:87], v[140:143]
v_exp_f32 v191, v191
v_mfma_f32_16x16x32_bf16 v[140:143], a[224:227], v[80:83], v[140:143]
v_cvt_pk_bf16_f32 v238, v188, v189
v_cvt_pk_bf16_f32 v239, v190, v191
v_mfma_f32_16x16x32_bf16 v[208:211], a[240:243], v[224:227], 0
TR 212,33,57344
v_mfma_f32_16x16x32_bf16 v[212:215], a[240:243], v[228:231], 0
TR 214,33,61440
v_mfma_f32_16x16x32_bf16 v[216:219], a[240:243], v[232:235], 0
TR 216,34,57344
v_mfma_f32_16x16x32_bf16 v[220:223], a[240:243], v[236:239], 0
TR 218,34,61440
v_mfma_f32_16x16x32_bf16 v[148:151], a[224:227], v[96:99], v[200:203]
buffer_load_dword v61, v60, s[32:35], s81 offen
v_mfma_f32_16x16x32_bf16 v[148:151], a[228:231], v[100:103], v[148:151]
s_add_u32 s81, s81, 1048576
v_mfma_f32_16x16x32_bf16 v[148:151], a[232:235], v[104:107], v[148:151]
v_mfma_f32_16x16x32_bf16 v[148:151], a[236:239], v[108:111], v[148:151]
v_mfma_f32_16x16x32_bf16 v[156:159], a[236:239], v[124:127], v[204:207]
v_mfma_f32_16x16x32_bf16 v[156:159], a[232:235], v[120:123], v[156:159]
v_mfma_f32_16x16x32_bf16 v[156:159], a[228:231], v[116:119], v[156:159]
v_max3_f32 v56, v208, v212, v216
v_max_f32 v56, v56, v220
v_mfma_f32_16x16x32_bf16 v[156:159], a[224:227], v[112:115], v[156:159]
v_cmp_lt_f32 vcc, 0x49800000, v56
s_nop 0
s_cbranch_vccnz t1_c19
t1_r20:
WL 4
v_mfma_f32_16x16x32_bf16 a[0:3], a[208:211], v[224:227], a[0:3]
TR 220,35,57344
v_add_f32 v48, v48, v208
v_add_f32 v49, v49, v212
v_mfma_f32_16x16x32_bf16 a[32:35], a[208:211], v[228:231], a[32:35]
TR 222,35,61440
v_add_f32 v50, v50, v216
v_add_f32 v51, v51, v220
v_mfma_f32_16x16x32_bf16 a[64:67], a[208:211], v[232:235], a[64:67]
v_exp_f32 v128, v128
v_mfma_f32_16x16x32_bf16 a[96:99], a[208:211], v[236:239], a[96:99]
v_exp_f32 v129, v129
WL 4
v_mfma_f32_16x16x32_bf16 a[100:103], a[212:215], v[236:239], a[100:103]
TR 208,36,57344
v_mfma_f32_16x16x32_bf16 a[68:71], a[212:215], v[232:235], a[68:71]
TR 210,36,61440
v_mfma_f32_16x16x32_bf16 a[36:39], a[212:215], v[228:231], a[36:39]
v_exp_f32 v130, v130
v_mfma_f32_16x16x32_bf16 a[4:7], a[212:215], v[224:227], a[4:7]
v_exp_f32 v131, v131
WL 4
v_mfma_f32_16x16x32_bf16 a[8:11], a[216:219], v[224:227], a[8:11]
TR 212,37,57344
v_exp_f32 v136, v136
v_mfma_f32_16x16x32_bf16 a[40:43], a[216:219], v[228:231], a[40:43]
TR 214,37,61440
v_exp_f32 v137, v137
v_mfma_f32_16x16x32_bf16 a[72:75], a[216:219], v[232:235], a[72:75]
v_exp_f32 v138, v138
v_mfma_f32_16x16x32_bf16 a[104:107], a[216:219], v[236:239], a[104:107]
v_exp_f32 v139, v139
WL 4
v_mfma_f32_16x16x32_bf16 a[108:111], a[220:223], v[236:239], a[108:111]
TR 216,38,57344
v_mfma_f32_16x16x32_bf16 a[76:79], a[220:223], v[232:235], a[76:79]
TR 218,38,61440
v_mfma_f32_16x16x32_bf16 a[44:47], a[220:223], v[228:231], a[44:47]
v_exp_f32 v144, v144
v_mfma_f32_16x16x32_bf16 a[12:15], a[220:223], v[224:227], a[12:15]
v_exp_f32 v145, v145
WL 4
v_mfma_f32_16x16x32_bf16 a[16:19], a[208:211], v[224:227], a[16:19]
TR 220,39,57344
v_exp_f32 v146, v146
v_mfma_f32_16x16x32_bf16 a[48:51], a[208:211], v[228:231], a[48:51]
TR 222,39,61440
v_mfma_f32_16x16x32_bf16 a[80:83], a[208:211], v[232:235], a[80:83]
v_exp_f32 v147, v147
v_mfma_f32_16x16x32_bf16 a[112:115], a[208:211], v[236:239], a[112:115]
v_exp_f32 v152, v152
WL 4
v_mfma_f32_16x16x32_bf16 a[116:119], a[212:215], v[236:239], a[116:119]
ds_read_b128 a[192:195], v40 offset:8192
v_exp_f32 v153, v153
v_mfma_f32_16x16x32_bf16 a[84:87], a[212:215], v[232:235], a[84:87]
v_exp_f32 v154, v154
v_mfma_f32_16x16x32_bf16 a[52:55], a[212:215], v[228:231], a[52:55]
ds_read_b128 a[196:199], v41 offset:8192
v_mfma_f32_16x16x32_bf16 a[20:23], a[212:215], v[224:227], a[20:23]
v_exp_f32 v155, v155
WL 4
v_mfma_f32_16x16x32_bf16 a[24:27], a[216:219], v[224:227], a[24:27]
ds_read_b128 a[200:203], v42 offset:8192
v_mfma_f32_16x16x32_bf16 a[56:59], a[216:219], v[228:231], a[56:59]
v_exp_f32 v132, v132
v_mfma_f32_16x16x32_bf16 a[88:91], a[216:219], v[232:235], a[88:91]
ds_read_b128 a[204:207], v43 offset:8192
v_exp_f32 v133, v133
v_mfma_f32_16x16x32_bf16 a[120:123], a[216:219], v[236:239], a[120:123]
v_exp_f32 v134, v134
WL 4
v_mfma_f32_16x16x32_bf16 a[124:127], a[220:223], v[236:239], a[124:127]
v_exp_f32 v135, v135
v_mfma_f32_16x16x32_bf16 a[92:95], a[220:223], v[232:235], a[92:95]
v_exp_f32 v140, v140
v_mfma_f32_16x16x32_bf16 a[60:63], a[220:223], v[228:231], a[60:63]
v_exp_f32 v141, v141
v_mfma_f32_16x16x32_bf16 a[28:31], a[220:223], v[224:227], a[28:31]
v_exp_f32 v142, v142
WL 0
v_mfma_f32_16x16x32_bf16 v[160:163], a[192:195], v[64:67], v[192:195]
v_exp_f32 v143, v143
v_mfma_f32_16x16x32_bf16 v[160:163], a[196:199], v[68:71], v[160:163]
ds_read_b128 a[224:227], v40 offset:12288
v_cvt_pk_bf16_f32 v224, v128, v129
v_mfma_f32_16x16x32_bf16 v[160:163], a[200:203], v[72:75], v[160:163]
v_exp_f32 v148, v148
v_cvt_pk_bf16_f32 v225, v130, v131
v_mfma_f32_16x16x32_bf16 v[160:163], a[204:207], v[76:79], v[160:163]
ds_read_b128 a[228:231], v41 offset:12288
s_lshl_b32 s51, s58, 2
v_mfma_f32_16x16x32_bf16 v[168:171], a[204:207], v[92:95], v[196:199]
v_exp_f32 v149, v149
v_mfma_f32_16x16x32_bf16 v[168:171], a[200:203], v[88:91], v[168:171]
ds_read_b128 a[232:235], v42 offset:12288
s_add_u32 s51, s51, s44
v_mfma_f32_16x16x32_bf16 v[168:171], a[196:199], v[84:87], v[168:171]
v_exp_f32 v150, v150
v_mfma_f32_16x16x32_bf16 v[168:171], a[192:195], v[80:83], v[168:171]
ds_read_b128 a[236:239], v43 offset:12288
s_mul_i32 s51, s51, 131072
v_cvt_pk_bf16_f32 v228, v136, v137
v_mfma_f32_16x16x32_bf16 v[176:179], a[192:195], v[96:99], v[200:203]
v_cvt_pk_bf16_f32 v229, v138, v139
v_cvt_pk_bf16_f32 v232, v144, v145
v_mfma_f32_16x16x32_bf16 v[176:179], a[196:199], v[100:103], v[176:179]
s_add_u32 s51, s51, 12582912
v_cvt_pk_bf16_f32 v233, v146, v147
v_mfma_f32_16x16x32_bf16 v[176:179], a[200:203], v[104:107], v[176:179]
v_exp_f32 v151, v151
v_mfma_f32_16x16x32_bf16 v[176:179], a[204:207], v[108:111], v[176:179]
s_mul_i32 s53, s44, 114688
v_cvt_pk_bf16_f32 v236, v152, v153
v_mfma_f32_16x16x32_bf16 v[184:187], a[204:207], v[124:127], v[204:207]
v_exp_f32 v156, v156
v_mfma_f32_16x16x32_bf16 v[184:187], a[200:203], v[120:123], v[184:187]
s_mul_i32 s62, s59, 192
v_cvt_pk_bf16_f32 v237, v154, v155
v_cvt_pk_bf16_f32 v226, v132, v133
v_mfma_f32_16x16x32_bf16 v[184:187], a[196:199], v[116:119], v[184:187]
v_exp_f32 v157, v157
v_mfma_f32_16x16x32_bf16 v[184:187], a[192:195], v[112:115], v[184:187]
s_add_u32 s53, s53, s62
v_cvt_pk_bf16_f32 v227, v134, v135
WL 0
v_mfma_f32_16x16x32_bf16 v[164:167], a[224:227], v[64:67], v[192:195]
v_exp_f32 v158, v158
v_mfma_f32_16x16x32_bf16 v[164:167], a[228:231], v[68:71], v[164:167]
s_mov_b32 s62, 7168
v_cvt_pk_bf16_f32 v230, v140, v141
v_mfma_f32_16x16x32_bf16 v[164:167], a[232:235], v[72:75], v[164:167]
v_cvt_pk_bf16_f32 v231, v142, v143
v_cvt_pk_bf16_f32 v234, v148, v149
v_mfma_f32_16x16x32_bf16 v[164:167], a[236:239], v[76:79], v[164:167]
v_mad_u32_u24 v12, v19, s62, v20
v_cvt_pk_bf16_f32 v235, v150, v151
v_mfma_f32_16x16x32_bf16 v[172:175], a[236:239], v[92:95], v[196:199]
TR 208,24,16384
v_cvt_pk_bf16_f32 v238, v156, v157
v_mfma_f32_16x16x32_bf16 v[172:175], a[232:235], v[88:91], v[172:175]
TR 210,24,20480
v_xor_b32 v13, 128, v12
v_mfma_f32_16x16x32_bf16 v[172:175], a[228:231], v[84:87], v[172:175]
v_exp_f32 v159, v159
v_mfma_f32_16x16x32_bf16 v[172:175], a[224:227], v[80:83], v[172:175]
v_add_u32 v14, 55296, v12
v_cvt_pk_bf16_f32 v239, v158, v159
v_mfma_f32_16x16x32_bf16 v[208:211], a[240:243], v[224:227], 0
TR 212,25,16384
v_mfma_f32_16x16x32_bf16 v[212:215], a[240:243], v[228:231], 0
TR 214,25,20480
v_mfma_f32_16x16x32_bf16 v[216:219], a[240:243], v[232:235], 0
v_add_u32 v15, 82944, v13
v_mfma_f32_16x16x32_bf16 v[220:223], a[240:243], v[236:239], 0
TR 216,26,16384
v_mfma_f32_16x16x32_bf16 v[180:183], a[224:227], v[96:99], v[200:203]
TR 218,26,20480
v_mfma_f32_16x16x32_bf16 v[180:183], a[228:231], v[100:103], v[180:183]
buffer_load_dword v61, v60, s[32:35], s81 offen
v_mfma_f32_16x16x32_bf16 v[180:183], a[232:235], v[104:107], v[180:183]
s_add_u32 s81, s81, 1048576
v_mfma_f32_16x16x32_bf16 v[180:183], a[236:239], v[108:111], v[180:183]
v_mfma_f32_16x16x32_bf16 v[188:191], a[236:239], v[124:127], v[204:207]
v_mfma_f32_16x16x32_bf16 v[188:191], a[232:235], v[120:123], v[188:191]
v_mfma_f32_16x16x32_bf16 v[188:191], a[228:231], v[116:119], v[188:191]
v_max3_f32 v56, v208, v212, v216
v_max_f32 v56, v56, v220
v_mfma_f32_16x16x32_bf16 v[188:191], a[224:227], v[112:115], v[188:191]
v_cmp_lt_f32 vcc, 0x49800000, v56
s_nop 0
s_cbranch_vccnz t1_c21
t1_r22:
WL 4
v_mfma_f32_16x16x32_bf16 a[0:3], a[208:211], v[224:227], a[0:3]
TR 220,27,16384
v_add_f32 v48, v48, v208
v_add_f32 v49, v49, v212
v_mfma_f32_16x16x32_bf16 a[32:35], a[208:211], v[228:231], a[32:35]
TR 222,27,20480
v_add_f32 v50, v50, v216
v_add_f32 v51, v51, v220
v_mfma_f32_16x16x32_bf16 a[64:67], a[208:211], v[232:235], a[64:67]
v_exp_f32 v160, v160
v_mfma_f32_16x16x32_bf16 a[96:99], a[208:211], v[236:239], a[96:99]
v_exp_f32 v161, v161
WL 4
v_mfma_f32_16x16x32_bf16 a[100:103], a[212:215], v[236:239], a[100:103]
TR 208,28,16384
v_exp_f32 v162, v162
v_mfma_f32_16x16x32_bf16 a[68:71], a[212:215], v[232:235], a[68:71]
TR 210,28,20480
v_mfma_f32_16x16x32_bf16 a[36:39], a[212:215], v[228:231], a[36:39]
v_exp_f32 v163, v163
v_mfma_f32_16x16x32_bf16 a[4:7], a[212:215], v[224:227], a[4:7]
v_exp_f32 v168, v168
WL 4
v_mfma_f32_16x16x32_bf16 a[8:11], a[216:219], v[224:227], a[8:11]
TR 212,29,16384
v_exp_f32 v169, v169
v_mfma_f32_16x16x32_bf16 a[40:43], a[216:219], v[228:231], a[40:43]
TR 214,29,20480
v_exp_f32 v170, v170
v_mfma_f32_16x16x32_bf16 a[72:75], a[216:219], v[232:235], a[72:75]
v_exp_f32 v171, v171
v_mfma_f32_16x16x32_bf16 a[104:107], a[216:219], v[236:239], a[104:107]
v_exp_f32 v176, v176
WL 4
v_mfma_f32_16x16x32_bf16 a[108:111], a[220:223], v[236:239], a[108:111]
TR 216,30,16384
v_exp_f32 v177, v177
v_mfma_f32_16x16x32_bf16 a[76:79], a[220:223], v[232:235], a[76:79]
TR 218,30,20480
v_mfma_f32_16x16x32_bf16 a[44:47], a[220:223], v[228:231], a[44:47]
v_exp_f32 v178, v178
v_mfma_f32_16x16x32_bf16 a[12:15], a[220:223], v[224:227], a[12:15]
v_exp_f32 v179, v179
WL 4
v_mfma_f32_16x16x32_bf16 a[16:19], a[208:211], v[224:227], a[16:19]
TR 220,31,16384
v_exp_f32 v184, v184
v_mfma_f32_16x16x32_bf16 a[48:51], a[208:211], v[228:231], a[48:51]
TR 222,31,20480
v_mfma_f32_16x16x32_bf16 a[80:83], a[208:211], v[232:235], a[80:83]
v_exp_f32 v185, v185
v_mfma_f32_16x16x32_bf16 a[112:115], a[208:211], v[236:239], a[112:115]
v_exp_f32 v186, v186
WV 13
s_barrier
WL 4
v_mfma_f32_16x16x32_bf16 a[116:119], a[212:215], v[236:239], a[116:119]
ds_read_b128 a[192:195], v40 offset:32768
v_exp_f32 v187, v187
v_mfma_f32_16x16x32_bf16 a[84:87], a[212:215], v[232:235], a[84:87]
v_exp_f32 v164, v164
v_mfma_f32_16x16x32_bf16 a[52:55], a[212:215], v[228:231], a[52:55]
ds_read_b128 a[196:199], v41 offset:32768
s_add_u32 m0, s48, 98304
v_exp_f32 v165, v165
v_mfma_f32_16x16x32_bf16 a[20:23], a[212:215], v[224:227], a[20:23]
DM 8,20,52,0
WL 4
v_mfma_f32_16x16x32_bf16 a[24:27], a[216:219], v[224:227], a[24:27]
ds_read_b128 a[200:203], v42 offset:32768
v_mfma_f32_16x16x32_bf16 a[56:59], a[216:219], v[228:231], a[56:59]
v_exp_f32 v166, v166
v_mfma_f32_16x16x32_bf16 a[88:91], a[216:219], v[232:235], a[88:91]
ds_read_b128 a[204:207], v43 offset:32768
v_exp_f32 v167, v167
v_mfma_f32_16x16x32_bf16 a[120:123], a[216:219], v[236:239], a[120:123]
DM 9,20,52,1024
WL 4
v_mfma_f32_16x16x32_bf16 a[124:127], a[220:223], v[236:239], a[124:127]
v_exp_f32 v172, v172
v_mfma_f32_16x16x32_bf16 a[92:95], a[220:223], v[232:235], a[92:95]
v_exp_f32 v173, v173
v_mfma_f32_16x16x32_bf16 a[60:63], a[220:223], v[228:231], a[60:63]
v_exp_f32 v174, v174
v_mfma_f32_16x16x32_bf16 a[28:31], a[220:223], v[224:227], a[28:31]
DM 10,20,52,2048
v_cvt_pk_bf16_f32 v224, v160, v161
WL 0
v_mfma_f32_16x16x32_bf16 v[128:131], a[192:195], v[64:67], v[192:195]
v_exp_f32 v175, v175
v_mfma_f32_16x16x32_bf16 v[128:131], a[196:199], v[68:71], v[128:131]
ds_read_b128 a[224:227], v40 offset:36864
v_cvt_pk_bf16_f32 v225, v162, v163
v_mfma_f32_16x16x32_bf16 v[128:131], a[200:203], v[72:75], v[128:131]
v_exp_f32 v180, v180
v_mfma_f32_16x16x32_bf16 v[128:131], a[204:207], v[76:79], v[128:131]
ds_read_b128 a[228:231], v41 offset:36864
DM 11,20,52,3072
v_add_u32 v13, 27648, v13
v_mfma_f32_16x16x32_bf16 v[136:139], a[204:207], v[92:95], v[196:199]
v_exp_f32 v181, v181
v_cvt_pk_bf16_f32 v228, v168, v169
v_mfma_f32_16x16x32_bf16 v[136:139], a[200:203], v[88:91], v[136:139]
ds_read_b128 a[232:235], v42 offset:36864
s_mov_b32 s62, 192
v_cvt_pk_bf16_f32 v229, v170, v171
v_mfma_f32_16x16x32_bf16 v[136:139], a[196:199], v[84:87], v[136:139]
s_add_u32 m0, s48, 114688
v_cvt_pk_bf16_f32 v232, v176, v177
v_mfma_f32_16x16x32_bf16 v[136:139], a[192:195], v[80:83], v[136:139]
ds_read_b128 a[236:239], v43 offset:36864
DM 16,24,52,0
v_mov_b32 v23, 0x80000000
v_mfma_f32_16x16x32_bf16 v[144:147], a[192:195], v[96:99], v[200:203]
v_exp_f32 v182, v182
v_mfma_f32_16x16x32_bf16 v[144:147], a[196:199], v[100:103], v[144:147]
v_cmp_gt_u32 s[68:69], s62, v20
v_cvt_pk_bf16_f32 v233, v178, v179
v_mfma_f32_16x16x32_bf16 v[144:147], a[200:203], v[104:107], v[144:147]
v_exp_f32 v183, v183
v_mfma_f32_16x16x32_bf16 v[144:147], a[204:207], v[108:111], v[144:147]
DM 4,24,52,1024
v_cndmask_b32 v12, v23, v12, s[68:69]
v_mfma_f32_16x16x32_bf16 v[152:155], a[204:207], v[124:127], v[204:207]
v_exp_f32 v188, v188
v_cvt_pk_bf16_f32 v236, v184, v185
v_mfma_f32_16x16x32_bf16 v[152:155], a[200:203], v[120:123], v[152:155]
v_cndmask_b32 v14, v23, v14, s[68:69]
v_cvt_pk_bf16_f32 v237, v186, v187
v_mfma_f32_16x16x32_bf16 v[152:155], a[196:199], v[116:119], v[152:155]
v_exp_f32 v189, v189
v_mfma_f32_16x16x32_bf16 v[152:155], a[192:195], v[112:115], v[152:155]
DM 16,24,52,2048
v_xor_b32 v17, 128, v20
WL 0
v_mfma_f32_16x16x32_bf16 v[132:135], a[224:227], v[64:67], v[192:195]
v_cvt_pk_bf16_f32 v226, v164, v165
v_cvt_pk_bf16_f32 v227, v166, v167
v_cvt_pk_bf16_f32 v230, v172, v173
v_mfma_f32_16x16x32_bf16 v[132:135], a[228:231], v[68:71], v[132:135]
v_cmp_gt_u32 s[68:69], s62, v17
v_cvt_pk_bf16_f32 v231, v174, v175
v_mfma_f32_16x16x32_bf16 v[132:135], a[232:235], v[72:75], v[132:135]
v_exp_f32 v190, v190
v_mfma_f32_16x16x32_bf16 v[132:135], a[236:239], v[76:79], v[132:135]
DM 4,24,52,3072
s_add_u32 s52, s52, 16384
v_cndmask_b32 v13, v23, v13, s[68:69]
v_mfma_f32_16x16x32_bf16 v[140:143], a[236:239], v[92:95], v[196:199]
TR 208,24,24576
v_exp_f32 v191, v191
v_mfma_f32_16x16x32_bf16 v[140:143], a[232:235], v[88:91], v[140:143]
TR 210,24,28672
v_cndmask_b32 v15, v23, v15, s[68:69]
v_mfma_f32_16x16x32_bf16 v[140:143], a[228:231], v[84:87], v[140:143]
v_cvt_pk_bf16_f32 v234, v180, v181
v_cvt_pk_bf16_f32 v235, v182, v183
v_mfma_f32_16x16x32_bf16 v[140:143], a[224:227], v[80:83], v[140:143]
v_cvt_pk_bf16_f32 v238, v188, v189
v_cvt_pk_bf16_f32 v239, v190, v191
v_mfma_f32_16x16x32_bf16 v[208:211], a[240:243], v[224:227], 0
TR 212,25,24576
v_mfma_f32_16x16x32_bf16 v[212:215], a[240:243], v[228:231], 0
TR 214,25,28672
v_mfma_f32_16x16x32_bf16 v[216:219], a[240:243], v[232:235], 0
TR 216,26,24576
v_mfma_f32_16x16x32_bf16 v[220:223], a[240:243], v[236:239], 0
TR 218,26,28672
v_mfma_f32_16x16x32_bf16 v[148:151], a[224:227], v[96:99], v[200:203]
buffer_load_dword v61, v60, s[32:35], s81 offen
v_mfma_f32_16x16x32_bf16 v[148:151], a[228:231], v[100:103], v[148:151]
s_add_u32 s81, s81, 1048576
v_mfma_f32_16x16x32_bf16 v[148:151], a[232:235], v[104:107], v[148:151]
v_mfma_f32_16x16x32_bf16 v[148:151], a[236:239], v[108:111], v[148:151]
v_mfma_f32_16x16x32_bf16 v[156:159], a[236:239], v[124:127], v[204:207]
v_mfma_f32_16x16x32_bf16 v[156:159], a[232:235], v[120:123], v[156:159]
v_mfma_f32_16x16x32_bf16 v[156:159], a[228:231], v[116:119], v[156:159]
v_max3_f32 v56, v208, v212, v216
v_max_f32 v56, v56, v220
v_mfma_f32_16x16x32_bf16 v[156:159], a[224:227], v[112:115], v[156:159]
v_cmp_lt_f32 vcc, 0x49800000, v56
s_nop 0
s_cbranch_vccnz t1_c23
t1_r24:
WL 4
v_mfma_f32_16x16x32_bf16 a[0:3], a[208:211], v[224:227], a[0:3]
TR 220,27,24576
v_add_f32 v48, v48, v208
v_add_f32 v49, v49, v212
v_mfma_f32_16x16x32_bf16 a[32:35], a[208:211], v[228:231], a[32:35]
TR 222,27,28672
v_add_f32 v50, v50, v216
v_add_f32 v51, v51, v220
v_mfma_f32_16x16x32_bf16 a[64:67], a[208:211], v[232:235], a[64:67]
v_exp_f32 v128, v128
v_mfma_f32_16x16x32_bf16 a[96:99], a[208:211], v[236:239], a[96:99]
v_exp_f32 v129, v129
WL 4
v_mfma_f32_16x16x32_bf16 a[100:103], a[212:215], v[236:239], a[100:103]
TR 208,28,24576
v_mfma_f32_16x16x32_bf16 a[68:71], a[212:215], v[232:235], a[68:71]
TR 210,28,28672
v_mfma_f32_16x16x32_bf16 a[36:39], a[212:215], v[228:231], a[36:39]
v_exp_f32 v130, v130
v_mfma_f32_16x16x32_bf16 a[4:7], a[212:215], v[224:227], a[4:7]
v_exp_f32 v131, v131
WL 4
v_mfma_f32_16x16x32_bf16 a[8:11], a[216:219], v[224:227], a[8:11]
TR 212,29,24576
v_mfma_f32_16x16x32_bf16 a[40:43], a[216:219], v[228:231], a[40:43]
TR 214,29,28672
v_mfma_f32_16x16x32_bf16 a[72:75], a[216:219], v[232:235], a[72:75]
v_exp_f32 v136, v136
v_mfma_f32_16x16x32_bf16 a[104:107], a[216:219], v[236:239], a[104:107]
v_exp_f32 v137, v137
WL 4
v_mfma_f32_16x16x32_bf16 a[108:111], a[220:223], v[236:239], a[108:111]
TR 216,30,24576
v_mfma_f32_16x16x32_bf16 a[76:79], a[220:223], v[232:235], a[76:79]
TR 218,30,28672
v_mfma_f32_16x16x32_bf16 a[44:47], a[220:223], v[228:231], a[44:47]
v_exp_f32 v138, v138
v_mfma_f32_16x16x32_bf16 a[12:15], a[220:223], v[224:227], a[12:15]
v_exp_f32 v139, v139
WL 4
v_mfma_f32_16x16x32_bf16 a[16:19], a[208:211], v[224:227], a[16:19]
TR 220,31,24576
v_exp_f32 v144, v144
v_mfma_f32_16x16x32_bf16 a[48:51], a[208:211], v[228:231], a[48:51]
TR 222,31,28672
v_mfma_f32_16x16x32_bf16 a[80:83], a[208:211], v[232:235], a[80:83]
v_exp_f32 v145, v145
v_mfma_f32_16x16x32_bf16 a[112:115], a[208:211], v[236:239], a[112:115]
v_exp_f32 v146, v146
WL 4
v_mfma_f32_16x16x32_bf16 a[116:119], a[212:215], v[236:239], a[116:119]
ds_read_b128 a[192:195], v40 offset:40960
v_mfma_f32_16x16x32_bf16 a[84:87], a[212:215], v[232:235], a[84:87]
v_exp_f32 v147, v147
v_mfma_f32_16x16x32_bf16 a[52:55], a[212:215], v[228:231], a[52:55]
ds_read_b128 a[196:199], v41 offset:40960
v_mfma_f32_16x16x32_bf16 a[20:23], a[212:215], v[224:227], a[20:23]
v_exp_f32 v152, v152
WL 4
v_mfma_f32_16x16x32_bf16 a[24:27], a[216:219], v[224:227], a[24:27]
ds_read_b128 a[200:203], v42 offset:40960
v_mfma_f32_16x16x32_bf16 a[56:59], a[216:219], v[228:231], a[56:59]
v_exp_f32 v153, v153
v_mfma_f32_16x16x32_bf16 a[88:91], a[216:219], v[232:235], a[88:91]
ds_read_b128 a[204:207], v43 offset:40960
v_mfma_f32_16x16x32_bf16 a[120:123], a[216:219], v[236:239], a[120:123]
v_exp_f32 v154, v154
WL 4
v_mfma_f32_16x16x32_bf16 a[124:127], a[220:223], v[236:239], a[124:127]
v_exp_f32 v155, v155
v_mfma_f32_16x16x32_bf16 a[92:95], a[220:223], v[232:235], a[92:95]
v_exp_f32 v132, v132
v_mfma_f32_16x16x32_bf16 a[60:63], a[220:223], v[228:231], a[60:63]
v_exp_f32 v133, v133
v_mfma_f32_16x16x32_bf16 a[28:31], a[220:223], v[224:227], a[28:31]
v_exp_f32 v134, v134
v_cvt_pk_bf16_f32 v224, v128, v129
WL 0
v_mfma_f32_16x16x32_bf16 v[160:163], a[192:195], v[64:67], v[192:195]
v_exp_f32 v135, v135
v_mfma_f32_16x16x32_bf16 v[160:163], a[196:199], v[68:71], v[160:163]
ds_read_b128 a[224:227], v40 offset:45056
v_cvt_pk_bf16_f32 v225, v130, v131
v_mfma_f32_16x16x32_bf16 v[160:163], a[200:203], v[72:75], v[160:163]
v_exp_f32 v140, v140
v_mfma_f32_16x16x32_bf16 v[160:163], a[204:207], v[76:79], v[160:163]
ds_read_b128 a[228:231], v41 offset:45056
v_cvt_pk_bf16_f32 v228, v136, v137
v_mfma_f32_16x16x32_bf16 v[168:171], a[204:207], v[92:95], v[196:199]
v_exp_f32 v141, v141
v_mfma_f32_16x16x32_bf16 v[168:171], a[200:203], v[88:91], v[168:171]
ds_read_b128 a[232:235], v42 offset:45056
v_cvt_pk_bf16_f32 v229, v138, v139
v_mfma_f32_16x16x32_bf16 v[168:171], a[196:199], v[84:87], v[168:171]
v_exp_f32 v142, v142
v_mfma_f32_16x16x32_bf16 v[168:171], a[192:195], v[80:83], v[168:171]
ds_read_b128 a[236:239], v43 offset:45056
v_cvt_pk_bf16_f32 v232, v144, v145
v_mfma_f32_16x16x32_bf16 v[176:179], a[192:195], v[96:99], v[200:203]
v_exp_f32 v143, v143
v_mfma_f32_16x16x32_bf16 v[176:179], a[196:199], v[100:103], v[176:179]
v_exp_f32 v148, v148
v_mfma_f32_16x16x32_bf16 v[176:179], a[200:203], v[104:107], v[176:179]
v_exp_f32 v149, v149
v_mfma_f32_16x16x32_bf16 v[176:179], a[204:207], v[108:111], v[176:179]
buffer_load_dword v61, v60, s[84:87], s77 offen
v_mfma_f32_16x16x32_bf16 v[184:187], a[204:207], v[124:127], v[204:207]
v_exp_f32 v150, v150
v_mfma_f32_16x16x32_bf16 v[184:187], a[200:203], v[120:123], v[184:187]
v_exp_f32 v151, v151
v_cvt_pk_bf16_f32 v233, v146, v147
v_mfma_f32_16x16x32_bf16 v[184:187], a[196:199], v[116:119], v[184:187]
v_exp_f32 v156, v156
v_mfma_f32_16x16x32_bf16 v[184:187], a[192:195], v[112:115], v[184:187]
v_cvt_pk_bf16_f32 v236, v152, v153
v_cvt_pk_bf16_f32 v237, v154, v155
WL 0
v_mfma_f32_16x16x32_bf16 v[164:167], a[224:227], v[64:67], v[192:195]
v_exp_f32 v157, v157
v_mfma_f32_16x16x32_bf16 v[164:167], a[228:231], v[68:71], v[164:167]
v_cvt_pk_bf16_f32 v226, v132, v133
v_cvt_pk_bf16_f32 v227, v134, v135
v_mfma_f32_16x16x32_bf16 v[164:167], a[232:235], v[72:75], v[164:167]
v_exp_f32 v158, v158
v_mfma_f32_16x16x32_bf16 v[164:167], a[236:239], v[76:79], v[164:167]
v_cvt_pk_bf16_f32 v230, v140, v141
v_cvt_pk_bf16_f32 v231, v142, v143
v_mfma_f32_16x16x32_bf16 v[172:175], a[236:239], v[92:95], v[196:199]
TR 208,24,49152
v_cvt_pk_bf16_f32 v234, v148, v149
v_mfma_f32_16x16x32_bf16 v[172:175], a[232:235], v[88:91], v[172:175]
TR 210,24,53248
v_cvt_pk_bf16_f32 v235, v150, v151
v_mfma_f32_16x16x32_bf16 v[172:175], a[228:231], v[84:87], v[172:175]
v_exp_f32 v159, v159
v_mfma_f32_16x16x32_bf16 v[172:175], a[224:227], v[80:83], v[172:175]
v_cvt_pk_bf16_f32 v238, v156, v157
v_cvt_pk_bf16_f32 v239, v158, v159
v_mfma_f32_16x16x32_bf16 v[208:211], a[240:243], v[224:227], 0
TR 212,25,49152
v_mfma_f32_16x16x32_bf16 v[212:215], a[240:243], v[228:231], 0
TR 214,25,53248
v_mfma_f32_16x16x32_bf16 v[216:219], a[240:243], v[232:235], 0
TR 216,26,49152
v_mfma_f32_16x16x32_bf16 v[220:223], a[240:243], v[236:239], 0
TR 218,26,53248
v_mfma_f32_16x16x32_bf16 v[180:183], a[224:227], v[96:99], v[200:203]
buffer_load_dword v61, v60, s[32:35], s81 offen
v_mfma_f32_16x16x32_bf16 v[180:183], a[228:231], v[100:103], v[180:183]
s_add_u32 s81, s81, 1048576
v_mfma_f32_16x16x32_bf16 v[180:183], a[232:235], v[104:107], v[180:183]
v_mfma_f32_16x16x32_bf16 v[180:183], a[236:239], v[108:111], v[180:183]
v_mfma_f32_16x16x32_bf16 v[188:191], a[236:239], v[124:127], v[204:207]
v_mfma_f32_16x16x32_bf16 v[188:191], a[232:235], v[120:123], v[188:191]
v_mfma_f32_16x16x32_bf16 v[188:191], a[228:231], v[116:119], v[188:191]
v_max3_f32 v56, v208, v212, v216
v_max_f32 v56, v56, v220
v_mfma_f32_16x16x32_bf16 v[188:191], a[224:227], v[112:115], v[188:191]
v_cmp_lt_f32 vcc, 0x49800000, v56
s_nop 0
s_cbranch_vccnz t1_c25
t1_r26:
WL 4
v_mfma_f32_16x16x32_bf16 a[0:3], a[208:211], v[224:227], a[0:3]
TR 220,27,49152
v_add_f32 v48, v48, v208
v_add_f32 v49, v49, v212
v_mfma_f32_16x16x32_bf16 a[32:35], a[208:211], v[228:231], a[32:35]
TR 222,27,53248
v_add_f32 v50, v50, v216
v_add_f32 v51, v51, v220
v_mfma_f32_16x16x32_bf16 a[64:67], a[208:211], v[232:235], a[64:67]
v_exp_f32 v160, v160
v_mfma_f32_16x16x32_bf16 a[96:99], a[208:211], v[236:239], a[96:99]
v_exp_f32 v161, v161
WL 4
v_mfma_f32_16x16x32_bf16 a[100:103], a[212:215], v[236:239], a[100:103]
TR 208,28,49152
v_mfma_f32_16x16x32_bf16 a[68:71], a[212:215], v[232:235], a[68:71]
TR 210,28,53248
v_mfma_f32_16x16x32_bf16 a[36:39], a[212:215], v[228:231], a[36:39]
v_exp_f32 v162, v162
v_mfma_f32_16x16x32_bf16 a[4:7], a[212:215], v[224:227], a[4:7]
v_exp_f32 v163, v163
WL 4
v_mfma_f32_16x16x32_bf16 a[8:11], a[216:219], v[224:227], a[8:11]
TR 212,29,49152
v_exp_f32 v168, v168
v_mfma_f32_16x16x32_bf16 a[40:43], a[216:219], v[228:231], a[40:43]
TR 214,29,53248
v_mfma_f32_16x16x32_bf16 a[72:75], a[216:219], v[232:235], a[72:75]
v_exp_f32 v169, v169
v_mfma_f32_16x16x32_bf16 a[104:107], a[216:219], v[236:239], a[104:107]
v_exp_f32 v170, v170
WL 4
v_mfma_f32_16x16x32_bf16 a[108:111], a[220:223], v[236:239], a[108:111]
TR 216,30,49152
v_mfma_f32_16x16x32_bf16 a[76:79], a[220:223], v[232:235], a[76:79]
TR 218,30,53248
v_exp_f32 v171, v171
v_mfma_f32_16x16x32_bf16 a[44:47], a[220:223], v[228:231], a[44:47]
v_exp_f32 v176, v176
v_mfma_f32_16x16x32_bf16 a[12:15], a[220:223], v[224:227], a[12:15]
v_exp_f32 v177, v177
WL 4
v_mfma_f32_16x16x32_bf16 a[16:19], a[208:211], v[224:227], a[16:19]
TR 220,31,49152
v_mfma_f32_16x16x32_bf16 a[48:51], a[208:211], v[228:231], a[48:51]
TR 222,31,53248
v_mfma_f32_16x16x32_bf16 a[80:83], a[208:211], v[232:235], a[80:83]
v_exp_f32 v178, v178
v_mfma_f32_16x16x32_bf16 a[112:115], a[208:211], v[236:239], a[112:115]
v_exp_f32 v179, v179
WV 13
s_barrier
WL 4
v_mfma_f32_16x16x32_bf16 a[116:119], a[212:215], v[236:239], a[116:119]
ds_read_b128 a[192:195], v44 offset:0
v_mfma_f32_16x16x32_bf16 a[84:87], a[212:215], v[232:235], a[84:87]
v_exp_f32 v184, v184
v_mfma_f32_16x16x32_bf16 a[52:55], a[212:215], v[228:231], a[52:55]
ds_read_b128 a[196:199], v45 offset:0
s_add_u32 m0, s48, 0
v_mfma_f32_16x16x32_bf16 a[20:23], a[212:215], v[224:227], a[20:23]
DM 12,28,53,0
WL 4
v_mfma_f32_16x16x32_bf16 a[24:27], a[216:219], v[224:227], a[24:27]
ds_read_b128 a[200:203], v46 offset:0
v_exp_f32 v185, v185
v_mfma_f32_16x16x32_bf16 a[56:59], a[216:219], v[228:231], a[56:59]
v_exp_f32 v186, v186
v_mfma_f32_16x16x32_bf16 a[88:91], a[216:219], v[232:235], a[88:91]
ds_read_b128 a[204:207], v47 offset:0
v_mfma_f32_16x16x32_bf16 a[120:123], a[216:219], v[236:239], a[120:123]
DM 13,28,53,1024
WL 4
v_mfma_f32_16x16x32_bf16 a[124:127], a[220:223], v[236:239], a[124:127]
v_exp_f32 v187, v187
v_mfma_f32_16x16x32_bf16 a[92:95], a[220:223], v[232:235], a[92:95]
v_exp_f32 v164, v164
v_mfma_f32_16x16x32_bf16 a[60:63], a[220:223], v[228:231], a[60:63]
v_exp_f32 v165, v165
v_mfma_f32_16x16x32_bf16 a[28:31], a[220:223], v[224:227], a[28:31]
DM 14,28,53,2048
v_cvt_pk_bf16_f32 v224, v160, v161
WL 0
v_mfma_f32_16x16x32_bf16 v[128:131], a[192:195], v[64:67], v[192:195]
v_exp_f32 v166, v166
v_mfma_f32_16x16x32_bf16 v[128:131], a[196:199], v[68:71], v[128:131]
ds_read_b128 a[224:227], v44 offset:4096
v_cvt_pk_bf16_f32 v225, v162, v163
v_mfma_f32_16x16x32_bf16 v[128:131], a[200:203], v[72:75], v[128:131]
v_exp_f32 v167, v167
v_mfma_f32_16x16x32_bf16 v[128:131], a[204:207], v[76:79], v[128:131]
ds_read_b128 a[228:231], v45 offset:4096
DM 15,28,53,3072
s_add_u32 s53, s53, 458752
v_mfma_f32_16x16x32_bf16 v[136:139], a[204:207], v[92:95], v[196:199]
v_exp_f32 v172, v172
v_mfma_f32_16x16x32_bf16 v[136:139], a[200:203], v[88:91], v[136:139]
ds_read_b128 a[232:235], v46 offset:4096
v_cvt_pk_bf16_f32 v228, v168, v169
v_mfma_f32_16x16x32_bf16 v[136:139], a[196:199], v[84:87], v[136:139]
v_exp_f32 v173, v173
v_mfma_f32_16x16x32_bf16 v[136:139], a[192:195], v[80:83], v[136:139]
ds_read_b128 a[236:239], v47 offset:4096
v_exp_f32 v174, v174
v_mfma_f32_16x16x32_bf16 v[144:147], a[192:195], v[96:99], v[200:203]
v_exp_f32 v175, v175
v_mfma_f32_16x16x32_bf16 v[144:147], a[196:199], v[100:103], v[144:147]
v_exp_f32 v180, v180
v_mfma_f32_16x16x32_bf16 v[144:147], a[200:203], v[104:107], v[144:147]
v_exp_f32 v181, v181
v_mfma_f32_16x16x32_bf16 v[144:147], a[204:207], v[108:111], v[144:147]
v_exp_f32 v182, v182
v_mfma_f32_16x16x32_bf16 v[152:155], a[204:207], v[124:127], v[204:207]
v_cvt_pk_bf16_f32 v229, v170, v171
v_cvt_pk_bf16_f32 v232, v176, v177
v_mfma_f32_16x16x32_bf16 v[152:155], a[200:203], v[120:123], v[152:155]
v_exp_f32 v183, v183
v_mfma_f32_16x16x32_bf16 v[152:155], a[196:199], v[116:119], v[152:155]
v_cvt_pk_bf16_f32 v233, v178, v179
v_cvt_pk_bf16_f32 v236, v184, v185
v_mfma_f32_16x16x32_bf16 v[152:155], a[192:195], v[112:115], v[152:155]
v_exp_f32 v188, v188
WL 0
v_mfma_f32_16x16x32_bf16 v[132:135], a[224:227], v[64:67], v[192:195]
v_cvt_pk_bf16_f32 v237, v186, v187
v_cvt_pk_bf16_f32 v226, v164, v165
v_mfma_f32_16x16x32_bf16 v[132:135], a[228:231], v[68:71], v[132:135]
v_exp_f32 v189, v189
v_mfma_f32_16x16x32_bf16 v[132:135], a[232:235], v[72:75], v[132:135]
v_cvt_pk_bf16_f32 v227, v166, v167
v_exp_f32 v190, v190
v_mfma_f32_16x16x32_bf16 v[132:135], a[236:239], v[76:79], v[132:135]
v_cvt_pk_bf16_f32 v230, v172, v173
v_cvt_pk_bf16_f32 v231, v174, v175
v_mfma_f32_16x16x32_bf16 v[140:143], a[236:239], v[92:95], v[196:199]
TR 208,24,57344
v_cvt_pk_bf16_f32 v234, v180, v181
v_mfma_f32_16x16x32_bf16 v[140:143], a[232:235], v[88:91], v[140:143]
TR 210,24,61440
v_cvt_pk_bf16_f32 v235, v182, v183
v_mfma_f32_16x16x32_bf16 v[140:143], a[228:231], v[84:87], v[140:143]
v_exp_f32 v191, v191
v_mfma_f32_16x16x32_bf16 v[140:143], a[224:227], v[80:83], v[140:143]
v_cvt_pk_bf16_f32 v238, v188, v189
v_cvt_pk_bf16_f32 v239, v190, v191
v_mfma_f32_16x16x32_bf16 v[208:211], a[240:243], v[224:227], 0
TR 212,25,57344
v_mfma_f32_16x16x32_bf16 v[212:215], a[240:243], v[228:231], 0
TR 214,25,61440
v_mfma_f32_16x16x32_bf16 v[216:219], a[240:243], v[232:235], 0
TR 216,26,57344
v_mfma_f32_16x16x32_bf16 v[220:223], a[240:243], v[236:239], 0
TR 218,26,61440
v_mfma_f32_16x16x32_bf16 v[148:151], a[224:227], v[96:99], v[200:203]
buffer_load_dword v61, v60, s[32:35], s81 offen
v_mfma_f32_16x16x32_bf16 v[148:151], a[228:231], v[100:103], v[148:151]
s_add_u32 s81, s81, 1048576
v_mfma_f32_16x16x32_bf16 v[148:151], a[232:235], v[104:107], v[148:151]
v_mfma_f32_16x16x32_bf16 v[148:151], a[236:239], v[108:111], v[148:151]
v_mfma_f32_16x16x32_bf16 v[156:159], a[236:239], v[124:127], v[204:207]
v_mfma_f32_16x16x32_bf16 v[156:159], a[232:235], v[120:123], v[156:159]
v_mfma_f32_16x16x32_bf16 v[156:159], a[228:231], v[116:119], v[156:159]
v_max3_f32 v56, v208, v212, v216
v_max_f32 v56, v56, v220
v_mfma_f32_16x16x32_bf16 v[156:159], a[224:227], v[112:115], v[156:159]
v_cmp_lt_f32 vcc, 0x49800000, v56
s_nop 0
s_cbranch_vccnz t1_c27
t1_r28:
WL 4
v_mfma_f32_16x16x32_bf16 a[0:3], a[208:211], v[224:227], a[0:3]
TR 220,27,57344
v_add_f32 v48, v48, v208
v_add_f32 v49, v49, v212
v_mfma_f32_16x16x32_bf16 a[32:35], a[208:211], v[228:231], a[32:35]
TR 222,27,61440
v_add_f32 v50, v50, v216
v_add_f32 v51, v51, v220
v_mfma_f32_16x16x32_bf16 a[64:67], a[208:211], v[232:235], a[64:67]
v_exp_f32 v128, v128
v_mfma_f32_16x16x32_bf16 a[96:99], a[208:211], v[236:239], a[96:99]
v_exp_f32 v129, v129
WL 4
v_mfma_f32_16x16x32_bf16 a[100:103], a[212:215], v[236:239], a[100:103]
TR 208,28,57344
v_mfma_f32_16x16x32_bf16 a[68:71], a[212:215], v[232:235], a[68:71]
TR 210,28,61440
v_mfma_f32_16x16x32_bf16 a[36:39], a[212:215], v[228:231], a[36:39]
v_exp_f32 v130, v130
v_mfma_f32_16x16x32_bf16 a[4:7], a[212:215], v[224:227], a[4:7]
v_exp_f32 v131, v131
WL 4
v_mfma_f32_16x16x32_bf16 a[8:11], a[216:219], v[224:227], a[8:11]
TR 212,29,57344
v_mfma_f32_16x16x32_bf16 a[40:43], a[216:219], v[228:231], a[40:43]
TR 214,29,61440
v_mfma_f32_16x16x32_bf16 a[72:75], a[216:219], v[232:235], a[72:75]
v_exp_f32 v136, v136
v_mfma_f32_16x16x32_bf16 a[104:107], a[216:219], v[236:239], a[104:107]
v_exp_f32 v137, v137
WL 4
v_mfma_f32_16x16x32_bf16 a[108:111], a[220:223], v[236:239], a[108:111]
TR 216,30,57344
v_mfma_f32_16x16x32_bf16 a[76:79], a[220:223], v[232:235], a[76:79]
TR 218,30,61440
v_mfma_f32_16x16x32_bf16 a[44:47], a[220:223], v[228:231], a[44:47]
v_exp_f32 v138, v138
v_mfma_f32_16x16x32_bf16 a[12:15], a[220:223], v[224:227], a[12:15]
v_exp_f32 v139, v139
WL 4
v_mfma_f32_16x16x32_bf16 a[16:19], a[208:211], v[224:227], a[16:19]
TR 220,31,57344
v_mfma_f32_16x16x32_bf16 a[48:51], a[208:211], v[228:231], a[48:51]
TR 222,31,61440
v_mfma_f32_16x16x32_bf16 a[80:83], a[208:211], v[232:235], a[80:83]
v_exp_f32 v144, v144
v_mfma_f32_16x16x32_bf16 a[112:115], a[208:211], v[236:239], a[112:115]
v_exp_f32 v145, v145
WL 4
v_mfma_f32_16x16x32_bf16 a[116:119], a[212:215], v[236:239], a[116:119]
ds_read_b128 a[192:195], v44 offset:8192
v_mfma_f32_16x16x32_bf16 a[84:87], a[212:215], v[232:235], a[84:87]
v_exp_f32 v146, v146
v_mfma_f32_16x16x32_bf16 a[52:55], a[212:215], v[228:231], a[52:55]
ds_read_b128 a[196:199], v45 offset:8192
v_mfma_f32_16x16x32_bf16 a[20:23], a[212:215], v[224:227], a[20:23]
v_exp_f32 v147, v147
WL 4
v_mfma_f32_16x16x32_bf16 a[24:27], a[216:219], v[224:227], a[24:27]
ds_read_b128 a[200:203], v46 offset:8192
v_exp_f32 v152, v152
v_mfma_f32_16x16x32_bf16 a[56:59], a[216:219], v[228:231], a[56:59]
v_exp_f32 v153, v153
v_mfma_f32_16x16x32_bf16 a[88:91], a[216:219], v[232:235], a[88:91]
ds_read_b128 a[204:207], v47 offset:8192
v_mfma_f32_16x16x32_bf16 a[120:123], a[216:219], v[236:239], a[120:123]
v_exp_f32 v154, v154
WL 4
v_mfma_f32_16x16x32_bf16 a[124:127], a[220:223], v[236:239], a[124:127]
v_exp_f32 v155, v155
v_mfma_f32_16x16x32_bf16 a[92:95], a[220:223], v[232:235], a[92:95]
v_exp_f32 v132, v132
v_mfma_f32_16x16x32_bf16 a[60:63], a[220:223], v[228:231], a[60:63]
v_exp_f32 v133, v133
v_mfma_f32_16x16x32_bf16 a[28:31], a[220:223], v[224:227], a[28:31]
v_exp_f32 v134, v134
WL 0
v_mfma_f32_16x16x32_bf16 v[160:163], a[192:195], v[64:67], v[192:195]
v_exp_f32 v135, v135
v_mfma_f32_16x16x32_bf16 v[160:163], a[196:199], v[68:71], v[160:163]
ds_read_b128 a[224:227], v44 offset:12288
v_cvt_pk_bf16_f32 v224, v128, v129
v_mfma_f32_16x16x32_bf16 v[160:163], a[200:203], v[72:75], v[160:163]
v_exp_f32 v140, v140
v_mfma_f32_16x16x32_bf16 v[160:163], a[204:207], v[76:79], v[160:163]
ds_read_b128 a[228:231], v45 offset:12288
v_cvt_pk_bf16_f32 v225, v130, v131
v_mfma_f32_16x16x32_bf16 v[168:171], a[204:207], v[92:95], v[196:199]
v_exp_f32 v141, v141
v_mfma_f32_16x16x32_bf16 v[168:171], a[200:203], v[88:91], v[168:171]
ds_read_b128 a[232:235], v46 offset:12288
v_cvt_pk_bf16_f32 v228, v136, v137
v_mfma_f32_16x16x32_bf16 v[168:171], a[196:199], v[84:87], v[168:171]
v_exp_f32 v142, v142
v_mfma_f32_16x16x32_bf16 v[168:171], a[192:195], v[80:83], v[168:171]
ds_read_b128 a[236:239], v47 offset:12288
v_cvt_pk_bf16_f32 v229, v138, v139
v_mfma_f32_16x16x32_bf16 v[176:179], a[192:195], v[96:99], v[200:203]
v_exp_f32 v143, v143
v_mfma_f32_16x16x32_bf16 v[176:179], a[196:199], v[100:103], v[176:179]
v_exp_f32 v148, v148
v_mfma_f32_16x16x32_bf16 v[176:179], a[200:203], v[104:107], v[176:179]
v_exp_f32 v149, v149
v_mfma_f32_16x16x32_bf16 v[176:179], a[204:207], v[108:111], v[176:179]
v_exp_f32 v150, v150
v_mfma_f32_16x16x32_bf16 v[184:187], a[204:207], v[124:127], v[204:207]
v_exp_f32 v151, v151
v_mfma_f32_16x16x32_bf16 v[184:187], a[200:203], v[120:123], v[184:187]
v_cvt_pk_bf16_f32 v232, v144, v145
v_cvt_pk_bf16_f32 v233, v146, v147
v_mfma_f32_16x16x32_bf16 v[184:187], a[196:199], v[116:119], v[184:187]
v_exp_f32 v156, v156
v_mfma_f32_16x16x32_bf16 v[184:187], a[192:195], v[112:115], v[184:187]
v_cvt_pk_bf16_f32 v236, v152, v153
v_cvt_pk_bf16_f32 v237, v154, v155
WL 0
v_mfma_f32_16x16x32_bf16 v[164:167], a[224:227], v[64:67], v[192:195]
v_exp_f32 v157, v157
v_mfma_f32_16x16x32_bf16 v[164:167], a[228:231], v[68:71], v[164:167]
v_cvt_pk_bf16_f32 v226, v132, v133
v_cvt_pk_bf16_f32 v227, v134, v135
v_mfma_f32_16x16x32_bf16 v[164:167], a[232:235], v[72:75], v[164:167]
v_exp_f32 v158, v158
v_mfma_f32_16x16x32_bf16 v[164:167], a[236:239], v[76:79], v[164:167]
v_cvt_pk_bf16_f32 v230, v140, v141
v_cvt_pk_bf16_f32 v231, v142, v143
v_mfma_f32_16x16x32_bf16 v[172:175], a[236:239], v[92:95], v[196:199]
TR 208,32,16384
v_cvt_pk_bf16_f32 v234, v148, v149
v_mfma_f32_16x16x32_bf16 v[172:175], a[232:235], v[88:91], v[172:175]
TR 210,32,20480
v_cvt_pk_bf16_f32 v235, v150, v151
v_mfma_f32_16x16x32_bf16 v[172:175], a[228:231], v[84:87], v[172:175]
v_exp_f32 v159, v159
v_mfma_f32_16x16x32_bf16 v[172:175], a[224:227], v[80:83], v[172:175]
v_cvt_pk_bf16_f32 v238, v156, v157
v_cvt_pk_bf16_f32 v239, v158, v159
v_mfma_f32_16x16x32_bf16 v[208:211], a[240:243], v[224:227], 0
TR 212,33,16384
v_mfma_f32_16x16x32_bf16 v[212:215], a[240:243], v[228:231], 0
TR 214,33,20480
v_mfma_f32_16x16x32_bf16 v[216:219], a[240:243], v[232:235], 0
TR 216,34,16384
v_mfma_f32_16x16x32_bf16 v[220:223], a[240:243], v[236:239], 0
TR 218,34,20480
v_mfma_f32_16x16x32_bf16 v[180:183], a[224:227], v[96:99], v[200:203]
v_mfma_f32_16x16x32_bf16 v[180:183], a[228:231], v[100:103], v[180:183]
v_mfma_f32_16x16x32_bf16 v[180:183], a[232:235], v[104:107], v[180:183]
v_mfma_f32_16x16x32_bf16 v[180:183], a[236:239], v[108:111], v[180:183]
v_mfma_f32_16x16x32_bf16 v[188:191], a[236:239], v[124:127], v[204:207]
v_mfma_f32_16x16x32_bf16 v[188:191], a[232:235], v[120:123], v[188:191]
v_mfma_f32_16x16x32_bf16 v[188:191], a[228:231], v[116:119], v[188:191]
v_max3_f32 v56, v208, v212, v216
v_max_f32 v56, v56, v220
v_mfma_f32_16x16x32_bf16 v[188:191], a[224:227], v[112:115], v[188:191]
v_cmp_lt_f32 vcc, 0x49800000, v56
s_nop 0
s_cbranch_vccnz t1_c29
t1_r30:
WL 4
v_mfma_f32_16x16x32_bf16 a[0:3], a[208:211], v[224:227], a[0:3]
TR 220,35,16384
v_add_f32 v48, v48, v208
v_add_f32 v49, v49, v212
v_mfma_f32_16x16x32_bf16 a[32:35], a[208:211], v[228:231], a[32:35]
TR 222,35,20480
v_add_f32 v50, v50, v216
v_add_f32 v51, v51, v220
v_mfma_f32_16x16x32_bf16 a[64:67], a[208:211], v[232:235], a[64:67]
v_exp_f32 v160, v160
v_mfma_f32_16x16x32_bf16 a[96:99], a[208:211], v[236:239], a[96:99]
v_exp_f32 v161, v161
WL 4
v_mfma_f32_16x16x32_bf16 a[100:103], a[212:215], v[236:239], a[100:103]
TR 208,36,16384
v_mfma_f32_16x16x32_bf16 a[68:71], a[212:215], v[232:235], a[68:71]
TR 210,36,20480
v_mfma_f32_16x16x32_bf16 a[36:39], a[212:215], v[228:231], a[36:39]
v_exp_f32 v162, v162
v_mfma_f32_16x16x32_bf16 a[4:7], a[212:215], v[224:227], a[4:7]
v_exp_f32 v163, v163
WL 4
v_mfma_f32_16x16x32_bf16 a[8:11], a[216:219], v[224:227], a[8:11]
TR 212,37,16384
v_exp_f32 v168, v168
v_mfma_f32_16x16x32_bf16 a[40:43], a[216:219], v[228:231], a[40:43]
TR 214,37,20480
v_mfma_f32_16x16x32_bf16 a[72:75], a[216:219], v[232:235], a[72:75]
v_exp_f32 v169, v169
v_mfma_f32_16x16x32_bf16 a[104:107], a[216:219], v[236:239], a[104:107]
v_exp_f32 v170, v170
WL 4
v_mfma_f32_16x16x32_bf16 a[108:111], a[220:223], v[236:239], a[108:111]
TR 216,38,16384
v_mfma_f32_16x16x32_bf16 a[76:79], a[220:223], v[232:235], a[76:79]
TR 218,38,20480
v_exp_f32 v171, v171
v_mfma_f32_16x16x32_bf16 a[44:47], a[220:223], v[228:231], a[44:47]
v_exp_f32 v176, v176
v_mfma_f32_16x16x32_bf16 a[12:15], a[220:223], v[224:227], a[12:15]
v_exp_f32 v177, v177
WL 4
v_mfma_f32_16x16x32_bf16 a[16:19], a[208:211], v[224:227], a[16:19]
TR 220,39,16384
v_mfma_f32_16x16x32_bf16 a[48:51], a[208:211], v[228:231], a[48:51]
TR 222,39,20480
v_mfma_f32_16x16x32_bf16 a[80:83], a[208:211], v[232:235], a[80:83]
v_exp_f32 v178, v178
v_mfma_f32_16x16x32_bf16 a[112:115], a[208:211], v[236:239], a[112:115]
v_exp_f32 v179, v179
WV 8
s_barrier
WL 4
v_mfma_f32_16x16x32_bf16 a[116:119], a[212:215], v[236:239], a[116:119]
ds_read_b128 a[192:195], v44 offset:32768
v_mfma_f32_16x16x32_bf16 a[84:87], a[212:215], v[232:235], a[84:87]
v_exp_f32 v184, v184
v_mfma_f32_16x16x32_bf16 a[52:55], a[212:215], v[228:231], a[52:55]
ds_read_b128 a[196:199], v45 offset:32768
s_add_u32 m0, s48, 32768
v_mfma_f32_16x16x32_bf16 a[20:23], a[212:215], v[224:227], a[20:23]
DM 12,28,53,0
WL 4
v_mfma_f32_16x16x32_bf16 a[24:27], a[216:219], v[224:227], a[24:27]
ds_read_b128 a[200:203], v46 offset:32768
v_exp_f32 v185, v185
v_mfma_f32_16x16x32_bf16 a[56:59], a[216:219], v[228:231], a[56:59]
v_exp_f32 v186, v186
v_mfma_f32_16x16x32_bf16 a[88:91], a[216:219], v[232:235], a[88:91]
ds_read_b128 a[204:207], v47 offset:32768
v_mfma_f32_16x16x32_bf16 a[120:123], a[216:219], v[236:239], a[120:123]
DM 13,28,53,1024
WL 4
v_mfma_f32_16x16x32_bf16 a[124:127], a[220:223], v[236:239], a[124:127]
v_exp_f32 v187, v187
v_mfma_f32_16x16x32_bf16 a[92:95], a[220:223], v[232:235], a[92:95]
v_exp_f32 v164, v164
v_mfma_f32_16x16x32_bf16 a[60:63], a[220:223], v[228:231], a[60:63]
v_exp_f32 v165, v165
v_mfma_f32_16x16x32_bf16 a[28:31], a[220:223], v[224:227], a[28:31]
DM 14,28,53,2048
v_cvt_pk_bf16_f32 v224, v160, v161
WL 0
v_mfma_f32_16x16x32_bf16 v[128:131], a[192:195], v[64:67], v[192:195]
v_exp_f32 v166, v166
v_mfma_f32_16x16x32_bf16 v[128:131], a[196:199], v[68:71], v[128:131]
ds_read_b128 a[224:227], v44 offset:36864
v_cvt_pk_bf16_f32 v225, v162, v163
v_mfma_f32_16x16x32_bf16 v[128:131], a[200:203], v[72:75], v[128:131]
v_exp_f32 v167, v167
v_mfma_f32_16x16x32_bf16 v[128:131], a[204:207], v[76:79], v[128:131]
ds_read_b128 a[228:231], v45 offset:36864
DM 15,28,53,3072
s_add_u32 s53, s53, 458752
v_mfma_f32_16x16x32_bf16 v[136:139], a[204:207], v[92:95], v[196:199]
v_exp_f32 v172, v172
v_mfma_f32_16x16x32_bf16 v[136:139], a[200:203], v[88:91], v[136:139]
ds_read_b128 a[232:235], v46 offset:36864
v_cvt_pk_bf16_f32 v228, v168, v169
v_mfma_f32_16x16x32_bf16 v[136:139], a[196:199], v[84:87], v[136:139]
v_exp_f32 v173, v173
v_mfma_f32_16x16x32_bf16 v[136:139], a[192:195], v[80:83], v[136:139]
ds_read_b128 a[236:239], v47 offset:36864
v_exp_f32 v174, v174
v_mfma_f32_16x16x32_bf16 v[144:147], a[192:195], v[96:99], v[200:203]
v_exp_f32 v175, v175
v_mfma_f32_16x16x32_bf16 v[144:147], a[196:199], v[100:103], v[144:147]
v_exp_f32 v180, v180
v_mfma_f32_16x16x32_bf16 v[144:147], a[200:203], v[104:107], v[144:147]
v_exp_f32 v181, v181
v_mfma_f32_16x16x32_bf16 v[144:147], a[204:207], v[108:111], v[144:147]
v_exp_f32 v182, v182
v_mfma_f32_16x16x32_bf16 v[152:155], a[204:207], v[124:127], v[204:207]
v_cvt_pk_bf16_f32 v229, v170, v171
v_cvt_pk_bf16_f32 v232, v176, v177
v_mfma_f32_16x16x32_bf16 v[152:155], a[200:203], v[120:123], v[152:155]
v_exp_f32 v183, v183
v_mfma_f32_16x16x32_bf16 v[152:155], a[196:199], v[116:119], v[152:155]
v_cvt_pk_bf16_f32 v233, v178, v179
v_cvt_pk_bf16_f32 v236, v184, v185
v_mfma_f32_16x16x32_bf16 v[152:155], a[192:195], v[112:115], v[152:155]
v_exp_f32 v188, v188
WL 0
v_mfma_f32_16x16x32_bf16 v[132:135], a[224:227], v[64:67], v[192:195]
v_cvt_pk_bf16_f32 v237, v186, v187
v_cvt_pk_bf16_f32 v226, v164, v165
v_mfma_f32_16x16x32_bf16 v[132:135], a[228:231], v[68:71], v[132:135]
v_exp_f32 v189, v189
v_mfma_f32_16x16x32_bf16 v[132:135], a[232:235], v[72:75], v[132:135]
v_cvt_pk_bf16_f32 v227, v166, v167
v_exp_f32 v190, v190
v_mfma_f32_16x16x32_bf16 v[132:135], a[236:239], v[76:79], v[132:135]
v_cvt_pk_bf16_f32 v230, v172, v173
v_cvt_pk_bf16_f32 v231, v174, v175
v_mfma_f32_16x16x32_bf16 v[140:143], a[236:239], v[92:95], v[196:199]
TR 208,32,24576
v_cvt_pk_bf16_f32 v234, v180, v181
v_mfma_f32_16x16x32_bf16 v[140:143], a[232:235], v[88:91], v[140:143]
TR 210,32,28672
v_cvt_pk_bf16_f32 v235, v182, v183
v_mfma_f32_16x16x32_bf16 v[140:143], a[228:231], v[84:87], v[140:143]
v_exp_f32 v191, v191
v_mfma_f32_16x16x32_bf16 v[140:143], a[224:227], v[80:83], v[140:143]
v_cvt_pk_bf16_f32 v238, v188, v189
v_cvt_pk_bf16_f32 v239, v190, v191
v_mfma_f32_16x16x32_bf16 v[208:211], a[240:243], v[224:227], 0
TR 212,33,24576
v_mfma_f32_16x16x32_bf16 v[212:215], a[240:243], v[228:231], 0
TR 214,33,28672
v_mfma_f32_16x16x32_bf16 v[216:219], a[240:243], v[232:235], 0
TR 216,34,24576
v_mfma_f32_16x16x32_bf16 v[220:223], a[240:243], v[236:239], 0
TR 218,34,28672
v_mfma_f32_16x16x32_bf16 v[148:151], a[224:227], v[96:99], v[200:203]
v_mfma_f32_16x16x32_bf16 v[148:151], a[228:231], v[100:103], v[148:151]
v_mfma_f32_16x16x32_bf16 v[148:151], a[232:235], v[104:107], v[148:151]
v_mfma_f32_16x16x32_bf16 v[148:151], a[236:239], v[108:111], v[148:151]
v_mfma_f32_16x16x32_bf16 v[156:159], a[236:239], v[124:127], v[204:207]
v_mfma_f32_16x16x32_bf16 v[156:159], a[232:235], v[120:123], v[156:159]
v_mfma_f32_16x16x32_bf16 v[156:159], a[228:231], v[116:119], v[156:159]
v_max3_f32 v56, v208, v212, v216
v_max_f32 v56, v56, v220
v_mfma_f32_16x16x32_bf16 v[156:159], a[224:227], v[112:115], v[156:159]
v_cmp_lt_f32 vcc, 0x49800000, v56
s_nop 0
s_cbranch_vccnz t1_c31
t1_r32:
WL 4
v_mfma_f32_16x16x32_bf16 a[0:3], a[208:211], v[224:227], a[0:3]
TR 220,35,24576
v_add_f32 v48, v48, v208
v_add_f32 v49, v49, v212
v_mfma_f32_16x16x32_bf16 a[32:35], a[208:211], v[228:231], a[32:35]
TR 222,35,28672
v_add_f32 v50, v50, v216
v_add_f32 v51, v51, v220
v_mfma_f32_16x16x32_bf16 a[64:67], a[208:211], v[232:235], a[64:67]
v_exp_f32 v128, v128
v_mfma_f32_16x16x32_bf16 a[96:99], a[208:211], v[236:239], a[96:99]
v_exp_f32 v129, v129
WL 4
v_mfma_f32_16x16x32_bf16 a[100:103], a[212:215], v[236:239], a[100:103]
TR 208,36,24576
v_mfma_f32_16x16x32_bf16 a[68:71], a[212:215], v[232:235], a[68:71]
TR 210,36,28672
v_mfma_f32_16x16x32_bf16 a[36:39], a[212:215], v[228:231], a[36:39]
v_exp_f32 v130, v130
v_mfma_f32_16x16x32_bf16 a[4:7], a[212:215], v[224:227], a[4:7]
v_exp_f32 v131, v131
WL 4
v_mfma_f32_16x16x32_bf16 a[8:11], a[216:219], v[224:227], a[8:11]
TR 212,37,24576
v_exp_f32 v136, v136
v_mfma_f32_16x16x32_bf16 a[40:43], a[216:219], v[228:231], a[40:43]
TR 214,37,28672
v_mfma_f32_16x16x32_bf16 a[72:75], a[216:219], v[232:235], a[72:75]
v_exp_f32 v137, v137
v_mfma_f32_16x16x32_bf16 a[104:107], a[216:219], v[236:239], a[104:107]
v_exp_f32 v138, v138
WL 4
v_mfma_f32_16x16x32_bf16 a[108:111], a[220:223], v[236:239], a[108:111]
TR 216,38,24576
v_exp_f32 v139, v139
v_mfma_f32_16x16x32_bf16 a[76:79], a[220:223], v[232:235], a[76:79]
TR 218,38,28672
v_mfma_f32_16x16x32_bf16 a[44:47], a[220:223], v[228:231], a[44:47]
v_exp_f32 v144, v144
v_mfma_f32_16x16x32_bf16 a[12:15], a[220:223], v[224:227], a[12:15]
v_exp_f32 v145, v145
WL 4
v_mfma_f32_16x16x32_bf16 a[16:19], a[208:211], v[224:227], a[16:19]
TR 220,39,24576
v_mfma_f32_16x16x32_bf16 a[48:51], a[208:211], v[228:231], a[48:51]
TR 222,39,28672
buffer_load_dword v17, v22, s[4:7], s80 offen offset:768 sc1
v_mfma_f32_16x16x32_bf16 a[80:83], a[208:211], v[232:235], a[80:83]
v_exp_f32 v146, v146
v_mfma_f32_16x16x32_bf16 a[112:115], a[208:211], v[236:239], a[112:115]
v_exp_f32 v147, v147
WL 4
v_mfma_f32_16x16x32_bf16 a[116:119], a[212:215], v[236:239], a[116:119]
ds_read_b128 a[192:195], v44 offset:40960
v_exp_f32 v152, v152
v_mfma_f32_16x16x32_bf16 a[84:87], a[212:215], v[232:235], a[84:87]
v_exp_f32 v153, v153
v_mfma_f32_16x16x32_bf16 a[52:55], a[212:215], v[228:231], a[52:55]
ds_read_b128 a[196:199], v45 offset:40960
v_mfma_f32_16x16x32_bf16 a[20:23], a[212:215], v[224:227], a[20:23]
v_exp_f32 v154, v154
WL 4
v_mfma_f32_16x16x32_bf16 a[24:27], a[216:219], v[224:227], a[24:27]
ds_read_b128 a[200:203], v46 offset:40960
v_mfma_f32_16x16x32_bf16 a[56:59], a[216:219], v[228:231], a[56:59]
v_exp_f32 v155, v155
v_mfma_f32_16x16x32_bf16 a[88:91], a[216:219], v[232:235], a[88:91]
ds_read_b128 a[204:207], v47 offset:40960
v_exp_f32 v132, v132
v_mfma_f32_16x16x32_bf16 a[120:123], a[216:219], v[236:239], a[120:123]
v_exp_f32 v133, v133
WL 4
v_mfma_f32_16x16x32_bf16 a[124:127], a[220:223], v[236:239], a[124:127]
v_exp_f32 v134, v134
v_mfma_f32_16x16x32_bf16 a[92:95], a[220:223], v[232:235], a[92:95]
v_exp_f32 v135, v135
v_mfma_f32_16x16x32_bf16 a[60:63], a[220:223], v[228:231], a[60:63]
v_exp_f32 v140, v140
v_mfma_f32_16x16x32_bf16 a[28:31], a[220:223], v[224:227], a[28:31]
v_exp_f32 v141, v141
WL 0
v_mfma_f32_16x16x32_bf16 v[160:163], a[192:195], v[64:67], v[192:195]
v_exp_f32 v142, v142
v_mfma_f32_16x16x32_bf16 v[160:163], a[196:199], v[68:71], v[160:163]
ds_read_b128 a[224:227], v44 offset:45056
v_cvt_pk_bf16_f32 v224, v128, v129
v_mfma_f32_16x16x32_bf16 v[160:163], a[200:203], v[72:75], v[160:163]
v_exp_f32 v143, v143
v_mfma_f32_16x16x32_bf16 v[160:163], a[204:207], v[76:79], v[160:163]
ds_read_b128 a[228:231], v45 offset:45056
v_cvt_pk_bf16_f32 v225, v130, v131
v_mfma_f32_16x16x32_bf16 v[168:171], a[204:207], v[92:95], v[196:199]
v_exp_f32 v148, v148
v_mfma_f32_16x16x32_bf16 v[168:171], a[200:203], v[88:91], v[168:171]
ds_read_b128 a[232:235], v46 offset:45056
v_cvt_pk_bf16_f32 v228, v136, v137
v_mfma_f32_16x16x32_bf16 v[168:171], a[196:199], v[84:87], v[168:171]
v_exp_f32 v149, v149
v_cvt_pk_bf16_f32 v229, v138, v139
v_mfma_f32_16x16x32_bf16 v[168:171], a[192:195], v[80:83], v[168:171]
ds_read_b128 a[236:239], v47 offset:45056
v_cvt_pk_bf16_f32 v232, v144, v145
v_mfma_f32_16x16x32_bf16 v[176:179], a[192:195], v[96:99], v[200:203]
v_exp_f32 v150, v150
v_mfma_f32_16x16x32_bf16 v[176:179], a[196:199], v[100:103], v[176:179]
v_exp_f32 v151, v151
v_mfma_f32_16x16x32_bf16 v[176:179], a[200:203], v[104:107], v[176:179]
v_cvt_pk_bf16_f32 v233, v146, v147
v_cvt_pk_bf16_f32 v236, v152, v153
v_mfma_f32_16x16x32_bf16 v[176:179], a[204:207], v[108:111], v[176:179]
buffer_load_dword v61, v60, s[84:87], s77 offen
v_mfma_f32_16x16x32_bf16 v[184:187], a[204:207], v[124:127], v[204:207]
v_exp_f32 v156, v156
v_mfma_f32_16x16x32_bf16 v[184:187], a[200:203], v[120:123], v[184:187]
v_xor_b32 v24, 0, v1
v_cvt_pk_bf16_f32 v237, v154, v155
v_mfma_f32_16x16x32_bf16 v[184:187], a[196:199], v[116:119], v[184:187]
v_exp_f32 v157, v157
v_mfma_f32_16x16x32_bf16 v[184:187], a[192:195], v[112:115], v[184:187]
v_xor_b32 v25, 32, v1
v_cvt_pk_bf16_f32 v226, v132, v133
WL 0
v_mfma_f32_16x16x32_bf16 v[164:167], a[224:227], v[64:67], v[192:195]
v_cvt_pk_bf16_f32 v227, v134, v135
v_cvt_pk_bf16_f32 v230, v140, v141
v_mfma_f32_16x16x32_bf16 v[164:167], a[228:231], v[68:71], v[164:167]
v_xor_b32 v26, 64, v1
v_exp_f32 v158, v158
v_mfma_f32_16x16x32_bf16 v[164:167], a[232:235], v[72:75], v[164:167]
v_cvt_pk_bf16_f32 v231, v142, v143
v_cvt_pk_bf16_f32 v234, v148, v149
v_mfma_f32_16x16x32_bf16 v[164:167], a[236:239], v[76:79], v[164:167]
v_xor_b32 v27, 96, v1
v_cvt_pk_bf16_f32 v235, v150, v151
v_mfma_f32_16x16x32_bf16 v[172:175], a[236:239], v[92:95], v[196:199]
TR 208,32,49152
v_cvt_pk_bf16_f32 v238, v156, v157
v_mfma_f32_16x16x32_bf16 v[172:175], a[232:235], v[88:91], v[172:175]
TR 210,32,53248
v_xor_b32 v28, 128, v1
v_mfma_f32_16x16x32_bf16 v[172:175], a[228:231], v[84:87], v[172:175]
v_exp_f32 v159, v159
v_mfma_f32_16x16x32_bf16 v[172:175], a[224:227], v[80:83], v[172:175]
v_xor_b32 v29, 160, v1
v_cvt_pk_bf16_f32 v239, v158, v159
v_mfma_f32_16x16x32_bf16 v[208:211], a[240:243], v[224:227], 0
TR 212,33,49152
v_mfma_f32_16x16x32_bf16 v[212:215], a[240:243], v[228:231], 0
TR 214,33,53248
v_mfma_f32_16x16x32_bf16 v[216:219], a[240:243], v[232:235], 0
TR 216,34,49152
v_mfma_f32_16x16x32_bf16 v[220:223], a[240:243], v[236:239], 0
TR 218,34,53248
v_mfma_f32_16x16x32_bf16 v[180:183], a[224:227], v[96:99], v[200:203]
v_mfma_f32_16x16x32_bf16 v[180:183], a[228:231], v[100:103], v[180:183]
v_mfma_f32_16x16x32_bf16 v[180:183], a[232:235], v[104:107], v[180:183]
v_mfma_f32_16x16x32_bf16 v[180:183], a[236:239], v[108:111], v[180:183]
v_mfma_f32_16x16x32_bf16 v[188:191], a[236:239], v[124:127], v[204:207]
v_mfma_f32_16x16x32_bf16 v[188:191], a[232:235], v[120:123], v[188:191]
v_mfma_f32_16x16x32_bf16 v[188:191], a[228:231], v[116:119], v[188:191]
v_max3_f32 v56, v208, v212, v216
v_max_f32 v56, v56, v220
v_mfma_f32_16x16x32_bf16 v[188:191], a[224:227], v[112:115], v[188:191]
v_cmp_lt_f32 vcc, 0x49800000, v56
s_nop 0
s_cbranch_vccnz t1_c33
t1_r34:
WL 4
v_mfma_f32_16x16x32_bf16 a[0:3], a[208:211], v[224:227], a[0:3]
TR 220,35,49152
v_add_f32 v48, v48, v208
v_add_f32 v49, v49, v212
v_mfma_f32_16x16x32_bf16 a[32:35], a[208:211], v[228:231], a[32:35]
TR 222,35,53248
v_add_f32 v50, v50, v216
v_add_f32 v51, v51, v220
v_mfma_f32_16x16x32_bf16 a[64:67], a[208:211], v[232:235], a[64:67]
v_exp_f32 v128, v160
v_mfma_f32_16x16x32_bf16 a[96:99], a[208:211], v[236:239], a[96:99]
v_exp_f32 v129, v161
WL 4
v_mfma_f32_16x16x32_bf16 a[100:103], a[212:215], v[236:239], a[100:103]
TR 208,36,49152
v_exp_f32 v130, v162
v_mfma_f32_16x16x32_bf16 a[68:71], a[212:215], v[232:235], a[68:71]
TR 210,36,53248
v_exp_f32 v131, v163
v_mfma_f32_16x16x32_bf16 a[36:39], a[212:215], v[228:231], a[36:39]
v_exp_f32 v136, v168
v_cvt_pk_bf16_f32 v240, v128, v129
v_mfma_f32_16x16x32_bf16 a[4:7], a[212:215], v[224:227], a[4:7]
v_exp_f32 v137, v169
v_cvt_pk_bf16_f32 v241, v130, v131
WL 4
v_mfma_f32_16x16x32_bf16 a[8:11], a[216:219], v[224:227], a[8:11]
TR 212,37,49152
v_exp_f32 v138, v170
v_mfma_f32_16x16x32_bf16 a[40:43], a[216:219], v[228:231], a[40:43]
TR 214,37,53248
v_exp_f32 v139, v171
v_mfma_f32_16x16x32_bf16 a[72:75], a[216:219], v[232:235], a[72:75]
v_exp_f32 v144, v176
v_mfma_f32_16x16x32_bf16 a[104:107], a[216:219], v[236:239], a[104:107]
v_exp_f32 v145, v177
v_cvt_pk_bf16_f32 v244, v136, v137
WL 4
v_mfma_f32_16x16x32_bf16 a[108:111], a[220:223], v[236:239], a[108:111]
TR 216,38,49152
v_exp_f32 v146, v178
v_mfma_f32_16x16x32_bf16 a[76:79], a[220:223], v[232:235], a[76:79]
TR 218,38,53248
v_exp_f32 v147, v179
v_mfma_f32_16x16x32_bf16 a[44:47], a[220:223], v[228:231], a[44:47]
v_exp_f32 v152, v184
v_mfma_f32_16x16x32_bf16 a[12:15], a[220:223], v[224:227], a[12:15]
v_exp_f32 v153, v185
v_cvt_pk_bf16_f32 v245, v138, v139
WL 4
v_mfma_f32_16x16x32_bf16 a[16:19], a[208:211], v[224:227], a[16:19]
TR 220,39,49152
v_exp_f32 v154, v186
v_mfma_f32_16x16x32_bf16 a[48:51], a[208:211], v[228:231], a[48:51]
TR 222,39,53248
v_exp_f32 v155, v187
v_mfma_f32_16x16x32_bf16 a[80:83], a[208:211], v[232:235], a[80:83]
v_exp_f32 v132, v164
v_mfma_f32_16x16x32_bf16 a[112:115], a[208:211], v[236:239], a[112:115]
v_exp_f32 v133, v165
v_cvt_pk_bf16_f32 v248, v144, v145
WV 1
v_cmp_gt_u32 s[68:69], 16, v17
s_nop 0
s_and_b64 s[68:69], s[68:69], s[74:75]
s_cbranch_scc1 t1_slow5
t1_back6:
s_barrier
WL 4
v_mfma_f32_16x16x32_bf16 a[116:119], a[212:215], v[236:239], a[116:119]
TR 208,32,57344
v_exp_f32 v134, v166
v_mfma_f32_16x16x32_bf16 a[84:87], a[212:215], v[232:235], a[84:87]
TR 210,32,61440
v_exp_f32 v135, v167
v_mfma_f32_16x16x32_bf16 a[52:55], a[212:215], v[228:231], a[52:55]
s_add_u32 m0, s48, 65536
v_exp_f32 v140, v172
v_mfma_f32_16x16x32_bf16 a[20:23], a[212:215], v[224:227], a[20:23]
DM 12,28,53,0
v_cvt_pk_bf16_f32 v249, v146, v147
WL 4
v_mfma_f32_16x16x32_bf16 a[24:27], a[216:219], v[224:227], a[24:27]
TR 212,33,57344
v_cvt_pk_bf16_f32 v252, v152, v153
v_mfma_f32_16x16x32_bf16 a[56:59], a[216:219], v[228:231], a[56:59]
TR 214,33,61440
DM 13,28,53,1024
v_mfma_f32_16x16x32_bf16 a[88:91], a[216:219], v[232:235], a[88:91]
v_exp_f32 v141, v173
v_exp_f32 v142, v174
v_mfma_f32_16x16x32_bf16 a[120:123], a[216:219], v[236:239], a[120:123]
DM 14,28,53,2048
v_cvt_pk_bf16_f32 v253, v154, v155
WL 4
v_mfma_f32_16x16x32_bf16 a[124:127], a[220:223], v[236:239], a[124:127]
TR 216,34,57344
v_cvt_pk_bf16_f32 v242, v132, v133
v_mfma_f32_16x16x32_bf16 a[92:95], a[220:223], v[232:235], a[92:95]
TR 218,34,61440
DM 15,28,53,3072
s_add_u32 s53, s53, 458752
v_mfma_f32_16x16x32_bf16 a[60:63], a[220:223], v[228:231], a[60:63]
v_exp_f32 v143, v175
v_exp_f32 v148, v180
v_mfma_f32_16x16x32_bf16 a[28:31], a[220:223], v[224:227], a[28:31]
v_exp_f32 v149, v181
v_cvt_pk_bf16_f32 v243, v134, v135
XL 128,5,4,51,0
v_exp_f32 v150, v182
XL 132,5,4,51,128
v_cvt_pk_bf16_f32 v246, v140, v141
XL 136,5,4,51,256
v_exp_f32 v151, v183
XL 140,5,4,51,384
s_add_u32 s51, s51, 4096
v_cvt_pk_bf16_f32 v247, v142, v143
XL 144,5,4,51,0
v_exp_f32 v156, v188
XL 148,5,4,51,128
v_cvt_pk_bf16_f32 v250, v148, v149
XL 152,5,4,51,256
v_exp_f32 v157, v189
XL 156,5,4,51,384
s_add_u32 s51, s51, 4096
v_cvt_pk_bf16_f32 v251, v150, v151
XL 160,5,4,51,0
v_exp_f32 v158, v190
XL 164,5,4,51,128
v_exp_f32 v159, v191
XL 168,5,4,51,256
v_cvt_pk_bf16_f32 v254, v156, v157
XL 172,5,4,51,384
s_add_u32 s51, s51, 4096
v_cvt_pk_bf16_f32 v255, v158, v159
v_mfma_f32_16x16x32_bf16 v[208:211], a[240:243], v[240:243], 0
v_mfma_f32_16x16x32_bf16 v[212:215], a[240:243], v[244:247], 0
v_mfma_f32_16x16x32_bf16 v[216:219], a[240:243], v[248:251], 0
v_mfma_f32_16x16x32_bf16 v[220:223], a[240:243], v[252:255], 0
s_nop 6
v_max3_f32 v56, v208, v212, v216
v_max_f32 v56, v56, v220
v_cmp_lt_f32 vcc, 0x49800000, v56
s_nop 0
s_cbranch_vccnz t1_c35
t1_r36:
WL 4
v_mfma_f32_16x16x32_bf16 a[0:3], a[208:211], v[240:243], a[0:3]
TR 220,35,57344
v_mfma_f32_16x16x32_bf16 a[32:35], a[208:211], v[244:247], a[32:35]
TR 222,35,61440
XL 176,5,4,51,0
v_mfma_f32_16x16x32_bf16 a[64:67], a[208:211], v[248:251], a[64:67]
v_mfma_f32_16x16x32_bf16 a[96:99], a[208:211], v[252:255], a[96:99]
XL 180,5,4,51,128
WL 4
v_mfma_f32_16x16x32_bf16 a[100:103], a[212:215], v[252:255], a[100:103]
TR 208,36,57344
v_mfma_f32_16x16x32_bf16 a[68:71], a[212:215], v[248:251], a[68:71]
TR 210,36,61440
XL 184,5,4,51,256
v_mfma_f32_16x16x32_bf16 a[36:39], a[212:215], v[244:247], a[36:39]
v_mfma_f32_16x16x32_bf16 a[4:7], a[212:215], v[240:243], a[4:7]
XL 188,5,4,51,384
s_add_u32 s51, s51, 4096
WL 4
v_mfma_f32_16x16x32_bf16 a[8:11], a[216:219], v[240:243], a[8:11]
TR 212,37,57344
v_mfma_f32_16x16x32_bf16 a[40:43], a[216:219], v[244:247], a[40:43]
TR 214,37,61440
XL 224,5,4,51,0
v_mfma_f32_16x16x32_bf16 a[72:75], a[216:219], v[248:251], a[72:75]
v_mfma_f32_16x16x32_bf16 a[104:107], a[216:219], v[252:255], a[104:107]
XL 228,5,4,51,128
WL 4
v_mfma_f32_16x16x32_bf16 a[108:111], a[220:223], v[252:255], a[108:111]
TR 216,38,57344
v_mfma_f32_16x16x32_bf16 a[76:79], a[220:223], v[248:251], a[76:79]
TR 218,38,61440
XL 232,5,4,51,256
v_mfma_f32_16x16x32_bf16 a[44:47], a[220:223], v[244:247], a[44:47]
v_mfma_f32_16x16x32_bf16 a[12:15], a[220:223], v[240:243], a[12:15]
XL 236,5,4,51,384
s_add_u32 s51, s51, 4096
WL 4
v_mfma_f32_16x16x32_bf16 a[16:19], a[208:211], v[240:243], a[16:19]
TR 220,39,57344
v_mfma_f32_16x16x32_bf16 a[48:51], a[208:211], v[244:247], a[48:51]
TR 222,39,61440
XL 240,5,4,51,0
v_mfma_f32_16x16x32_bf16 a[80:83], a[208:211], v[248:251], a[80:83]
v_mfma_f32_16x16x32_bf16 a[112:115], a[208:211], v[252:255], a[112:115]
XL 244,5,4,51,128
WL 4
v_mfma_f32_16x16x32_bf16 a[116:119], a[212:215], v[252:255], a[116:119]
v_mfma_f32_16x16x32_bf16 a[84:87], a[212:215], v[248:251], a[84:87]
XL 248,5,4,51,256
v_mfma_f32_16x16x32_bf16 a[52:55], a[212:215], v[244:247], a[52:55]
v_mfma_f32_16x16x32_bf16 a[20:23], a[212:215], v[240:243], a[20:23]
XL 252,5,4,51,384
s_add_u32 s51, s51, 4096
WL 0
s_barrier
v_mfma_f32_16x16x32_bf16 a[24:27], a[216:219], v[240:243], a[24:27]
TR 192,24,0
v_mfma_f32_16x16x32_bf16 a[56:59], a[216:219], v[244:247], a[56:59]
TR 194,24,4096
v_mfma_f32_16x16x32_bf16 a[88:91], a[216:219], v[248:251], a[88:91]
TR 196,24,8192
v_mfma_f32_16x16x32_bf16 a[120:123], a[216:219], v[252:255], a[120:123]
TR 198,24,12288
v_mfma_f32_16x16x32_bf16 a[124:127], a[220:223], v[252:255], a[124:127]
TR 200,25,0
v_mfma_f32_16x16x32_bf16 a[92:95], a[220:223], v[248:251], a[92:95]
TR 202,25,4096
v_mfma_f32_16x16x32_bf16 a[60:63], a[220:223], v[244:247], a[60:63]
TR 204,25,8192
v_mfma_f32_16x16x32_bf16 a[28:31], a[220:223], v[240:243], a[28:31]
TR 206,25,12288
v_add_f32 v208, v208, v48
v_add_f32 v212, v212, v49
v_add_f32 v216, v216, v50
v_add_f32 v220, v220, v51
v_rcp_f32 v208, v208
v_rcp_f32 v212, v212
v_rcp_f32 v216, v216
v_rcp_f32 v220, v220
s_lshl_b32 s83, s56, 2
s_add_u32 s83, s83, s44
s_lshl_b32 s83, s83, 19
s_lshl_b32 s62, s57, 14
s_add_u32 s83, s83, s62
s_add_u32 s83, s83, 25165824
v_accvgpr_read_b32 v128, a0
v_accvgpr_read_b32 v129, a1
v_accvgpr_read_b32 v130, a2
v_accvgpr_read_b32 v131, a3
v_accvgpr_read_b32 v132, a4
v_accvgpr_read_b32 v133, a5
v_accvgpr_read_b32 v134, a6
v_accvgpr_read_b32 v135, a7
v_pk_mul_f32 v[128:129], v[128:129], v[208:209] op_sel_hi:[1,0]
v_pk_mul_f32 v[130:131], v[130:131], v[208:209] op_sel_hi:[1,0]
v_pk_mul_f32 v[132:133], v[132:133], v[208:209] op_sel_hi:[1,0]
v_pk_mul_f32 v[134:135], v[134:135], v[208:209] op_sel_hi:[1,0]
v_cvt_pk_bf16_f32 v160, v128, v129
v_cvt_pk_bf16_f32 v161, v130, v131
v_cvt_pk_bf16_f32 v162, v132, v133
v_cvt_pk_bf16_f32 v163, v134, v135
buffer_store_dwordx4 v[160:163], v5, s[4:7], s83 offen offset:0 sc1
v_accvgpr_read_b32 v136, a32
v_accvgpr_read_b32 v137, a33
v_accvgpr_read_b32 v138, a34
v_accvgpr_read_b32 v139, a35
v_accvgpr_read_b32 v140, a36
v_accvgpr_read_b32 v141, a37
v_accvgpr_read_b32 v142, a38
v_accvgpr_read_b32 v143, a39
v_pk_mul_f32 v[136:137], v[136:137], v[212:213] op_sel_hi:[1,0]
v_pk_mul_f32 v[138:139], v[138:139], v[212:213] op_sel_hi:[1,0]
v_pk_mul_f32 v[140:141], v[140:141], v[212:213] op_sel_hi:[1,0]
v_pk_mul_f32 v[142:143], v[142:143], v[212:213] op_sel_hi:[1,0]
v_cvt_pk_bf16_f32 v164, v136, v137
v_cvt_pk_bf16_f32 v165, v138, v139
v_cvt_pk_bf16_f32 v166, v140, v141
v_cvt_pk_bf16_f32 v167, v142, v143
buffer_store_dwordx4 v[164:167], v5, s[4:7], s83 offen offset:128 sc1
v_accvgpr_read_b32 v128, a64
v_accvgpr_read_b32 v129, a65
v_accvgpr_read_b32 v130, a66
v_accvgpr_read_b32 v131, a67
v_accvgpr_read_b32 v132, a68
v_accvgpr_read_b32 v133, a69
v_accvgpr_read_b32 v134, a70
v_accvgpr_read_b32 v135, a71
v_pk_mul_f32 v[128:129], v[128:129], v[216:217] op_sel_hi:[1,0]
v_pk_mul_f32 v[130:131], v[130:131], v[216:217] op_sel_hi:[1,0]
v_pk_mul_f32 v[132:133], v[132:133], v[216:217] op_sel_hi:[1,0]
v_pk_mul_f32 v[134:135], v[134:135], v[216:217] op_sel_hi:[1,0]
v_cvt_pk_bf16_f32 v168, v128, v129
v_cvt_pk_bf16_f32 v169, v130, v131
v_cvt_pk_bf16_f32 v170, v132, v133
v_cvt_pk_bf16_f32 v171, v134, v135
buffer_store_dwordx4 v[168:171], v5, s[4:7], s83 offen offset:256 sc1
v_accvgpr_read_b32 v136, a96
v_accvgpr_read_b32 v137, a97
v_accvgpr_read_b32 v138, a98
v_accvgpr_read_b32 v139, a99
v_accvgpr_read_b32 v140, a100
v_accvgpr_read_b32 v141, a101
v_accvgpr_read_b32 v142, a102
v_accvgpr_read_b32 v143, a103
v_pk_mul_f32 v[136:137], v[136:137], v[220:221] op_sel_hi:[1,0]
v_pk_mul_f32 v[138:139], v[138:139], v[220:221] op_sel_hi:[1,0]
v_pk_mul_f32 v[140:141], v[140:141], v[220:221] op_sel_hi:[1,0]
v_pk_mul_f32 v[142:143], v[142:143], v[220:221] op_sel_hi:[1,0]
v_cvt_pk_bf16_f32 v172, v136, v137
v_cvt_pk_bf16_f32 v173, v138, v139
v_cvt_pk_bf16_f32 v174, v140, v141
v_cvt_pk_bf16_f32 v175, v142, v143
buffer_store_dwordx4 v[172:175], v5, s[4:7], s83 offen offset:384 sc1
s_add_u32 s83, s83, 4096
v_accvgpr_read_b32 v128, a8
v_accvgpr_read_b32 v129, a9
v_accvgpr_read_b32 v130, a10
v_accvgpr_read_b32 v131, a11
v_accvgpr_read_b32 v132, a12
v_accvgpr_read_b32 v133, a13
v_accvgpr_read_b32 v134, a14
v_accvgpr_read_b32 v135, a15
v_pk_mul_f32 v[128:129], v[128:129], v[208:209] op_sel_hi:[1,0]
v_pk_mul_f32 v[130:131], v[130:131], v[208:209] op_sel_hi:[1,0]
v_pk_mul_f32 v[132:133], v[132:133], v[208:209] op_sel_hi:[1,0]
v_pk_mul_f32 v[134:135], v[134:135], v[208:209] op_sel_hi:[1,0]
v_cvt_pk_bf16_f32 v160, v128, v129
v_cvt_pk_bf16_f32 v161, v130, v131
v_cvt_pk_bf16_f32 v162, v132, v133
v_cvt_pk_bf16_f32 v163, v134, v135
buffer_store_dwordx4 v[160:163], v5, s[4:7], s83 offen offset:0 sc1
v_accvgpr_read_b32 v136, a40
v_accvgpr_read_b32 v137, a41
v_accvgpr_read_b32 v138, a42
v_accvgpr_read_b32 v139, a43
v_accvgpr_read_b32 v140, a44
v_accvgpr_read_b32 v141, a45
v_accvgpr_read_b32 v142, a46
v_accvgpr_read_b32 v143, a47
v_pk_mul_f32 v[136:137], v[136:137], v[212:213] op_sel_hi:[1,0]
v_pk_mul_f32 v[138:139], v[138:139], v[212:213] op_sel_hi:[1,0]
v_pk_mul_f32 v[140:141], v[140:141], v[212:213] op_sel_hi:[1,0]
v_pk_mul_f32 v[142:143], v[142:143], v[212:213] op_sel_hi:[1,0]
v_cvt_pk_bf16_f32 v164, v136, v137
v_cvt_pk_bf16_f32 v165, v138, v139
v_cvt_pk_bf16_f32 v166, v140, v141
v_cvt_pk_bf16_f32 v167, v142, v143
buffer_store_dwordx4 v[164:167], v5, s[4:7], s83 offen offset:128 sc1
v_accvgpr_read_b32 v128, a72
v_accvgpr_read_b32 v129, a73
v_accvgpr_read_b32 v130, a74
v_accvgpr_read_b32 v131, a75
v_accvgpr_read_b32 v132, a76
v_accvgpr_read_b32 v133, a77
v_accvgpr_read_b32 v134, a78
v_accvgpr_read_b32 v135, a79
v_pk_mul_f32 v[128:129], v[128:129], v[216:217] op_sel_hi:[1,0]
v_pk_mul_f32 v[130:131], v[130:131], v[216:217] op_sel_hi:[1,0]
v_pk_mul_f32 v[132:133], v[132:133], v[216:217] op_sel_hi:[1,0]
v_pk_mul_f32 v[134:135], v[134:135], v[216:217] op_sel_hi:[1,0]
v_cvt_pk_bf16_f32 v168, v128, v129
v_cvt_pk_bf16_f32 v169, v130, v131
v_cvt_pk_bf16_f32 v170, v132, v133
v_cvt_pk_bf16_f32 v171, v134, v135
buffer_store_dwordx4 v[168:171], v5, s[4:7], s83 offen offset:256 sc1
v_accvgpr_read_b32 v136, a104
v_accvgpr_read_b32 v137, a105
v_accvgpr_read_b32 v138, a106
v_accvgpr_read_b32 v139, a107
v_accvgpr_read_b32 v140, a108
v_accvgpr_read_b32 v141, a109
v_accvgpr_read_b32 v142, a110
v_accvgpr_read_b32 v143, a111
v_pk_mul_f32 v[136:137], v[136:137], v[220:221] op_sel_hi:[1,0]
v_pk_mul_f32 v[138:139], v[138:139], v[220:221] op_sel_hi:[1,0]
v_pk_mul_f32 v[140:141], v[140:141], v[220:221] op_sel_hi:[1,0]
v_pk_mul_f32 v[142:143], v[142:143], v[220:221] op_sel_hi:[1,0]
v_cvt_pk_bf16_f32 v172, v136, v137
v_cvt_pk_bf16_f32 v173, v138, v139
v_cvt_pk_bf16_f32 v174, v140, v141
v_cvt_pk_bf16_f32 v175, v142, v143
buffer_store_dwordx4 v[172:175], v5, s[4:7], s83 offen offset:384 sc1
s_add_u32 s83, s83, 4096
v_accvgpr_read_b32 v128, a16
v_accvgpr_read_b32 v129, a17
v_accvgpr_read_b32 v130, a18
v_accvgpr_read_b32 v131, a19
v_accvgpr_read_b32 v132, a20
v_accvgpr_read_b32 v133, a21
v_accvgpr_read_b32 v134, a22
v_accvgpr_read_b32 v135, a23
v_pk_mul_f32 v[128:129], v[128:129], v[208:209] op_sel_hi:[1,0]
v_pk_mul_f32 v[130:131], v[130:131], v[208:209] op_sel_hi:[1,0]
v_pk_mul_f32 v[132:133], v[132:133], v[208:209] op_sel_hi:[1,0]
v_pk_mul_f32 v[134:135], v[134:135], v[208:209] op_sel_hi:[1,0]
v_cvt_pk_bf16_f32 v160, v128, v129
v_cvt_pk_bf16_f32 v161, v130, v131
v_cvt_pk_bf16_f32 v162, v132, v133
v_cvt_pk_bf16_f32 v163, v134, v135
buffer_store_dwordx4 v[160:163], v5, s[4:7], s83 offen offset:0 sc1
v_accvgpr_read_b32 v136, a48
v_accvgpr_read_b32 v137, a49
v_accvgpr_read_b32 v138, a50
v_accvgpr_read_b32 v139, a51
v_accvgpr_read_b32 v140, a52
v_accvgpr_read_b32 v141, a53
v_accvgpr_read_b32 v142, a54
v_accvgpr_read_b32 v143, a55
v_pk_mul_f32 v[136:137], v[136:137], v[212:213] op_sel_hi:[1,0]
v_pk_mul_f32 v[138:139], v[138:139], v[212:213] op_sel_hi:[1,0]
v_pk_mul_f32 v[140:141], v[140:141], v[212:213] op_sel_hi:[1,0]
v_pk_mul_f32 v[142:143], v[142:143], v[212:213] op_sel_hi:[1,0]
v_cvt_pk_bf16_f32 v164, v136, v137
v_cvt_pk_bf16_f32 v165, v138, v139
v_cvt_pk_bf16_f32 v166, v140, v141
v_cvt_pk_bf16_f32 v167, v142, v143
buffer_store_dwordx4 v[164:167], v5, s[4:7], s83 offen offset:128 sc1
v_accvgpr_read_b32 v128, a80
v_accvgpr_read_b32 v129, a81
v_accvgpr_read_b32 v130, a82
v_accvgpr_read_b32 v131, a83
v_accvgpr_read_b32 v132, a84
v_accvgpr_read_b32 v133, a85
v_accvgpr_read_b32 v134, a86
v_accvgpr_read_b32 v135, a87
v_pk_mul_f32 v[128:129], v[128:129], v[216:217] op_sel_hi:[1,0]
v_pk_mul_f32 v[130:131], v[130:131], v[216:217] op_sel_hi:[1,0]
v_pk_mul_f32 v[132:133], v[132:133], v[216:217] op_sel_hi:[1,0]
v_pk_mul_f32 v[134:135], v[134:135], v[216:217] op_sel_hi:[1,0]
v_cvt_pk_bf16_f32 v168, v128, v129
v_cvt_pk_bf16_f32 v169, v130, v131
v_cvt_pk_bf16_f32 v170, v132, v133
v_cvt_pk_bf16_f32 v171, v134, v135
buffer_store_dwordx4 v[168:171], v5, s[4:7], s83 offen offset:256 sc1
v_accvgpr_read_b32 v136, a112
v_accvgpr_read_b32 v137, a113
v_accvgpr_read_b32 v138, a114
v_accvgpr_read_b32 v139, a115
v_accvgpr_read_b32 v140, a116
v_accvgpr_read_b32 v141, a117
v_accvgpr_read_b32 v142, a118
v_accvgpr_read_b32 v143, a119
v_pk_mul_f32 v[136:137], v[136:137], v[220:221] op_sel_hi:[1,0]
v_pk_mul_f32 v[138:139], v[138:139], v[220:221] op_sel_hi:[1,0]
v_pk_mul_f32 v[140:141], v[140:141], v[220:221] op_sel_hi:[1,0]
v_pk_mul_f32 v[142:143], v[142:143], v[220:221] op_sel_hi:[1,0]
v_cvt_pk_bf16_f32 v172, v136, v137
v_cvt_pk_bf16_f32 v173, v138, v139
v_cvt_pk_bf16_f32 v174, v140, v141
v_cvt_pk_bf16_f32 v175, v142, v143
buffer_store_dwordx4 v[172:175], v5, s[4:7], s83 offen offset:384 sc1
s_add_u32 s83, s83, 4096
v_accvgpr_read_b32 v128, a24
v_accvgpr_read_b32 v129, a25
v_accvgpr_read_b32 v130, a26
v_accvgpr_read_b32 v131, a27
v_accvgpr_read_b32 v132, a28
v_accvgpr_read_b32 v133, a29
v_accvgpr_read_b32 v134, a30
v_accvgpr_read_b32 v135, a31
v_pk_mul_f32 v[128:129], v[128:129], v[208:209] op_sel_hi:[1,0]
v_pk_mul_f32 v[130:131], v[130:131], v[208:209] op_sel_hi:[1,0]
v_pk_mul_f32 v[132:133], v[132:133], v[208:209] op_sel_hi:[1,0]
v_pk_mul_f32 v[134:135], v[134:135], v[208:209] op_sel_hi:[1,0]
v_cvt_pk_bf16_f32 v160, v128, v129
v_cvt_pk_bf16_f32 v161, v130, v131
v_cvt_pk_bf16_f32 v162, v132, v133
v_cvt_pk_bf16_f32 v163, v134, v135
buffer_store_dwordx4 v[160:163], v5, s[4:7], s83 offen offset:0 sc1
v_accvgpr_read_b32 v136, a56
v_accvgpr_read_b32 v137, a57
v_accvgpr_read_b32 v138, a58
v_accvgpr_read_b32 v139, a59
v_accvgpr_read_b32 v140, a60
v_accvgpr_read_b32 v141, a61
v_accvgpr_read_b32 v142, a62
v_accvgpr_read_b32 v143, a63
v_pk_mul_f32 v[136:137], v[136:137], v[212:213] op_sel_hi:[1,0]
v_pk_mul_f32 v[138:139], v[138:139], v[212:213] op_sel_hi:[1,0]
v_pk_mul_f32 v[140:141], v[140:141], v[212:213] op_sel_hi:[1,0]
v_pk_mul_f32 v[142:143], v[142:143], v[212:213] op_sel_hi:[1,0]
v_cvt_pk_bf16_f32 v164, v136, v137
v_cvt_pk_bf16_f32 v165, v138, v139
v_cvt_pk_bf16_f32 v166, v140, v141
v_cvt_pk_bf16_f32 v167, v142, v143
buffer_store_dwordx4 v[164:167], v5, s[4:7], s83 offen offset:128 sc1
v_accvgpr_read_b32 v128, a88
v_accvgpr_read_b32 v129, a89
v_accvgpr_read_b32 v130, a90
v_accvgpr_read_b32 v131, a91
v_accvgpr_read_b32 v132, a92
v_accvgpr_read_b32 v133, a93
v_accvgpr_read_b32 v134, a94
v_accvgpr_read_b32 v135, a95
v_pk_mul_f32 v[128:129], v[128:129], v[216:217] op_sel_hi:[1,0]
v_pk_mul_f32 v[130:131], v[130:131], v[216:217] op_sel_hi:[1,0]
v_pk_mul_f32 v[132:133], v[132:133], v[216:217] op_sel_hi:[1,0]
v_pk_mul_f32 v[134:135], v[134:135], v[216:217] op_sel_hi:[1,0]
v_cvt_pk_bf16_f32 v168, v128, v129
v_cvt_pk_bf16_f32 v169, v130, v131
v_cvt_pk_bf16_f32 v170, v132, v133
v_cvt_pk_bf16_f32 v171, v134, v135
buffer_store_dwordx4 v[168:171], v5, s[4:7], s83 offen offset:256 sc1
v_accvgpr_read_b32 v136, a120
v_accvgpr_read_b32 v137, a121
v_accvgpr_read_b32 v138, a122
v_accvgpr_read_b32 v139, a123
v_accvgpr_read_b32 v140, a124
v_accvgpr_read_b32 v141, a125
v_accvgpr_read_b32 v142, a126
v_accvgpr_read_b32 v143, a127
v_pk_mul_f32 v[136:137], v[136:137], v[220:221] op_sel_hi:[1,0]
v_pk_mul_f32 v[138:139], v[138:139], v[220:221] op_sel_hi:[1,0]
v_pk_mul_f32 v[140:141], v[140:141], v[220:221] op_sel_hi:[1,0]
v_pk_mul_f32 v[142:143], v[142:143], v[220:221] op_sel_hi:[1,0]
v_cvt_pk_bf16_f32 v172, v136, v137
v_cvt_pk_bf16_f32 v173, v138, v139
v_cvt_pk_bf16_f32 v174, v140, v141
v_cvt_pk_bf16_f32 v175, v142, v143
buffer_store_dwordx4 v[172:175], v5, s[4:7], s83 offen offset:384 sc1
s_add_u32 s83, s83, 4096
s_waitcnt vmcnt(32) lgkmcnt(4)
MZ 128,192,128
TR 208,26,0
MA 128,196,144
s_add_u32 m0, s48, 98304
TR 210,26,4096
MZ 152,196,148
DM 12,28,53,0
MA 152,192,132
v_xor_b32 v32, 65536, v1
MZ 176,192,136
TR 212,26,8192
MA 176,196,152
TR 214,26,12288
MZ 200,196,156
DM 13,28,53,1024
MA 200,192,140
v_xor_b32 v33, 65568, v1
WL 4
MZ 204,200,140
TR 216,27,0
MA 204,204,156
TR 218,27,4096
MZ 180,204,152
DM 14,28,53,2048
MA 180,200,136
v_xor_b32 v34, 65600, v1
MZ 156,200,132
TR 220,27,8192
MA 156,204,148
TR 222,27,12288
MZ 132,204,144
DM 15,28,53,3072
MA 132,200,128
s_add_u32 s53, s53, 458752
v_xor_b32 v35, 65632, v1
WL 4
MZ 136,208,128
TR 192,28,0
MA 136,212,144
TR 194,28,4096
MZ 160,212,148
XL 0,5,4,51,0
MA 160,208,132
v_xor_b32 v36, 65664, v1
MZ 184,208,136
TR 196,28,8192
MA 184,212,152
TR 198,28,12288
MZ 208,212,156
XL 4,5,4,51,128
MA 208,208,140
v_xor_b32 v37, 65696, v1
WL 4
MZ 212,216,140
TR 200,29,0
MA 212,220,156
TR 202,29,4096
MZ 188,220,152
XL 8,5,4,51,256
MA 188,216,136
s_lshl_b32 s50, s58, 2
MZ 164,216,132
TR 204,29,8192
MA 164,220,148
TR 206,29,12288
MZ 140,220,144
XL 12,5,4,51,384
MA 140,216,128
s_add_u32 s51, s51, 4096
s_add_u32 s50, s50, s44
WL 4
MZ 144,192,128
MA 144,196,144
MZ 168,196,148
XL 16,5,4,51,0
MA 168,192,132
s_mul_i32 s50, s50, 524288
WL 0
s_barrier
MZ 192,192,136
TR 208,24,32768
MA 192,196,152
TR 210,24,36864
MZ 216,196,156
XL 20,5,4,51,128
TR 212,24,40960
MA 216,192,140
TR 214,24,45056
s_add_u32 s50, s50, 25165824
MZ 220,200,140
TR 216,25,32768
MA 220,204,156
TR 218,25,36864
MZ 196,204,152
XL 24,5,4,51,256
MA 196,200,136
s_mul_i32 s52, s44, 32768
MZ 172,200,132
TR 220,25,40960
MA 172,204,148
TR 222,25,45056
MZ 148,204,144
XL 28,5,4,51,384
MA 148,200,128
s_add_u32 s51, s51, 4096
s_mul_i32 s62, s96, 256
s_waitcnt vmcnt(36) lgkmcnt(4)
MA 128,208,160
TR 192,26,32768
MA 128,212,176
s_add_u32 m0, s48, 0
TR 194,26,36864
MA 152,212,180
DM 12,28,53,0
MA 152,208,164
s_add_u32 s52, s52, s62
MA 176,208,168
TR 196,26,40960
MA 176,212,184
TR 198,26,45056
MA 200,212,188
DM 13,28,53,1024
MA 200,208,172
s_mul_i32 s62, s97, 262144
WL 4
MA 204,216,172
TR 200,27,32768
MA 204,220,188
TR 202,27,36864
MA 180,220,184
DM 14,28,53,2048
MA 180,216,168
s_add_u32 s50, s50, s62
MA 156,216,164
TR 204,27,40960
MA 156,220,180
TR 206,27,45056
MA 132,220,176
DM 15,28,53,3072
MA 132,216,160
s_add_u32 s53, s53, 458752
s_mul_i32 s62, s97, 4194304
WL 4
MA 136,192,160
TR 208,28,32768
MA 136,196,176
TR 210,28,36864
MA 160,196,180
XL 128,5,4,51,0
MA 160,192,164
s_add_u32 s52, s52, s62
MA 184,192,168
TR 212,28,40960
MA 184,196,184
TR 214,28,45056
MA 208,196,188
XL 132,5,4,51,128
MA 208,192,172
s_mov_b32 s62, 2048
WL 4
MA 212,200,172
TR 216,29,32768
MA 212,204,188
TR 218,29,36864
MA 188,204,184
XL 136,5,4,51,256
MA 188,200,168
v_mad_u32_u24 v8, v19, s62, v20
MA 164,200,164
TR 220,29,40960
MA 164,204,180
TR 222,29,45056
MA 140,204,176
XL 140,5,4,51,384
MA 140,200,160
s_add_u32 s51, s51, 4096
v_xor_b32 v9, 128, v8
WL 4
MA 144,208,160
MA 144,212,176
MA 168,212,180
XL 144,5,4,51,0
MA 168,208,164
v_add_u32 v10, 14336, v8
WL 0
s_barrier
MA 192,208,168
TR 192,32,0
MA 192,212,184
TR 194,32,4096
MA 216,212,188
XL 148,5,4,51,128
TR 196,32,8192
MA 216,208,172
TR 198,32,12288
v_add_u32 v11, 21504, v9
MA 220,216,172
TR 200,33,0
MA 220,220,188
TR 202,33,4096
MA 196,220,184
XL 152,5,4,51,256
MA 196,216,168
v_add_u32 v9, 7168, v9
MA 172,216,164
TR 204,33,8192
MA 172,220,180
TR 206,33,12288
MA 148,220,176
XL 156,5,4,51,384
MA 148,216,160
s_add_u32 s51, s51, 4096
s_waitcnt vmcnt(40) lgkmcnt(4)
MA 128,192,224
TR 208,34,0
MA 128,196,240
s_add_u32 m0, s48, 32768
TR 210,34,4096
MA 152,196,244
DM 12,28,53,0
MA 152,192,228
MA 176,192,232
TR 212,34,8192
MA 176,196,248
TR 214,34,12288
MA 200,196,252
DM 13,28,53,1024
MA 200,192,236
WL 4
MA 204,200,236
TR 216,35,0
MA 204,204,252
TR 218,35,4096
MA 180,204,248
DM 14,28,53,2048
MA 180,200,232
MA 156,200,228
TR 220,35,8192
MA 156,204,244
TR 222,35,12288
MA 132,204,240
DM 15,28,53,3072
MA 132,200,224
s_add_u32 s53, s53, 458752
WL 4
MA 136,208,224
TR 192,36,0
MA 136,212,240
TR 194,36,4096
MA 160,212,244
XL 160,5,4,51,0
MA 160,208,228
MA 184,208,232
TR 196,36,8192
MA 184,212,248
TR 198,36,12288
MA 208,212,252
XL 164,5,4,51,128
MA 208,208,236
WL 4
MA 212,216,236
TR 200,37,0
MA 212,220,252
TR 202,37,4096
MA 188,220,248
XL 168,5,4,51,256
MA 188,216,232
MA 164,216,228
TR 204,37,8192
MA 164,220,244
TR 206,37,12288
MA 140,220,240
XL 172,5,4,51,384
MA 140,216,224
s_add_u32 s51, s51, 4096
WL 4
MA 144,192,224
MA 144,196,240
MA 168,196,244
XL 176,5,4,51,0
MA 168,192,228
s_waitcnt vmcnt(29) lgkmcnt(0)
s_barrier
buffer_atomic_add v21, v18, s[4:7], s80 offen offset:1024
MA 192,192,232
TR 208,32,32768
MA 192,196,248
TR 210,32,36864
MA 216,196,252
XL 180,5,4,51,128
TR 212,32,40960
MA 216,192,236
TR 214,32,45056
MA 220,200,236
TR 216,33,32768
MA 220,204,252
TR 218,33,36864
MA 196,204,248
XL 184,5,4,51,256
MA 196,200,232
MA 172,200,228
TR 220,33,40960
MA 172,204,244
TR 222,33,45056
MA 148,204,240
XL 188,5,4,51,384
MA 148,200,224
s_add_u32 s51, s51, 4096
s_waitcnt vmcnt(25) lgkmcnt(4)
MA 128,208,0
TR 192,34,32768
MA 128,212,16
s_add_u32 m0, s48, 65536
TR 194,34,36864
MA 152,212,20
DM 12,28,53,0
MA 152,208,4
MA 176,208,8
TR 196,34,40960
MA 176,212,24
TR 198,34,45056
MA 200,212,28
DM 13,28,53,1024
MA 200,208,12
WL 4
MA 204,216,12
TR 200,35,32768
MA 204,220,28
TR 202,35,36864
MA 180,220,24
DM 14,28,53,2048
MA 180,216,8
MA 156,216,4
TR 204,35,40960
MA 156,220,20
TR 206,35,45056
MA 132,220,16
DM 15,28,53,3072
MA 132,216,0
s_add_u32 s53, s53, 458752
buffer_load_dword v61, v60, s[84:87], s77 offen
WL 4
MA 136,192,0
TR 208,36,32768
MA 136,196,16
TR 210,36,36864
MA 160,196,20
XL 224,5,4,51,0
MA 160,192,4
MA 184,192,8
TR 212,36,40960
MA 184,196,24
TR 214,36,45056
MA 208,196,28
XL 228,5,4,51,128
MA 208,192,12
WL 4
MA 212,200,12
TR 216,37,32768
MA 212,204,28
TR 218,37,36864
MA 188,204,24
XL 232,5,4,51,256
MA 188,200,8
MA 164,200,4
TR 220,37,40960
MA 164,204,20
TR 222,37,45056
MA 140,204,16
XL 236,5,4,51,384
MA 140,200,0
s_add_u32 s51, s51, 4096
WL 4
MA 144,208,0
MA 144,212,16
MA 168,212,20
XL 240,5,4,51,0
MA 168,208,4
s_waitcnt vmcnt(31) lgkmcnt(0)
s_barrier
MA 192,208,8
TR 192,24,0
MA 192,212,24
TR 194,24,4096
MA 216,212,28
XL 244,5,4,51,128
TR 196,24,8192
MA 216,208,12
TR 198,24,12288
MA 220,216,12
TR 200,25,0
MA 220,220,28
TR 202,25,4096
MA 196,220,24
XL 248,5,4,51,256
MA 196,216,8
MA 172,216,4
TR 204,25,8192
MA 172,220,20
TR 206,25,12288
MA 148,220,16
XL 252,5,4,51,384
MA 148,216,0
s_add_u32 s51, s51, 4096
s_mov_b32 s47, 1
t1_L32:
s_waitcnt vmcnt(25) lgkmcnt(4)
MA 128,192,128
TR 208,26,0
MA 128,196,144
s_add_u32 m0, s48, 98304
TR 210,26,4096
MA 152,196,148
DM 12,28,53,0
MA 152,192,132
MA 176,192,136
TR 212,26,8192
MA 176,196,152
TR 214,26,12288
MA 200,196,156
DM 13,28,53,1024
MA 200,192,140
WL 4
MA 204,200,140
TR 216,27,0
MA 204,204,156
TR 218,27,4096
MA 180,204,152
DM 14,28,53,2048
MA 180,200,136
MA 156,200,132
TR 220,27,8192
MA 156,204,148
TR 222,27,12288
MA 132,204,144
DM 15,28,53,3072
MA 132,200,128
s_add_u32 s53, s53, 458752
WL 4
MA 136,208,128
TR 192,28,0
MA 136,212,144
TR 194,28,4096
MA 160,212,148
XL 0,5,4,51,0
MA 160,208,132
MA 184,208,136
TR 196,28,8192
MA 184,212,152
TR 198,28,12288
MA 208,212,156
XL 4,5,4,51,128
MA 208,208,140
WL 4
MA 212,216,140
TR 200,29,0
MA 212,220,156
TR 202,29,4096
MA 188,220,152
XL 8,5,4,51,256
MA 188,216,136
MA 164,216,132
TR 204,29,8192
MA 164,220,148
TR 206,29,12288
MA 140,220,144
XL 12,5,4,51,384
MA 140,216,128
s_add_u32 s51, s51, 4096
WL 4
MA 144,192,128
MA 144,196,144
MA 168,196,148
XL 16,5,4,51,0
MA 168,192,132
s_waitcnt vmcnt(30) lgkmcnt(0)
s_barrier
MA 192,192,136
TR 208,24,32768
MA 192,196,152
TR 210,24,36864
MA 216,196,156
XL 20,5,4,51,128
TR 212,24,40960
MA 216,192,140
TR 214,24,45056
MA 220,200,140
TR 216,25,32768
MA 220,204,156
TR 218,25,36864
MA 196,204,152
XL 24,5,4,51,256
MA 196,200,136
MA 172,200,132
TR 220,25,40960
MA 172,204,148
TR 222,25,45056
MA 148,204,144
XL 28,5,4,51,384
MA 148,200,128
s_add_u32 s51, s51, 4096
s_waitcnt vmcnt(25) lgkmcnt(4)
MA 128,208,160
TR 192,26,32768
MA 128,212,176
s_add_u32 m0, s48, 0
TR 194,26,36864
MA 152,212,180
DM 12,28,53,0
MA 152,208,164
MA 176,208,168
TR 196,26,40960
MA 176,212,184
TR 198,26,45056
MA 200,212,188
DM 13,28,53,1024
MA 200,208,172
WL 4
MA 204,216,172
TR 200,27,32768
MA 204,220,188
TR 202,27,36864
MA 180,220,184
DM 14,28,53,2048
MA 180,216,168
MA 156,216,164
TR 204,27,40960
MA 156,220,180
TR 206,27,45056
MA 132,220,176
DM 15,28,53,3072
MA 132,216,160
s_add_u32 s53, s53, 458752
WL 4
MA 136,192,160
TR 208,28,32768
MA 136,196,176
TR 210,28,36864
MA 160,196,180
XL 128,5,4,51,0
MA 160,192,164
MA 184,192,168
TR 212,28,40960
MA 184,196,184
TR 214,28,45056
MA 208,196,188
XL 132,5,4,51,128
MA 208,192,172
WL 4
MA 212,200,172
TR 216,29,32768
MA 212,204,188
TR 218,29,36864
MA 188,204,184
XL 136,5,4,51,256
MA 188,200,168
MA 164,200,164
TR 220,29,40960
MA 164,204,180
TR 222,29,45056
MA 140,204,176
XL 140,5,4,51,384
MA 140,200,160
s_add_u32 s51, s51, 4096
WL 4
MA 144,208,160
MA 144,212,176
MA 168,212,180
XL 144,5,4,51,0
MA 168,208,164
s_waitcnt vmcnt(30) lgkmcnt(0)
s_barrier
MA 192,208,168
TR 192,32,0
MA 192,212,184
TR 194,32,4096
MA 216,212,188
XL 148,5,4,51,128
TR 196,32,8192
MA 216,208,172
TR 198,32,12288
MA 220,216,172
TR 200,33,0
MA 220,220,188
TR 202,33,4096
MA 196,220,184
XL 152,5,4,51,256
MA 196,216,168
MA 172,216,164
TR 204,33,8192
MA 172,220,180
TR 206,33,12288
MA 148,220,176
XL 156,5,4,51,384
MA 148,216,160
s_add_u32 s51, s51, 4096
s_waitcnt vmcnt(24) lgkmcnt(4)
MA 128,192,224
TR 208,34,0
MA 128,196,240
s_add_u32 m0, s48, 32768
TR 210,34,4096
MA 152,196,244
DM 12,28,53,0
MA 152,192,228
MA 176,192,232
TR 212,34,8192
MA 176,196,248
TR 214,34,12288
MA 200,196,252
DM 13,28,53,1024
MA 200,192,236
WL 4
MA 204,200,236
TR 216,35,0
MA 204,204,252
TR 218,35,4096
MA 180,204,248
DM 14,28,53,2048
MA 180,200,232
MA 156,200,228
TR 220,35,8192
MA 156,204,244
TR 222,35,12288
MA 132,204,240
DM 15,28,53,3072
MA 132,200,224
s_add_u32 s53, s53, 458752
WL 4
MA 136,208,224
TR 192,36,0
MA 136,212,240
TR 194,36,4096
MA 160,212,244
XL 160,5,4,51,0
MA 160,208,228
MA 184,208,232
TR 196,36,8192
MA 184,212,248
TR 198,36,12288
MA 208,212,252
XL 164,5,4,51,128
MA 208,208,236
WL 4
MA 212,216,236
TR 200,37,0
MA 212,220,252
TR 202,37,4096
MA 188,220,248
XL 168,5,4,51,256
MA 188,216,232
MA 164,216,228
TR 204,37,8192
MA 164,220,244
TR 206,37,12288
MA 140,220,240
XL 172,5,4,51,384
MA 140,216,224
s_add_u32 s51, s51, 4096
WL 4
MA 144,192,224
MA 144,196,240
MA 168,196,244
XL 176,5,4,51,0
MA 168,192,228
s_waitcnt vmcnt(29) lgkmcnt(0)
s_barrier
MA 192,192,232
TR 208,32,32768
MA 192,196,248
TR 210,32,36864
MA 216,196,252
XL 180,5,4,51,128
TR 212,32,40960
MA 216,192,236
TR 214,32,45056
MA 220,200,236
TR 216,33,32768
MA 220,204,252
TR 218,33,36864
MA 196,204,248
XL 184,5,4,51,256
MA 196,200,232
MA 172,200,228
TR 220,33,40960
MA 172,204,244
TR 222,33,45056
MA 148,204,240
XL 188,5,4,51,384
MA 148,200,224
s_add_u32 s51, s51, 4096
s_waitcnt vmcnt(24) lgkmcnt(4)
MA 128,208,0
TR 192,34,32768
MA 128,212,16
s_add_u32 m0, s48, 65536
TR 194,34,36864
MA 152,212,20
DM 12,28,53,0
MA 152,208,4
MA 176,208,8
TR 196,34,40960
MA 176,212,24
TR 198,34,45056
MA 200,212,28
DM 13,28,53,1024
MA 200,208,12
WL 4
MA 204,216,12
TR 200,35,32768
MA 204,220,28
TR 202,35,36864
MA 180,220,24
DM 14,28,53,2048
MA 180,216,8
MA 156,216,4
TR 204,35,40960
MA 156,220,20
TR 206,35,45056
MA 132,220,16
DM 15,28,53,3072
MA 132,216,0
s_add_u32 s53, s53, 458752
buffer_load_dword v61, v60, s[84:87], s77 offen
WL 4
MA 136,192,0
TR 208,36,32768
MA 136,196,16
TR 210,36,36864
MA 160,196,20
XL 224,5,4,51,0
MA 160,192,4
MA 184,192,8
TR 212,36,40960
MA 184,196,24
TR 214,36,45056
MA 208,196,28
XL 228,5,4,51,128
MA 208,192,12
WL 4
MA 212,200,12
TR 216,37,32768
MA 212,204,28
TR 218,37,36864
MA 188,204,24
XL 232,5,4,51,256
MA 188,200,8
MA 164,200,4
TR 220,37,40960
MA 164,204,20
TR 222,37,45056
MA 140,204,16
XL 236,5,4,51,384
MA 140,200,0
s_add_u32 s51, s51, 4096
WL 4
MA 144,208,0
MA 144,212,16
MA 168,212,20
XL 240,5,4,51,0
MA 168,208,4
s_waitcnt vmcnt(30) lgkmcnt(0)
s_barrier
MA 192,208,8
TR 192,24,0
MA 192,212,24
TR 194,24,4096
MA 216,212,28
XL 244,5,4,51,128
TR 196,24,8192
MA 216,208,12
TR 198,24,12288
MA 220,216,12
TR 200,25,0
MA 220,220,28
TR 202,25,4096
MA 196,220,24
XL 248,5,4,51,256
MA 196,216,8
MA 172,216,4
TR 204,25,8192
MA 172,220,20
TR 206,25,12288
MA 148,220,16
XL 252,5,4,51,384
MA 148,216,0
s_add_u32 s51, s51, 4096
s_sub_u32 s47, s47, 1
s_cbranch_scc0 t1_L32
s_waitcnt vmcnt(25) lgkmcnt(4)
MA 128,192,128
TR 208,26,0
MA 128,196,144
s_add_u32 m0, s48, 98304
TR 210,26,4096
MA 152,196,148
DM 12,28,53,0
MA 152,192,132
MA 176,192,136
TR 212,26,8192
MA 176,196,152
TR 214,26,12288
MA 200,196,156
DM 13,28,53,1024
MA 200,192,140
WL 4
MA 204,200,140
TR 216,27,0
MA 204,204,156
TR 218,27,4096
MA 180,204,152
DM 14,28,53,2048
MA 180,200,136
MA 156,200,132
TR 220,27,8192
MA 156,204,148
TR 222,27,12288
MA 132,204,144
DM 15,28,53,3072
MA 132,200,128
s_add_u32 s53, s53, 458752
WL 4
MA 136,208,128
TR 192,28,0
MA 136,212,144
TR 194,28,4096
MA 160,212,148
XL 0,5,4,51,0
MA 160,208,132
MA 184,208,136
TR 196,28,8192
MA 184,212,152
TR 198,28,12288
MA 208,212,156
XL 4,5,4,51,128
MA 208,208,140
WL 4
MA 212,216,140
TR 200,29,0
MA 212,220,156
TR 202,29,4096
MA 188,220,152
XL 8,5,4,51,256
MA 188,216,136
MA 164,216,132
TR 204,29,8192
MA 164,220,148
TR 206,29,12288
MA 140,220,144
XL 12,5,4,51,384
MA 140,216,128
s_add_u32 s51, s51, 4096
WL 4
MA 144,192,128
MA 144,196,144
MA 168,196,148
XL 16,5,4,51,0
MA 168,192,132
s_waitcnt vmcnt(30) lgkmcnt(0)
s_barrier
MA 192,192,136
TR 208,24,32768
MA 192,196,152
TR 210,24,36864
MA 216,196,156
XL 20,5,4,51,128
TR 212,24,40960
MA 216,192,140
TR 214,24,45056
MA 220,200,140
TR 216,25,32768
MA 220,204,156
TR 218,25,36864
MA 196,204,152
XL 24,5,4,51,256
MA 196,200,136
MA 172,200,132
TR 220,25,40960
MA 172,204,148
TR 222,25,45056
MA 148,204,144
XL 28,5,4,51,384
MA 148,200,128
s_add_u32 s51, s51, 4096
s_waitcnt vmcnt(25) lgkmcnt(4)
MA 128,208,160
TR 192,26,32768
MA 128,212,176
s_add_u32 m0, s48, 0
TR 194,26,36864
MA 152,212,180
DM 8,32,52,0
MA 152,208,164
MA 176,208,168
TR 196,26,40960
MA 176,212,184
TR 198,26,45056
MA 200,212,188
MA 200,208,172
WL 4
MA 204,216,172
TR 200,27,32768
MA 204,220,188
TR 202,27,36864
MA 180,220,184
MA 180,216,168
MA 156,216,164
TR 204,27,40960
MA 156,220,180
TR 206,27,45056
MA 132,220,176
DM 9,32,52,1024
MA 132,216,160
WL 4
MA 136,192,160
TR 208,28,32768
MA 136,196,176
TR 210,28,36864
MA 160,196,180
MA 160,192,164
MA 184,192,168
TR 212,28,40960
MA 184,196,184
TR 214,28,45056
MA 208,196,188
MA 208,192,172
WL 4
MA 212,200,172
TR 216,29,32768
MA 212,204,188
TR 218,29,36864
MA 188,204,184
DM 10,32,52,2048
MA 188,200,168
MA 164,200,164
TR 220,29,40960
MA 164,204,180
TR 222,29,45056
MA 140,204,176
MA 140,200,160
buffer_load_dword v17, v22, s[4:7], s80 offen offset:1024 sc1
WL 4
MA 144,208,160
MA 144,212,176
MA 168,212,180
MA 168,208,164
s_waitcnt vmcnt(25) lgkmcnt(0)
s_barrier
MA 192,208,168
TR 192,32,0
MA 192,212,184
TR 194,32,4096
MA 216,212,188
DM 11,32,52,3072
TR 196,32,8192
MA 216,208,172
s_add_u32 s52, s52, 131072
TR 198,32,12288
MA 220,216,172
TR 200,33,0
MA 220,220,188
TR 202,33,4096
MA 196,220,184
MA 196,216,168
MA 172,216,164
TR 204,33,8192
MA 172,220,180
TR 206,33,12288
MA 148,220,176
MA 148,216,160
s_waitcnt vmcnt(17) lgkmcnt(4)
MA 128,192,224
TR 208,34,0
MA 128,196,240
s_add_u32 m0, s48, 32768
TR 210,34,4096
MA 152,196,244
DM 8,32,52,0
MA 152,192,228
MA 176,192,232
TR 212,34,8192
MA 176,196,248
TR 214,34,12288
MA 200,196,252
MA 200,192,236
WL 4
MA 204,200,236
TR 216,35,0
MA 204,204,252
TR 218,35,4096
MA 180,204,248
MA 180,200,232
MA 156,200,228
TR 220,35,8192
MA 156,204,244
TR 222,35,12288
MA 132,204,240
DM 9,32,52,1024
MA 132,200,224
WL 4
MA 136,208,224
TR 192,36,0
MA 136,212,240
TR 194,36,4096
MA 160,212,244
MA 160,208,228
MA 184,208,232
TR 196,36,8192
MA 184,212,248
TR 198,36,12288
MA 208,212,252
MA 208,208,236
WL 4
MA 212,216,236
TR 200,37,0
MA 212,220,252
TR 202,37,4096
MA 188,220,248
DM 10,32,52,2048
MA 188,216,232
v_xor_b32 v24, 0, v1
MA 164,216,228
TR 204,37,8192
MA 164,220,244
TR 206,37,12288
MA 140,220,240
MA 140,216,224
v_xor_b32 v25, 32, v1
WL 4
MA 144,192,224
MA 144,196,240
MA 168,196,244
MA 168,192,228
v_xor_b32 v26, 64, v1
WV 4
v_cmp_gt_u32 s[68:69], 32, v17
s_nop 0
s_and_b64 s[68:69], s[68:69], s[74:75]
s_cbranch_scc1 t1_slow37
t1_back38:
WL 0
s_barrier
MA 192,192,232
TR 208,32,32768
MA 192,196,248
TR 210,32,36864
MA 216,196,252
DM 11,32,52,3072
TR 212,32,40960
MA 216,192,236
s_add_u32 s52, s52, 131072
TR 214,32,45056
v_xor_b32 v27, 96, v1
MA 220,200,236
TR 216,33,32768
MA 220,204,252
TR 218,33,36864
MA 196,204,248
MA 196,200,232
v_xor_b32 v28, 128, v1
MA 172,200,228
TR 220,33,40960
MA 172,204,244
TR 222,33,45056
MA 148,204,240
MA 148,200,224
v_xor_b32 v29, 160, v1
WL 4
MA 128,208,0
TR 192,34,32768
MA 128,212,16
s_add_u32 m0, s48, 65536
TR 194,34,36864
MA 152,212,20
DM 8,32,52,0
MA 152,208,4
v_xor_b32 v30, 192, v1
MA 176,208,8
TR 196,34,40960
MA 176,212,24
TR 198,34,45056
MA 200,212,28
DM 9,32,52,1024
MA 200,208,12
v_xor_b32 v31, 224, v1
WL 4
MA 204,216,12
TR 200,35,32768
MA 204,220,28
TR 202,35,36864
MA 180,220,24
DM 10,32,52,2048
MA 180,216,8
MA 156,216,4
TR 204,35,40960
MA 156,220,20
TR 206,35,45056
MA 132,220,16
DM 11,32,52,3072
MA 132,216,0
s_add_u32 s52, s52, 131072
buffer_load_dword v61, v60, s[84:87], s77 offen
WL 4
MA 136,192,0
TR 208,36,32768
MA 136,196,16
TR 210,36,36864
MA 160,196,20
XL 128,5,4,50,0
MA 160,192,4
MA 184,192,8
TR 212,36,40960
MA 184,196,24
TR 214,36,45056
MA 208,196,28
XL 132,5,4,50,128
MA 208,192,12
WL 4
MA 212,200,12
TR 216,37,32768
MA 212,204,28
TR 218,37,36864
MA 188,204,24
XL 136,5,4,50,256
MA 188,200,8
MA 164,200,4
TR 220,37,40960
MA 164,204,20
TR 222,37,45056
MA 140,204,16
XL 140,5,4,50,384
MA 140,200,0
s_add_u32 s50, s50, 4096
WL 4
MA 144,208,0
MA 144,212,16
MA 168,212,20
XL 144,5,4,50,0
MA 168,208,4
s_waitcnt vmcnt(14) lgkmcnt(0)
s_barrier
MA 192,208,8
TR 192,28,0
MA 192,212,24
TR 194,28,4096
MA 216,212,28
XL 148,5,4,50,128
TR 196,28,8192
MA 216,208,12
TR 198,28,12288
MA 220,216,12
TR 200,29,0
MA 220,220,28
TR 202,29,4096
MA 196,220,24
XL 152,5,4,50,256
MA 196,216,8
MA 172,216,4
TR 204,29,8192
MA 172,220,20
TR 206,29,12288
MA 148,220,16
XL 156,5,4,50,384
MA 148,216,0
s_add_u32 s50, s50, 4096
v_mov_b32 v50, 0xc0135761
v_mov_b32 v51, 0xc0135761
v_mov_b32 v52, 0xbdd2d3e8
v_mov_b32 v53, 0xbdd2d3e8
s_lshl_b32 s60, s58, 2
s_add_u32 s60, s60, s44
s_mul_i32 s60, s60, 458752
s_mul_i32 s62, s59, 12288
s_add_u32 s60, s60, s62
s_add_u32 s60, s60, 41943040
XL 160,5,4,50,0
v_pk_mul_f32 v[64:65], v[128:129], v[128:129]
v_pk_mul_f32 v[66:67], v[130:131], v[130:131]
v_pk_mul_f32 v[68:69], v[132:133], v[132:133]
v_pk_mul_f32 v[70:71], v[134:135], v[134:135]
v_pk_fma_f32 v[64:65], v[64:65], v[52:53], v[50:51]
v_pk_fma_f32 v[66:67], v[66:67], v[52:53], v[50:51]
v_pk_fma_f32 v[68:69], v[68:69], v[52:53], v[50:51]
v_pk_fma_f32 v[70:71], v[70:71], v[52:53], v[50:51]
v_pk_mul_f32 v[64:65], v[64:65], v[128:129]
v_pk_mul_f32 v[66:67], v[66:67], v[130:131]
v_pk_mul_f32 v[68:69], v[68:69], v[132:133]
v_pk_mul_f32 v[70:71], v[70:71], v[134:135]
v_exp_f32 v64, v64
v_pk_mul_f32 v[72:73], v[152:153], v[152:153]
v_exp_f32 v65, v65
v_pk_mul_f32 v[74:75], v[154:155], v[154:155]
v_exp_f32 v66, v66
v_pk_mul_f32 v[76:77], v[156:157], v[156:157]
v_exp_f32 v67, v67
v_pk_mul_f32 v[78:79], v[158:159], v[158:159]
v_exp_f32 v68, v68
v_pk_fma_f32 v[72:73], v[72:73], v[52:53], v[50:51]
v_exp_f32 v69, v69
v_pk_fma_f32 v[74:75], v[74:75], v[52:53], v[50:51]
v_exp_f32 v70, v70
XL 164,5,4,50,128
v_pk_fma_f32 v[76:77], v[76:77], v[52:53], v[50:51]
v_exp_f32 v71, v71
v_pk_add_f32 v[64:65], v[64:65], 1.0 op_sel_hi:[1,0]
v_pk_add_f32 v[66:67], v[66:67], 1.0 op_sel_hi:[1,0]
v_pk_add_f32 v[68:69], v[68:69], 1.0 op_sel_hi:[1,0]
v_pk_add_f32 v[70:71], v[70:71], 1.0 op_sel_hi:[1,0]
v_rcp_f32 v64, v64
v_pk_fma_f32 v[78:79], v[78:79], v[52:53], v[50:51]
v_rcp_f32 v65, v65
v_pk_mul_f32 v[72:73], v[72:73], v[152:153]
v_rcp_f32 v66, v66
v_pk_mul_f32 v[74:75], v[74:75], v[154:155]
v_rcp_f32 v67, v67
v_pk_mul_f32 v[76:77], v[76:77], v[156:157]
v_rcp_f32 v68, v68
v_pk_mul_f32 v[78:79], v[78:79], v[158:159]
v_rcp_f32 v69, v69
v_rcp_f32 v70, v70
v_rcp_f32 v71, v71
v_pk_mul_f32 v[64:65], v[64:65], v[128:129]
v_exp_f32 v72, v72
v_pk_mul_f32 v[66:67], v[66:67], v[130:131]
v_exp_f32 v73, v73
v_pk_mul_f32 v[68:69], v[68:69], v[132:133]
v_exp_f32 v74, v74
XL 168,5,4,50,256
v_pk_mul_f32 v[70:71], v[70:71], v[134:135]
v_exp_f32 v75, v75
v_cvt_pk_bf16_f32 v80, v64, v65
v_exp_f32 v76, v76
v_cvt_pk_bf16_f32 v81, v66, v67
v_exp_f32 v77, v77
v_cvt_pk_bf16_f32 v82, v68, v69
v_exp_f32 v78, v78
v_cvt_pk_bf16_f32 v83, v70, v71
v_exp_f32 v79, v79
buffer_store_dwordx4 v[80:83], v5, s[4:7], s60 offen offset:0 sc1
v_pk_add_f32 v[72:73], v[72:73], 1.0 op_sel_hi:[1,0]
v_pk_add_f32 v[74:75], v[74:75], 1.0 op_sel_hi:[1,0]
v_pk_add_f32 v[76:77], v[76:77], 1.0 op_sel_hi:[1,0]
v_pk_add_f32 v[78:79], v[78:79], 1.0 op_sel_hi:[1,0]
v_rcp_f32 v72, v72
v_pk_mul_f32 v[64:65], v[176:177], v[176:177]
v_rcp_f32 v73, v73
v_pk_mul_f32 v[66:67], v[178:179], v[178:179]
v_rcp_f32 v74, v74
v_pk_mul_f32 v[68:69], v[180:181], v[180:181]
v_rcp_f32 v75, v75
v_pk_mul_f32 v[70:71], v[182:183], v[182:183]
v_rcp_f32 v76, v76
v_pk_fma_f32 v[64:65], v[64:65], v[52:53], v[50:51]
XL 172,5,4,50,384
s_add_u32 s50, s50, 4096
v_rcp_f32 v77, v77
v_pk_fma_f32 v[66:67], v[66:67], v[52:53], v[50:51]
v_rcp_f32 v78, v78
v_pk_fma_f32 v[68:69], v[68:69], v[52:53], v[50:51]
v_rcp_f32 v79, v79
v_pk_mul_f32 v[72:73], v[72:73], v[152:153]
v_pk_mul_f32 v[74:75], v[74:75], v[154:155]
v_pk_mul_f32 v[76:77], v[76:77], v[156:157]
v_pk_mul_f32 v[78:79], v[78:79], v[158:159]
v_cvt_pk_bf16_f32 v84, v72, v73
v_cvt_pk_bf16_f32 v85, v74, v75
v_cvt_pk_bf16_f32 v86, v76, v77
v_cvt_pk_bf16_f32 v87, v78, v79
buffer_store_dwordx4 v[84:87], v5, s[4:7], s60 offen offset:128 sc1
v_pk_fma_f32 v[70:71], v[70:71], v[52:53], v[50:51]
v_pk_mul_f32 v[64:65], v[64:65], v[176:177]
v_pk_mul_f32 v[66:67], v[66:67], v[178:179]
v_pk_mul_f32 v[68:69], v[68:69], v[180:181]
v_pk_mul_f32 v[70:71], v[70:71], v[182:183]
v_exp_f32 v64, v64
v_pk_mul_f32 v[72:73], v[200:201], v[200:201]
v_exp_f32 v65, v65
v_pk_mul_f32 v[74:75], v[202:203], v[202:203]
v_exp_f32 v66, v66
v_pk_mul_f32 v[76:77], v[204:205], v[204:205]
XL 176,5,4,50,0
v_exp_f32 v67, v67
v_pk_mul_f32 v[78:79], v[206:207], v[206:207]
v_exp_f32 v68, v68
v_pk_fma_f32 v[72:73], v[72:73], v[52:53], v[50:51]
v_exp_f32 v69, v69
v_pk_fma_f32 v[74:75], v[74:75], v[52:53], v[50:51]
v_exp_f32 v70, v70
v_pk_fma_f32 v[76:77], v[76:77], v[52:53], v[50:51]
v_exp_f32 v71, v71
v_pk_add_f32 v[64:65], v[64:65], 1.0 op_sel_hi:[1,0]
v_pk_add_f32 v[66:67], v[66:67], 1.0 op_sel_hi:[1,0]
v_pk_add_f32 v[68:69], v[68:69], 1.0 op_sel_hi:[1,0]
v_pk_add_f32 v[70:71], v[70:71], 1.0 op_sel_hi:[1,0]
v_rcp_f32 v64, v64
v_pk_fma_f32 v[78:79], v[78:79], v[52:53], v[50:51]
v_rcp_f32 v65, v65
v_pk_mul_f32 v[72:73], v[72:73], v[200:201]
v_rcp_f32 v66, v66
v_pk_mul_f32 v[74:75], v[74:75], v[202:203]
v_rcp_f32 v67, v67
v_pk_mul_f32 v[76:77], v[76:77], v[204:205]
v_rcp_f32 v68, v68
v_pk_mul_f32 v[78:79], v[78:79], v[206:207]
v_rcp_f32 v69, v69
v_rcp_f32 v70, v70
XL 180,5,4,50,128
v_rcp_f32 v71, v71
v_pk_mul_f32 v[64:65], v[64:65], v[176:177]
v_exp_f32 v72, v72
v_pk_mul_f32 v[66:67], v[66:67], v[178:179]
v_exp_f32 v73, v73
v_pk_mul_f32 v[68:69], v[68:69], v[180:181]
v_exp_f32 v74, v74
v_pk_mul_f32 v[70:71], v[70:71], v[182:183]
v_exp_f32 v75, v75
v_cvt_pk_bf16_f32 v80, v64, v65
v_exp_f32 v76, v76
v_cvt_pk_bf16_f32 v81, v66, v67
v_exp_f32 v77, v77
v_cvt_pk_bf16_f32 v82, v68, v69
v_exp_f32 v78, v78
v_cvt_pk_bf16_f32 v83, v70, v71
v_exp_f32 v79, v79
buffer_store_dwordx4 v[80:83], v5, s[4:7], s60 offen offset:256 sc1
v_pk_add_f32 v[72:73], v[72:73], 1.0 op_sel_hi:[1,0]
v_pk_add_f32 v[74:75], v[74:75], 1.0 op_sel_hi:[1,0]
v_pk_add_f32 v[76:77], v[76:77], 1.0 op_sel_hi:[1,0]
v_pk_add_f32 v[78:79], v[78:79], 1.0 op_sel_hi:[1,0]
v_rcp_f32 v72, v72
v_pk_mul_f32 v[64:65], v[136:137], v[136:137]
v_rcp_f32 v73, v73
XL 184,5,4,50,256
v_pk_mul_f32 v[66:67], v[138:139], v[138:139]
v_rcp_f32 v74, v74
v_pk_mul_f32 v[68:69], v[140:141], v[140:141]
v_rcp_f32 v75, v75
v_pk_mul_f32 v[70:71], v[142:143], v[142:143]
v_rcp_f32 v76, v76
v_pk_fma_f32 v[64:65], v[64:65], v[52:53], v[50:51]
v_rcp_f32 v77, v77
v_pk_fma_f32 v[66:67], v[66:67], v[52:53], v[50:51]
v_rcp_f32 v78, v78
v_pk_fma_f32 v[68:69], v[68:69], v[52:53], v[50:51]
v_rcp_f32 v79, v79
v_pk_mul_f32 v[72:73], v[72:73], v[200:201]
v_pk_mul_f32 v[74:75], v[74:75], v[202:203]
v_pk_mul_f32 v[76:77], v[76:77], v[204:205]
v_pk_mul_f32 v[78:79], v[78:79], v[206:207]
v_cvt_pk_bf16_f32 v84, v72, v73
v_cvt_pk_bf16_f32 v85, v74, v75
v_cvt_pk_bf16_f32 v86, v76, v77
v_cvt_pk_bf16_f32 v87, v78, v79
buffer_store_dwordx4 v[84:87], v5, s[4:7], s60 offen offset:384 sc1
s_add_u32 s60, s60, 4096
v_pk_fma_f32 v[70:71], v[70:71], v[52:53], v[50:51]
v_pk_mul_f32 v[64:65], v[64:65], v[136:137]
v_pk_mul_f32 v[66:67], v[66:67], v[138:139]
XL 188,5,4,50,384
s_add_u32 s50, s50, 4096
v_pk_mul_f32 v[68:69], v[68:69], v[140:141]
v_pk_mul_f32 v[70:71], v[70:71], v[142:143]
v_exp_f32 v64, v64
v_pk_mul_f32 v[72:73], v[160:161], v[160:161]
v_exp_f32 v65, v65
v_pk_mul_f32 v[74:75], v[162:163], v[162:163]
v_exp_f32 v66, v66
v_pk_mul_f32 v[76:77], v[164:165], v[164:165]
v_exp_f32 v67, v67
v_pk_mul_f32 v[78:79], v[166:167], v[166:167]
v_exp_f32 v68, v68
v_pk_fma_f32 v[72:73], v[72:73], v[52:53], v[50:51]
v_exp_f32 v69, v69
v_pk_fma_f32 v[74:75], v[74:75], v[52:53], v[50:51]
v_exp_f32 v70, v70
v_pk_fma_f32 v[76:77], v[76:77], v[52:53], v[50:51]
v_exp_f32 v71, v71
v_pk_add_f32 v[64:65], v[64:65], 1.0 op_sel_hi:[1,0]
v_pk_add_f32 v[66:67], v[66:67], 1.0 op_sel_hi:[1,0]
v_pk_add_f32 v[68:69], v[68:69], 1.0 op_sel_hi:[1,0]
v_pk_add_f32 v[70:71], v[70:71], 1.0 op_sel_hi:[1,0]
v_rcp_f32 v64, v64
v_pk_fma_f32 v[78:79], v[78:79], v[52:53], v[50:51]
v_rcp_f32 v65, v65
v_pk_mul_f32 v[72:73], v[72:73], v[160:161]
XL 0,5,4,50,0
v_rcp_f32 v66, v66
v_pk_mul_f32 v[74:75], v[74:75], v[162:163]
v_rcp_f32 v67, v67
v_pk_mul_f32 v[76:77], v[76:77], v[164:165]
v_rcp_f32 v68, v68
v_pk_mul_f32 v[78:79], v[78:79], v[166:167]
v_rcp_f32 v69, v69
v_rcp_f32 v70, v70
v_rcp_f32 v71, v71
v_pk_mul_f32 v[64:65], v[64:65], v[136:137]
v_exp_f32 v72, v72
v_pk_mul_f32 v[66:67], v[66:67], v[138:139]
v_exp_f32 v73, v73
v_pk_mul_f32 v[68:69], v[68:69], v[140:141]
v_exp_f32 v74, v74
v_pk_mul_f32 v[70:71], v[70:71], v[142:143]
v_exp_f32 v75, v75
v_cvt_pk_bf16_f32 v80, v64, v65
v_exp_f32 v76, v76
v_cvt_pk_bf16_f32 v81, v66, v67
v_exp_f32 v77, v77
v_cvt_pk_bf16_f32 v82, v68, v69
v_exp_f32 v78, v78
v_cvt_pk_bf16_f32 v83, v70, v71
v_exp_f32 v79, v79
XL 4,5,4,50,128
buffer_store_dwordx4 v[80:83], v5, s[4:7], s60 offen offset:0 sc1
v_pk_add_f32 v[72:73], v[72:73], 1.0 op_sel_hi:[1,0]
v_pk_add_f32 v[74:75], v[74:75], 1.0 op_sel_hi:[1,0]
v_pk_add_f32 v[76:77], v[76:77], 1.0 op_sel_hi:[1,0]
v_pk_add_f32 v[78:79], v[78:79], 1.0 op_sel_hi:[1,0]
v_rcp_f32 v72, v72
v_pk_mul_f32 v[64:65], v[184:185], v[184:185]
v_rcp_f32 v73, v73
v_pk_mul_f32 v[66:67], v[186:187], v[186:187]
v_rcp_f32 v74, v74
v_pk_mul_f32 v[68:69], v[188:189], v[188:189]
v_rcp_f32 v75, v75
v_pk_mul_f32 v[70:71], v[190:191], v[190:191]
v_rcp_f32 v76, v76
v_pk_fma_f32 v[64:65], v[64:65], v[52:53], v[50:51]
v_rcp_f32 v77, v77
v_pk_fma_f32 v[66:67], v[66:67], v[52:53], v[50:51]
v_rcp_f32 v78, v78
v_pk_fma_f32 v[68:69], v[68:69], v[52:53], v[50:51]
v_rcp_f32 v79, v79
v_pk_mul_f32 v[72:73], v[72:73], v[160:161]
v_pk_mul_f32 v[74:75], v[74:75], v[162:163]
v_pk_mul_f32 v[76:77], v[76:77], v[164:165]
v_pk_mul_f32 v[78:79], v[78:79], v[166:167]
v_cvt_pk_bf16_f32 v84, v72, v73
XL 8,5,4,50,256
v_cvt_pk_bf16_f32 v85, v74, v75
v_cvt_pk_bf16_f32 v86, v76, v77
v_cvt_pk_bf16_f32 v87, v78, v79
buffer_store_dwordx4 v[84:87], v5, s[4:7], s60 offen offset:128 sc1
v_pk_fma_f32 v[70:71], v[70:71], v[52:53], v[50:51]
v_pk_mul_f32 v[64:65], v[64:65], v[184:185]
v_pk_mul_f32 v[66:67], v[66:67], v[186:187]
v_pk_mul_f32 v[68:69], v[68:69], v[188:189]
v_pk_mul_f32 v[70:71], v[70:71], v[190:191]
v_exp_f32 v64, v64
v_pk_mul_f32 v[72:73], v[208:209], v[208:209]
v_exp_f32 v65, v65
v_pk_mul_f32 v[74:75], v[210:211], v[210:211]
v_exp_f32 v66, v66
v_pk_mul_f32 v[76:77], v[212:213], v[212:213]
v_exp_f32 v67, v67
v_pk_mul_f32 v[78:79], v[214:215], v[214:215]
v_exp_f32 v68, v68
v_pk_fma_f32 v[72:73], v[72:73], v[52:53], v[50:51]
v_exp_f32 v69, v69
v_pk_fma_f32 v[74:75], v[74:75], v[52:53], v[50:51]
v_exp_f32 v70, v70
v_pk_fma_f32 v[76:77], v[76:77], v[52:53], v[50:51]
v_exp_f32 v71, v71
v_pk_add_f32 v[64:65], v[64:65], 1.0 op_sel_hi:[1,0]
XL 12,5,4,50,384
s_add_u32 s50, s50, 4096
v_pk_add_f32 v[66:67], v[66:67], 1.0 op_sel_hi:[1,0]
v_pk_add_f32 v[68:69], v[68:69], 1.0 op_sel_hi:[1,0]
v_pk_add_f32 v[70:71], v[70:71], 1.0 op_sel_hi:[1,0]
v_rcp_f32 v64, v64
v_pk_fma_f32 v[78:79], v[78:79], v[52:53], v[50:51]
v_rcp_f32 v65, v65
v_pk_mul_f32 v[72:73], v[72:73], v[208:209]
v_rcp_f32 v66, v66
v_pk_mul_f32 v[74:75], v[74:75], v[210:211]
v_rcp_f32 v67, v67
v_pk_mul_f32 v[76:77], v[76:77], v[212:213]
v_rcp_f32 v68, v68
v_pk_mul_f32 v[78:79], v[78:79], v[214:215]
v_rcp_f32 v69, v69
v_rcp_f32 v70, v70
v_rcp_f32 v71, v71
v_pk_mul_f32 v[64:65], v[64:65], v[184:185]
v_exp_f32 v72, v72
v_pk_mul_f32 v[66:67], v[66:67], v[186:187]
v_exp_f32 v73, v73
v_pk_mul_f32 v[68:69], v[68:69], v[188:189]
v_exp_f32 v74, v74
v_pk_mul_f32 v[70:71], v[70:71], v[190:191]
v_exp_f32 v75, v75
v_cvt_pk_bf16_f32 v80, v64, v65
XL 16,5,4,50,0
v_exp_f32 v76, v76
v_cvt_pk_bf16_f32 v81, v66, v67
v_exp_f32 v77, v77
v_cvt_pk_bf16_f32 v82, v68, v69
v_exp_f32 v78, v78
v_cvt_pk_bf16_f32 v83, v70, v71
v_exp_f32 v79, v79
buffer_store_dwordx4 v[80:83], v5, s[4:7], s60 offen offset:256 sc1
v_pk_add_f32 v[72:73], v[72:73], 1.0 op_sel_hi:[1,0]
v_pk_add_f32 v[74:75], v[74:75], 1.0 op_sel_hi:[1,0]
v_pk_add_f32 v[76:77], v[76:77], 1.0 op_sel_hi:[1,0]
v_pk_add_f32 v[78:79], v[78:79], 1.0 op_sel_hi:[1,0]
v_rcp_f32 v72, v72
v_pk_mul_f32 v[64:65], v[144:145], v[144:145]
v_rcp_f32 v73, v73
v_pk_mul_f32 v[66:67], v[146:147], v[146:147]
v_rcp_f32 v74, v74
v_pk_mul_f32 v[68:69], v[148:149], v[148:149]
v_rcp_f32 v75, v75
v_pk_mul_f32 v[70:71], v[150:151], v[150:151]
v_rcp_f32 v76, v76
v_pk_fma_f32 v[64:65], v[64:65], v[52:53], v[50:51]
v_rcp_f32 v77, v77
v_pk_fma_f32 v[66:67], v[66:67], v[52:53], v[50:51]
v_rcp_f32 v78, v78
XL 20,5,4,50,128
v_pk_fma_f32 v[68:69], v[68:69], v[52:53], v[50:51]
v_rcp_f32 v79, v79
v_pk_mul_f32 v[72:73], v[72:73], v[208:209]
v_pk_mul_f32 v[74:75], v[74:75], v[210:211]
v_pk_mul_f32 v[76:77], v[76:77], v[212:213]
v_pk_mul_f32 v[78:79], v[78:79], v[214:215]
v_cvt_pk_bf16_f32 v84, v72, v73
v_cvt_pk_bf16_f32 v85, v74, v75
v_cvt_pk_bf16_f32 v86, v76, v77
v_cvt_pk_bf16_f32 v87, v78, v79
buffer_store_dwordx4 v[84:87], v5, s[4:7], s60 offen offset:384 sc1
s_add_u32 s60, s60, 4096
v_pk_fma_f32 v[70:71], v[70:71], v[52:53], v[50:51]
v_pk_mul_f32 v[64:65], v[64:65], v[144:145]
v_pk_mul_f32 v[66:67], v[66:67], v[146:147]
v_pk_mul_f32 v[68:69], v[68:69], v[148:149]
v_pk_mul_f32 v[70:71], v[70:71], v[150:151]
v_exp_f32 v64, v64
v_pk_mul_f32 v[72:73], v[168:169], v[168:169]
v_exp_f32 v65, v65
v_pk_mul_f32 v[74:75], v[170:171], v[170:171]
v_exp_f32 v66, v66
v_pk_mul_f32 v[76:77], v[172:173], v[172:173]
v_exp_f32 v67, v67
v_pk_mul_f32 v[78:79], v[174:175], v[174:175]
XL 24,5,4,50,256
v_exp_f32 v68, v68
v_pk_fma_f32 v[72:73], v[72:73], v[52:53], v[50:51]
v_exp_f32 v69, v69
v_pk_fma_f32 v[74:75], v[74:75], v[52:53], v[50:51]
v_exp_f32 v70, v70
v_pk_fma_f32 v[76:77], v[76:77], v[52:53], v[50:51]
v_exp_f32 v71, v71
v_pk_add_f32 v[64:65], v[64:65], 1.0 op_sel_hi:[1,0]
v_pk_add_f32 v[66:67], v[66:67], 1.0 op_sel_hi:[1,0]
v_pk_add_f32 v[68:69], v[68:69], 1.0 op_sel_hi:[1,0]
v_pk_add_f32 v[70:71], v[70:71], 1.0 op_sel_hi:[1,0]
v_rcp_f32 v64, v64
v_pk_fma_f32 v[78:79], v[78:79], v[52:53], v[50:51]
v_rcp_f32 v65, v65
v_pk_mul_f32 v[72:73], v[72:73], v[168:169]
v_rcp_f32 v66, v66
v_pk_mul_f32 v[74:75], v[74:75], v[170:171]
v_rcp_f32 v67, v67
v_pk_mul_f32 v[76:77], v[76:77], v[172:173]
v_rcp_f32 v68, v68
v_pk_mul_f32 v[78:79], v[78:79], v[174:175]
v_rcp_f32 v69, v69
v_rcp_f32 v70, v70
v_rcp_f32 v71, v71
v_pk_mul_f32 v[64:65], v[64:65], v[144:145]
XL 28,5,4,50,384
s_add_u32 s50, s50, 4096
v_exp_f32 v72, v72
v_pk_mul_f32 v[66:67], v[66:67], v[146:147]
v_exp_f32 v73, v73
v_pk_mul_f32 v[68:69], v[68:69], v[148:149]
v_exp_f32 v74, v74
v_pk_mul_f32 v[70:71], v[70:71], v[150:151]
v_exp_f32 v75, v75
v_cvt_pk_bf16_f32 v80, v64, v65
v_exp_f32 v76, v76
v_cvt_pk_bf16_f32 v81, v66, v67
v_exp_f32 v77, v77
v_cvt_pk_bf16_f32 v82, v68, v69
v_exp_f32 v78, v78
v_cvt_pk_bf16_f32 v83, v70, v71
v_exp_f32 v79, v79
buffer_store_dwordx4 v[80:83], v5, s[4:7], s60 offen offset:0 sc1
v_pk_add_f32 v[72:73], v[72:73], 1.0 op_sel_hi:[1,0]
v_pk_add_f32 v[74:75], v[74:75], 1.0 op_sel_hi:[1,0]
v_pk_add_f32 v[76:77], v[76:77], 1.0 op_sel_hi:[1,0]
v_pk_add_f32 v[78:79], v[78:79], 1.0 op_sel_hi:[1,0]
v_rcp_f32 v72, v72
v_pk_mul_f32 v[64:65], v[192:193], v[192:193]
v_rcp_f32 v73, v73
v_pk_mul_f32 v[66:67], v[194:195], v[194:195]
v_rcp_f32 v74, v74
v_pk_mul_f32 v[68:69], v[196:197], v[196:197]
v_rcp_f32 v75, v75
v_pk_mul_f32 v[70:71], v[198:199], v[198:199]
v_rcp_f32 v76, v76
v_pk_fma_f32 v[64:65], v[64:65], v[52:53], v[50:51]
v_rcp_f32 v77, v77
v_pk_fma_f32 v[66:67], v[66:67], v[52:53], v[50:51]
v_rcp_f32 v78, v78
v_pk_fma_f32 v[68:69], v[68:69], v[52:53], v[50:51]
v_rcp_f32 v79, v79
v_pk_mul_f32 v[72:73], v[72:73], v[168:169]
v_pk_mul_f32 v[74:75], v[74:75], v[170:171]
v_pk_mul_f32 v[76:77], v[76:77], v[172:173]
v_pk_mul_f32 v[78:79], v[78:79], v[174:175]
v_cvt_pk_bf16_f32 v84, v72, v73
v_cvt_pk_bf16_f32 v85, v74, v75
v_cvt_pk_bf16_f32 v86, v76, v77
v_cvt_pk_bf16_f32 v87, v78, v79
buffer_store_dwordx4 v[84:87], v5, s[4:7], s60 offen offset:128 sc1
v_pk_fma_f32 v[70:71], v[70:71], v[52:53], v[50:51]
v_pk_mul_f32 v[64:65], v[64:65], v[192:193]
v_pk_mul_f32 v[66:67], v[66:67], v[194:195]
v_pk_mul_f32 v[68:69], v[68:69], v[196:197]
v_pk_mul_f32 v[70:71], v[70:71], v[198:199]
v_exp_f32 v64, v64
v_pk_mul_f32 v[72:73], v[216:217], v[216:217]
v_exp_f32 v65, v65
v_pk_mul_f32 v[74:75], v[218:219], v[218:219]
v_exp_f32 v66, v66
v_pk_mul_f32 v[76:77], v[220:221], v[220:221]
v_exp_f32 v67, v67
v_pk_mul_f32 v[78:79], v[222:223], v[222:223]
v_exp_f32 v68, v68
v_pk_fma_f32 v[72:73], v[72:73], v[52:53], v[50:51]
v_exp_f32 v69, v69
v_pk_fma_f32 v[74:75], v[74:75], v[52:53], v[50:51]
v_exp_f32 v70, v70
v_pk_fma_f32 v[76:77], v[76:77], v[52:53], v[50:51]
v_exp_f32 v71, v71
v_pk_add_f32 v[64:65], v[64:65], 1.0 op_sel_hi:[1,0]
v_pk_add_f32 v[66:67], v[66:67], 1.0 op_sel_hi:[1,0]
v_pk_add_f32 v[68:69], v[68:69], 1.0 op_sel_hi:[1,0]
v_pk_add_f32 v[70:71], v[70:71], 1.0 op_sel_hi:[1,0]
v_rcp_f32 v64, v64
v_pk_fma_f32 v[78:79], v[78:79], v[52:53], v[50:51]
v_rcp_f32 v65, v65
v_pk_mul_f32 v[72:73], v[72:73], v[216:217]
v_rcp_f32 v66, v66
v_pk_mul_f32 v[74:75], v[74:75], v[218:219]
v_rcp_f32 v67, v67
v_pk_mul_f32 v[76:77], v[76:77], v[220:221]
v_rcp_f32 v68, v68
v_pk_mul_f32 v[78:79], v[78:79], v[222:223]
v_rcp_f32 v69, v69
v_rcp_f32 v70, v70
v_rcp_f32 v71, v71
v_pk_mul_f32 v[64:65], v[64:65], v[192:193]
v_exp_f32 v72, v72
v_pk_mul_f32 v[66:67], v[66:67], v[194:195]
v_exp_f32 v73, v73
v_pk_mul_f32 v[68:69], v[68:69], v[196:197]
v_exp_f32 v74, v74
v_pk_mul_f32 v[70:71], v[70:71], v[198:199]
v_exp_f32 v75, v75
v_cvt_pk_bf16_f32 v80, v64, v65
v_exp_f32 v76, v76
v_cvt_pk_bf16_f32 v81, v66, v67
v_exp_f32 v77, v77
v_cvt_pk_bf16_f32 v82, v68, v69
v_exp_f32 v78, v78
v_cvt_pk_bf16_f32 v83, v70, v71
v_exp_f32 v79, v79
buffer_store_dwordx4 v[80:83], v5, s[4:7], s60 offen offset:256 sc1
v_pk_add_f32 v[72:73], v[72:73], 1.0 op_sel_hi:[1,0]
v_pk_add_f32 v[74:75], v[74:75], 1.0 op_sel_hi:[1,0]
v_pk_add_f32 v[76:77], v[76:77], 1.0 op_sel_hi:[1,0]
v_pk_add_f32 v[78:79], v[78:79], 1.0 op_sel_hi:[1,0]
v_rcp_f32 v72, v72
v_rcp_f32 v73, v73
v_rcp_f32 v74, v74
v_rcp_f32 v75, v75
v_rcp_f32 v76, v76
v_rcp_f32 v77, v77
v_rcp_f32 v78, v78
v_rcp_f32 v79, v79
v_pk_mul_f32 v[72:73], v[72:73], v[216:217]
v_pk_mul_f32 v[74:75], v[74:75], v[218:219]
v_pk_mul_f32 v[76:77], v[76:77], v[220:221]
v_pk_mul_f32 v[78:79], v[78:79], v[222:223]
v_cvt_pk_bf16_f32 v84, v72, v73
v_cvt_pk_bf16_f32 v85, v74, v75
v_cvt_pk_bf16_f32 v86, v76, v77
v_cvt_pk_bf16_f32 v87, v78, v79
buffer_store_dwordx4 v[84:87], v5, s[4:7], s60 offen offset:384 sc1
s_add_u32 s60, s60, 4096
s_waitcnt vmcnt(28) lgkmcnt(4)
MZ 144,192,128
TR 208,30,0
MA 144,196,144
s_add_u32 m0, s48, 98304
TR 210,30,4096
MZ 176,196,148
DM 8,32,52,0
MA 176,192,132
v_xor_b32 v32, 65536, v1
MZ 208,192,136
TR 212,30,8192
MA 208,196,152
TR 214,30,12288
MZ 240,196,156
DM 9,32,52,1024
MA 240,192,140
v_xor_b32 v33, 65568, v1
WL 4
MZ 244,200,140
TR 216,31,0
MA 244,204,156
TR 218,31,4096
MZ 212,204,152
DM 10,32,52,2048
MA 212,200,136
v_xor_b32 v34, 65600, v1
MZ 180,200,132
TR 220,31,8192
MA 180,204,148
TR 222,31,12288
MZ 148,204,144
MA 148,200,128
v_xor_b32 v35, 65632, v1
WL 4
MZ 152,208,128
TR 192,24,0
MA 152,212,144
TR 194,24,4096
MZ 184,212,148
DM 11,32,52,3072
MA 184,208,132
s_add_u32 s52, s52, 131072
v_xor_b32 v36, 65664, v1
MZ 216,208,136
TR 196,24,8192
MA 216,212,152
TR 198,24,12288
MZ 248,212,156
XL 32,5,4,50,0
MA 248,208,140
v_xor_b32 v37, 65696, v1
WL 4
MZ 252,216,140
TR 200,25,0
MA 252,220,156
TR 202,25,4096
MZ 220,220,152
XL 36,5,4,50,128
MA 220,216,136
v_xor_b32 v38, 65728, v1
MZ 188,216,132
TR 204,25,8192
MA 188,220,148
TR 206,25,12288
MZ 156,220,144
MA 156,216,128
v_xor_b32 v39, 65760, v1
WL 4
MZ 128,192,128
TR 208,26,0
MA 128,196,144
TR 210,26,4096
MZ 160,196,148
XL 40,5,4,50,256
MA 160,192,132
MZ 192,192,136
TR 212,26,8192
MA 192,196,152
TR 214,26,12288
MZ 224,196,156
XL 44,5,4,50,384
MA 224,192,140
s_add_u32 s50, s50, 4096
WL 4
MZ 228,200,140
TR 216,27,0
MA 228,204,156
TR 218,27,4096
MZ 196,204,152
XL 48,5,4,50,0
MA 196,200,136
MZ 164,200,132
TR 220,27,8192
MA 164,204,148
TR 222,27,12288
MZ 132,204,144
MA 132,200,128
WL 4
MZ 136,208,128
MA 136,212,144
MZ 168,212,148
XL 52,5,4,50,128
MA 168,208,132
s_waitcnt vmcnt(10) lgkmcnt(0)
s_barrier
buffer_atomic_add v21, v18, s[4:7], s80 offen offset:1536
MZ 200,208,136
TR 192,28,32768
MA 200,212,152
TR 194,28,36864
MZ 232,212,156
XL 56,5,4,50,256
TR 196,28,40960
MA 232,208,140
TR 198,28,45056
MZ 236,216,140
TR 200,29,32768
MA 236,220,156
TR 202,29,36864
MZ 204,220,152
XL 60,5,4,50,384
MA 204,216,136
s_add_u32 s50, s50, 4096
MZ 172,216,132
TR 204,29,40960
MA 172,220,148
TR 206,29,45056
MZ 140,220,144
MA 140,216,128
WL 4
MA 144,192,160
TR 208,30,32768
MA 144,196,176
s_add_u32 m0, s48, 0
TR 210,30,36864
MA 176,196,180
DM 8,32,52,0
MA 176,192,164
MA 208,192,168
TR 212,30,40960
MA 208,196,184
TR 214,30,45056
MA 240,196,188
DM 9,32,52,1024
MA 240,192,172
WL 4
MA 244,200,172
TR 216,31,32768
MA 244,204,188
TR 218,31,36864
MA 212,204,184
DM 10,32,52,2048
MA 212,200,168
MA 180,200,164
TR 220,31,40960
MA 180,204,180
TR 222,31,45056
MA 148,204,176
MA 148,200,160
WL 4
MA 152,208,160
TR 192,24,32768
MA 152,212,176
TR 194,24,36864
MA 184,212,180
DM 11,32,52,3072
MA 184,208,164
s_add_u32 s52, s52, 131072
MA 216,208,168
TR 196,24,40960
MA 216,212,184
TR 198,24,45056
MA 248,212,188
XL 128,5,4,50,0
MA 248,208,172
WL 4
MA 252,216,172
TR 200,25,32768
MA 252,220,188
TR 202,25,36864
MA 220,220,184
XL 132,5,4,50,128
MA 220,216,168
MA 188,216,164
TR 204,25,40960
MA 188,220,180
TR 206,25,45056
MA 156,220,176
MA 156,216,160
WL 4
MA 128,192,160
TR 208,26,32768
MA 128,196,176
TR 210,26,36864
MA 160,196,180
XL 136,5,4,50,256
MA 160,192,164
MA 192,192,168
TR 212,26,40960
MA 192,196,184
TR 214,26,45056
MA 224,196,188
XL 140,5,4,50,384
MA 224,192,172
s_add_u32 s50, s50, 4096
WL 4
MA 228,200,172
TR 216,27,32768
MA 228,204,188
TR 218,27,36864
MA 196,204,184
XL 144,5,4,50,0
MA 196,200,168
MA 164,200,164
TR 220,27,40960
MA 164,204,180
TR 222,27,45056
MA 132,204,176
MA 132,200,160
WL 4
MA 136,208,160
MA 136,212,176
MA 168,212,180
XL 148,5,4,50,128
MA 168,208,164
WL 0
s_barrier
MA 200,208,168
TR 192,36,0
MA 200,212,184
TR 194,36,4096
MA 232,212,188
XL 152,5,4,50,256
TR 196,36,8192
MA 232,208,172
TR 198,36,12288
MA 236,216,172
TR 200,37,0
MA 236,220,188
TR 202,37,4096
MA 204,220,184
XL 156,5,4,50,384
MA 204,216,168
s_add_u32 s50, s50, 4096
MA 172,216,164
TR 204,37,8192
MA 172,220,180
TR 206,37,12288
MA 140,220,176
MA 140,216,160
WL 4
MA 144,192,0
TR 208,38,0
MA 144,196,16
s_add_u32 m0, s48, 32768
TR 210,38,4096
MA 176,196,20
DM 8,32,52,0
MA 176,192,4
MA 208,192,8
TR 212,38,8192
MA 208,196,24
TR 214,38,12288
MA 240,196,28
DM 9,32,52,1024
MA 240,192,12
WL 4
MA 244,200,12
TR 216,39,0
MA 244,204,28
TR 218,39,4096
MA 212,204,24
DM 10,32,52,2048
MA 212,200,8
MA 180,200,4
TR 220,39,8192
MA 180,204,20
TR 222,39,12288
MA 148,204,16
MA 148,200,0
WL 4
MA 152,208,0
TR 192,32,0
MA 152,212,16
TR 194,32,4096
MA 184,212,20
DM 11,32,52,3072
MA 184,208,4
s_add_u32 s52, s52, 131072
MA 216,208,8
TR 196,32,8192
MA 216,212,24
TR 198,32,12288
MA 248,212,28
XL 160,5,4,50,0
MA 248,208,12
WL 4
MA 252,216,12
TR 200,33,0
MA 252,220,28
TR 202,33,4096
MA 220,220,24
XL 164,5,4,50,128
MA 220,216,8
MA 188,216,4
TR 204,33,8192
MA 188,220,20
TR 206,33,12288
MA 156,220,16
MA 156,216,0
WL 4
MA 128,192,0
TR 208,34,0
MA 128,196,16
TR 210,34,4096
MA 160,196,20
XL 168,5,4,50,256
MA 160,192,4
MA 192,192,8
TR 212,34,8192
MA 192,196,24
TR 214,34,12288
MA 224,196,28
XL 172,5,4,50,384
MA 224,192,12
s_add_u32 s50, s50, 4096
WL 4
MA 228,200,12
TR 216,35,0
MA 228,204,28
TR 218,35,4096
MA 196,204,24
XL 176,5,4,50,0
MA 196,200,8
MA 164,200,4
TR 220,35,8192
MA 164,204,20
TR 222,35,12288
MA 132,204,16
MA 132,200,0
WL 4
MA 136,208,0
MA 136,212,16
MA 168,212,20
XL 180,5,4,50,128
MA 168,208,4
s_waitcnt vmcnt(31) lgkmcnt(0)
s_barrier
MA 200,208,8
TR 192,36,32768
MA 200,212,24
TR 194,36,36864
MA 232,212,28
XL 184,5,4,50,256
TR 196,36,40960
MA 232,208,12
TR 198,36,45056
MA 236,216,12
TR 200,37,32768
MA 236,220,28
TR 202,37,36864
MA 204,220,24
XL 188,5,4,50,384
MA 204,216,8
s_add_u32 s50, s50, 4096
MA 172,216,4
TR 204,37,40960
MA 172,220,20
TR 206,37,45056
MA 140,220,16
MA 140,216,0
s_waitcnt vmcnt(24) lgkmcnt(4)
MA 144,192,32
TR 208,38,32768
MA 144,196,48
s_add_u32 m0, s48, 65536
TR 210,38,36864
MA 176,196,52
DM 8,32,52,0
MA 176,192,36
MA 208,192,40
TR 212,38,40960
MA 208,196,56
TR 214,38,45056
MA 240,196,60
DM 9,32,52,1024
MA 240,192,44
WL 4
MA 244,200,44
TR 216,39,32768
MA 244,204,60
TR 218,39,36864
MA 212,204,56
DM 10,32,52,2048
MA 212,200,40
MA 180,200,36
TR 220,39,40960
MA 180,204,52
TR 222,39,45056
MA 148,204,48
MA 148,200,32
buffer_load_dword v61, v60, s[84:87], s77 offen
WL 4
MA 152,208,32
TR 192,32,32768
MA 152,212,48
TR 194,32,36864
MA 184,212,52
DM 11,32,52,3072
MA 184,208,36
s_add_u32 s52, s52, 131072
MA 216,208,40
TR 196,32,40960
MA 216,212,56
TR 198,32,45056
MA 248,212,60
XL 0,5,4,50,0
MA 248,208,44
WL 4
MA 252,216,44
TR 200,33,32768
MA 252,220,60
TR 202,33,36864
MA 220,220,56
XL 4,5,4,50,128
MA 220,216,40
MA 188,216,36
TR 204,33,40960
MA 188,220,52
TR 206,33,45056
MA 156,220,48
MA 156,216,32
WL 4
MA 128,192,32
TR 208,34,32768
MA 128,196,48
TR 210,34,36864
MA 160,196,52
XL 8,5,4,50,256
MA 160,192,36
MA 192,192,40
TR 212,34,40960
MA 192,196,56
TR 214,34,45056
MA 224,196,60
XL 12,5,4,50,384
MA 224,192,44
s_add_u32 s50, s50, 4096
WL 4
MA 228,200,44
TR 216,35,32768
MA 228,204,60
TR 218,35,36864
MA 196,204,56
XL 16,5,4,50,0
MA 196,200,40
MA 164,200,36
TR 220,35,40960
MA 164,204,52
TR 222,35,45056
MA 132,204,48
MA 132,200,32
WL 4
MA 136,208,32
MA 136,212,48
MA 168,212,52
XL 20,5,4,50,128
MA 168,208,36
s_waitcnt vmcnt(31) lgkmcnt(0)
s_barrier
MA 200,208,40
TR 192,28,0
MA 200,212,56
TR 194,28,4096
MA 232,212,60
XL 24,5,4,50,256
TR 196,28,8192
MA 232,208,44
TR 198,28,12288
MA 236,216,44
TR 200,29,0
MA 236,220,60
TR 202,29,4096
MA 204,220,56
XL 28,5,4,50,384
MA 204,216,40
s_add_u32 s50, s50, 4096
MA 172,216,36
TR 204,29,8192
MA 172,220,52
TR 206,29,12288
MA 140,220,48
MA 140,216,32
s_mov_b32 s47, 5
t1_L36:
s_waitcnt vmcnt(25) lgkmcnt(4)
MA 144,192,128
TR 208,30,0
MA 144,196,144
s_add_u32 m0, s48, 98304
TR 210,30,4096
MA 176,196,148
DM 8,32,52,0
MA 176,192,132
MA 208,192,136
TR 212,30,8192
MA 208,196,152
TR 214,30,12288
MA 240,196,156
DM 9,32,52,1024
MA 240,192,140
WL 4
MA 244,200,140
TR 216,31,0
MA 244,204,156
TR 218,31,4096
MA 212,204,152
DM 10,32,52,2048
MA 212,200,136
MA 180,200,132
TR 220,31,8192
MA 180,204,148
TR 222,31,12288
MA 148,204,144
MA 148,200,128
WL 4
MA 152,208,128
TR 192,24,0
MA 152,212,144
TR 194,24,4096
MA 184,212,148
DM 11,32,52,3072
MA 184,208,132
s_add_u32 s52, s52, 131072
MA 216,208,136
TR 196,24,8192
MA 216,212,152
TR 198,24,12288
MA 248,212,156
XL 32,5,4,50,0
MA 248,208,140
WL 4
MA 252,216,140
TR 200,25,0
MA 252,220,156
TR 202,25,4096
MA 220,220,152
XL 36,5,4,50,128
MA 220,216,136
MA 188,216,132
TR 204,25,8192
MA 188,220,148
TR 206,25,12288
MA 156,220,144
MA 156,216,128
WL 4
MA 128,192,128
TR 208,26,0
MA 128,196,144
TR 210,26,4096
MA 160,196,148
XL 40,5,4,50,256
MA 160,192,132
MA 192,192,136
TR 212,26,8192
MA 192,196,152
TR 214,26,12288
MA 224,196,156
XL 44,5,4,50,384
MA 224,192,140
s_add_u32 s50, s50, 4096
WL 4
MA 228,200,140
TR 216,27,0
MA 228,204,156
TR 218,27,4096
MA 196,204,152
XL 48,5,4,50,0
MA 196,200,136
MA 164,200,132
TR 220,27,8192
MA 164,204,148
TR 222,27,12288
MA 132,204,144
MA 132,200,128
WL 4
MA 136,208,128
MA 136,212,144
MA 168,212,148
XL 52,5,4,50,128
MA 168,208,132
s_waitcnt vmcnt(31) lgkmcnt(0)
s_barrier
MA 200,208,136
TR 192,28,32768
MA 200,212,152
TR 194,28,36864
MA 232,212,156
XL 56,5,4,50,256
TR 196,28,40960
MA 232,208,140
TR 198,28,45056
MA 236,216,140
TR 200,29,32768
MA 236,220,156
TR 202,29,36864
MA 204,220,152
XL 60,5,4,50,384
MA 204,216,136
s_add_u32 s50, s50, 4096
MA 172,216,132
TR 204,29,40960
MA 172,220,148
TR 206,29,45056
MA 140,220,144
MA 140,216,128
s_waitcnt vmcnt(25) lgkmcnt(4)
MA 144,192,160
TR 208,30,32768
MA 144,196,176
s_add_u32 m0, s48, 0
TR 210,30,36864
MA 176,196,180
DM 8,32,52,0
MA 176,192,164
MA 208,192,168
TR 212,30,40960
MA 208,196,184
TR 214,30,45056
MA 240,196,188
DM 9,32,52,1024
MA 240,192,172
WL 4
MA 244,200,172
TR 216,31,32768
MA 244,204,188
TR 218,31,36864
MA 212,204,184
DM 10,32,52,2048
MA 212,200,168
MA 180,200,164
TR 220,31,40960
MA 180,204,180
TR 222,31,45056
MA 148,204,176
MA 148,200,160
WL 4
MA 152,208,160
TR 192,24,32768
MA 152,212,176
TR 194,24,36864
MA 184,212,180
DM 11,32,52,3072
MA 184,208,164
s_add_u32 s52, s52, 131072
MA 216,208,168
TR 196,24,40960
MA 216,212,184
TR 198,24,45056
MA 248,212,188
XL 128,5,4,50,0
MA 248,208,172
WL 4
MA 252,216,172
TR 200,25,32768
MA 252,220,188
TR 202,25,36864
MA 220,220,184
XL 132,5,4,50,128
MA 220,216,168
MA 188,216,164
TR 204,25,40960
MA 188,220,180
TR 206,25,45056
MA 156,220,176
MA 156,216,160
WL 4
MA 128,192,160
TR 208,26,32768
MA 128,196,176
TR 210,26,36864
MA 160,196,180
XL 136,5,4,50,256
MA 160,192,164
MA 192,192,168
TR 212,26,40960
MA 192,196,184
TR 214,26,45056
MA 224,196,188
XL 140,5,4,50,384
MA 224,192,172
s_add_u32 s50, s50, 4096
WL 4
MA 228,200,172
TR 216,27,32768
MA 228,204,188
TR 218,27,36864
MA 196,204,184
XL 144,5,4,50,0
MA 196,200,168
MA 164,200,164
TR 220,27,40960
MA 164,204,180
TR 222,27,45056
MA 132,204,176
MA 132,200,160
WL 4
MA 136,208,160
MA 136,212,176
MA 168,212,180
XL 148,5,4,50,128
MA 168,208,164
s_waitcnt vmcnt(30) lgkmcnt(0)
s_barrier
MA 200,208,168
TR 192,36,0
MA 200,212,184
TR 194,36,4096
MA 232,212,188
XL 152,5,4,50,256
TR 196,36,8192
MA 232,208,172
TR 198,36,12288
MA 236,216,172
TR 200,37,0
MA 236,220,188
TR 202,37,4096
MA 204,220,184
XL 156,5,4,50,384
MA 204,216,168
s_add_u32 s50, s50, 4096
MA 172,216,164
TR 204,37,8192
MA 172,220,180
TR 206,37,12288
MA 140,220,176
MA 140,216,160
s_waitcnt vmcnt(24) lgkmcnt(4)
MA 144,192,0
TR 208,38,0
MA 144,196,16
s_add_u32 m0, s48, 32768
TR 210,38,4096
MA 176,196,20
DM 8,32,52,0
MA 176,192,4
MA 208,192,8
TR 212,38,8192
MA 208,196,24
TR 214,38,12288
MA 240,196,28
DM 9,32,52,1024
MA 240,192,12
WL 4
MA 244,200,12
TR 216,39,0
MA 244,204,28
TR 218,39,4096
MA 212,204,24
DM 10,32,52,2048
MA 212,200,8
MA 180,200,4
TR 220,39,8192
MA 180,204,20
TR 222,39,12288
MA 148,204,16
MA 148,200,0
WL 4
MA 152,208,0
TR 192,32,0
MA 152,212,16
TR 194,32,4096
MA 184,212,20
DM 11,32,52,3072
MA 184,208,4
s_add_u32 s52, s52, 131072
MA 216,208,8
TR 196,32,8192
MA 216,212,24
TR 198,32,12288
MA 248,212,28
XL 160,5,4,50,0
MA 248,208,12
WL 4
MA 252,216,12
TR 200,33,0
MA 252,220,28
TR 202,33,4096
MA 220,220,24
XL 164,5,4,50,128
MA 220,216,8
MA 188,216,4
TR 204,33,8192
MA 188,220,20
TR 206,33,12288
MA 156,220,16
MA 156,216,0
WL 4
MA 128,192,0
TR 208,34,0
MA 128,196,16
TR 210,34,4096
MA 160,196,20
XL 168,5,4,50,256
MA 160,192,4
MA 192,192,8
TR 212,34,8192
MA 192,196,24
TR 214,34,12288
MA 224,196,28
XL 172,5,4,50,384
MA 224,192,12
s_add_u32 s50, s50, 4096
WL 4
MA 228,200,12
TR 216,35,0
MA 228,204,28
TR 218,35,4096
MA 196,204,24
XL 176,5,4,50,0
MA 196,200,8
MA 164,200,4
TR 220,35,8192
MA 164,204,20
TR 222,35,12288
MA 132,204,16
MA 132,200,0
WL 4
MA 136,208,0
MA 136,212,16
MA 168,212,20
XL 180,5,4,50,128
MA 168,208,4
s_waitcnt vmcnt(30) lgkmcnt(0)
s_barrier
MA 200,208,8
TR 192,36,32768
MA 200,212,24
TR 194,36,36864
MA 232,212,28
XL 184,5,4,50,256
TR 196,36,40960
MA 232,208,12
TR 198,36,45056
MA 236,216,12
TR 200,37,32768
MA 236,220,28
TR 202,37,36864
MA 204,220,24
XL 188,5,4,50,384
MA 204,216,8
s_add_u32 s50, s50, 4096
MA 172,216,4
TR 204,37,40960
MA 172,220,20
TR 206,37,45056
MA 140,220,16
MA 140,216,0
s_waitcnt vmcnt(24) lgkmcnt(4)
MA 144,192,32
TR 208,38,32768
MA 144,196,48
s_add_u32 m0, s48, 65536
TR 210,38,36864
MA 176,196,52
DM 8,32,52,0
MA 176,192,36
MA 208,192,40
TR 212,38,40960
MA 208,196,56
TR 214,38,45056
MA 240,196,60
DM 9,32,52,1024
MA 240,192,44
WL 4
MA 244,200,44
TR 216,39,32768
MA 244,204,60
TR 218,39,36864
MA 212,204,56
DM 10,32,52,2048
MA 212,200,40
MA 180,200,36
TR 220,39,40960
MA 180,204,52
TR 222,39,45056
MA 148,204,48
MA 148,200,32
buffer_load_dword v61, v60, s[84:87], s77 offen
WL 4
MA 152,208,32
TR 192,32,32768
MA 152,212,48
TR 194,32,36864
MA 184,212,52
DM 11,32,52,3072
MA 184,208,36
s_add_u32 s52, s52, 131072
MA 216,208,40
TR 196,32,40960
MA 216,212,56
TR 198,32,45056
MA 248,212,60
XL 0,5,4,50,0
MA 248,208,44
WL 4
MA 252,216,44
TR 200,33,32768
MA 252,220,60
TR 202,33,36864
MA 220,220,56
XL 4,5,4,50,128
MA 220,216,40
MA 188,216,36
TR 204,33,40960
MA 188,220,52
TR 206,33,45056
MA 156,220,48
MA 156,216,32
WL 4
MA 128,192,32
TR 208,34,32768
MA 128,196,48
TR 210,34,36864
MA 160,196,52
XL 8,5,4,50,256
MA 160,192,36
MA 192,192,40
TR 212,34,40960
MA 192,196,56
TR 214,34,45056
MA 224,196,60
XL 12,5,4,50,384
MA 224,192,44
s_add_u32 s50, s50, 4096
WL 4
MA 228,200,44
TR 216,35,32768
MA 228,204,60
TR 218,35,36864
MA 196,204,56
XL 16,5,4,50,0
MA 196,200,40
MA 164,200,36
TR 220,35,40960
MA 164,204,52
TR 222,35,45056
MA 132,204,48
MA 132,200,32
WL 4
MA 136,208,32
MA 136,212,48
MA 168,212,52
XL 20,5,4,50,128
MA 168,208,36
s_waitcnt vmcnt(31) lgkmcnt(0)
s_barrier
MA 200,208,40
TR 192,28,0
MA 200,212,56
TR 194,28,4096
MA 232,212,60
XL 24,5,4,50,256
TR 196,28,8192
MA 232,208,44
TR 198,28,12288
MA 236,216,44
TR 200,29,0
MA 236,220,60
TR 202,29,4096
MA 204,220,56
XL 28,5,4,50,384
MA 204,216,40
s_add_u32 s50, s50, 4096
MA 172,216,36
TR 204,29,8192
MA 172,220,52
TR 206,29,12288
MA 140,220,48
MA 140,216,32
s_sub_u32 s47, s47, 1
s_cbranch_scc0 t1_L36
s_waitcnt vmcnt(25) lgkmcnt(4)
MA 144,192,128
TR 208,30,0
MA 144,196,144
s_add_u32 m0, s48, 98304
TR 210,30,4096
MA 176,196,148
DM 8,32,52,0
MA 176,192,132
s_lshl_b32 s60, s58, 2
MA 208,192,136
TR 212,30,8192
MA 208,196,152
TR 214,30,12288
MA 240,196,156
DM 9,32,52,1024
MA 240,192,140
s_add_u32 s60, s60, s44
WL 4
MA 244,200,140
TR 216,31,0
MA 244,204,156
TR 218,31,4096
MA 212,204,152
DM 10,32,52,2048
MA 212,200,136
s_lshl_b32 s60, s60, 17
MA 180,200,132
TR 220,31,8192
MA 180,204,148
TR 222,31,12288
MA 148,204,144
MA 148,200,128
s_lshl_b32 s65, s96, 14
WL 4
MA 152,208,128
MA 152,212,144
MA 184,212,148
DM 11,32,52,3072
MA 184,208,132
s_add_u32 s52, s52, 131072
s_add_u32 s60, s60, s65
WV 25
s_barrier
MA 216,208,136
TR 192,28,32768
MA 216,212,152
TR 194,28,36864
MA 248,212,156
XL 32,5,4,50,0
TR 196,28,40960
MA 248,208,140
TR 198,28,45056
s_add_u32 s60, s60, 4194304
WL 4
MA 252,216,140
TR 200,29,32768
MA 252,220,156
TR 202,29,36864
MA 220,220,152
XL 36,5,4,50,128
MA 220,216,136
s_mul_i32 s65, s97, 12582912
MA 188,216,132
TR 204,29,40960
MA 188,220,148
TR 206,29,45056
MA 156,220,144
MA 156,216,128
s_add_u32 s60, s60, s65
s_waitcnt vmcnt(19) lgkmcnt(4)
MA 144,192,160
TR 208,30,32768
MA 144,196,176
TR 210,30,36864
MA 176,196,180
XL 40,5,4,50,256
MA 176,192,164
s_add_u32 s61, s60, 8192
MA 208,192,168
TR 212,30,40960
MA 208,196,184
TR 214,30,45056
MA 240,196,188
XL 44,5,4,50,384
MA 240,192,172
s_add_u32 s50, s50, 4096
s_lshl_b32 s78, s58, 3
WL 4
MA 244,200,172
TR 216,31,32768
MA 244,204,188
TR 218,31,36864
MA 212,204,184
XL 48,5,4,50,0
MA 212,200,168
s_add_u32 s78, s78, s96
MA 180,200,164
TR 220,31,40960
MA 180,204,180
TR 222,31,45056
MA 148,204,176
MA 148,200,160
s_lshl_b32 s78, s78, 8
WL 4
MA 152,208,160
MA 152,212,176
MA 184,212,180
XL 52,5,4,50,128
MA 184,208,164
s_add_u32 s78, s78, 22052864
WV 18
s_barrier
MA 216,208,168
TR 192,36,0
MA 216,212,184
TR 194,36,4096
MA 248,212,188
XL 56,5,4,50,256
TR 196,36,8192
MA 248,208,172
TR 198,36,12288
WL 4
MA 252,216,172
TR 200,37,0
MA 252,220,188
TR 202,37,4096
MA 220,220,184
XL 60,5,4,50,384
MA 220,216,168
s_add_u32 s50, s50, 4096
MA 188,216,164
TR 204,37,8192
MA 188,220,180
TR 206,37,12288
MA 156,220,176
MA 156,216,160
s_waitcnt vmcnt(12) lgkmcnt(4)
MA 144,192,0
TR 208,38,0
MA 144,196,16
TR 210,38,4096
MA 176,196,20
MA 176,192,4
MA 208,192,8
TR 212,38,8192
MA 208,196,24
TR 214,38,12288
MA 240,196,28
MA 240,192,12
WL 4
MA 244,200,12
TR 216,39,0
MA 244,204,28
TR 218,39,4096
MA 212,204,24
MA 212,200,8
MA 180,200,4
TR 220,39,8192
MA 180,204,20
TR 222,39,12288
MA 148,204,16
MA 148,200,0
WL 4
MA 152,208,0
MA 152,212,16
MA 184,212,20
MA 184,208,4
WV 8
s_barrier
MA 216,208,8
TR 192,36,32768
MA 216,212,24
TR 194,36,36864
MA 248,212,28
TR 196,36,40960
MA 248,208,12
TR 198,36,45056
WL 4
MA 252,216,12
TR 200,37,32768
MA 252,220,28
TR 202,37,36864
MA 220,220,24
MA 220,216,8
MA 188,216,4
TR 204,37,40960
MA 188,220,20
TR 206,37,45056
MA 156,220,16
MA 156,216,0
s_waitcnt vmcnt(0) lgkmcnt(4)
MA 144,192,32
TR 208,38,32768
MA 144,196,48
TR 210,38,36864
MA 176,196,52
MA 176,192,36
MA 208,192,40
TR 212,38,40960
MA 208,196,56
TR 214,38,45056
MA 240,196,60
MA 240,192,44
WL 4
MA 244,200,44
TR 216,39,32768
MA 244,204,60
TR 218,39,36864
MA 212,204,56
MA 212,200,40
MA 180,200,36
TR 220,39,40960
MA 180,204,52
TR 222,39,45056
MA 148,204,48
MA 148,200,32
WL 4
MA 152,208,32
TR 192,24,0
MA 152,212,48
TR 194,24,4096
MA 184,212,52
MA 184,208,36
MA 216,208,40
TR 196,24,8192
MA 216,212,56
TR 198,24,12288
MA 248,212,60
MA 248,208,44
WL 4
MA 252,216,44
TR 200,25,0
MA 252,220,60
TR 202,25,4096
MA 220,220,56
MA 220,216,40
MA 188,216,36
TR 204,25,8192
MA 188,220,52
TR 206,25,12288
MA 156,220,48
MA 156,216,32
WL 4
MA 128,192,128
TR 208,26,0
MA 128,196,144
TR 210,26,4096
MA 160,196,148
v_cvt_pk_bf16_f32 v64, v144, v145
MA 160,192,132
v_cvt_pk_bf16_f32 v65, v146, v147
MA 192,192,136
TR 212,26,8192
v_cvt_pk_bf16_f32 v66, v148, v149
MA 192,196,152
TR 214,26,12288
v_cvt_pk_bf16_f32 v67, v150, v151
MA 224,196,156
buffer_store_dwordx4 v[64:67], v5, s[4:7], s61 offen offset:0 sc1
MA 224,192,140
v_cvt_pk_bf16_f32 v68, v176, v177
WL 4
MA 228,200,140
TR 216,27,0
v_cvt_pk_bf16_f32 v69, v178, v179
MA 228,204,156
TR 218,27,4096
v_cvt_pk_bf16_f32 v70, v180, v181
MA 196,204,152
v_cvt_pk_bf16_f32 v71, v182, v183
MA 196,200,136
buffer_store_dwordx4 v[68:71], v5, s[4:7], s61 offen offset:128 sc1
MA 164,200,132
TR 220,27,8192
v_cvt_pk_bf16_f32 v72, v208, v209
MA 164,204,148
TR 222,27,12288
v_cvt_pk_bf16_f32 v73, v210, v211
MA 132,204,144
v_cvt_pk_bf16_f32 v74, v212, v213
MA 132,200,128
v_cvt_pk_bf16_f32 v75, v214, v215
WL 4
MA 136,208,128
TR 192,24,32768
buffer_store_dwordx4 v[72:75], v5, s[4:7], s61 offen offset:256 sc1
MA 136,212,144
TR 194,24,36864
v_cvt_pk_bf16_f32 v76, v240, v241
MA 168,212,148
v_cvt_pk_bf16_f32 v77, v242, v243
MA 168,208,132
v_cvt_pk_bf16_f32 v78, v244, v245
MA 200,208,136
TR 196,24,40960
v_cvt_pk_bf16_f32 v79, v246, v247
MA 200,212,152
TR 198,24,45056
buffer_store_dwordx4 v[76:79], v5, s[4:7], s61 offen offset:384 sc1
MA 232,212,156
s_add_u32 s61, s61, 4096
MA 232,208,140
WL 4
MA 236,216,140
TR 200,25,32768
v_cvt_pk_bf16_f32 v80, v152, v153
MA 236,220,156
TR 202,25,36864
v_cvt_pk_bf16_f32 v81, v154, v155
MA 204,220,152
v_cvt_pk_bf16_f32 v82, v156, v157
MA 204,216,136
v_cvt_pk_bf16_f32 v83, v158, v159
MA 172,216,132
TR 204,25,40960
buffer_store_dwordx4 v[80:83], v5, s[4:7], s61 offen offset:0 sc1
MA 172,220,148
TR 206,25,45056
v_cvt_pk_bf16_f32 v84, v184, v185
MA 140,220,144
v_cvt_pk_bf16_f32 v85, v186, v187
MA 140,216,128
v_cvt_pk_bf16_f32 v86, v188, v189
WL 4
MA 128,192,160
TR 208,26,32768
v_cvt_pk_bf16_f32 v87, v190, v191
MA 128,196,176
TR 210,26,36864
buffer_store_dwordx4 v[84:87], v5, s[4:7], s61 offen offset:128 sc1
MA 160,196,180
v_cvt_pk_bf16_f32 v88, v216, v217
MA 160,192,164
v_cvt_pk_bf16_f32 v89, v218, v219
MA 192,192,168
TR 212,26,40960
v_cvt_pk_bf16_f32 v90, v220, v221
MA 192,196,184
TR 214,26,45056
v_cvt_pk_bf16_f32 v91, v222, v223
MA 224,196,188
buffer_store_dwordx4 v[88:91], v5, s[4:7], s61 offen offset:256 sc1
MA 224,192,172
v_cvt_pk_bf16_f32 v92, v248, v249
WL 4
MA 228,200,172
TR 216,27,32768
v_cvt_pk_bf16_f32 v93, v250, v251
MA 228,204,188
TR 218,27,36864
v_cvt_pk_bf16_f32 v94, v252, v253
MA 196,204,184
v_cvt_pk_bf16_f32 v95, v254, v255
MA 196,200,168
buffer_store_dwordx4 v[92:95], v5, s[4:7], s61 offen offset:384 sc1
MA 164,200,164
TR 220,27,40960
s_add_u32 s61, s61, 4096
MA 164,204,180
TR 222,27,45056
MA 132,204,176
MA 132,200,160
WL 4
MA 136,208,160
TR 192,32,0
MA 136,212,176
TR 194,32,4096
MA 168,212,180
MA 168,208,164
MA 200,208,168
TR 196,32,8192
MA 200,212,184
TR 198,32,12288
MA 232,212,188
MA 232,208,172
WL 4
MA 236,216,172
TR 200,33,0
MA 236,220,188
TR 202,33,4096
MA 204,220,184
MA 204,216,168
MA 172,216,164
TR 204,33,8192
MA 172,220,180
TR 206,33,12288
MA 140,220,176
MA 140,216,160
WL 4
MA 128,192,0
TR 208,34,0
MA 128,196,16
TR 210,34,4096
MA 160,196,20
MA 160,192,4
MA 192,192,8
TR 212,34,8192
MA 192,196,24
TR 214,34,12288
MA 224,196,28
MA 224,192,12
WL 4
MA 228,200,12
TR 216,35,0
MA 228,204,28
TR 218,35,4096
MA 196,204,24
MA 196,200,8
MA 164,200,4
TR 220,35,8192
MA 164,204,20
TR 222,35,12288
MA 132,204,16
MA 132,200,0
WL 4
MA 136,208,0
TR 192,32,32768
MA 136,212,16
TR 194,32,36864
MA 168,212,20
MA 168,208,4
MA 200,208,8
TR 196,32,40960
MA 200,212,24
TR 198,32,45056
MA 232,212,28
MA 232,208,12
WL 4
MA 236,216,12
TR 200,33,32768
MA 236,220,28
TR 202,33,36864
MA 204,220,24
MA 204,216,8
MA 172,216,4
TR 204,33,40960
MA 172,220,20
TR 206,33,45056
MA 140,220,16
MA 140,216,0
WL 4
MA 128,192,32
TR 208,34,32768
MA 128,196,48
TR 210,34,36864
MA 160,196,52
MA 160,192,36
MA 192,192,40
TR 212,34,40960
MA 192,196,56
TR 214,34,45056
MA 224,196,60
MA 224,192,44
WL 4
MA 228,200,44
TR 216,35,32768
MA 228,204,60
TR 218,35,36864
MA 196,204,56
MA 196,200,40
MA 164,200,36
TR 220,35,40960
MA 164,204,52
TR 222,35,45056
MA 132,204,48
MA 132,200,32
WL 4
MA 136,208,32
MA 136,212,48
MA 168,212,52
MA 168,208,36
MA 200,208,40
MA 200,212,56
MA 232,212,60
MA 232,208,44
WL 0
MA 236,216,44
MA 236,220,60
MA 204,220,56
MA 204,216,40
MA 172,216,36
MA 172,220,52
MA 140,220,48
MA 140,216,32
v_cvt_pk_bf16_f32 v64, v128, v129
v_cvt_pk_bf16_f32 v65, v130, v131
v_cvt_pk_bf16_f32 v66, v132, v133
v_cvt_pk_bf16_f32 v67, v134, v135
buffer_store_dwordx4 v[64:67], v5, s[4:7], s60 offen offset:0 sc1
v_cvt_pk_bf16_f32 v68, v160, v161
v_cvt_pk_bf16_f32 v69, v162, v163
v_cvt_pk_bf16_f32 v70, v164, v165
v_cvt_pk_bf16_f32 v71, v166, v167
buffer_store_dwordx4 v[68:71], v5, s[4:7], s60 offen offset:128 sc1
v_cvt_pk_bf16_f32 v72, v192, v193
v_cvt_pk_bf16_f32 v73, v194, v195
v_cvt_pk_bf16_f32 v74, v196, v197
v_cvt_pk_bf16_f32 v75, v198, v199
buffer_store_dwordx4 v[72:75], v5, s[4:7], s60 offen offset:256 sc1
v_cvt_pk_bf16_f32 v76, v224, v225
v_cvt_pk_bf16_f32 v77, v226, v227
v_cvt_pk_bf16_f32 v78, v228, v229
v_cvt_pk_bf16_f32 v79, v230, v231
buffer_store_dwordx4 v[76:79], v5, s[4:7], s60 offen offset:384 sc1
s_add_u32 s60, s60, 4096
v_cvt_pk_bf16_f32 v80, v136, v137
v_cvt_pk_bf16_f32 v81, v138, v139
v_cvt_pk_bf16_f32 v82, v140, v141
v_cvt_pk_bf16_f32 v83, v142, v143
buffer_store_dwordx4 v[80:83], v5, s[4:7], s60 offen offset:0 sc1
v_cvt_pk_bf16_f32 v84, v168, v169
v_cvt_pk_bf16_f32 v85, v170, v171
v_cvt_pk_bf16_f32 v86, v172, v173
v_cvt_pk_bf16_f32 v87, v174, v175
buffer_store_dwordx4 v[84:87], v5, s[4:7], s60 offen offset:128 sc1
v_cvt_pk_bf16_f32 v88, v200, v201
v_cvt_pk_bf16_f32 v89, v202, v203
v_cvt_pk_bf16_f32 v90, v204, v205
v_cvt_pk_bf16_f32 v91, v206, v207
buffer_store_dwordx4 v[88:91], v5, s[4:7], s60 offen offset:256 sc1
v_cvt_pk_bf16_f32 v92, v232, v233
v_cvt_pk_bf16_f32 v93, v234, v235
v_cvt_pk_bf16_f32 v94, v236, v237
v_cvt_pk_bf16_f32 v95, v238, v239
buffer_store_dwordx4 v[92:95], v5, s[4:7], s60 offen offset:384 sc1
s_add_u32 s60, s60, 4096
v_min_u32 v23, 1, v0
v_lshlrev_b32 v23, 31, v23
WV 0
buffer_atomic_add v21, v23, s[4:7], s78 offen
s_endpgm
t1_slow1:
s_mov_b32 s71, 0x20000
t1_slow1_r:
s_sleep 8
buffer_load_dword v17, v22, s[8:11], s63 offen offset:0 sc1
WV 0
v_cmp_gt_u32 s[68:69], 16, v17
s_sub_u32 s71, s71, 1
s_cbranch_scc1 t1_back2
s_nop 1
s_and_b64 s[68:69], s[68:69], s[74:75]
s_cbranch_scc1 t1_slow1_r
s_branch t1_back2
t1_slow3:
s_mov_b32 s71, 0x20000
t1_slow3_r:
s_sleep 8
buffer_load_dword v17, v23, s[8:11], 0 offen offset:0 sc1
WV 0
v_cmp_gt_u32 s[68:69], 16, v17
s_sub_u32 s71, s71, 1
s_cbranch_scc1 t1_back4
s_nop 1
s_and_b64 s[68:69], s[68:69], s[74:75]
s_cbranch_scc1 t1_slow3_r
s_branch t1_back4
t1_slow5:
s_mov_b32 s71, 0x20000
t1_slow5_r:
s_sleep 8
buffer_load_dword v17, v22, s[4:7], s80 offen offset:768 sc1
WV 0
v_cmp_gt_u32 s[68:69], 16, v17
s_sub_u32 s71, s71, 1
s_cbranch_scc1 t1_back6
s_nop 1
s_and_b64 s[68:69], s[68:69], s[74:75]
s_cbranch_scc1 t1_slow5_r
s_branch t1_back6
t1_rare_0:
WL 0
s_nop 7
s_nop 7
v_xor_b32 v208, 0, v3
v_add_u32 v208, s70, v208
ds_read_b128 a[192:195], v208 offset:0
v_xor_b32 v208, 64, v3
v_add_u32 v208, s70, v208
ds_read_b128 a[196:199], v208 offset:0
v_xor_b32 v208, 128, v3
v_add_u32 v208, s70, v208
ds_read_b128 a[200:203], v208 offset:0
v_xor_b32 v208, 192, v3
v_add_u32 v208, s70, v208
ds_read_b128 a[204:207], v208 offset:0
WL 0
v_mfma_f32_16x16x32_bf16 v[128:131], a[192:195], v[64:67], v[192:195]
v_mfma_f32_16x16x32_bf16 v[128:131], a[196:199], v[68:71], v[128:131]
v_mfma_f32_16x16x32_bf16 v[128:131], a[200:203], v[72:75], v[128:131]
v_mfma_f32_16x16x32_bf16 v[128:131], a[204:207], v[76:79], v[128:131]
v_mfma_f32_16x16x32_bf16 v[136:139], a[192:195], v[80:83], v[196:199]
v_mfma_f32_16x16x32_bf16 v[136:139], a[196:199], v[84:87], v[136:139]
v_mfma_f32_16x16x32_bf16 v[136:139], a[200:203], v[88:91], v[136:139]
v_mfma_f32_16x16x32_bf16 v[136:139], a[204:207], v[92:95], v[136:139]
v_mfma_f32_16x16x32_bf16 v[144:147], a[192:195], v[96:99], v[200:203]
v_mfma_f32_16x16x32_bf16 v[144:147], a[196:199], v[100:103], v[144:147]
v_mfma_f32_16x16x32_bf16 v[144:147], a[200:203], v[104:107], v[144:147]
v_mfma_f32_16x16x32_bf16 v[144:147], a[204:207], v[108:111], v[144:147]
v_mfma_f32_16x16x32_bf16 v[152:155], a[192:195], v[112:115], v[204:207]
v_mfma_f32_16x16x32_bf16 v[152:155], a[196:199], v[116:119], v[152:155]
v_mfma_f32_16x16x32_bf16 v[152:155], a[200:203], v[120:123], v[152:155]
v_mfma_f32_16x16x32_bf16 v[152:155], a[204:207], v[124:127], v[152:155]
s_nop 7
s_nop 7
v_xor_b32 v208, 0, v3
v_add_u32 v208, s70, v208
ds_read_b128 a[192:195], v208 offset:4096
v_xor_b32 v208, 64, v3
v_add_u32 v208, s70, v208
ds_read_b128 a[196:199], v208 offset:4096
v_xor_b32 v208, 128, v3
v_add_u32 v208, s70, v208
ds_read_b128 a[200:203], v208 offset:4096
v_xor_b32 v208, 192, v3
v_add_u32 v208, s70, v208
ds_read_b128 a[204:207], v208 offset:4096
WL 0
v_mfma_f32_16x16x32_bf16 v[132:135], a[192:195], v[64:67], v[192:195]
v_mfma_f32_16x16x32_bf16 v[132:135], a[196:199], v[68:71], v[132:135]
v_mfma_f32_16x16x32_bf16 v[132:135], a[200:203], v[72:75], v[132:135]
v_mfma_f32_16x16x32_bf16 v[132:135], a[204:207], v[76:79], v[132:135]
v_mfma_f32_16x16x32_bf16 v[140:143], a[192:195], v[80:83], v[196:199]
v_mfma_f32_16x16x32_bf16 v[140:143], a[196:199], v[84:87], v[140:143]
v_mfma_f32_16x16x32_bf16 v[140:143], a[200:203], v[88:91], v[140:143]
v_mfma_f32_16x16x32_bf16 v[140:143], a[204:207], v[92:95], v[140:143]
v_mfma_f32_16x16x32_bf16 v[148:151], a[192:195], v[96:99], v[200:203]
v_mfma_f32_16x16x32_bf16 v[148:151], a[196:199], v[100:103], v[148:151]
v_mfma_f32_16x16x32_bf16 v[148:151], a[200:203], v[104:107], v[148:151]
v_mfma_f32_16x16x32_bf16 v[148:151], a[204:207], v[108:111], v[148:151]
v_mfma_f32_16x16x32_bf16 v[156:159], a[192:195], v[112:115], v[204:207]
v_mfma_f32_16x16x32_bf16 v[156:159], a[196:199], v[116:119], v[156:159]
v_mfma_f32_16x16x32_bf16 v[156:159], a[200:203], v[120:123], v[156:159]
v_mfma_f32_16x16x32_bf16 v[156:159], a[204:207], v[124:127], v[156:159]
s_nop 7
s_nop 7
v_max3_f32 v208, v128, v129, v130
v_max3_f32 v208, v208, v131, v132
v_max3_f32 v208, v208, v133, v134
v_max_f32 v208, v208, v135
v_mov_b32 v209, v208
s_nop 1
v_permlane16_swap_b32 v208, v209
v_max_f32 v208, v208, v209
v_mov_b32 v209, v208
s_nop 1
v_permlane32_swap_b32 v208, v209
v_max_f32 v208, v208, v209
v_max_f32 v208, 0, v208
v_exp_f32 v52, -v208
v_sub_f32 v128, v128, v208
v_sub_f32 v129, v129, v208
v_sub_f32 v130, v130, v208
v_sub_f32 v131, v131, v208
v_sub_f32 v132, v132, v208
v_sub_f32 v133, v133, v208
v_sub_f32 v134, v134, v208
v_sub_f32 v135, v135, v208
v_sub_f32 v160, v160, v208
v_sub_f32 v161, v161, v208
v_sub_f32 v162, v162, v208
v_sub_f32 v163, v163, v208
v_sub_f32 v164, v164, v208
v_sub_f32 v165, v165, v208
v_sub_f32 v166, v166, v208
v_sub_f32 v167, v167, v208
v_sub_f32 v192, v192, v208
v_sub_f32 v193, v193, v208
v_sub_f32 v194, v194, v208
v_sub_f32 v195, v195, v208
v_mul_f32 v48, v48, v52
v_exp_f32 v128, v128
v_exp_f32 v129, v129
v_exp_f32 v130, v130
v_exp_f32 v131, v131
v_exp_f32 v132, v132
v_exp_f32 v133, v133
v_exp_f32 v134, v134
v_exp_f32 v135, v135
s_nop 0
v_cvt_pk_bf16_f32 v224, v128, v129
v_cvt_pk_bf16_f32 v225, v130, v131
v_cvt_pk_bf16_f32 v226, v132, v133
v_cvt_pk_bf16_f32 v227, v134, v135
v_max3_f32 v208, v136, v137, v138
v_max3_f32 v208, v208, v139, v140
v_max3_f32 v208, v208, v141, v142
v_max_f32 v208, v208, v143
v_mov_b32 v209, v208
s_nop 1
v_permlane16_swap_b32 v208, v209
v_max_f32 v208, v208, v209
v_mov_b32 v209, v208
s_nop 1
v_permlane32_swap_b32 v208, v209
v_max_f32 v208, v208, v209
v_max_f32 v208, 0, v208
v_exp_f32 v53, -v208
v_sub_f32 v136, v136, v208
v_sub_f32 v137, v137, v208
v_sub_f32 v138, v138, v208
v_sub_f32 v139, v139, v208
v_sub_f32 v140, v140, v208
v_sub_f32 v141, v141, v208
v_sub_f32 v142, v142, v208
v_sub_f32 v143, v143, v208
v_sub_f32 v168, v168, v208
v_sub_f32 v169, v169, v208
v_sub_f32 v170, v170, v208
v_sub_f32 v171, v171, v208
v_sub_f32 v172, v172, v208
v_sub_f32 v173, v173, v208
v_sub_f32 v174, v174, v208
v_sub_f32 v175, v175, v208
v_sub_f32 v196, v196, v208
v_sub_f32 v197, v197, v208
v_sub_f32 v198, v198, v208
v_sub_f32 v199, v199, v208
v_mul_f32 v49, v49, v53
v_exp_f32 v136, v136
v_exp_f32 v137, v137
v_exp_f32 v138, v138
v_exp_f32 v139, v139
v_exp_f32 v140, v140
v_exp_f32 v141, v141
v_exp_f32 v142, v142
v_exp_f32 v143, v143
s_nop 0
v_cvt_pk_bf16_f32 v228, v136, v137
v_cvt_pk_bf16_f32 v229, v138, v139
v_cvt_pk_bf16_f32 v230, v140, v141
v_cvt_pk_bf16_f32 v231, v142, v143
v_max3_f32 v208, v144, v145, v146
v_max3_f32 v208, v208, v147, v148
v_max3_f32 v208, v208, v149, v150
v_max_f32 v208, v208, v151
v_mov_b32 v209, v208
s_nop 1
v_permlane16_swap_b32 v208, v209
v_max_f32 v208, v208, v209
v_mov_b32 v209, v208
s_nop 1
v_permlane32_swap_b32 v208, v209
v_max_f32 v208, v208, v209
v_max_f32 v208, 0, v208
v_exp_f32 v54, -v208
v_sub_f32 v144, v144, v208
v_sub_f32 v145, v145, v208
v_sub_f32 v146, v146, v208
v_sub_f32 v147, v147, v208
v_sub_f32 v148, v148, v208
v_sub_f32 v149, v149, v208
v_sub_f32 v150, v150, v208
v_sub_f32 v151, v151, v208
v_sub_f32 v176, v176, v208
v_sub_f32 v177, v177, v208
v_sub_f32 v178, v178, v208
v_sub_f32 v179, v179, v208
v_sub_f32 v180, v180, v208
v_sub_f32 v181, v181, v208
v_sub_f32 v182, v182, v208
v_sub_f32 v183, v183, v208
v_sub_f32 v200, v200, v208
v_sub_f32 v201, v201, v208
v_sub_f32 v202, v202, v208
v_sub_f32 v203, v203, v208
v_mul_f32 v50, v50, v54
v_exp_f32 v144, v144
v_exp_f32 v145, v145
v_exp_f32 v146, v146
v_exp_f32 v147, v147
v_exp_f32 v148, v148
v_exp_f32 v149, v149
v_exp_f32 v150, v150
v_exp_f32 v151, v151
s_nop 0
v_cvt_pk_bf16_f32 v232, v144, v145
v_cvt_pk_bf16_f32 v233, v146, v147
v_cvt_pk_bf16_f32 v234, v148, v149
v_cvt_pk_bf16_f32 v235, v150, v151
v_max3_f32 v208, v152, v153, v154
v_max3_f32 v208, v208, v155, v156
v_max3_f32 v208, v208, v157, v158
v_max_f32 v208, v208, v159
v_mov_b32 v209, v208
s_nop 1
v_permlane16_swap_b32 v208, v209
v_max_f32 v208, v208, v209
v_mov_b32 v209, v208
s_nop 1
v_permlane32_swap_b32 v208, v209
v_max_f32 v208, v208, v209
v_max_f32 v208, 0, v208
v_exp_f32 v55, -v208
v_sub_f32 v152, v152, v208
v_sub_f32 v153, v153, v208
v_sub_f32 v154, v154, v208
v_sub_f32 v155, v155, v208
v_sub_f32 v156, v156, v208
v_sub_f32 v157, v157, v208
v_sub_f32 v158, v158, v208
v_sub_f32 v159, v159, v208
v_sub_f32 v184, v184, v208
v_sub_f32 v185, v185, v208
v_sub_f32 v186, v186, v208
v_sub_f32 v187, v187, v208
v_sub_f32 v188, v188, v208
v_sub_f32 v189, v189, v208
v_sub_f32 v190, v190, v208
v_sub_f32 v191, v191, v208
v_sub_f32 v204, v204, v208
v_sub_f32 v205, v205, v208
v_sub_f32 v206, v206, v208
v_sub_f32 v207, v207, v208
v_mul_f32 v51, v51, v55
v_exp_f32 v152, v152
v_exp_f32 v153, v153
v_exp_f32 v154, v154
v_exp_f32 v155, v155
v_exp_f32 v156, v156
v_exp_f32 v157, v157
v_exp_f32 v158, v158
v_exp_f32 v159, v159
s_nop 0
v_cvt_pk_bf16_f32 v236, v152, v153
v_cvt_pk_bf16_f32 v237, v154, v155
v_cvt_pk_bf16_f32 v238, v156, v157
v_cvt_pk_bf16_f32 v239, v158, v159
s_nop 1
s_mov_b32 s70, 1
s_branch t1_rare_o
t1_rare_1:
WL 0
s_nop 7
s_nop 7
v_xor_b32 v208, 0, v3
v_add_u32 v208, s70, v208
ds_read_b128 a[192:195], v208 offset:0
v_xor_b32 v208, 64, v3
v_add_u32 v208, s70, v208
ds_read_b128 a[196:199], v208 offset:0
v_xor_b32 v208, 128, v3
v_add_u32 v208, s70, v208
ds_read_b128 a[200:203], v208 offset:0
v_xor_b32 v208, 192, v3
v_add_u32 v208, s70, v208
ds_read_b128 a[204:207], v208 offset:0
WL 0
v_mfma_f32_16x16x32_bf16 v[160:163], a[192:195], v[64:67], v[192:195]
v_mfma_f32_16x16x32_bf16 v[160:163], a[196:199], v[68:71], v[160:163]
v_mfma_f32_16x16x32_bf16 v[160:163], a[200:203], v[72:75], v[160:163]
v_mfma_f32_16x16x32_bf16 v[160:163], a[204:207], v[76:79], v[160:163]
v_mfma_f32_16x16x32_bf16 v[168:171], a[192:195], v[80:83], v[196:199]
v_mfma_f32_16x16x32_bf16 v[168:171], a[196:199], v[84:87], v[168:171]
v_mfma_f32_16x16x32_bf16 v[168:171], a[200:203], v[88:91], v[168:171]
v_mfma_f32_16x16x32_bf16 v[168:171], a[204:207], v[92:95], v[168:171]
v_mfma_f32_16x16x32_bf16 v[176:179], a[192:195], v[96:99], v[200:203]
v_mfma_f32_16x16x32_bf16 v[176:179], a[196:199], v[100:103], v[176:179]
v_mfma_f32_16x16x32_bf16 v[176:179], a[200:203], v[104:107], v[176:179]
v_mfma_f32_16x16x32_bf16 v[176:179], a[204:207], v[108:111], v[176:179]
v_mfma_f32_16x16x32_bf16 v[184:187], a[192:195], v[112:115], v[204:207]
v_mfma_f32_16x16x32_bf16 v[184:187], a[196:199], v[116:119], v[184:187]
v_mfma_f32_16x16x32_bf16 v[184:187], a[200:203], v[120:123], v[184:187]
v_mfma_f32_16x16x32_bf16 v[184:187], a[204:207], v[124:127], v[184:187]
s_nop 7
s_nop 7
v_xor_b32 v208, 0, v3
v_add_u32 v208, s70, v208
ds_read_b128 a[192:195], v208 offset:4096
v_xor_b32 v208, 64, v3
v_add_u32 v208, s70, v208
ds_read_b128 a[196:199], v208 offset:4096
v_xor_b32 v208, 128, v3
v_add_u32 v208, s70, v208
ds_read_b128 a[200:203], v208 offset:4096
v_xor_b32 v208, 192, v3
v_add_u32 v208, s70, v208
ds_read_b128 a[204:207], v208 offset:4096
WL 0
v_mfma_f32_16x16x32_bf16 v[164:167], a[192:195], v[64:67], v[192:195]
v_mfma_f32_16x16x32_bf16 v[164:167], a[196:199], v[68:71], v[164:167]
v_mfma_f32_16x16x32_bf16 v[164:167], a[200:203], v[72:75], v[164:167]
v_mfma_f32_16x16x32_bf16 v[164:167], a[204:207], v[76:79], v[164:167]
v_mfma_f32_16x16x32_bf16 v[172:175], a[192:195], v[80:83], v[196:199]
v_mfma_f32_16x16x32_bf16 v[172:175], a[196:199], v[84:87], v[172:175]
v_mfma_f32_16x16x32_bf16 v[172:175], a[200:203], v[88:91], v[172:175]
v_mfma_f32_16x16x32_bf16 v[172:175], a[204:207], v[92:95], v[172:175]
v_mfma_f32_16x16x32_bf16 v[180:183], a[192:195], v[96:99], v[200:203]
v_mfma_f32_16x16x32_bf16 v[180:183], a[196:199], v[100:103], v[180:183]
v_mfma_f32_16x16x32_bf16 v[180:183], a[200:203], v[104:107], v[180:183]
v_mfma_f32_16x16x32_bf16 v[180:183], a[204:207], v[108:111], v[180:183]
v_mfma_f32_16x16x32_bf16 v[188:191], a[192:195], v[112:115], v[204:207]
v_mfma_f32_16x16x32_bf16 v[188:191], a[196:199], v[116:119], v[188:191]
v_mfma_f32_16x16x32_bf16 v[188:191], a[200:203], v[120:123], v[188:191]
v_mfma_f32_16x16x32_bf16 v[188:191], a[204:207], v[124:127], v[188:191]
s_nop 7
s_nop 7
v_max3_f32 v208, v160, v161, v162
v_max3_f32 v208, v208, v163, v164
v_max3_f32 v208, v208, v165, v166
v_max_f32 v208, v208, v167
v_mov_b32 v209, v208
s_nop 1
v_permlane16_swap_b32 v208, v209
v_max_f32 v208, v208, v209
v_mov_b32 v209, v208
s_nop 1
v_permlane32_swap_b32 v208, v209
v_max_f32 v208, v208, v209
v_max_f32 v208, 0, v208
v_exp_f32 v52, -v208
v_sub_f32 v160, v160, v208
v_sub_f32 v161, v161, v208
v_sub_f32 v162, v162, v208
v_sub_f32 v163, v163, v208
v_sub_f32 v164, v164, v208
v_sub_f32 v165, v165, v208
v_sub_f32 v166, v166, v208
v_sub_f32 v167, v167, v208
v_sub_f32 v128, v128, v208
v_sub_f32 v129, v129, v208
v_sub_f32 v130, v130, v208
v_sub_f32 v131, v131, v208
v_sub_f32 v132, v132, v208
v_sub_f32 v133, v133, v208
v_sub_f32 v134, v134, v208
v_sub_f32 v135, v135, v208
v_sub_f32 v192, v192, v208
v_sub_f32 v193, v193, v208
v_sub_f32 v194, v194, v208
v_sub_f32 v195, v195, v208
v_mul_f32 v48, v48, v52
v_exp_f32 v160, v160
v_exp_f32 v161, v161
v_exp_f32 v162, v162
v_exp_f32 v163, v163
v_exp_f32 v164, v164
v_exp_f32 v165, v165
v_exp_f32 v166, v166
v_exp_f32 v167, v167
s_nop 0
v_cvt_pk_bf16_f32 v224, v160, v161
v_cvt_pk_bf16_f32 v225, v162, v163
v_cvt_pk_bf16_f32 v226, v164, v165
v_cvt_pk_bf16_f32 v227, v166, v167
v_max3_f32 v208, v168, v169, v170
v_max3_f32 v208, v208, v171, v172
v_max3_f32 v208, v208, v173, v174
v_max_f32 v208, v208, v175
v_mov_b32 v209, v208
s_nop 1
v_permlane16_swap_b32 v208, v209
v_max_f32 v208, v208, v209
v_mov_b32 v209, v208
s_nop 1
v_permlane32_swap_b32 v208, v209
v_max_f32 v208, v208, v209
v_max_f32 v208, 0, v208
v_exp_f32 v53, -v208
v_sub_f32 v168, v168, v208
v_sub_f32 v169, v169, v208
v_sub_f32 v170, v170, v208
v_sub_f32 v171, v171, v208
v_sub_f32 v172, v172, v208
v_sub_f32 v173, v173, v208
v_sub_f32 v174, v174, v208
v_sub_f32 v175, v175, v208
v_sub_f32 v136, v136, v208
v_sub_f32 v137, v137, v208
v_sub_f32 v138, v138, v208
v_sub_f32 v139, v139, v208
v_sub_f32 v140, v140, v208
v_sub_f32 v141, v141, v208
v_sub_f32 v142, v142, v208
v_sub_f32 v143, v143, v208
v_sub_f32 v196, v196, v208
v_sub_f32 v197, v197, v208
v_sub_f32 v198, v198, v208
v_sub_f32 v199, v199, v208
v_mul_f32 v49, v49, v53
v_exp_f32 v168, v168
v_exp_f32 v169, v169
v_exp_f32 v170, v170
v_exp_f32 v171, v171
v_exp_f32 v172, v172
v_exp_f32 v173, v173
v_exp_f32 v174, v174
v_exp_f32 v175, v175
s_nop 0
v_cvt_pk_bf16_f32 v228, v168, v169
v_cvt_pk_bf16_f32 v229, v170, v171
v_cvt_pk_bf16_f32 v230, v172, v173
v_cvt_pk_bf16_f32 v231, v174, v175
v_max3_f32 v208, v176, v177, v178
v_max3_f32 v208, v208, v179, v180
v_max3_f32 v208, v208, v181, v182
v_max_f32 v208, v208, v183
v_mov_b32 v209, v208
s_nop 1
v_permlane16_swap_b32 v208, v209
v_max_f32 v208, v208, v209
v_mov_b32 v209, v208
s_nop 1
v_permlane32_swap_b32 v208, v209
v_max_f32 v208, v208, v209
v_max_f32 v208, 0, v208
v_exp_f32 v54, -v208
v_sub_f32 v176, v176, v208
v_sub_f32 v177, v177, v208
v_sub_f32 v178, v178, v208
v_sub_f32 v179, v179, v208
v_sub_f32 v180, v180, v208
v_sub_f32 v181, v181, v208
v_sub_f32 v182, v182, v208
v_sub_f32 v183, v183, v208
v_sub_f32 v144, v144, v208
v_sub_f32 v145, v145, v208
v_sub_f32 v146, v146, v208
v_sub_f32 v147, v147, v208
v_sub_f32 v148, v148, v208
v_sub_f32 v149, v149, v208
v_sub_f32 v150, v150, v208
v_sub_f32 v151, v151, v208
v_sub_f32 v200, v200, v208
v_sub_f32 v201, v201, v208
v_sub_f32 v202, v202, v208
v_sub_f32 v203, v203, v208
v_mul_f32 v50, v50, v54
v_exp_f32 v176, v176
v_exp_f32 v177, v177
v_exp_f32 v178, v178
v_exp_f32 v179, v179
v_exp_f32 v180, v180
v_exp_f32 v181, v181
v_exp_f32 v182, v182
v_exp_f32 v183, v183
s_nop 0
v_cvt_pk_bf16_f32 v232, v176, v177
v_cvt_pk_bf16_f32 v233, v178, v179
v_cvt_pk_bf16_f32 v234, v180, v181
v_cvt_pk_bf16_f32 v235, v182, v183
v_max3_f32 v208, v184, v185, v186
v_max3_f32 v208, v208, v187, v188
v_max3_f32 v208, v208, v189, v190
v_max_f32 v208, v208, v191
v_mov_b32 v209, v208
s_nop 1
v_permlane16_swap_b32 v208, v209
v_max_f32 v208, v208, v209
v_mov_b32 v209, v208
s_nop 1
v_permlane32_swap_b32 v208, v209
v_max_f32 v208, v208, v209
v_max_f32 v208, 0, v208
v_exp_f32 v55, -v208
v_sub_f32 v184, v184, v208
v_sub_f32 v185, v185, v208
v_sub_f32 v186, v186, v208
v_sub_f32 v187, v187, v208
v_sub_f32 v188, v188, v208
v_sub_f32 v189, v189, v208
v_sub_f32 v190, v190, v208
v_sub_f32 v191, v191, v208
v_sub_f32 v152, v152, v208
v_sub_f32 v153, v153, v208
v_sub_f32 v154, v154, v208
v_sub_f32 v155, v155, v208
v_sub_f32 v156, v156, v208
v_sub_f32 v157, v157, v208
v_sub_f32 v158, v158, v208
v_sub_f32 v159, v159, v208
v_sub_f32 v204, v204, v208
v_sub_f32 v205, v205, v208
v_sub_f32 v206, v206, v208
v_sub_f32 v207, v207, v208
v_mul_f32 v51, v51, v55
v_exp_f32 v184, v184
v_exp_f32 v185, v185
v_exp_f32 v186, v186
v_exp_f32 v187, v187
v_exp_f32 v188, v188
v_exp_f32 v189, v189
v_exp_f32 v190, v190
v_exp_f32 v191, v191
s_nop 0
v_cvt_pk_bf16_f32 v236, v184, v185
v_cvt_pk_bf16_f32 v237, v186, v187
v_cvt_pk_bf16_f32 v238, v188, v189
v_cvt_pk_bf16_f32 v239, v190, v191
s_nop 1
s_mov_b32 s70, 1
s_branch t1_rare_o
t1_rare_last:
WL 0
s_nop 7
s_nop 7
v_max3_f32 v208, v160, v161, v162
v_max3_f32 v208, v208, v163, v164
v_max3_f32 v208, v208, v165, v166
v_max_f32 v208, v208, v167
v_mov_b32 v209, v208
s_nop 1
v_permlane16_swap_b32 v208, v209
v_max_f32 v208, v208, v209
v_mov_b32 v209, v208
s_nop 1
v_permlane32_swap_b32 v208, v209
v_max_f32 v208, v208, v209
v_max_f32 v208, 0, v208
v_exp_f32 v52, -v208
v_sub_f32 v160, v160, v208
v_sub_f32 v161, v161, v208
v_sub_f32 v162, v162, v208
v_sub_f32 v163, v163, v208
v_sub_f32 v164, v164, v208
v_sub_f32 v165, v165, v208
v_sub_f32 v166, v166, v208
v_sub_f32 v167, v167, v208
v_mul_f32 v48, v48, v52
v_exp_f32 v160, v160
v_exp_f32 v161, v161
v_exp_f32 v162, v162
v_exp_f32 v163, v163
v_exp_f32 v164, v164
v_exp_f32 v165, v165
v_exp_f32 v166, v166
v_exp_f32 v167, v167
s_nop 0
v_cvt_pk_bf16_f32 v240, v160, v161
v_cvt_pk_bf16_f32 v241, v162, v163
v_cvt_pk_bf16_f32 v242, v164, v165
v_cvt_pk_bf16_f32 v243, v166, v167
v_max3_f32 v208, v168, v169, v170
v_max3_f32 v208, v208, v171, v172
v_max3_f32 v208, v208, v173, v174
v_max_f32 v208, v208, v175
v_mov_b32 v209, v208
s_nop 1
v_permlane16_swap_b32 v208, v209
v_max_f32 v208, v208, v209
v_mov_b32 v209, v208
s_nop 1
v_permlane32_swap_b32 v208, v209
v_max_f32 v208, v208, v209
v_max_f32 v208, 0, v208
v_exp_f32 v53, -v208
v_sub_f32 v168, v168, v208
v_sub_f32 v169, v169, v208
v_sub_f32 v170, v170, v208
v_sub_f32 v171, v171, v208
v_sub_f32 v172, v172, v208
v_sub_f32 v173, v173, v208
v_sub_f32 v174, v174, v208
v_sub_f32 v175, v175, v208
v_mul_f32 v49, v49, v53
v_exp_f32 v168, v168
v_exp_f32 v169, v169
v_exp_f32 v170, v170
v_exp_f32 v171, v171
v_exp_f32 v172, v172
v_exp_f32 v173, v173
v_exp_f32 v174, v174
v_exp_f32 v175, v175
s_nop 0
v_cvt_pk_bf16_f32 v244, v168, v169
v_cvt_pk_bf16_f32 v245, v170, v171
v_cvt_pk_bf16_f32 v246, v172, v173
v_cvt_pk_bf16_f32 v247, v174, v175
v_max3_f32 v208, v176, v177, v178
v_max3_f32 v208, v208, v179, v180
v_max3_f32 v208, v208, v181, v182
v_max_f32 v208, v208, v183
v_mov_b32 v209, v208
s_nop 1
v_permlane16_swap_b32 v208, v209
v_max_f32 v208, v208, v209
v_mov_b32 v209, v208
s_nop 1
v_permlane32_swap_b32 v208, v209
v_max_f32 v208, v208, v209
v_max_f32 v208, 0, v208
v_exp_f32 v54, -v208
v_sub_f32 v176, v176, v208
v_sub_f32 v177, v177, v208
v_sub_f32 v178, v178, v208
v_sub_f32 v179, v179, v208
v_sub_f32 v180, v180, v208
v_sub_f32 v181, v181, v208
v_sub_f32 v182, v182, v208
v_sub_f32 v183, v183, v208
v_mul_f32 v50, v50, v54
v_exp_f32 v176, v176
v_exp_f32 v177, v177
v_exp_f32 v178, v178
v_exp_f32 v179, v179
v_exp_f32 v180, v180
v_exp_f32 v181, v181
v_exp_f32 v182, v182
v_exp_f32 v183, v183
s_nop 0
v_cvt_pk_bf16_f32 v248, v176, v177
v_cvt_pk_bf16_f32 v249, v178, v179
v_cvt_pk_bf16_f32 v250, v180, v181
v_cvt_pk_bf16_f32 v251, v182, v183
v_max3_f32 v208, v184, v185, v186
v_max3_f32 v208, v208, v187, v188
v_max3_f32 v208, v208, v189, v190
v_max_f32 v208, v208, v191
v_mov_b32 v209, v208
s_nop 1
v_permlane16_swap_b32 v208, v209
v_max_f32 v208, v208, v209
v_mov_b32 v209, v208
s_nop 1
v_permlane32_swap_b32 v208, v209
v_max_f32 v208, v208, v209
v_max_f32 v208, 0, v208
v_exp_f32 v55, -v208
v_sub_f32 v184, v184, v208
v_sub_f32 v185, v185, v208
v_sub_f32 v186, v186, v208
v_sub_f32 v187, v187, v208
v_sub_f32 v188, v188, v208
v_sub_f32 v189, v189, v208
v_sub_f32 v190, v190, v208
v_sub_f32 v191, v191, v208
v_mul_f32 v51, v51, v55
v_exp_f32 v184, v184
v_exp_f32 v185, v185
v_exp_f32 v186, v186
v_exp_f32 v187, v187
v_exp_f32 v188, v188
v_exp_f32 v189, v189
v_exp_f32 v190, v190
v_exp_f32 v191, v191
s_nop 0
v_cvt_pk_bf16_f32 v252, v184, v185
v_cvt_pk_bf16_f32 v253, v186, v187
v_cvt_pk_bf16_f32 v254, v188, v189
v_cvt_pk_bf16_f32 v255, v190, v191
s_nop 1
s_mov_b32 s70, 0
s_branch t1_rare_o
t1_rare_o:
v_accvgpr_read_b32 v208, a0
v_accvgpr_read_b32 v209, a1
v_accvgpr_read_b32 v210, a2
v_accvgpr_read_b32 v211, a3
v_mul_f32 v208, v208, v52
v_mul_f32 v209, v209, v52
v_mul_f32 v210, v210, v52
v_mul_f32 v211, v211, v52
v_accvgpr_write_b32 a0, v208
v_accvgpr_write_b32 a1, v209
v_accvgpr_write_b32 a2, v210
v_accvgpr_write_b32 a3, v211
v_accvgpr_read_b32 v208, a4
v_accvgpr_read_b32 v209, a5
v_accvgpr_read_b32 v210, a6
v_accvgpr_read_b32 v211, a7
v_mul_f32 v208, v208, v52
v_mul_f32 v209, v209, v52
v_mul_f32 v210, v210, v52
v_mul_f32 v211, v211, v52
v_accvgpr_write_b32 a4, v208
v_accvgpr_write_b32 a5, v209
v_accvgpr_write_b32 a6, v210
v_accvgpr_write_b32 a7, v211
v_accvgpr_read_b32 v208, a8
v_accvgpr_read_b32 v209, a9
v_accvgpr_read_b32 v210, a10
v_accvgpr_read_b32 v211, a11
v_mul_f32 v208, v208, v52
v_mul_f32 v209, v209, v52
v_mul_f32 v210, v210, v52
v_mul_f32 v211, v211, v52
v_accvgpr_write_b32 a8, v208
v_accvgpr_write_b32 a9, v209
v_accvgpr_write_b32 a10, v210
v_accvgpr_write_b32 a11, v211
v_accvgpr_read_b32 v208, a12
v_accvgpr_read_b32 v209, a13
v_accvgpr_read_b32 v210, a14
v_accvgpr_read_b32 v211, a15
v_mul_f32 v208, v208, v52
v_mul_f32 v209, v209, v52
v_mul_f32 v210, v210, v52
v_mul_f32 v211, v211, v52
v_accvgpr_write_b32 a12, v208
v_accvgpr_write_b32 a13, v209
v_accvgpr_write_b32 a14, v210
v_accvgpr_write_b32 a15, v211
v_accvgpr_read_b32 v208, a16
v_accvgpr_read_b32 v209, a17
v_accvgpr_read_b32 v210, a18
v_accvgpr_read_b32 v211, a19
v_mul_f32 v208, v208, v52
v_mul_f32 v209, v209, v52
v_mul_f32 v210, v210, v52
v_mul_f32 v211, v211, v52
v_accvgpr_write_b32 a16, v208
v_accvgpr_write_b32 a17, v209
v_accvgpr_write_b32 a18, v210
v_accvgpr_write_b32 a19, v211
v_accvgpr_read_b32 v208, a20
v_accvgpr_read_b32 v209, a21
v_accvgpr_read_b32 v210, a22
v_accvgpr_read_b32 v211, a23
v_mul_f32 v208, v208, v52
v_mul_f32 v209, v209, v52
v_mul_f32 v210, v210, v52
v_mul_f32 v211, v211, v52
v_accvgpr_write_b32 a20, v208
v_accvgpr_write_b32 a21, v209
v_accvgpr_write_b32 a22, v210
v_accvgpr_write_b32 a23, v211
v_accvgpr_read_b32 v208, a24
v_accvgpr_read_b32 v209, a25
v_accvgpr_read_b32 v210, a26
v_accvgpr_read_b32 v211, a27
v_mul_f32 v208, v208, v52
v_mul_f32 v209, v209, v52
v_mul_f32 v210, v210, v52
v_mul_f32 v211, v211, v52
v_accvgpr_write_b32 a24, v208
v_accvgpr_write_b32 a25, v209
v_accvgpr_write_b32 a26, v210
v_accvgpr_write_b32 a27, v211
v_accvgpr_read_b32 v208, a28
v_accvgpr_read_b32 v209, a29
v_accvgpr_read_b32 v210, a30
v_accvgpr_read_b32 v211, a31
v_mul_f32 v208, v208, v52
v_mul_f32 v209, v209, v52
v_mul_f32 v210, v210, v52
v_mul_f32 v211, v211, v52
v_accvgpr_write_b32 a28, v208
v_accvgpr_write_b32 a29, v209
v_accvgpr_write_b32 a30, v210
v_accvgpr_write_b32 a31, v211
v_accvgpr_read_b32 v208, a32
v_accvgpr_read_b32 v209, a33
v_accvgpr_read_b32 v210, a34
v_accvgpr_read_b32 v211, a35
v_mul_f32 v208, v208, v53
v_mul_f32 v209, v209, v53
v_mul_f32 v210, v210, v53
v_mul_f32 v211, v211, v53
v_accvgpr_write_b32 a32, v208
v_accvgpr_write_b32 a33, v209
v_accvgpr_write_b32 a34, v210
v_accvgpr_write_b32 a35, v211
v_accvgpr_read_b32 v208, a36
v_accvgpr_read_b32 v209, a37
v_accvgpr_read_b32 v210, a38
v_accvgpr_read_b32 v211, a39
v_mul_f32 v208, v208, v53
v_mul_f32 v209, v209, v53
v_mul_f32 v210, v210, v53
v_mul_f32 v211, v211, v53
v_accvgpr_write_b32 a36, v208
v_accvgpr_write_b32 a37, v209
v_accvgpr_write_b32 a38, v210
v_accvgpr_write_b32 a39, v211
v_accvgpr_read_b32 v208, a40
v_accvgpr_read_b32 v209, a41
v_accvgpr_read_b32 v210, a42
v_accvgpr_read_b32 v211, a43
v_mul_f32 v208, v208, v53
v_mul_f32 v209, v209, v53
v_mul_f32 v210, v210, v53
v_mul_f32 v211, v211, v53
v_accvgpr_write_b32 a40, v208
v_accvgpr_write_b32 a41, v209
v_accvgpr_write_b32 a42, v210
v_accvgpr_write_b32 a43, v211
v_accvgpr_read_b32 v208, a44
v_accvgpr_read_b32 v209, a45
v_accvgpr_read_b32 v210, a46
v_accvgpr_read_b32 v211, a47
v_mul_f32 v208, v208, v53
v_mul_f32 v209, v209, v53
v_mul_f32 v210, v210, v53
v_mul_f32 v211, v211, v53
v_accvgpr_write_b32 a44, v208
v_accvgpr_write_b32 a45, v209
v_accvgpr_write_b32 a46, v210
v_accvgpr_write_b32 a47, v211
v_accvgpr_read_b32 v208, a48
v_accvgpr_read_b32 v209, a49
v_accvgpr_read_b32 v210, a50
v_accvgpr_read_b32 v211, a51
v_mul_f32 v208, v208, v53
v_mul_f32 v209, v209, v53
v_mul_f32 v210, v210, v53
v_mul_f32 v211, v211, v53
v_accvgpr_write_b32 a48, v208
v_accvgpr_write_b32 a49, v209
v_accvgpr_write_b32 a50, v210
v_accvgpr_write_b32 a51, v211
v_accvgpr_read_b32 v208, a52
v_accvgpr_read_b32 v209, a53
v_accvgpr_read_b32 v210, a54
v_accvgpr_read_b32 v211, a55
v_mul_f32 v208, v208, v53
v_mul_f32 v209, v209, v53
v_mul_f32 v210, v210, v53
v_mul_f32 v211, v211, v53
v_accvgpr_write_b32 a52, v208
v_accvgpr_write_b32 a53, v209
v_accvgpr_write_b32 a54, v210
v_accvgpr_write_b32 a55, v211
v_accvgpr_read_b32 v208, a56
v_accvgpr_read_b32 v209, a57
v_accvgpr_read_b32 v210, a58
v_accvgpr_read_b32 v211, a59
v_mul_f32 v208, v208, v53
v_mul_f32 v209, v209, v53
v_mul_f32 v210, v210, v53
v_mul_f32 v211, v211, v53
v_accvgpr_write_b32 a56, v208
v_accvgpr_write_b32 a57, v209
v_accvgpr_write_b32 a58, v210
v_accvgpr_write_b32 a59, v211
v_accvgpr_read_b32 v208, a60
v_accvgpr_read_b32 v209, a61
v_accvgpr_read_b32 v210, a62
v_accvgpr_read_b32 v211, a63
v_mul_f32 v208, v208, v53
v_mul_f32 v209, v209, v53
v_mul_f32 v210, v210, v53
v_mul_f32 v211, v211, v53
v_accvgpr_write_b32 a60, v208
v_accvgpr_write_b32 a61, v209
v_accvgpr_write_b32 a62, v210
v_accvgpr_write_b32 a63, v211
v_accvgpr_read_b32 v208, a64
v_accvgpr_read_b32 v209, a65
v_accvgpr_read_b32 v210, a66
v_accvgpr_read_b32 v211, a67
v_mul_f32 v208, v208, v54
v_mul_f32 v209, v209, v54
v_mul_f32 v210, v210, v54
v_mul_f32 v211, v211, v54
v_accvgpr_write_b32 a64, v208
v_accvgpr_write_b32 a65, v209
v_accvgpr_write_b32 a66, v210
v_accvgpr_write_b32 a67, v211
v_accvgpr_read_b32 v208, a68
v_accvgpr_read_b32 v209, a69
v_accvgpr_read_b32 v210, a70
v_accvgpr_read_b32 v211, a71
v_mul_f32 v208, v208, v54
v_mul_f32 v209, v209, v54
v_mul_f32 v210, v210, v54
v_mul_f32 v211, v211, v54
v_accvgpr_write_b32 a68, v208
v_accvgpr_write_b32 a69, v209
v_accvgpr_write_b32 a70, v210
v_accvgpr_write_b32 a71, v211
v_accvgpr_read_b32 v208, a72
v_accvgpr_read_b32 v209, a73
v_accvgpr_read_b32 v210, a74
v_accvgpr_read_b32 v211, a75
v_mul_f32 v208, v208, v54
v_mul_f32 v209, v209, v54
v_mul_f32 v210, v210, v54
v_mul_f32 v211, v211, v54
v_accvgpr_write_b32 a72, v208
v_accvgpr_write_b32 a73, v209
v_accvgpr_write_b32 a74, v210
v_accvgpr_write_b32 a75, v211
v_accvgpr_read_b32 v208, a76
v_accvgpr_read_b32 v209, a77
v_accvgpr_read_b32 v210, a78
v_accvgpr_read_b32 v211, a79
v_mul_f32 v208, v208, v54
v_mul_f32 v209, v209, v54
v_mul_f32 v210, v210, v54
v_mul_f32 v211, v211, v54
v_accvgpr_write_b32 a76, v208
v_accvgpr_write_b32 a77, v209
v_accvgpr_write_b32 a78, v210
v_accvgpr_write_b32 a79, v211
v_accvgpr_read_b32 v208, a80
v_accvgpr_read_b32 v209, a81
v_accvgpr_read_b32 v210, a82
v_accvgpr_read_b32 v211, a83
v_mul_f32 v208, v208, v54
v_mul_f32 v209, v209, v54
v_mul_f32 v210, v210, v54
v_mul_f32 v211, v211, v54
v_accvgpr_write_b32 a80, v208
v_accvgpr_write_b32 a81, v209
v_accvgpr_write_b32 a82, v210
v_accvgpr_write_b32 a83, v211
v_accvgpr_read_b32 v208, a84
v_accvgpr_read_b32 v209, a85
v_accvgpr_read_b32 v210, a86
v_accvgpr_read_b32 v211, a87
v_mul_f32 v208, v208, v54
v_mul_f32 v209, v209, v54
v_mul_f32 v210, v210, v54
v_mul_f32 v211, v211, v54
v_accvgpr_write_b32 a84, v208
v_accvgpr_write_b32 a85, v209
v_accvgpr_write_b32 a86, v210
v_accvgpr_write_b32 a87, v211
v_accvgpr_read_b32 v208, a88
v_accvgpr_read_b32 v209, a89
v_accvgpr_read_b32 v210, a90
v_accvgpr_read_b32 v211, a91
v_mul_f32 v208, v208, v54
v_mul_f32 v209, v209, v54
v_mul_f32 v210, v210, v54
v_mul_f32 v211, v211, v54
v_accvgpr_write_b32 a88, v208
v_accvgpr_write_b32 a89, v209
v_accvgpr_write_b32 a90, v210
v_accvgpr_write_b32 a91, v211
v_accvgpr_read_b32 v208, a92
v_accvgpr_read_b32 v209, a93
v_accvgpr_read_b32 v210, a94
v_accvgpr_read_b32 v211, a95
v_mul_f32 v208, v208, v54
v_mul_f32 v209, v209, v54
v_mul_f32 v210, v210, v54
v_mul_f32 v211, v211, v54
v_accvgpr_write_b32 a92, v208
v_accvgpr_write_b32 a93, v209
v_accvgpr_write_b32 a94, v210
v_accvgpr_write_b32 a95, v211
v_accvgpr_read_b32 v208, a96
v_accvgpr_read_b32 v209, a97
v_accvgpr_read_b32 v210, a98
v_accvgpr_read_b32 v211, a99
v_mul_f32 v208, v208, v55
v_mul_f32 v209, v209, v55
v_mul_f32 v210, v210, v55
v_mul_f32 v211, v211, v55
v_accvgpr_write_b32 a96, v208
v_accvgpr_write_b32 a97, v209
v_accvgpr_write_b32 a98, v210
v_accvgpr_write_b32 a99, v211
v_accvgpr_read_b32 v208, a100
v_accvgpr_read_b32 v209, a101
v_accvgpr_read_b32 v210, a102
v_accvgpr_read_b32 v211, a103
v_mul_f32 v208, v208, v55
v_mul_f32 v209, v209, v55
v_mul_f32 v210, v210, v55
v_mul_f32 v211, v211, v55
v_accvgpr_write_b32 a100, v208
v_accvgpr_write_b32 a101, v209
v_accvgpr_write_b32 a102, v210
v_accvgpr_write_b32 a103, v211
v_accvgpr_read_b32 v208, a104
v_accvgpr_read_b32 v209, a105
v_accvgpr_read_b32 v210, a106
v_accvgpr_read_b32 v211, a107
v_mul_f32 v208, v208, v55
v_mul_f32 v209, v209, v55
v_mul_f32 v210, v210, v55
v_mul_f32 v211, v211, v55
v_accvgpr_write_b32 a104, v208
v_accvgpr_write_b32 a105, v209
v_accvgpr_write_b32 a106, v210
v_accvgpr_write_b32 a107, v211
v_accvgpr_read_b32 v208, a108
v_accvgpr_read_b32 v209, a109
v_accvgpr_read_b32 v210, a110
v_accvgpr_read_b32 v211, a111
v_mul_f32 v208, v208, v55
v_mul_f32 v209, v209, v55
v_mul_f32 v210, v210, v55
v_mul_f32 v211, v211, v55
v_accvgpr_write_b32 a108, v208
v_accvgpr_write_b32 a109, v209
v_accvgpr_write_b32 a110, v210
v_accvgpr_write_b32 a111, v211
v_accvgpr_read_b32 v208, a112
v_accvgpr_read_b32 v209, a113
v_accvgpr_read_b32 v210, a114
v_accvgpr_read_b32 v211, a115
v_mul_f32 v208, v208, v55
v_mul_f32 v209, v209, v55
v_mul_f32 v210, v210, v55
v_mul_f32 v211, v211, v55
v_accvgpr_write_b32 a112, v208
v_accvgpr_write_b32 a113, v209
v_accvgpr_write_b32 a114, v210
v_accvgpr_write_b32 a115, v211
v_accvgpr_read_b32 v208, a116
v_accvgpr_read_b32 v209, a117
v_accvgpr_read_b32 v210, a118
v_accvgpr_read_b32 v211, a119
v_mul_f32 v208, v208, v55
v_mul_f32 v209, v209, v55
v_mul_f32 v210, v210, v55
v_mul_f32 v211, v211, v55
v_accvgpr_write_b32 a116, v208
v_accvgpr_write_b32 a117, v209
v_accvgpr_write_b32 a118, v210
v_accvgpr_write_b32 a119, v211
v_accvgpr_read_b32 v208, a120
v_accvgpr_read_b32 v209, a121
v_accvgpr_read_b32 v210, a122
v_accvgpr_read_b32 v211, a123
v_mul_f32 v208, v208, v55
v_mul_f32 v209, v209, v55
v_mul_f32 v210, v210, v55
v_mul_f32 v211, v211, v55
v_accvgpr_write_b32 a120, v208
v_accvgpr_write_b32 a121, v209
v_accvgpr_write_b32 a122, v210
v_accvgpr_write_b32 a123, v211
v_accvgpr_read_b32 v208, a124
v_accvgpr_read_b32 v209, a125
v_accvgpr_read_b32 v210, a126
v_accvgpr_read_b32 v211, a127
v_mul_f32 v208, v208, v55
v_mul_f32 v209, v209, v55
v_mul_f32 v210, v210, v55
v_mul_f32 v211, v211, v55
v_accvgpr_write_b32 a124, v208
v_accvgpr_write_b32 a125, v209
v_accvgpr_write_b32 a126, v210
v_accvgpr_write_b32 a127, v211
s_nop 1
s_cmp_eq_u32 s70, 0
s_cbranch_scc1 t1_rare_l
v_mfma_f32_16x16x32_bf16 v[208:211], a[240:243], v[224:227], 0
v_mfma_f32_16x16x32_bf16 v[212:215], a[240:243], v[228:231], 0
v_mfma_f32_16x16x32_bf16 v[216:219], a[240:243], v[232:235], 0
v_mfma_f32_16x16x32_bf16 v[220:223], a[240:243], v[236:239], 0
s_branch t1_rare_e
t1_rare_l:
v_mfma_f32_16x16x32_bf16 v[208:211], a[240:243], v[240:243], 0
v_mfma_f32_16x16x32_bf16 v[212:215], a[240:243], v[244:247], 0
v_mfma_f32_16x16x32_bf16 v[216:219], a[240:243], v[248:251], 0
v_mfma_f32_16x16x32_bf16 v[220:223], a[240:243], v[252:255], 0
t1_rare_e:
s_nop 7
s_nop 7
s_setpc_b64 s[66:67]
t1_c7:
s_mov_b32 s70, 8192
s_call_b64 s[66:67], t1_rare_1
s_branch t1_r8
t1_c9:
s_mov_b32 s70, 32768
s_call_b64 s[66:67], t1_rare_0
s_branch t1_r10
t1_c11:
s_mov_b32 s70, 40960
s_call_b64 s[66:67], t1_rare_1
s_branch t1_r12
t1_c13:
s_mov_b32 s70, 65536
s_call_b64 s[66:67], t1_rare_0
s_branch t1_r14
t1_c15:
s_mov_b32 s70, 73728
s_call_b64 s[66:67], t1_rare_1
s_branch t1_r16
t1_c17:
s_mov_b32 s70, 98304
s_call_b64 s[66:67], t1_rare_0
s_branch t1_r18
t1_c19:
s_mov_b32 s70, 106496
s_call_b64 s[66:67], t1_rare_1
s_branch t1_r20
t1_c21:
s_mov_b32 s70, 0
s_call_b64 s[66:67], t1_rare_0
s_branch t1_r22
t1_c23:
s_mov_b32 s70, 8192
s_call_b64 s[66:67], t1_rare_1
s_branch t1_r24
t1_c25:
s_mov_b32 s70, 32768
s_call_b64 s[66:67], t1_rare_0
s_branch t1_r26
t1_c27:
s_mov_b32 s70, 40960
s_call_b64 s[66:67], t1_rare_1
s_branch t1_r28
t1_c29:
s_mov_b32 s70, 65536
s_call_b64 s[66:67], t1_rare_0
s_branch t1_r30
t1_c31:
s_mov_b32 s70, 73728
s_call_b64 s[66:67], t1_rare_1
s_branch t1_r32
t1_c33:
s_mov_b32 s70, 98304
s_call_b64 s[66:67], t1_rare_0
s_branch t1_r34
t1_c35:
s_mov_b32 s70, 106496
s_call_b64 s[66:67], t1_rare_last
s_branch t1_r36
t1_slow37:
s_mov_b32 s71, 0x20000
t1_slow37_r:
s_sleep 8
buffer_load_dword v17, v22, s[4:7], s80 offen offset:1024 sc1
WV 0
v_cmp_gt_u32 s[68:69], 32, v17
s_sub_u32 s71, s71, 1
s_cbranch_scc1 t1_back38
s_nop 1
s_and_b64 s[68:69], s[68:69], s[74:75]
s_cbranch_scc1 t1_slow37_r
s_branch t1_back38
t1_end:
t2_entry:
v_and_b32 v0, 63, v0
v_and_b32 v48, 7, v0
v_lshlrev_b32 v49, 11, v48
v_bfe_u32 v50, v0, 3, 1
v_lshl_add_u32 v49, v50, 6, v49
v_bfe_u32 v50, v0, 4, 1
v_lshl_add_u32 v49, v50, 5, v49
v_lshrrev_b32 v50, 5, v0
v_lshl_add_u32 v49, v50, 4, v49
s_lshl_b32 s60, s2, 14
s_lshl_b32 s61, s44, 9
s_add_u32 s60, s60, s61
buffer_load_dwordx4 v[128:131], v49, s[36:39], s60 offen offset:0
buffer_load_dwordx4 v[132:135], v49, s[36:39], s60 offen offset:128
buffer_load_dwordx4 v[136:139], v49, s[36:39], s60 offen offset:256
buffer_load_dwordx4 v[140:143], v49, s[36:39], s60 offen offset:384
s_and_b32 s45, s2, 3
s_lshr_b32 s46, s2, 3
s_lshr_b32 s62, s2, 4
s_lshl_b32 s62, s62, 0
s_and_b32 s63, s46, 0
s_add_u32 s99, s62, s63
s_lshr_b32 s62, s99, 2
s_lshl_b32 s62, s62, 3
s_and_b32 s63, s99, 3
s_add_u32 s46, s62, s63
s_and_b32 s62, s2, 4
s_add_u32 s46, s46, s62
s_and_b32 s62, s45, 1
s_lshr_b32 s63, s45, 1
s_and_b32 s64, s46, 7
s_lshl_b32 s54, s62, 3
s_add_u32 s54, s54, s64
s_lshr_b32 s64, s46, 3
s_and_b32 s64, s64, 3
s_lshl_b32 s55, s63, 2
s_add_u32 s55, s55, s64
s_lshr_b32 s64, s46, 3
s_lshl_b32 s58, s62, 2
s_add_u32 s58, s58, s64
s_mov_b32 s56, s58
s_and_b32 s64, s46, 7
s_lshl_b32 s59, s63, 3
s_add_u32 s59, s59, s64
s_add_u32 s57, s59, 16
s_lshl_b32 s94, s55, 2
s_lshl_b32 s96, s63, 2
s_and_b32 s64, s46, 3
s_add_u32 s96, s96, s64
s_bfe_u32 s97, s46, 0x10002
s_mov_b32 s12, s78
s_mov_b32 s13, s79
s_mov_b32 s14, 2097152
s_mov_b32 s15, 0x20000
s_mov_b32 s32, s82
s_mov_b32 s33, s83
s_mov_b32 s34, 7340032
s_mov_b32 s35, 0x20000
s_lshr_b32 s72, s44, 1
s_and_b32 s73, s44, 1
s_lshr_b32 s78, s54, 0
s_lshl_b32 s78, s78, 11
s_add_u32 s78, s78, 22020096
s_lshr_b32 s79, s54, 1
s_lshl_b32 s79, s79, 11
s_add_u32 s79, s79, 22020096
s_lshr_b32 s80, s58, 0
s_lshl_b32 s80, s80, 11
s_add_u32 s80, s80, 22020096
v_and_b32 v5, 7, v0
v_lshlrev_b32 v5, 4, v5
v_lshrrev_b32 v19, 3, v0
v_lshl_add_u32 v5, v19, 9, v5
v_lshrrev_b32 v19, 4, v0
v_lshrrev_b32 v48, 2, v0
v_lshlrev_b32 v1, 8, v48
v_and_b32 v49, 7, v48
v_lshl_add_u32 v1, v49, 5, v1
v_and_b32 v49, 3, v0
v_lshl_add_u32 v1, v49, 3, v1
s_lshl_b32 s62, s72, 14
v_add_u32 v2, s62, v1
v_and_b32 v48, 31, v0
v_lshlrev_b32 v3, 8, v48
v_lshrrev_b32 v50, 5, v0
v_and_b32 v48, 15, v0
v_xor_b32 v48, v50, v48
v_lshl_add_u32 v3, v48, 4, v3
v_bfe_u32 v48, v0, 2, 2
v_lshl_add_u32 v4, v50, 2, v48
v_lshlrev_b32 v4, 8, v4
v_lshl_add_u32 v4, v48, 6, v4
v_and_b32 v48, 1, v19
v_lshl_add_u32 v4, v48, 5, v4
v_lshl_add_u32 v4, v49, 3, v4
v_and_b32 v48, 15, v0
v_lshlrev_b32 v49, 1, v19
v_xor_b32 v20, v48, v49
v_lshlrev_b32 v20, 4, v20
v_lshlrev_b32 v49, 2, v19
v_xor_b32 v16, v48, v49
v_lshlrev_b32 v16, 4, v16
v_lshl_add_u32 v16, v19, 8, v16
v_and_b32 v48, 1, v19
v_lshrrev_b32 v49, 1, v19
v_lshl_add_u32 v48, v48, 1, v49
v_and_b32 v49, 15, v0
v_xor_b32 v48, v48, v49
v_lshlrev_b32 v3, 8, v49
v_lshl_add_u32 v3, v48, 4, v3
v_lshl_add_u32 v16, v19, 8, v20
v_xor_b32 v4, 128, v16
s_mul_i32 s62, s72, 8448
v_add_u32 v6, s62, v5
s_mul_i32 s62, s72, 7936
s_add_u32 s62, s62, 256
v_add_u32 v7, s62, v5
v_add_u32 v48, s44, v0
v_min_u32 v48, 1, v48
v_lshlrev_b32 v18, 31, v48
v_mov_b32 v21, 1
s_xor_b32 s62, s44, 3
s_min_u32 s62, s62, 1
s_lshl_b32 s63, s62, 31
v_mov_b32 v22, s63
s_sub_u32 s74, s62, 1
s_mov_b32 s75, s74
s_mov_b32 s76, 22020096
s_lshl_b32 s82, s46, 2
s_add_u32 s82, s82, s45
s_lshl_b32 s82, s82, 2
s_add_u32 s82, s82, s44
v_lshlrev_b32 v64, 7, v0
v_lshrrev_b32 v60, 4, v0
v_lshl_add_u32 v60, v60, 29, v64
s_getpc_b64 s[84:85]
t2_entry_pc:
s_sub_u32 s84, s84, t2_entry_pc-t2_entry
s_subb_u32 s85, s85, 0
s_mov_b32 s86, t2_end-t2_entry
s_mov_b32 s87, 0x20000
s_lshl_b32 s77, s99, 2
s_add_u32 s77, s77, s44
s_lshl_b32 s77, s77, 11
buffer_load_dword v61, v60, s[84:87], s77 offen
s_lshl_b32 s50, s56, 2
s_add_u32 s50, s50, s44
s_mul_i32 s50, s50, 131072
s_add_u32 s50, s50, 0
s_mul_i32 s52, s44, 131072
s_mul_i32 s62, s57, 256
s_add_u32 s52, s52, s62
s_mov_b32 s62, 8192
v_mad_u32_u24 v8, v19, s62, v20
v_xor_b32 v9, 128, v8
v_add_u32 v10, 63488, v8
v_add_u32 v11, 95232, v9
v_add_u32 v9, 31744, v9
v_xor_b32 v24, 0, v1
v_xor_b32 v25, 32, v1
v_xor_b32 v26, 64, v1
v_xor_b32 v27, 96, v1
v_xor_b32 v28, 128, v1
v_xor_b32 v29, 160, v1
v_xor_b32 v30, 192, v1
v_xor_b32 v31, 224, v1
v_xor_b32 v32, 65536, v1
v_xor_b32 v33, 65568, v1
v_xor_b32 v34, 65600, v1
v_xor_b32 v35, 65632, v1
v_xor_b32 v36, 65664, v1
v_xor_b32 v37, 65696, v1
v_xor_b32 v38, 65728, v1
v_xor_b32 v39, 65760, v1
v_and_b32 v72, 7, v0
v_lshlrev_b32 v74, 3, v72
s_lshl_b32 s62, s44, 6
s_add_u32 s62, s62, 131072
v_add_u32 v75, s62, v74
v_lshl_add_u32 v74, v19, 6, v74
v_add_u32 v74, 131072, v74
v_lshlrev_b32 v76, 4, v72
v_lshl_add_u32 v76, v19, 10, v76
v_bfe_u32 v77, v0, 3, 1
v_lshl_add_u32 v76, v77, 12, v76
s_lshr_b32 s60, s2, 3
s_lshl_b32 s60, s60, 17
s_bfe_u32 s62, s2, 0x20001
s_lshl_b32 s62, s62, 7
s_add_u32 s60, s60, s62
s_and_b32 s62, s2, 1
s_lshl_b32 s62, s62, 9
s_add_u32 s60, s60, s62
s_lshl_b32 s62, s44, 15
s_add_u32 s60, s60, s62
s_lshl_b32 s61, s2, 5
s_add_u32 s61, s61, 21495808
v_lshrrev_b32 v77, 3, v0
v_add_u32 v77, s44, v77
v_lshlrev_b32 v77, 26, v77
v_lshl_add_u32 v77, v72, 2, v77
s_and_b32 s64, s2, 0xf0
s_lshl_b32 s63, s2, 8
s_add_u32 s63, s63, 22020096
v_mov_b32 v73, 0
buffer_store_dword v73, v18, s[4:7], s63 offen sc1
s_mov_b32 s62, 0x3f803f80
v_mov_b32 v50, 0
v_mov_b32 v51, 0
v_mov_b32 v52, 0
v_mov_b32 v53, 0
WV 5
v_dot2_f32_bf16 v50, v128, s62, v50
v_dot2_f32_bf16 v52, v128, v128, v52
v_dot2_f32_bf16 v51, v129, s62, v51
v_dot2_f32_bf16 v53, v129, v129, v53
v_dot2_f32_bf16 v50, v130, s62, v50
v_dot2_f32_bf16 v52, v130, v130, v52
v_dot2_f32_bf16 v51, v131, s62, v51
v_dot2_f32_bf16 v53, v131, v131, v53
WV 4
v_dot2_f32_bf16 v50, v132, s62, v50
v_dot2_f32_bf16 v52, v132, v132, v52
v_dot2_f32_bf16 v51, v133, s62, v51
v_dot2_f32_bf16 v53, v133, v133, v53
v_dot2_f32_bf16 v50, v134, s62, v50
v_dot2_f32_bf16 v52, v134, v134, v52
v_dot2_f32_bf16 v51, v135, s62, v51
v_dot2_f32_bf16 v53, v135, v135, v53
WV 3
v_dot2_f32_bf16 v50, v136, s62, v50
v_dot2_f32_bf16 v52, v136, v136, v52
v_dot2_f32_bf16 v51, v137, s62, v51
v_dot2_f32_bf16 v53, v137, v137, v53
v_dot2_f32_bf16 v50, v138, s62, v50
v_dot2_f32_bf16 v52, v138, v138, v52
v_dot2_f32_bf16 v51, v139, s62, v51
v_dot2_f32_bf16 v53, v139, v139, v53
WV 2
v_dot2_f32_bf16 v50, v140, s62, v50
v_dot2_f32_bf16 v52, v140, v140, v52
v_dot2_f32_bf16 v51, v141, s62, v51
v_dot2_f32_bf16 v53, v141, v141, v53
v_dot2_f32_bf16 v50, v142, s62, v50
v_dot2_f32_bf16 v52, v142, v142, v52
v_dot2_f32_bf16 v51, v143, s62, v51
v_dot2_f32_bf16 v53, v143, v143, v53
s_nop 2
v_add_f32 v50, v50, v51
v_add_f32 v51, v52, v53
v_permlane16_swap_b32 v128, v130
v_permlane16_swap_b32 v129, v131
v_add_f32_dpp v50, v50, v50 row_ror:8 row_mask:0xf bank_mask:0xf
v_add_f32_dpp v51, v51, v51 row_ror:8 row_mask:0xf bank_mask:0xf
v_permlane16_swap_b32 v132, v134
v_permlane16_swap_b32 v133, v135
v_mov_b32 v72, v50
v_mov_b32 v73, v51
v_permlane16_swap_b32 v136, v138
v_permlane16_swap_b32 v137, v139
v_permlane16_swap_b32 v50, v72
v_permlane16_swap_b32 v51, v73
v_add_f32 v50, v50, v72
v_add_f32 v51, v51, v73
v_mov_b32 v72, v50
v_mov_b32 v73, v51
v_permlane16_swap_b32 v140, v142
v_permlane16_swap_b32 v141, v143
v_permlane32_swap_b32 v50, v72
v_permlane32_swap_b32 v51, v73
v_add_f32 v50, v50, v72
v_add_f32 v51, v51, v73
ds_write_b64 v75, v[50:51]
v_lshlrev_b32 v144, 16, v128
v_and_b32 v145, 0xffff0000, v128
v_lshlrev_b32 v146, 16, v129
v_and_b32 v147, 0xffff0000, v129
v_lshlrev_b32 v148, 16, v130
v_and_b32 v149, 0xffff0000, v130
v_lshlrev_b32 v150, 16, v131
v_and_b32 v151, 0xffff0000, v131
v_lshlrev_b32 v152, 16, v132
v_and_b32 v153, 0xffff0000, v132
v_lshlrev_b32 v154, 16, v133
v_and_b32 v155, 0xffff0000, v133
WL 0
s_barrier
ds_read_b64 v[50:51], v74
v_lshlrev_b32 v156, 16, v134
v_and_b32 v157, 0xffff0000, v134
v_lshlrev_b32 v158, 16, v135
v_and_b32 v159, 0xffff0000, v135
v_lshlrev_b32 v160, 16, v136
v_and_b32 v161, 0xffff0000, v136
v_lshlrev_b32 v162, 16, v137
v_and_b32 v163, 0xffff0000, v137
v_lshlrev_b32 v164, 16, v138
v_and_b32 v165, 0xffff0000, v138
v_lshlrev_b32 v166, 16, v139
v_and_b32 v167, 0xffff0000, v139
v_lshlrev_b32 v168, 16, v140
v_and_b32 v169, 0xffff0000, v140
v_lshlrev_b32 v170, 16, v141
v_and_b32 v171, 0xffff0000, v141
WL 0
v_mov_b32 v72, v50
v_mov_b32 v73, v51
v_lshlrev_b32 v172, 16, v142
v_and_b32 v173, 0xffff0000, v142
v_permlane16_swap_b32 v50, v72
v_permlane16_swap_b32 v51, v73
v_add_f32 v50, v50, v72
v_add_f32 v51, v51, v73
v_mov_b32 v72, v50
v_mov_b32 v73, v51
v_lshlrev_b32 v174, 16, v143
v_and_b32 v175, 0xffff0000, v143
v_permlane32_swap_b32 v50, v72
v_permlane32_swap_b32 v51, v73
v_add_f32 v50, v50, v72
v_add_f32 v51, v51, v73
v_mul_f32 v50, 0x3a800000, v50
v_mul_f32 v51, 0x3a800000, v51
v_fma_f32 v51, -v50, v50, v51
v_max_f32 v51, 0, v51
v_cvt_pk_bf16_f32 v52, v51, v51
v_lshlrev_b32 v52, 16, v52
v_add_f32 v52, 0x3727c5ac, v52
v_cvt_pk_bf16_f32 v52, v52, v52
v_lshlrev_b32 v52, 16, v52
v_sqrt_f32 v52, v52
s_nop 0
v_cvt_pk_bf16_f32 v52, v52, v52
v_lshlrev_b32 v52, 16, v52
v_rcp_f32 v52, v52
s_nop 0
v_mul_f32 v54, -v50, v52
v_pk_fma_f32 v[144:145], v[144:145], v[52:53], v[54:55] op_sel_hi:[1,0,0]
v_pk_fma_f32 v[146:147], v[146:147], v[52:53], v[54:55] op_sel_hi:[1,0,0]
v_pk_fma_f32 v[148:149], v[148:149], v[52:53], v[54:55] op_sel_hi:[1,0,0]
v_pk_fma_f32 v[150:151], v[150:151], v[52:53], v[54:55] op_sel_hi:[1,0,0]
v_cvt_pk_bf16_f32 v128, v144, v145
v_cvt_pk_bf16_f32 v129, v146, v147
v_cvt_pk_bf16_f32 v130, v148, v149
v_cvt_pk_bf16_f32 v131, v150, v151
buffer_store_dwordx4 v[128:131], v76, s[4:7], s60 offen sc1
s_add_u32 s60, s60, 8192
v_pk_fma_f32 v[152:153], v[152:153], v[52:53], v[54:55] op_sel_hi:[1,0,0]
v_pk_fma_f32 v[154:155], v[154:155], v[52:53], v[54:55] op_sel_hi:[1,0,0]
v_pk_fma_f32 v[156:157], v[156:157], v[52:53], v[54:55] op_sel_hi:[1,0,0]
v_pk_fma_f32 v[158:159], v[158:159], v[52:53], v[54:55] op_sel_hi:[1,0,0]
v_cvt_pk_bf16_f32 v132, v152, v153
v_cvt_pk_bf16_f32 v133, v154, v155
v_cvt_pk_bf16_f32 v134, v156, v157
v_cvt_pk_bf16_f32 v135, v158, v159
buffer_store_dwordx4 v[132:135], v76, s[4:7], s60 offen sc1
s_add_u32 s60, s60, 8192
v_pk_fma_f32 v[160:161], v[160:161], v[52:53], v[54:55] op_sel_hi:[1,0,0]
v_pk_fma_f32 v[162:163], v[162:163], v[52:53], v[54:55] op_sel_hi:[1,0,0]
v_pk_fma_f32 v[164:165], v[164:165], v[52:53], v[54:55] op_sel_hi:[1,0,0]
v_pk_fma_f32 v[166:167], v[166:167], v[52:53], v[54:55] op_sel_hi:[1,0,0]
v_cvt_pk_bf16_f32 v136, v160, v161
v_cvt_pk_bf16_f32 v137, v162, v163
v_cvt_pk_bf16_f32 v138, v164, v165
v_cvt_pk_bf16_f32 v139, v166, v167
buffer_store_dwordx4 v[136:139], v76, s[4:7], s60 offen sc1
s_add_u32 s60, s60, 8192
v_pk_fma_f32 v[168:169], v[168:169], v[52:53], v[54:55] op_sel_hi:[1,0,0]
v_pk_fma_f32 v[170:171], v[170:171], v[52:53], v[54:55] op_sel_hi:[1,0,0]
v_pk_fma_f32 v[172:173], v[172:173], v[52:53], v[54:55] op_sel_hi:[1,0,0]
v_pk_fma_f32 v[174:175], v[174:175], v[52:53], v[54:55] op_sel_hi:[1,0,0]
v_cvt_pk_bf16_f32 v140, v168, v169
v_cvt_pk_bf16_f32 v141, v170, v171
v_cvt_pk_bf16_f32 v142, v172, v173
v_cvt_pk_bf16_f32 v143, v174, v175
buffer_store_dwordx4 v[140:143], v76, s[4:7], s60 offen sc1
s_add_u32 s60, s60, 8192
v_mul_f32 v51, v51, v52
v_mul_f32 v51, v51, v52
v_cvt_pk_bf16_f32 v51, v51, v51
v_lshlrev_b32 v51, 16, v51
v_add_f32 v51, 0x3727c5ac, v51
v_cvt_pk_bf16_f32 v51, v51, v51
v_lshlrev_b32 v51, 16, v51
v_sqrt_f32 v51, v51
s_nop 0
v_cvt_pk_bf16_f32 v51, v51, v51
v_lshlrev_b32 v51, 16, v51
v_rcp_f32 v51, v51
s_nop 0
buffer_store_dword v51, v77, s[4:7], s61 offen sc1
WV 0
s_barrier
buffer_atomic_add v21, v18, s[8:11], s64 offen offset:0
s_add_u32 m0, s48, 0
s_nop 0
DM 8,16,52,0
DM 9,16,52,1024
DM 10,16,52,2048
DM 11,16,52,3072
s_add_u32 s52, s52, 524288
s_add_u32 m0, s48, 32768
s_nop 0
DM 8,16,52,0
DM 9,16,52,1024
DM 10,16,52,2048
DM 11,16,52,3072
s_add_u32 s52, s52, 524288
s_add_u32 m0, s48, 65536
s_nop 0
DM 8,16,52,0
DM 9,16,52,1024
DM 10,16,52,2048
DM 11,16,52,3072
s_add_u32 s52, s52, 524288
s_lshr_b32 s81, s82, 1
s_mul_i32 s81, s81, 8192
s_and_b32 s65, s82, 1
s_mul_i32 s65, s65, 2048
s_add_u32 s81, s81, s65
s_add_u32 s81, s81, 4096
buffer_load_dword v61, v60, s[16:19], s81 offen
s_add_u32 s81, s81, 2097152
buffer_load_dword v61, v60, s[16:19], s81 offen
s_add_u32 s81, s81, 2097152
s_lshl_b32 s63, s56, 1
v_min_u32 v23, 1, v0
v_add_u32 v23, s63, v23
v_and_b32 v23, 15, v23
v_lshl_add_u32 v23, v23, 4, v22
buffer_load_dword v17, v23, s[8:11], 0 offen offset:0 sc1
WV 0
v_cmp_gt_u32 s[68:69], 16, v17
s_nop 0
s_and_b64 s[68:69], s[68:69], s[74:75]
s_cbranch_scc1 t2_slow1
t2_back2:
s_barrier
XL 0,5,4,50,0
XL 4,5,4,50,128
XL 8,5,4,50,256
XL 12,5,4,50,384
s_add_u32 s50, s50, 4096
XL 16,5,4,50,0
XL 20,5,4,50,128
XL 24,5,4,50,256
XL 28,5,4,50,384
s_add_u32 s50, s50, 4096
XL 32,5,4,50,0
XL 36,5,4,50,128
XL 40,5,4,50,256
XL 44,5,4,50,384
s_add_u32 s50, s50, 4096
XL 48,5,4,50,0
XL 52,5,4,50,128
XL 56,5,4,50,256
XL 60,5,4,50,384
s_add_u32 s50, s50, 4096
XL 64,5,4,50,0
XL 68,5,4,50,128
XL 72,5,4,50,256
XL 76,5,4,50,384
s_add_u32 s50, s50, 4096
XL 80,5,4,50,0
XL 84,5,4,50,128
XL 88,5,4,50,256
XL 92,5,4,50,384
s_add_u32 s50, s50, 4096
s_barrier
TR 192,24,0
TR 194,24,4096
TR 196,24,8192
TR 198,24,12288
TR 200,25,0
TR 202,25,4096
TR 204,25,8192
TR 206,25,12288
s_waitcnt vmcnt(16) lgkmcnt(4)
MZ 128,192,0
TR 208,26,0
MA 128,196,16
s_add_u32 m0, s48, 98304
TR 210,26,4096
MZ 160,196,20
DM 8,16,52,0
MA 160,192,4
MZ 192,192,8
TR 212,26,8192
MA 192,196,24
TR 214,26,12288
MZ 224,196,28
DM 9,16,52,1024
MA 224,192,12
WL 4
MZ 228,200,12
TR 216,27,0
MA 228,204,28
TR 218,27,4096
MZ 196,204,24
DM 10,16,52,2048
MA 196,200,8
MZ 164,200,4
TR 220,27,8192
MA 164,204,20
TR 222,27,12288
MZ 132,204,16
MA 132,200,0
WL 4
MZ 136,208,0
TR 192,28,0
MA 136,212,16
TR 194,28,4096
MZ 168,212,20
DM 11,16,52,3072
MA 168,208,4
s_add_u32 s52, s52, 524288
MZ 200,208,8
TR 196,28,8192
MA 200,212,24
TR 198,28,12288
MZ 232,212,28
XL 96,5,4,50,0
MA 232,208,12
WL 4
MZ 236,216,12
TR 200,29,0
MA 236,220,28
TR 202,29,4096
MZ 204,220,24
XL 100,5,4,50,128
MA 204,216,8
MZ 172,216,4
TR 204,29,8192
MA 172,220,20
TR 206,29,12288
MZ 140,220,16
MA 140,216,0
WL 4
MZ 144,192,0
TR 208,30,0
MA 144,196,16
TR 210,30,4096
MZ 176,196,20
XL 104,5,4,50,256
MA 176,192,4
s_lshl_b32 s51, s54, 1
MZ 208,192,8
TR 212,30,8192
MA 208,196,24
TR 214,30,12288
MZ 240,196,28
XL 108,5,4,50,384
MA 240,192,12
s_add_u32 s50, s50, 4096
s_add_u32 s51, s51, s73
WL 4
MZ 244,200,12
TR 216,31,0
MA 244,204,28
TR 218,31,4096
MZ 212,204,24
XL 112,5,4,50,0
MA 212,200,8
s_mul_i32 s51, s51, 131072
MZ 180,200,4
TR 220,31,8192
MA 180,204,20
TR 222,31,12288
MZ 148,204,16
MA 148,200,0
s_add_u32 s51, s51, 8388608
WL 4
MZ 152,208,0
MA 152,212,16
MZ 184,212,20
XL 116,5,4,50,128
MA 184,208,4
s_mul_i32 s53, s44, 65536
WL 0
s_barrier
MZ 216,208,8
TR 192,24,32768
MA 216,212,24
TR 194,24,36864
MZ 248,212,28
XL 120,5,4,50,256
TR 196,24,40960
MA 248,208,12
TR 198,24,45056
s_mul_i32 s62, s94, 64
MZ 252,216,12
TR 200,25,32768
MA 252,220,28
TR 202,25,36864
MZ 220,220,24
XL 124,5,4,50,384
MA 220,216,8
s_add_u32 s50, s50, 4096
s_add_u32 s53, s53, s62
MZ 188,216,4
TR 204,25,40960
MA 188,220,20
TR 206,25,45056
MZ 156,220,16
MA 156,216,0
v_min_u32 v23, 15, v0
s_waitcnt vmcnt(20) lgkmcnt(4)
MA 128,192,32
TR 208,26,32768
MA 128,196,48
s_add_u32 m0, s48, 0
TR 210,26,36864
MA 160,196,52
DM 8,16,52,0
MA 160,192,36
v_and_b32 v23, 15, v23
v_bfe_u32 v59, v0, 4, 1
MA 192,192,40
TR 212,26,40960
MA 192,196,56
TR 214,26,45056
MA 224,196,60
DM 9,16,52,1024
MA 224,192,44
v_lshl_add_u32 v23, v23, 4, v22
s_mov_b32 s65, 3758098432
WL 4
MA 228,200,44
TR 216,27,32768
MA 228,204,60
TR 218,27,36864
MA 196,204,56
DM 10,16,52,2048
MA 196,200,40
s_mov_b32 s62, 2048
v_mul_lo_u32 v59, v59, s65
MA 164,200,36
TR 220,27,40960
MA 164,204,52
TR 222,27,45056
MA 132,204,48
MA 132,200,32
v_mad_u32_u24 v12, v19, s62, v20
v_add_u32 v59, v59, v60
WL 4
MA 136,208,32
TR 192,28,32768
MA 136,212,48
TR 194,28,36864
MA 168,212,52
DM 11,16,52,3072
MA 168,208,36
s_add_u32 s52, s52, 524288
v_xor_b32 v13, 128, v12
s_add_u32 s95, s81, 4294963200
MA 200,208,40
TR 196,28,40960
MA 200,212,56
TR 198,28,45056
MA 232,212,60
XL 0,5,4,50,0
MA 232,208,44
v_add_u32 v14, 14336, v12
buffer_load_dword v61, v59, s[16:19], s95 offen
WL 4
MA 236,216,44
TR 200,29,32768
MA 236,220,60
TR 202,29,36864
MA 204,220,56
XL 4,5,4,50,128
MA 204,216,40
v_add_u32 v15, 21504, v13
MA 172,216,36
TR 204,29,40960
MA 172,220,52
TR 206,29,45056
MA 140,220,48
MA 140,216,32
v_add_u32 v13, 7168, v13
WL 4
MA 144,192,32
TR 208,30,32768
MA 144,196,48
TR 210,30,36864
MA 176,196,52
XL 8,5,4,50,256
MA 176,192,36
MA 208,192,40
TR 212,30,40960
MA 208,196,56
TR 214,30,45056
MA 240,196,60
XL 12,5,4,50,384
MA 240,192,44
s_add_u32 s50, s50, 4096
WL 4
MA 244,200,44
TR 216,31,32768
MA 244,204,60
TR 218,31,36864
MA 212,204,56
XL 16,5,4,50,0
MA 212,200,40
MA 180,200,36
TR 220,31,40960
MA 180,204,52
TR 222,31,45056
MA 148,204,48
MA 148,200,32
WL 4
MA 152,208,32
MA 152,212,48
MA 184,212,52
XL 20,5,4,50,128
MA 184,208,36
WL 0
s_barrier
MA 216,208,40
TR 192,32,0
MA 216,212,56
TR 194,32,4096
MA 248,212,60
XL 24,5,4,50,256
TR 196,32,8192
MA 248,208,44
TR 198,32,12288
MA 252,216,44
TR 200,33,0
MA 252,220,60
TR 202,33,4096
MA 220,220,56
XL 28,5,4,50,384
MA 220,216,40
s_add_u32 s50, s50, 4096
MA 188,216,36
TR 204,33,8192
MA 188,220,52
TR 206,33,12288
MA 156,220,48
MA 156,216,32
s_waitcnt vmcnt(25) lgkmcnt(4)
MA 128,192,64
TR 208,34,0
MA 128,196,80
s_add_u32 m0, s48, 32768
TR 210,34,4096
MA 160,196,84
DM 8,16,52,0
MA 160,192,68
MA 192,192,72
TR 212,34,8192
MA 192,196,88
TR 214,34,12288
MA 224,196,92
DM 9,16,52,1024
MA 224,192,76
WL 4
MA 228,200,76
TR 216,35,0
MA 228,204,92
TR 218,35,4096
MA 196,204,88
DM 10,16,52,2048
MA 196,200,72
MA 164,200,68
TR 220,35,8192
MA 164,204,84
TR 222,35,12288
MA 132,204,80
MA 132,200,64
WL 4
MA 136,208,64
TR 192,36,0
MA 136,212,80
TR 194,36,4096
MA 168,212,84
DM 11,16,52,3072
MA 168,208,68
s_add_u32 s52, s52, 524288
MA 200,208,72
TR 196,36,8192
MA 200,212,88
TR 198,36,12288
MA 232,212,92
XL 32,5,4,50,0
MA 232,208,76
WL 4
MA 236,216,76
TR 200,37,0
MA 236,220,92
TR 202,37,4096
MA 204,220,88
XL 36,5,4,50,128
MA 204,216,72
MA 172,216,68
TR 204,37,8192
MA 172,220,84
TR 206,37,12288
MA 140,220,80
MA 140,216,64
WL 4
MA 144,192,64
TR 208,38,0
MA 144,196,80
TR 210,38,4096
MA 176,196,84
XL 40,5,4,50,256
MA 176,192,68
MA 208,192,72
TR 212,38,8192
MA 208,196,88
TR 214,38,12288
MA 240,196,92
XL 44,5,4,50,384
MA 240,192,76
s_add_u32 s50, s50, 4096
buffer_load_dword v17, v23, s[8:11], 0 offen offset:0 sc1
WL 4
MA 244,200,76
TR 216,39,0
MA 244,204,92
TR 218,39,4096
MA 212,204,88
XL 48,5,4,50,0
MA 212,200,72
MA 180,200,68
TR 220,39,8192
MA 180,204,84
TR 222,39,12288
MA 148,204,80
MA 148,200,64
WL 4
MA 152,208,64
MA 152,212,80
MA 184,212,84
XL 52,5,4,50,128
MA 184,208,68
s_waitcnt vmcnt(32) lgkmcnt(0)
s_barrier
MA 216,208,72
TR 192,32,32768
MA 216,212,88
TR 194,32,36864
MA 248,212,92
XL 56,5,4,50,256
TR 196,32,40960
MA 248,208,76
TR 198,32,45056
MA 252,216,76
TR 200,33,32768
MA 252,220,92
TR 202,33,36864
MA 220,220,88
XL 60,5,4,50,384
MA 220,216,72
s_add_u32 s50, s50, 4096
MA 188,216,68
TR 204,33,40960
MA 188,220,84
TR 206,33,45056
MA 156,220,80
MA 156,216,64
s_waitcnt vmcnt(26) lgkmcnt(4)
MA 128,192,96
TR 208,34,32768
MA 128,196,112
s_add_u32 m0, s48, 65536
TR 210,34,36864
MA 160,196,116
DM 8,16,52,0
MA 160,192,100
v_bfe_u32 v59, v0, 4, 1
MA 192,192,104
TR 212,34,40960
MA 192,196,120
TR 214,34,45056
MA 224,196,124
DM 9,16,52,1024
MA 224,192,108
s_mov_b32 s65, 3760191488
WL 4
MA 228,200,108
TR 216,35,32768
MA 228,204,124
TR 218,35,36864
MA 196,204,120
DM 10,16,52,2048
MA 196,200,104
v_mul_lo_u32 v59, v59, s65
MA 164,200,100
TR 220,35,40960
MA 164,204,116
TR 222,35,45056
MA 132,204,112
MA 132,200,96
v_add_u32 v59, v59, v60
buffer_load_dword v61, v60, s[84:87], s77 offen
WL 4
MA 136,208,96
TR 192,36,32768
MA 136,212,112
TR 194,36,36864
MA 168,212,116
DM 11,16,52,3072
MA 168,208,100
s_add_u32 s52, s52, 524288
s_add_u32 s95, s81, 4290768896
MA 200,208,104
TR 196,36,40960
MA 200,212,120
TR 198,36,45056
MA 232,212,124
XL 64,5,4,50,0
MA 232,208,108
buffer_load_dword v61, v59, s[16:19], s95 offen
WL 4
MA 236,216,108
TR 200,37,32768
MA 236,220,124
TR 202,37,36864
MA 204,220,120
XL 68,5,4,50,128
MA 204,216,104
MA 172,216,100
TR 204,37,40960
MA 172,220,116
TR 206,37,45056
MA 140,220,112
MA 140,216,96
WL 4
MA 144,192,96
TR 208,38,32768
MA 144,196,112
TR 210,38,36864
MA 176,196,116
XL 72,5,4,50,256
MA 176,192,100
MA 208,192,104
TR 212,38,40960
MA 208,196,120
TR 214,38,45056
MA 240,196,124
XL 76,5,4,50,384
MA 240,192,108
s_add_u32 s50, s50, 4096
WL 4
MA 244,200,108
TR 216,39,32768
MA 244,204,124
TR 218,39,36864
MA 212,204,120
XL 80,5,4,50,0
MA 212,200,104
MA 180,200,100
TR 220,39,40960
MA 180,204,116
TR 222,39,45056
MA 148,204,112
MA 148,200,96
WL 4
MA 152,208,96
MA 152,212,112
MA 184,212,116
XL 84,5,4,50,128
MA 184,208,100
WV 16
v_cmp_gt_u32 s[68:69], 16, v17
s_nop 0
s_and_b64 s[68:69], s[68:69], s[74:75]
s_cbranch_scc1 t2_slow3
t2_back4:
WL 0
s_barrier
MA 216,208,104
TR 192,24,0
MA 216,212,120
TR 194,24,4096
MA 248,212,124
XL 88,5,4,50,256
TR 196,24,8192
MA 248,208,108
TR 198,24,12288
MA 252,216,108
TR 200,25,0
MA 252,220,124
TR 202,25,4096
MA 220,220,120
XL 92,5,4,50,384
MA 220,216,104
s_add_u32 s50, s50, 4096
MA 188,216,100
TR 204,25,8192
MA 188,220,116
TR 206,25,12288
MA 156,220,112
MA 156,216,96
WL 4
MA 128,192,0
TR 208,26,0
MA 128,196,16
s_add_u32 m0, s48, 98304
TR 210,26,4096
MA 160,196,20
DM 8,16,52,0
MA 160,192,4
MA 192,192,8
TR 212,26,8192
MA 192,196,24
TR 214,26,12288
MA 224,196,28
DM 9,16,52,1024
MA 224,192,12
WL 4
MA 228,200,12
TR 216,27,0
MA 228,204,28
TR 218,27,4096
MA 196,204,24
DM 10,16,52,2048
MA 196,200,8
MA 164,200,4
TR 220,27,8192
MA 164,204,20
TR 222,27,12288
MA 132,204,16
MA 132,200,0
WL 4
MA 136,208,0
TR 192,28,0
MA 136,212,16
TR 194,28,4096
MA 168,212,20
DM 11,16,52,3072
MA 168,208,4
s_add_u32 s52, s52, 524288
MA 200,208,8
TR 196,28,8192
MA 200,212,24
TR 198,28,12288
MA 232,212,28
XL 96,5,4,50,0
MA 232,208,12
WL 4
MA 236,216,12
TR 200,29,0
MA 236,220,28
TR 202,29,4096
MA 204,220,24
XL 100,5,4,50,128
MA 204,216,8
MA 172,216,4
TR 204,29,8192
MA 172,220,20
TR 206,29,12288
MA 140,220,16
MA 140,216,0
WL 4
MA 144,192,0
TR 208,30,0
MA 144,196,16
TR 210,30,4096
MA 176,196,20
XL 104,5,4,50,256
MA 176,192,4
s_add_u32 s63, s54, 15
MA 208,192,8
TR 212,30,8192
MA 208,196,24
TR 214,30,12288
MA 240,196,28
XL 108,5,4,50,384
MA 240,192,12
s_add_u32 s50, s50, 4096
v_min_u32 v23, 2, v0
WL 4
MA 244,200,12
TR 216,31,0
MA 244,204,28
TR 218,31,4096
MA 212,204,24
XL 112,5,4,50,0
MA 212,200,8
v_add_u32 v23, s63, v23
MA 180,200,4
TR 220,31,8192
MA 180,204,20
TR 222,31,12288
MA 148,204,16
MA 148,200,0
v_and_b32 v23, 15, v23
WL 4
MA 152,208,0
MA 152,212,16
MA 184,212,20
XL 116,5,4,50,128
MA 184,208,4
v_lshl_add_u32 v23, v23, 11, v22
WL 0
s_barrier
MA 216,208,8
TR 192,24,32768
MA 216,212,24
TR 194,24,36864
MA 248,212,28
XL 120,5,4,50,256
TR 196,24,40960
MA 248,208,12
TR 198,24,45056
MA 252,216,12
TR 200,25,32768
MA 252,220,28
TR 202,25,36864
MA 220,220,24
XL 124,5,4,50,384
MA 220,216,8
s_add_u32 s50, s50, 4096
MA 188,216,4
TR 204,25,40960
MA 188,220,20
TR 206,25,45056
MA 156,220,16
MA 156,216,0
s_waitcnt vmcnt(26) lgkmcnt(4)
MA 128,192,32
TR 208,26,32768
MA 128,196,48
s_add_u32 m0, s48, 0
TR 210,26,36864
MA 160,196,52
DM 8,16,52,0
MA 160,192,36
v_bfe_u32 v59, v0, 4, 1
MA 192,192,40
TR 212,26,40960
MA 192,196,56
TR 214,26,45056
MA 224,196,60
DM 9,16,52,1024
MA 224,192,44
s_mov_b32 s65, 3758098432
WL 4
MA 228,200,44
TR 216,27,32768
MA 228,204,60
TR 218,27,36864
MA 196,204,56
DM 10,16,52,2048
MA 196,200,40
v_mul_lo_u32 v59, v59, s65
MA 164,200,36
TR 220,27,40960
MA 164,204,52
TR 222,27,45056
MA 132,204,48
MA 132,200,32
v_add_u32 v59, v59, v60
WL 4
MA 136,208,32
TR 192,28,32768
MA 136,212,48
TR 194,28,36864
MA 168,212,52
DM 11,16,52,3072
MA 168,208,36
s_add_u32 s52, s52, 524288
s_add_u32 s95, s81, 2093056
MA 200,208,40
TR 196,28,40960
MA 200,212,56
TR 198,28,45056
MA 232,212,60
XL 0,5,4,50,0
MA 232,208,44
buffer_load_dword v61, v59, s[16:19], s95 offen
WL 4
MA 236,216,44
TR 200,29,32768
MA 236,220,60
TR 202,29,36864
MA 204,220,56
XL 4,5,4,50,128
MA 204,216,40
MA 172,216,36
TR 204,29,40960
MA 172,220,52
TR 206,29,45056
MA 140,220,48
MA 140,216,32
WL 4
MA 144,192,32
TR 208,30,32768
MA 144,196,48
TR 210,30,36864
MA 176,196,52
XL 8,5,4,50,256
MA 176,192,36
MA 208,192,40
TR 212,30,40960
MA 208,196,56
TR 214,30,45056
MA 240,196,60
XL 12,5,4,50,384
MA 240,192,44
s_add_u32 s50, s50, 4096
WL 4
MA 244,200,44
TR 216,31,32768
MA 244,204,60
TR 218,31,36864
MA 212,204,56
XL 16,5,4,50,0
MA 212,200,40
MA 180,200,36
TR 220,31,40960
MA 180,204,52
TR 222,31,45056
MA 148,204,48
MA 148,200,32
WL 4
MA 152,208,32
MA 152,212,48
MA 184,212,52
XL 20,5,4,50,128
MA 184,208,36
s_waitcnt vmcnt(32) lgkmcnt(0)
s_barrier
MA 216,208,40
TR 192,32,0
MA 216,212,56
TR 194,32,4096
MA 248,212,60
XL 24,5,4,50,256
TR 196,32,8192
MA 248,208,44
TR 198,32,12288
MA 252,216,44
TR 200,33,0
MA 252,220,60
TR 202,33,4096
MA 220,220,56
XL 28,5,4,50,384
MA 220,216,40
s_add_u32 s50, s50, 4096
MA 188,216,36
TR 204,33,8192
MA 188,220,52
TR 206,33,12288
MA 156,220,48
MA 156,216,32
s_waitcnt vmcnt(25) lgkmcnt(4)
MA 128,192,64
TR 208,34,0
MA 128,196,80
s_add_u32 m0, s48, 32768
TR 210,34,4096
MA 160,196,84
DM 8,16,52,0
MA 160,192,68
MA 192,192,72
TR 212,34,8192
MA 192,196,88
TR 214,34,12288
MA 224,196,92
DM 9,16,52,1024
MA 224,192,76
WL 4
MA 228,200,76
TR 216,35,0
MA 228,204,92
TR 218,35,4096
MA 196,204,88
DM 10,16,52,2048
MA 196,200,72
MA 164,200,68
TR 220,35,8192
MA 164,204,84
TR 222,35,12288
MA 132,204,80
MA 132,200,64
WL 4
MA 136,208,64
TR 192,36,0
MA 136,212,80
TR 194,36,4096
MA 168,212,84
DM 11,16,52,3072
MA 168,208,68
s_add_u32 s52, s52, 524288
MA 200,208,72
TR 196,36,8192
MA 200,212,88
TR 198,36,12288
MA 232,212,92
XL 32,5,4,50,0
MA 232,208,76
WL 4
MA 236,216,76
TR 200,37,0
MA 236,220,92
TR 202,37,4096
MA 204,220,88
XL 36,5,4,50,128
MA 204,216,72
MA 172,216,68
TR 204,37,8192
MA 172,220,84
TR 206,37,12288
MA 140,220,80
MA 140,216,64
WL 4
MA 144,192,64
TR 208,38,0
MA 144,196,80
TR 210,38,4096
MA 176,196,84
XL 40,5,4,50,256
MA 176,192,68
MA 208,192,72
TR 212,38,8192
MA 208,196,88
TR 214,38,12288
MA 240,196,92
XL 44,5,4,50,384
MA 240,192,76
s_add_u32 s50, s50, 4096
WL 4
MA 244,200,76
TR 216,39,0
MA 244,204,92
TR 218,39,4096
MA 212,204,88
XL 48,5,4,50,0
MA 212,200,72
MA 180,200,68
TR 220,39,8192
MA 180,204,84
TR 222,39,12288
MA 148,204,80
MA 148,200,64
WL 4
MA 152,208,64
MA 152,212,80
MA 184,212,84
XL 52,5,4,50,128
MA 184,208,68
s_waitcnt vmcnt(31) lgkmcnt(0)
s_barrier
MA 216,208,72
TR 192,32,32768
MA 216,212,88
TR 194,32,36864
MA 248,212,92
XL 56,5,4,50,256
TR 196,32,40960
MA 248,208,76
TR 198,32,45056
MA 252,216,76
TR 200,33,32768
MA 252,220,92
TR 202,33,36864
MA 220,220,88
XL 60,5,4,50,384
MA 220,216,72
s_add_u32 s50, s50, 4096
MA 188,216,68
TR 204,33,40960
MA 188,220,84
TR 206,33,45056
MA 156,220,80
MA 156,216,64
s_waitcnt vmcnt(25) lgkmcnt(4)
MA 128,192,96
TR 208,34,32768
MA 128,196,112
s_add_u32 m0, s48, 65536
TR 210,34,36864
MA 160,196,116
DM 8,16,52,0
MA 160,192,100
MA 192,192,104
TR 212,34,40960
MA 192,196,120
TR 214,34,45056
MA 224,196,124
DM 9,16,52,1024
MA 224,192,108
WL 4
MA 228,200,108
TR 216,35,32768
MA 228,204,124
TR 218,35,36864
MA 196,204,120
DM 10,16,52,2048
MA 196,200,104
MA 164,200,100
TR 220,35,40960
MA 164,204,116
TR 222,35,45056
MA 132,204,112
MA 132,200,96
buffer_load_dword v61, v60, s[84:87], s77 offen
WL 4
MA 136,208,96
TR 192,36,32768
MA 136,212,112
TR 194,36,36864
MA 168,212,116
DM 11,16,52,3072
MA 168,208,100
s_add_u32 s52, s52, 524288
MA 200,208,104
TR 196,36,40960
MA 200,212,120
TR 198,36,45056
MA 232,212,124
XL 64,5,4,50,0
MA 232,208,108
WL 4
MA 236,216,108
TR 200,37,32768
MA 236,220,124
TR 202,37,36864
MA 204,220,120
XL 68,5,4,50,128
MA 204,216,104
MA 172,216,100
TR 204,37,40960
MA 172,220,116
TR 206,37,45056
MA 140,220,112
MA 140,216,96
WL 4
MA 144,192,96
TR 208,38,32768
MA 144,196,112
TR 210,38,36864
MA 176,196,116
XL 72,5,4,50,256
MA 176,192,100
MA 208,192,104
TR 212,38,40960
MA 208,196,120
TR 214,38,45056
MA 240,196,124
XL 76,5,4,50,384
MA 240,192,108
s_add_u32 s50, s50, 4096
WL 4
MA 244,200,108
TR 216,39,32768
MA 244,204,124
TR 218,39,36864
MA 212,204,120
XL 80,5,4,50,0
MA 212,200,104
MA 180,200,100
TR 220,39,40960
MA 180,204,116
TR 222,39,45056
MA 148,204,112
MA 148,200,96
WL 4
MA 152,208,96
MA 152,212,112
MA 184,212,116
XL 84,5,4,50,128
MA 184,208,100
s_waitcnt vmcnt(32) lgkmcnt(0)
s_barrier
MA 216,208,104
TR 192,24,0
MA 216,212,120
TR 194,24,4096
MA 248,212,124
XL 88,5,4,50,256
TR 196,24,8192
MA 248,208,108
TR 198,24,12288
MA 252,216,108
TR 200,25,0
MA 252,220,124
TR 202,25,4096
MA 220,220,120
XL 92,5,4,50,384
MA 220,216,104
s_add_u32 s50, s50, 4096
MA 188,216,100
TR 204,25,8192
MA 188,220,116
TR 206,25,12288
MA 156,220,112
MA 156,216,96
s_waitcnt vmcnt(25) lgkmcnt(4)
MA 128,192,0
TR 208,26,0
MA 128,196,16
s_add_u32 m0, s48, 98304
TR 210,26,4096
MA 160,196,20
DM 8,16,52,0
MA 160,192,4
MA 192,192,8
TR 212,26,8192
MA 192,196,24
TR 214,26,12288
MA 224,196,28
DM 9,16,52,1024
MA 224,192,12
WL 4
MA 228,200,12
TR 216,27,0
MA 228,204,28
TR 218,27,4096
MA 196,204,24
DM 10,16,52,2048
MA 196,200,8
MA 164,200,4
TR 220,27,8192
MA 164,204,20
TR 222,27,12288
MA 132,204,16
MA 132,200,0
WL 4
MA 136,208,0
TR 192,28,0
MA 136,212,16
TR 194,28,4096
MA 168,212,20
DM 11,16,52,3072
MA 168,208,4
s_add_u32 s52, s52, 524288
MA 200,208,8
TR 196,28,8192
MA 200,212,24
TR 198,28,12288
MA 232,212,28
XL 96,5,4,50,0
MA 232,208,12
WL 4
MA 236,216,12
TR 200,29,0
MA 236,220,28
TR 202,29,4096
MA 204,220,24
XL 100,5,4,50,128
MA 204,216,8
MA 172,216,4
TR 204,29,8192
MA 172,220,20
TR 206,29,12288
MA 140,220,16
MA 140,216,0
WL 4
MA 144,192,0
TR 208,30,0
MA 144,196,16
TR 210,30,4096
MA 176,196,20
XL 104,5,4,50,256
MA 176,192,4
MA 208,192,8
TR 212,30,8192
MA 208,196,24
TR 214,30,12288
MA 240,196,28
XL 108,5,4,50,384
MA 240,192,12
s_add_u32 s50, s50, 4096
WL 4
MA 244,200,12
TR 216,31,0
MA 244,204,28
TR 218,31,4096
MA 212,204,24
XL 112,5,4,50,0
MA 212,200,8
MA 180,200,4
TR 220,31,8192
MA 180,204,20
TR 222,31,12288
MA 148,204,16
MA 148,200,0
WL 4
MA 152,208,0
MA 152,212,16
MA 184,212,20
XL 116,5,4,50,128
MA 184,208,4
s_waitcnt vmcnt(31) lgkmcnt(0)
s_barrier
MA 216,208,8
TR 192,24,32768
MA 216,212,24
TR 194,24,36864
MA 248,212,28
XL 120,5,4,50,256
TR 196,24,40960
MA 248,208,12
TR 198,24,45056
MA 252,216,12
TR 200,25,32768
MA 252,220,28
TR 202,25,36864
MA 220,220,24
XL 124,5,4,50,384
MA 220,216,8
s_add_u32 s50, s50, 4096
MA 188,216,4
TR 204,25,40960
MA 188,220,20
TR 206,25,45056
MA 156,220,16
MA 156,216,0
s_waitcnt vmcnt(25) lgkmcnt(4)
MA 128,192,32
TR 208,26,32768
MA 128,196,48
s_add_u32 m0, s48, 0
TR 210,26,36864
MA 160,196,52
DM 8,16,52,0
MA 160,192,36
v_bfe_u32 v59, v0, 4, 1
MA 192,192,40
TR 212,26,40960
MA 192,196,56
TR 214,26,45056
MA 224,196,60
DM 9,16,52,1024
MA 224,192,44
s_mov_b32 s65, 3759142912
WL 4
MA 228,200,44
TR 216,27,32768
MA 228,204,60
TR 218,27,36864
MA 196,204,56
DM 10,16,52,2048
MA 196,200,40
v_mul_lo_u32 v59, v59, s65
MA 164,200,36
TR 220,27,40960
MA 164,204,52
TR 222,27,45056
MA 132,204,48
MA 132,200,32
v_add_u32 v59, v59, v60
WL 4
MA 136,208,32
TR 192,28,32768
MA 136,212,48
TR 194,28,36864
MA 168,212,52
DM 11,16,52,3072
MA 168,208,36
s_add_u32 s52, s52, 524288
s_lshl_b32 s95, s82, 11
MA 200,208,40
TR 196,28,40960
MA 200,212,56
TR 198,28,45056
MA 232,212,60
XL 0,5,4,50,0
MA 232,208,44
buffer_load_dword v61, v59, s[12:15], s95 offen
WL 4
MA 236,216,44
TR 200,29,32768
MA 236,220,60
TR 202,29,36864
MA 204,220,56
XL 4,5,4,50,128
MA 204,216,40
MA 172,216,36
TR 204,29,40960
MA 172,220,52
TR 206,29,45056
MA 140,220,48
MA 140,216,32
WL 4
MA 144,192,32
TR 208,30,32768
MA 144,196,48
TR 210,30,36864
MA 176,196,52
XL 8,5,4,50,256
MA 176,192,36
MA 208,192,40
TR 212,30,40960
MA 208,196,56
TR 214,30,45056
MA 240,196,60
XL 12,5,4,50,384
MA 240,192,44
s_add_u32 s50, s50, 4096
WL 4
MA 244,200,44
TR 216,31,32768
MA 244,204,60
TR 218,31,36864
MA 212,204,56
XL 16,5,4,50,0
MA 212,200,40
MA 180,200,36
TR 220,31,40960
MA 180,204,52
TR 222,31,45056
MA 148,204,48
MA 148,200,32
WL 4
MA 152,208,32
MA 152,212,48
MA 184,212,52
XL 20,5,4,50,128
MA 184,208,36
s_waitcnt vmcnt(31) lgkmcnt(0)
s_barrier
MA 216,208,40
TR 192,32,0
MA 216,212,56
TR 194,32,4096
MA 248,212,60
XL 24,5,4,50,256
TR 196,32,8192
MA 248,208,44
TR 198,32,12288
MA 252,216,44
TR 200,33,0
MA 252,220,60
TR 202,33,4096
MA 220,220,56
XL 28,5,4,50,384
MA 220,216,40
s_add_u32 s50, s50, 4096
MA 188,216,36
TR 204,33,8192
MA 188,220,52
TR 206,33,12288
MA 156,220,48
MA 156,216,32
s_waitcnt vmcnt(25) lgkmcnt(4)
MA 128,192,64
TR 208,34,0
MA 128,196,80
s_add_u32 m0, s48, 32768
TR 210,34,4096
MA 160,196,84
DM 8,16,52,0
MA 160,192,68
MA 192,192,72
TR 212,34,8192
MA 192,196,88
TR 214,34,12288
MA 224,196,92
DM 9,16,52,1024
MA 224,192,76
WL 4
MA 228,200,76
TR 216,35,0
MA 228,204,92
TR 218,35,4096
MA 196,204,88
DM 10,16,52,2048
MA 196,200,72
MA 164,200,68
TR 220,35,8192
MA 164,204,84
TR 222,35,12288
MA 132,204,80
MA 132,200,64
WL 4
MA 136,208,64
TR 192,36,0
MA 136,212,80
TR 194,36,4096
MA 168,212,84
DM 11,16,52,3072
MA 168,208,68
s_add_u32 s52, s52, 524288
MA 200,208,72
TR 196,36,8192
MA 200,212,88
TR 198,36,12288
MA 232,212,92
XL 32,5,4,50,0
MA 232,208,76
WL 4
MA 236,216,76
TR 200,37,0
MA 236,220,92
TR 202,37,4096
MA 204,220,88
XL 36,5,4,50,128
MA 204,216,72
MA 172,216,68
TR 204,37,8192
MA 172,220,84
TR 206,37,12288
MA 140,220,80
MA 140,216,64
WL 4
MA 144,192,64
TR 208,38,0
MA 144,196,80
TR 210,38,4096
MA 176,196,84
XL 40,5,4,50,256
MA 176,192,68
MA 208,192,72
TR 212,38,8192
MA 208,196,88
TR 214,38,12288
MA 240,196,92
XL 44,5,4,50,384
MA 240,192,76
s_add_u32 s50, s50, 4096
WL 4
MA 244,200,76
TR 216,39,0
MA 244,204,92
TR 218,39,4096
MA 212,204,88
XL 48,5,4,50,0
MA 212,200,72
MA 180,200,68
TR 220,39,8192
MA 180,204,84
TR 222,39,12288
MA 148,204,80
MA 148,200,64
WL 4
MA 152,208,64
MA 152,212,80
MA 184,212,84
XL 52,5,4,50,128
MA 184,208,68
s_waitcnt vmcnt(31) lgkmcnt(0)
s_barrier
MA 216,208,72
TR 192,32,32768
MA 216,212,88
TR 194,32,36864
MA 248,212,92
XL 56,5,4,50,256
TR 196,32,40960
MA 248,208,76
TR 198,32,45056
MA 252,216,76
TR 200,33,32768
MA 252,220,92
TR 202,33,36864
MA 220,220,88
XL 60,5,4,50,384
MA 220,216,72
s_add_u32 s50, s50, 4096
MA 188,216,68
TR 204,33,40960
MA 188,220,84
TR 206,33,45056
MA 156,220,80
MA 156,216,64
s_waitcnt vmcnt(25) lgkmcnt(4)
MA 128,192,96
TR 208,34,32768
MA 128,196,112
s_add_u32 m0, s48, 65536
TR 210,34,36864
MA 160,196,116
DM 8,16,52,0
MA 160,192,100
MA 192,192,104
TR 212,34,40960
MA 192,196,120
TR 214,34,45056
MA 224,196,124
DM 9,16,52,1024
MA 224,192,108
WL 4
MA 228,200,108
TR 216,35,32768
MA 228,204,124
TR 218,35,36864
MA 196,204,120
DM 10,16,52,2048
MA 196,200,104
MA 164,200,100
TR 220,35,40960
MA 164,204,116
TR 222,35,45056
MA 132,204,112
MA 132,200,96
buffer_load_dword v61, v60, s[84:87], s77 offen
WL 4
MA 136,208,96
TR 192,36,32768
MA 136,212,112
TR 194,36,36864
MA 168,212,116
DM 11,16,52,3072
MA 168,208,100
s_add_u32 s52, s52, 524288
MA 200,208,104
TR 196,36,40960
MA 200,212,120
TR 198,36,45056
MA 232,212,124
XL 64,5,4,50,0
MA 232,208,108
WL 4
MA 236,216,108
TR 200,37,32768
MA 236,220,124
TR 202,37,36864
MA 204,220,120
XL 68,5,4,50,128
MA 204,216,104
MA 172,216,100
TR 204,37,40960
MA 172,220,116
TR 206,37,45056
MA 140,220,112
MA 140,216,96
WL 4
MA 144,192,96
TR 208,38,32768
MA 144,196,112
TR 210,38,36864
MA 176,196,116
XL 72,5,4,50,256
MA 176,192,100
MA 208,192,104
TR 212,38,40960
MA 208,196,120
TR 214,38,45056
MA 240,196,124
XL 76,5,4,50,384
MA 240,192,108
s_add_u32 s50, s50, 4096
WL 4
MA 244,200,108
TR 216,39,32768
MA 244,204,124
TR 218,39,36864
MA 212,204,120
XL 80,5,4,50,0
MA 212,200,104
MA 180,200,100
TR 220,39,40960
MA 180,204,116
TR 222,39,45056
MA 148,204,112
MA 148,200,96
WL 4
MA 152,208,96
MA 152,212,112
MA 184,212,116
XL 84,5,4,50,128
MA 184,208,100
s_waitcnt vmcnt(32) lgkmcnt(0)
s_barrier
MA 216,208,104
TR 192,24,0
MA 216,212,120
TR 194,24,4096
MA 248,212,124
XL 88,5,4,50,256
TR 196,24,8192
MA 248,208,108
TR 198,24,12288
MA 252,216,108
TR 200,25,0
MA 252,220,124
TR 202,25,4096
MA 220,220,120
XL 92,5,4,50,384
MA 220,216,104
s_add_u32 s50, s50, 4096
MA 188,216,100
TR 204,25,8192
MA 188,220,116
TR 206,25,12288
MA 156,220,112
MA 156,216,96
s_waitcnt vmcnt(25) lgkmcnt(4)
MA 128,192,0
TR 208,26,0
MA 128,196,16
s_add_u32 m0, s48, 98304
TR 210,26,4096
MA 160,196,20
DM 8,16,52,0
MA 160,192,4
MA 192,192,8
TR 212,26,8192
MA 192,196,24
TR 214,26,12288
MA 224,196,28
DM 9,16,52,1024
MA 224,192,12
WL 4
MA 228,200,12
TR 216,27,0
MA 228,204,28
TR 218,27,4096
MA 196,204,24
DM 10,16,52,2048
MA 196,200,8
MA 164,200,4
TR 220,27,8192
MA 164,204,20
TR 222,27,12288
MA 132,204,16
MA 132,200,0
WL 4
MA 136,208,0
TR 192,28,0
MA 136,212,16
TR 194,28,4096
MA 168,212,20
DM 11,16,52,3072
MA 168,208,4
s_add_u32 s52, s52, 524288
MA 200,208,8
TR 196,28,8192
MA 200,212,24
TR 198,28,12288
MA 232,212,28
XL 96,5,4,50,0
MA 232,208,12
WL 4
MA 236,216,12
TR 200,29,0
MA 236,220,28
TR 202,29,4096
MA 204,220,24
XL 100,5,4,50,128
MA 204,216,8
MA 172,216,4
TR 204,29,8192
MA 172,220,20
TR 206,29,12288
MA 140,220,16
MA 140,216,0
WL 4
MA 144,192,0
TR 208,30,0
MA 144,196,16
TR 210,30,4096
MA 176,196,20
XL 104,5,4,50,256
MA 176,192,4
MA 208,192,8
TR 212,30,8192
MA 208,196,24
TR 214,30,12288
MA 240,196,28
XL 108,5,4,50,384
MA 240,192,12
s_add_u32 s50, s50, 4096
buffer_load_dword v17, v23, s[4:7], s76 offen offset:0 sc1
WL 4
MA 244,200,12
TR 216,31,0
MA 244,204,28
TR 218,31,4096
MA 212,204,24
XL 112,5,4,50,0
MA 212,200,8
MA 180,200,4
TR 220,31,8192
MA 180,204,20
TR 222,31,12288
MA 148,204,16
MA 148,200,0
WL 4
MA 152,208,0
MA 152,212,16
MA 184,212,20
XL 116,5,4,50,128
MA 184,208,4
s_waitcnt vmcnt(32) lgkmcnt(0)
s_barrier
MA 216,208,8
TR 192,24,32768
MA 216,212,24
TR 194,24,36864
MA 248,212,28
XL 120,5,4,50,256
TR 196,24,40960
MA 248,208,12
TR 198,24,45056
MA 252,216,12
TR 200,25,32768
MA 252,220,28
TR 202,25,36864
MA 220,220,24
XL 124,5,4,50,384
MA 220,216,8
s_add_u32 s50, s50, 4096
MA 188,216,4
TR 204,25,40960
MA 188,220,20
TR 206,25,45056
MA 156,220,16
MA 156,216,0
s_waitcnt vmcnt(26) lgkmcnt(4)
MA 128,192,32
TR 208,26,32768
MA 128,196,48
s_add_u32 m0, s49, 0
TR 210,26,36864
MA 160,196,52
DM 12,12,53,0
MA 160,192,36
MA 192,192,40
TR 212,26,40960
MA 192,196,56
TR 214,26,45056
MA 224,196,60
MA 224,192,44
WL 4
MA 228,200,44
TR 216,27,32768
MA 228,204,60
TR 218,27,36864
MA 196,204,56
DM 13,12,53,1024
MA 196,200,40
MA 164,200,36
TR 220,27,40960
MA 164,204,52
TR 222,27,45056
MA 132,204,48
MA 132,200,32
WL 4
MA 136,208,32
TR 192,28,32768
MA 136,212,48
TR 194,28,36864
MA 168,212,52
DM 14,12,53,2048
MA 168,208,36
MA 200,208,40
TR 196,28,40960
MA 200,212,56
TR 198,28,45056
MA 232,212,60
MA 232,208,44
WL 4
MA 236,216,44
TR 200,29,32768
MA 236,220,60
TR 202,29,36864
MA 204,220,56
DM 15,12,53,3072
MA 204,216,40
s_add_u32 s53, s53, 32768
MA 172,216,36
TR 204,29,40960
MA 172,220,52
TR 206,29,45056
MA 140,220,48
MA 140,216,32
WL 4
MA 144,192,32
TR 208,30,32768
MA 144,196,48
s_add_u32 m0, s49, 4096
TR 210,30,36864
MA 176,196,52
DM 12,12,53,0
MA 176,192,36
MA 208,192,40
TR 212,30,40960
MA 208,196,56
TR 214,30,45056
MA 240,196,60
MA 240,192,44
WL 4
MA 244,200,44
TR 216,31,32768
MA 244,204,60
TR 218,31,36864
MA 212,204,56
DM 13,12,53,1024
MA 212,200,40
MA 180,200,36
TR 220,31,40960
MA 180,204,52
TR 222,31,45056
MA 148,204,48
MA 148,200,32
WL 4
MA 152,208,32
MA 152,212,48
MA 184,212,52
DM 14,12,53,2048
MA 184,208,36
WV 11
v_cmp_gt_u32 s[68:69], 8, v17
s_nop 0
s_and_b64 s[68:69], s[68:69], s[74:75]
s_cbranch_scc1 t2_slow5
t2_back6:
WL 0
s_barrier
MA 216,208,40
TR 192,32,0
MA 216,212,56
TR 194,32,4096
MA 248,212,60
TR 196,32,8192
MA 248,208,44
TR 198,32,12288
MA 252,216,44
TR 200,33,0
MA 252,220,60
TR 202,33,4096
MA 220,220,56
DM 15,12,53,3072
MA 220,216,40
s_add_u32 s53, s53, 229376
MA 188,216,36
TR 204,33,8192
MA 188,220,52
TR 206,33,12288
MA 156,220,48
MA 156,216,32
WL 4
MA 128,192,64
TR 208,34,0
MA 128,196,80
s_add_u32 m0, s49, 32768
TR 210,34,4096
MA 160,196,84
DM 12,12,53,0
MA 160,192,68
MA 192,192,72
TR 212,34,8192
MA 192,196,88
TR 214,34,12288
MA 224,196,92
DM 13,12,53,1024
MA 224,192,76
WL 4
MA 228,200,76
TR 216,35,0
MA 228,204,92
TR 218,35,4096
MA 196,204,88
DM 14,12,53,2048
MA 196,200,72
MA 164,200,68
TR 220,35,8192
MA 164,204,84
TR 222,35,12288
MA 132,204,80
DM 15,12,53,3072
MA 132,200,64
s_add_u32 s53, s53, 32768
WL 4
MA 136,208,64
TR 192,36,0
MA 136,212,80
s_add_u32 m0, s49, 36864
TR 194,36,4096
MA 168,212,84
DM 12,12,53,0
MA 168,208,68
MA 200,208,72
TR 196,36,8192
MA 200,212,88
TR 198,36,12288
MA 232,212,92
DM 13,12,53,1024
MA 232,208,76
WL 4
MA 236,216,76
TR 200,37,0
MA 236,220,92
TR 202,37,4096
MA 204,220,88
DM 14,12,53,2048
MA 204,216,72
MA 172,216,68
TR 204,37,8192
MA 172,220,84
TR 206,37,12288
MA 140,220,80
DM 15,12,53,3072
MA 140,216,64
s_add_u32 s53, s53, 229376
WL 4
MA 144,192,64
TR 208,38,0
MA 144,196,80
TR 210,38,4096
MA 176,196,84
XL 0,6,4,51,0
MA 176,192,68
v_xor_b32 v24, 0, v2
MA 208,192,72
TR 212,38,8192
MA 208,196,88
TR 214,38,12288
MA 240,196,92
XL 4,6,4,51,128
MA 240,192,76
v_xor_b32 v25, 32, v2
WL 4
MA 244,200,76
TR 216,39,0
MA 244,204,92
TR 218,39,4096
MA 212,204,88
XL 8,7,4,51,0
MA 212,200,72
v_xor_b32 v26, 64, v2
MA 180,200,68
TR 220,39,8192
MA 180,204,84
TR 222,39,12288
MA 148,204,80
XL 12,7,4,51,128
MA 148,200,64
s_add_u32 s51, s51, 4096
v_xor_b32 v27, 96, v2
WL 4
MA 152,208,64
MA 152,212,80
MA 184,212,84
XL 16,6,4,51,0
MA 184,208,68
v_xor_b32 v28, 128, v2
WL 0
s_barrier
MA 216,208,72
TR 192,32,32768
MA 216,212,88
TR 194,32,36864
MA 248,212,92
XL 20,6,4,51,128
TR 196,32,40960
MA 248,208,76
TR 198,32,45056
v_xor_b32 v29, 160, v2
MA 252,216,76
TR 200,33,32768
MA 252,220,92
TR 202,33,36864
MA 220,220,88
XL 24,7,4,51,0
MA 220,216,72
v_xor_b32 v30, 192, v2
MA 188,216,68
TR 204,33,40960
MA 188,220,84
TR 206,33,45056
MA 156,220,80
XL 28,7,4,51,128
MA 156,216,64
s_add_u32 s51, s51, 12288
v_xor_b32 v31, 224, v2
s_waitcnt vmcnt(24) lgkmcnt(4)
MA 128,192,96
TR 208,34,32768
MA 128,196,112
s_add_u32 m0, s49, 65536
TR 210,34,36864
MA 160,196,116
DM 12,12,53,0
MA 160,192,100
MA 192,192,104
TR 212,34,40960
MA 192,196,120
TR 214,34,45056
MA 224,196,124
DM 13,12,53,1024
MA 224,192,108
WL 4
MA 228,200,108
TR 216,35,32768
MA 228,204,124
TR 218,35,36864
MA 196,204,120
DM 14,12,53,2048
MA 196,200,104
MA 164,200,100
TR 220,35,40960
MA 164,204,116
TR 222,35,45056
MA 132,204,112
DM 15,12,53,3072
MA 132,200,96
s_add_u32 s53, s53, 32768
buffer_load_dword v61, v60, s[84:87], s77 offen
WL 4
MA 136,208,96
TR 192,36,32768
MA 136,212,112
s_add_u32 m0, s49, 69632
TR 194,36,36864
MA 168,212,116
DM 12,12,53,0
MA 168,208,100
MA 200,208,104
TR 196,36,40960
MA 200,212,120
TR 198,36,45056
MA 232,212,124
DM 13,12,53,1024
MA 232,208,108
WL 4
MA 236,216,108
TR 200,37,32768
MA 236,220,124
TR 202,37,36864
MA 204,220,120
DM 14,12,53,2048
MA 204,216,104
MA 172,216,100
TR 204,37,40960
MA 172,220,116
TR 206,37,45056
MA 140,220,112
DM 15,12,53,3072
MA 140,216,96
s_add_u32 s53, s53, 229376
WL 4
MA 144,192,96
TR 208,38,32768
MA 144,196,112
TR 210,38,36864
MA 176,196,116
XL 32,6,4,51,0
MA 176,192,100
MA 208,192,104
TR 212,38,40960
MA 208,196,120
TR 214,38,45056
MA 240,196,124
XL 36,6,4,51,128
MA 240,192,108
WL 4
MA 244,200,108
TR 216,39,32768
MA 244,204,124
TR 218,39,36864
MA 212,204,120
XL 40,7,4,51,0
MA 212,200,104
MA 180,200,100
TR 220,39,40960
MA 180,204,116
TR 222,39,45056
MA 148,204,112
XL 44,7,4,51,128
MA 148,200,96
s_add_u32 s51, s51, 4096
WL 4
MA 152,208,96
MA 152,212,112
MA 184,212,116
XL 48,6,4,51,0
MA 184,208,100
s_waitcnt vmcnt(30) lgkmcnt(0)
s_barrier
MA 216,208,104
TR 192,24,0
MA 216,212,120
TR 194,24,4096
MA 248,212,124
XL 52,6,4,51,128
TR 196,24,8192
MA 248,208,108
TR 198,24,12288
MA 252,216,108
TR 200,25,0
MA 252,220,124
TR 202,25,4096
MA 220,220,120
XL 56,7,4,51,0
MA 220,216,104
MA 188,216,100
TR 204,25,8192
MA 188,220,116
TR 206,25,12288
MA 156,220,112
XL 60,7,4,51,128
MA 156,216,96
s_add_u32 s51, s51, 12288
v_mov_b32 v48, 0x3e0293ee
XL 64,6,4,51,0
v_pk_mul_f32 v[128:129], v[128:129], v[48:49] op_sel_hi:[1,0]
v_pk_mul_f32 v[130:131], v[130:131], v[48:49] op_sel_hi:[1,0]
v_pk_mul_f32 v[132:133], v[132:133], v[48:49] op_sel_hi:[1,0]
v_pk_mul_f32 v[134:135], v[134:135], v[48:49] op_sel_hi:[1,0]
v_cvt_pk_bf16_f32 v64, v128, v129
v_cvt_pk_bf16_f32 v65, v130, v131
v_cvt_pk_bf16_f32 v66, v132, v133
v_cvt_pk_bf16_f32 v67, v134, v135
v_pk_mul_f32 v[136:137], v[136:137], v[48:49] op_sel_hi:[1,0]
v_pk_mul_f32 v[138:139], v[138:139], v[48:49] op_sel_hi:[1,0]
v_pk_mul_f32 v[140:141], v[140:141], v[48:49] op_sel_hi:[1,0]
v_pk_mul_f32 v[142:143], v[142:143], v[48:49] op_sel_hi:[1,0]
XL 68,6,4,51,128
v_cvt_pk_bf16_f32 v68, v136, v137
v_cvt_pk_bf16_f32 v69, v138, v139
v_cvt_pk_bf16_f32 v70, v140, v141
v_cvt_pk_bf16_f32 v71, v142, v143
v_permlane16_swap_b32 v64, v66
v_permlane16_swap_b32 v65, v67
v_permlane16_swap_b32 v68, v70
v_permlane16_swap_b32 v69, v71
v_accvgpr_write_b32 a128, v64
v_accvgpr_write_b32 a129, v65
v_accvgpr_write_b32 a130, v66
v_accvgpr_write_b32 a131, v67
XL 72,7,4,51,0
v_accvgpr_write_b32 a132, v68
v_accvgpr_write_b32 a133, v69
v_accvgpr_write_b32 a134, v70
v_accvgpr_write_b32 a135, v71
v_pk_mul_f32 v[144:145], v[144:145], v[48:49] op_sel_hi:[1,0]
v_pk_mul_f32 v[146:147], v[146:147], v[48:49] op_sel_hi:[1,0]
v_pk_mul_f32 v[148:149], v[148:149], v[48:49] op_sel_hi:[1,0]
v_pk_mul_f32 v[150:151], v[150:151], v[48:49] op_sel_hi:[1,0]
v_cvt_pk_bf16_f32 v72, v144, v145
v_cvt_pk_bf16_f32 v73, v146, v147
v_cvt_pk_bf16_f32 v74, v148, v149
v_cvt_pk_bf16_f32 v75, v150, v151
XL 76,7,4,51,128
s_add_u32 s51, s51, 4096
v_pk_mul_f32 v[152:153], v[152:153], v[48:49] op_sel_hi:[1,0]
v_pk_mul_f32 v[154:155], v[154:155], v[48:49] op_sel_hi:[1,0]
v_pk_mul_f32 v[156:157], v[156:157], v[48:49] op_sel_hi:[1,0]
v_pk_mul_f32 v[158:159], v[158:159], v[48:49] op_sel_hi:[1,0]
v_cvt_pk_bf16_f32 v76, v152, v153
v_cvt_pk_bf16_f32 v77, v154, v155
v_cvt_pk_bf16_f32 v78, v156, v157
v_cvt_pk_bf16_f32 v79, v158, v159
v_permlane16_swap_b32 v72, v74
v_permlane16_swap_b32 v73, v75
v_permlane16_swap_b32 v76, v78
v_permlane16_swap_b32 v77, v79
XL 80,6,4,51,0
v_accvgpr_write_b32 a136, v72
v_accvgpr_write_b32 a137, v73
v_accvgpr_write_b32 a138, v74
v_accvgpr_write_b32 a139, v75
v_accvgpr_write_b32 a140, v76
v_accvgpr_write_b32 a141, v77
v_accvgpr_write_b32 a142, v78
v_accvgpr_write_b32 a143, v79
v_pk_mul_f32 v[160:161], v[160:161], v[48:49] op_sel_hi:[1,0]
v_pk_mul_f32 v[162:163], v[162:163], v[48:49] op_sel_hi:[1,0]
v_pk_mul_f32 v[164:165], v[164:165], v[48:49] op_sel_hi:[1,0]
v_pk_mul_f32 v[166:167], v[166:167], v[48:49] op_sel_hi:[1,0]
XL 84,6,4,51,128
v_cvt_pk_bf16_f32 v64, v160, v161
v_cvt_pk_bf16_f32 v65, v162, v163
v_cvt_pk_bf16_f32 v66, v164, v165
v_cvt_pk_bf16_f32 v67, v166, v167
v_pk_mul_f32 v[168:169], v[168:169], v[48:49] op_sel_hi:[1,0]
v_pk_mul_f32 v[170:171], v[170:171], v[48:49] op_sel_hi:[1,0]
v_pk_mul_f32 v[172:173], v[172:173], v[48:49] op_sel_hi:[1,0]
v_pk_mul_f32 v[174:175], v[174:175], v[48:49] op_sel_hi:[1,0]
v_cvt_pk_bf16_f32 v68, v168, v169
v_cvt_pk_bf16_f32 v69, v170, v171
v_cvt_pk_bf16_f32 v70, v172, v173
v_cvt_pk_bf16_f32 v71, v174, v175
XL 88,7,4,51,0
v_permlane16_swap_b32 v64, v66
v_permlane16_swap_b32 v65, v67
v_permlane16_swap_b32 v68, v70
v_permlane16_swap_b32 v69, v71
v_accvgpr_write_b32 a144, v64
v_accvgpr_write_b32 a145, v65
v_accvgpr_write_b32 a146, v66
v_accvgpr_write_b32 a147, v67
v_accvgpr_write_b32 a148, v68
v_accvgpr_write_b32 a149, v69
v_accvgpr_write_b32 a150, v70
v_accvgpr_write_b32 a151, v71
XL 92,7,4,51,128
s_add_u32 s51, s51, 12288
v_pk_mul_f32 v[176:177], v[176:177], v[48:49] op_sel_hi:[1,0]
v_pk_mul_f32 v[178:179], v[178:179], v[48:49] op_sel_hi:[1,0]
v_pk_mul_f32 v[180:181], v[180:181], v[48:49] op_sel_hi:[1,0]
v_pk_mul_f32 v[182:183], v[182:183], v[48:49] op_sel_hi:[1,0]
v_cvt_pk_bf16_f32 v72, v176, v177
v_cvt_pk_bf16_f32 v73, v178, v179
v_cvt_pk_bf16_f32 v74, v180, v181
v_cvt_pk_bf16_f32 v75, v182, v183
v_pk_mul_f32 v[184:185], v[184:185], v[48:49] op_sel_hi:[1,0]
v_pk_mul_f32 v[186:187], v[186:187], v[48:49] op_sel_hi:[1,0]
v_pk_mul_f32 v[188:189], v[188:189], v[48:49] op_sel_hi:[1,0]
v_pk_mul_f32 v[190:191], v[190:191], v[48:49] op_sel_hi:[1,0]
s_add_u32 m0, s49, 98304
s_nop 0
DM 12,12,53,0
v_cvt_pk_bf16_f32 v76, v184, v185
v_cvt_pk_bf16_f32 v77, v186, v187
v_cvt_pk_bf16_f32 v78, v188, v189
v_cvt_pk_bf16_f32 v79, v190, v191
v_permlane16_swap_b32 v72, v74
v_permlane16_swap_b32 v73, v75
v_permlane16_swap_b32 v76, v78
v_permlane16_swap_b32 v77, v79
v_accvgpr_write_b32 a152, v72
v_accvgpr_write_b32 a153, v73
v_accvgpr_write_b32 a154, v74
v_accvgpr_write_b32 a155, v75
DM 13,12,53,1024
v_accvgpr_write_b32 a156, v76
v_accvgpr_write_b32 a157, v77
v_accvgpr_write_b32 a158, v78
v_accvgpr_write_b32 a159, v79
v_pk_mul_f32 v[192:193], v[192:193], v[48:49] op_sel_hi:[1,0]
v_pk_mul_f32 v[194:195], v[194:195], v[48:49] op_sel_hi:[1,0]
v_pk_mul_f32 v[196:197], v[196:197], v[48:49] op_sel_hi:[1,0]
v_pk_mul_f32 v[198:199], v[198:199], v[48:49] op_sel_hi:[1,0]
v_cvt_pk_bf16_f32 v64, v192, v193
v_cvt_pk_bf16_f32 v65, v194, v195
v_cvt_pk_bf16_f32 v66, v196, v197
v_cvt_pk_bf16_f32 v67, v198, v199
DM 14,12,53,2048
v_pk_mul_f32 v[200:201], v[200:201], v[48:49] op_sel_hi:[1,0]
v_pk_mul_f32 v[202:203], v[202:203], v[48:49] op_sel_hi:[1,0]
v_pk_mul_f32 v[204:205], v[204:205], v[48:49] op_sel_hi:[1,0]
v_pk_mul_f32 v[206:207], v[206:207], v[48:49] op_sel_hi:[1,0]
v_cvt_pk_bf16_f32 v68, v200, v201
v_cvt_pk_bf16_f32 v69, v202, v203
v_cvt_pk_bf16_f32 v70, v204, v205
v_cvt_pk_bf16_f32 v71, v206, v207
v_permlane16_swap_b32 v64, v66
v_permlane16_swap_b32 v65, v67
v_permlane16_swap_b32 v68, v70
v_permlane16_swap_b32 v69, v71
DM 15,12,53,3072
s_add_u32 s53, s53, 32768
v_accvgpr_write_b32 a160, v64
v_accvgpr_write_b32 a161, v65
v_accvgpr_write_b32 a162, v66
v_accvgpr_write_b32 a163, v67
v_accvgpr_write_b32 a164, v68
v_accvgpr_write_b32 a165, v69
v_accvgpr_write_b32 a166, v70
v_accvgpr_write_b32 a167, v71
v_pk_mul_f32 v[208:209], v[208:209], v[48:49] op_sel_hi:[1,0]
v_pk_mul_f32 v[210:211], v[210:211], v[48:49] op_sel_hi:[1,0]
v_pk_mul_f32 v[212:213], v[212:213], v[48:49] op_sel_hi:[1,0]
v_pk_mul_f32 v[214:215], v[214:215], v[48:49] op_sel_hi:[1,0]
s_add_u32 m0, s49, 102400
s_nop 0
DM 12,12,53,0
v_cvt_pk_bf16_f32 v72, v208, v209
v_cvt_pk_bf16_f32 v73, v210, v211
v_cvt_pk_bf16_f32 v74, v212, v213
v_cvt_pk_bf16_f32 v75, v214, v215
v_pk_mul_f32 v[216:217], v[216:217], v[48:49] op_sel_hi:[1,0]
v_pk_mul_f32 v[218:219], v[218:219], v[48:49] op_sel_hi:[1,0]
v_pk_mul_f32 v[220:221], v[220:221], v[48:49] op_sel_hi:[1,0]
v_pk_mul_f32 v[222:223], v[222:223], v[48:49] op_sel_hi:[1,0]
v_cvt_pk_bf16_f32 v76, v216, v217
v_cvt_pk_bf16_f32 v77, v218, v219
v_cvt_pk_bf16_f32 v78, v220, v221
v_cvt_pk_bf16_f32 v79, v222, v223
DM 13,12,53,1024
v_permlane16_swap_b32 v72, v74
v_permlane16_swap_b32 v73, v75
v_permlane16_swap_b32 v76, v78
v_permlane16_swap_b32 v77, v79
v_accvgpr_write_b32 a168, v72
v_accvgpr_write_b32 a169, v73
v_accvgpr_write_b32 a170, v74
v_accvgpr_write_b32 a171, v75
v_accvgpr_write_b32 a172, v76
v_accvgpr_write_b32 a173, v77
v_accvgpr_write_b32 a174, v78
v_accvgpr_write_b32 a175, v79
DM 14,12,53,2048
v_pk_mul_f32 v[224:225], v[224:225], v[48:49] op_sel_hi:[1,0]
v_pk_mul_f32 v[226:227], v[226:227], v[48:49] op_sel_hi:[1,0]
v_pk_mul_f32 v[228:229], v[228:229], v[48:49] op_sel_hi:[1,0]
v_pk_mul_f32 v[230:231], v[230:231], v[48:49] op_sel_hi:[1,0]
v_cvt_pk_bf16_f32 v64, v224, v225
v_cvt_pk_bf16_f32 v65, v226, v227
v_cvt_pk_bf16_f32 v66, v228, v229
v_cvt_pk_bf16_f32 v67, v230, v231
v_pk_mul_f32 v[232:233], v[232:233], v[48:49] op_sel_hi:[1,0]
v_pk_mul_f32 v[234:235], v[234:235], v[48:49] op_sel_hi:[1,0]
v_pk_mul_f32 v[236:237], v[236:237], v[48:49] op_sel_hi:[1,0]
v_pk_mul_f32 v[238:239], v[238:239], v[48:49] op_sel_hi:[1,0]
DM 15,12,53,3072
s_add_u32 s53, s53, 229376
v_cvt_pk_bf16_f32 v68, v232, v233
v_cvt_pk_bf16_f32 v69, v234, v235
v_cvt_pk_bf16_f32 v70, v236, v237
v_cvt_pk_bf16_f32 v71, v238, v239
v_permlane16_swap_b32 v64, v66
v_permlane16_swap_b32 v65, v67
v_permlane16_swap_b32 v68, v70
v_permlane16_swap_b32 v69, v71
v_accvgpr_write_b32 a176, v64
v_accvgpr_write_b32 a177, v65
v_accvgpr_write_b32 a178, v66
v_accvgpr_write_b32 a179, v67
v_accvgpr_write_b32 a180, v68
v_accvgpr_write_b32 a181, v69
v_accvgpr_write_b32 a182, v70
v_accvgpr_write_b32 a183, v71
v_pk_mul_f32 v[240:241], v[240:241], v[48:49] op_sel_hi:[1,0]
v_pk_mul_f32 v[242:243], v[242:243], v[48:49] op_sel_hi:[1,0]
v_pk_mul_f32 v[244:245], v[244:245], v[48:49] op_sel_hi:[1,0]
v_pk_mul_f32 v[246:247], v[246:247], v[48:49] op_sel_hi:[1,0]
v_cvt_pk_bf16_f32 v72, v240, v241
v_cvt_pk_bf16_f32 v73, v242, v243
v_cvt_pk_bf16_f32 v74, v244, v245
v_cvt_pk_bf16_f32 v75, v246, v247
v_pk_mul_f32 v[248:249], v[248:249], v[48:49] op_sel_hi:[1,0]
v_pk_mul_f32 v[250:251], v[250:251], v[48:49] op_sel_hi:[1,0]
v_pk_mul_f32 v[252:253], v[252:253], v[48:49] op_sel_hi:[1,0]
v_pk_mul_f32 v[254:255], v[254:255], v[48:49] op_sel_hi:[1,0]
v_cvt_pk_bf16_f32 v76, v248, v249
v_cvt_pk_bf16_f32 v77, v250, v251
v_cvt_pk_bf16_f32 v78, v252, v253
v_cvt_pk_bf16_f32 v79, v254, v255
v_permlane16_swap_b32 v72, v74
v_permlane16_swap_b32 v73, v75
v_permlane16_swap_b32 v76, v78
v_permlane16_swap_b32 v77, v79
v_accvgpr_write_b32 a184, v72
v_accvgpr_write_b32 a185, v73
v_accvgpr_write_b32 a186, v74
v_accvgpr_write_b32 a187, v75
v_accvgpr_write_b32 a188, v76
v_accvgpr_write_b32 a189, v77
v_accvgpr_write_b32 a190, v78
v_accvgpr_write_b32 a191, v79
s_waitcnt vmcnt(33) lgkmcnt(4)
MZ 128,192,0
TR 208,26,0
MA 128,196,16
TR 210,26,4096
MZ 160,196,20
XL 96,6,4,51,0
MA 160,192,4
v_xor_b32 v32, 65536, v2
MZ 192,192,8
TR 212,26,8192
MA 192,196,24
TR 214,26,12288
MZ 224,196,28
MA 224,192,12
v_xor_b32 v33, 65568, v2
WL 4
MZ 228,200,12
TR 216,27,0
MA 228,204,28
TR 218,27,4096
MZ 196,204,24
XL 100,6,4,51,128
MA 196,200,8
v_xor_b32 v34, 65600, v2
MZ 164,200,4
TR 220,27,8192
MA 164,204,20
TR 222,27,12288
MZ 132,204,16
MA 132,200,0
v_xor_b32 v35, 65632, v2
WL 4
MZ 136,208,0
TR 192,28,0
MA 136,212,16
TR 194,28,4096
MZ 168,212,20
XL 104,7,4,51,0
MA 168,208,4
v_xor_b32 v36, 65664, v2
MZ 200,208,8
TR 196,28,8192
MA 200,212,24
TR 198,28,12288
MZ 232,212,28
MA 232,208,12
v_xor_b32 v37, 65696, v2
WL 4
MZ 236,216,12
TR 200,29,0
MA 236,220,28
TR 202,29,4096
MZ 204,220,24
XL 108,7,4,51,128
MA 204,216,8
s_add_u32 s51, s51, 4096
v_xor_b32 v38, 65728, v2
MZ 172,216,4
TR 204,29,8192
MA 172,220,20
TR 206,29,12288
MZ 140,220,16
MA 140,216,0
v_xor_b32 v39, 65760, v2
WL 4
MZ 144,192,0
TR 208,30,0
MA 144,196,16
TR 210,30,4096
MZ 176,196,20
XL 112,6,4,51,0
MA 176,192,4
s_lshr_b32 s52, s57, 3
MZ 208,192,8
TR 212,30,8192
MA 208,196,24
TR 214,30,12288
MZ 240,196,28
MA 240,192,12
s_lshl_b32 s52, s52, 19
WL 4
MZ 244,200,12
TR 216,31,0
MA 244,204,28
TR 218,31,4096
MZ 212,204,24
XL 116,6,4,51,128
MA 212,200,8
s_add_u32 s52, s52, s48
MZ 180,200,4
TR 220,31,8192
MA 180,204,20
TR 222,31,12288
MZ 148,204,16
MA 148,200,0
s_add_u32 s52, s52, 393216
WL 4
MZ 152,208,0
MA 152,212,16
MZ 184,212,20
XL 120,7,4,51,0
MA 184,208,4
v_and_b32 v8, 15, v0
WL 0
s_barrier
MZ 216,208,8
TR 192,24,32768
MA 216,212,24
TR 194,24,36864
MZ 248,212,28
TR 196,24,40960
MA 248,208,12
TR 198,24,45056
v_xor_b32 v8, v19, v8
MZ 252,216,12
TR 200,25,32768
MA 252,220,28
TR 202,25,36864
MZ 220,220,24
XL 124,7,4,51,128
MA 220,216,8
s_add_u32 s51, s51, 12288
v_lshlrev_b32 v8, 4, v8
MZ 188,216,4
TR 204,25,40960
MA 188,220,20
TR 206,25,45056
MZ 156,220,16
MA 156,216,0
v_lshl_add_u32 v8, v19, 8, v8
s_waitcnt vmcnt(24) lgkmcnt(4)
MA 128,192,32
TR 208,26,32768
MA 128,196,48
s_add_u32 m0, s49, 0
TR 210,26,36864
MA 160,196,52
DM 12,12,53,0
MA 160,192,36
v_xor_b32 v9, 64, v8
MA 192,192,40
TR 212,26,40960
MA 192,196,56
TR 214,26,45056
MA 224,196,60
DM 13,12,53,1024
MA 224,192,44
v_xor_b32 v10, 128, v8
WL 4
MA 228,200,44
TR 216,27,32768
MA 228,204,60
TR 218,27,36864
MA 196,204,56
DM 14,12,53,2048
MA 196,200,40
v_xor_b32 v11, 192, v8
MA 164,200,36
TR 220,27,40960
MA 164,204,52
TR 222,27,45056
MA 132,204,48
DM 15,12,53,3072
MA 132,200,32
s_add_u32 s53, s53, 32768
WL 4
MA 136,208,32
TR 192,28,32768
MA 136,212,48
s_add_u32 m0, s49, 4096
TR 194,28,36864
MA 168,212,52
DM 12,12,53,0
MA 168,208,36
MA 200,208,40
TR 196,28,40960
MA 200,212,56
TR 198,28,45056
MA 232,212,60
DM 13,12,53,1024
MA 232,208,44
WL 4
MA 236,216,44
TR 200,29,32768
MA 236,220,60
TR 202,29,36864
MA 204,220,56
DM 14,12,53,2048
MA 204,216,40
MA 172,216,36
TR 204,29,40960
MA 172,220,52
TR 206,29,45056
MA 140,220,48
DM 15,12,53,3072
MA 140,216,32
s_add_u32 s53, s53, 229376
WL 4
MA 144,192,32
TR 208,30,32768
MA 144,196,48
TR 210,30,36864
MA 176,196,52
XL 0,6,4,51,0
MA 176,192,36
s_lshr_b32 s81, s82, 6
MA 208,192,40
TR 212,30,40960
MA 208,196,56
TR 214,30,45056
MA 240,196,60
XL 4,6,4,51,128
MA 240,192,44
s_add_u32 s81, s81, 2
WL 4
MA 244,200,44
TR 216,31,32768
MA 244,204,60
TR 218,31,36864
MA 212,204,56
XL 8,7,4,51,0
MA 212,200,40
s_lshl_b32 s81, s81, 19
MA 180,200,36
TR 220,31,40960
MA 180,204,52
TR 222,31,45056
MA 148,204,48
XL 12,7,4,51,128
MA 148,200,32
s_add_u32 s51, s51, 4096
s_and_b32 s65, s82, 63
WL 4
MA 152,208,32
MA 152,212,48
MA 184,212,52
XL 16,6,4,51,0
MA 184,208,36
s_lshl_b32 s65, s65, 11
WL 0
s_barrier
MA 216,208,40
TR 192,32,0
MA 216,212,56
TR 194,32,4096
MA 248,212,60
XL 20,6,4,51,128
TR 196,32,8192
MA 248,208,44
TR 198,32,12288
s_add_u32 s81, s81, s65
MA 252,216,44
TR 200,33,0
MA 252,220,60
TR 202,33,4096
MA 220,220,56
XL 24,7,4,51,0
MA 220,216,40
s_add_u32 s81, s81, 393216
MA 188,216,36
TR 204,33,8192
MA 188,220,52
TR 206,33,12288
MA 156,220,48
XL 28,7,4,51,128
MA 156,216,32
s_add_u32 s51, s51, 12288
s_lshr_b32 s65, s82, 7
s_waitcnt vmcnt(32) lgkmcnt(4)
MA 128,192,64
TR 208,34,0
MA 128,196,80
s_add_u32 m0, s49, 32768
TR 210,34,4096
MA 160,196,84
DM 12,12,53,0
MA 160,192,68
s_lshl_b32 s65, s65, 30
MA 192,192,72
TR 212,34,8192
MA 192,196,88
TR 214,34,12288
MA 224,196,92
DM 13,12,53,1024
MA 224,192,76
s_add_u32 s81, s81, s65
WL 4
MA 228,200,76
TR 216,35,0
MA 228,204,92
TR 218,35,4096
MA 196,204,88
DM 14,12,53,2048
MA 196,200,72
buffer_load_dword v61, v60, s[20:23], s81 offen
MA 164,200,68
TR 220,35,8192
MA 164,204,84
TR 222,35,12288
MA 132,204,80
DM 15,12,53,3072
MA 132,200,64
s_add_u32 s53, s53, 32768
buffer_load_dword v61, v60, s[24:27], s81 offen
WL 4
MA 136,208,64
TR 192,36,0
MA 136,212,80
s_add_u32 m0, s49, 36864
TR 194,36,4096
MA 168,212,84
DM 12,12,53,0
MA 168,208,68
MA 200,208,72
TR 196,36,8192
MA 200,212,88
TR 198,36,12288
MA 232,212,92
DM 13,12,53,1024
MA 232,208,76
WL 4
MA 236,216,76
TR 200,37,0
MA 236,220,92
TR 202,37,4096
MA 204,220,88
DM 14,12,53,2048
MA 204,216,72
MA 172,216,68
TR 204,37,8192
MA 172,220,84
TR 206,37,12288
MA 140,220,80
DM 15,12,53,3072
MA 140,216,64
s_add_u32 s53, s53, 229376
WL 4
MA 144,192,64
TR 208,38,0
MA 144,196,80
TR 210,38,4096
MA 176,196,84
XL 32,6,4,51,0
MA 176,192,68
MA 208,192,72
TR 212,38,8192
MA 208,196,88
TR 214,38,12288
MA 240,196,92
XL 36,6,4,51,128
MA 240,192,76
WL 4
MA 244,200,76
TR 216,39,0
MA 244,204,92
TR 218,39,4096
MA 212,204,88
XL 40,7,4,51,0
MA 212,200,72
MA 180,200,68
TR 220,39,8192
MA 180,204,84
TR 222,39,12288
MA 148,204,80
XL 44,7,4,51,128
MA 148,200,64
s_add_u32 s51, s51, 4096
WL 4
MA 152,208,64
MA 152,212,80
MA 184,212,84
XL 48,6,4,51,0
MA 184,208,68
s_waitcnt vmcnt(39) lgkmcnt(0)
s_barrier
MA 216,208,72
TR 192,32,32768
MA 216,212,88
TR 194,32,36864
MA 248,212,92
XL 52,6,4,51,128
TR 196,32,40960
MA 248,208,76
TR 198,32,45056
MA 252,216,76
TR 200,33,32768
MA 252,220,92
TR 202,33,36864
MA 220,220,88
XL 56,7,4,51,0
MA 220,216,72
MA 188,216,68
TR 204,33,40960
MA 188,220,84
TR 206,33,45056
MA 156,220,80
XL 60,7,4,51,128
MA 156,216,64
s_add_u32 s51, s51, 12288
s_waitcnt vmcnt(34) lgkmcnt(4)
MA 128,192,96
TR 208,34,32768
MA 128,196,112
s_add_u32 m0, s49, 65536
TR 210,34,36864
MA 160,196,116
DM 12,12,53,0
MA 160,192,100
MA 192,192,104
TR 212,34,40960
MA 192,196,120
TR 214,34,45056
MA 224,196,124
DM 13,12,53,1024
MA 224,192,108
WL 4
MA 228,200,108
TR 216,35,32768
MA 228,204,124
TR 218,35,36864
MA 196,204,120
DM 14,12,53,2048
MA 196,200,104
MA 164,200,100
TR 220,35,40960
MA 164,204,116
TR 222,35,45056
MA 132,204,112
DM 15,12,53,3072
MA 132,200,96
s_add_u32 s53, s53, 32768
buffer_load_dword v61, v60, s[84:87], s77 offen
WL 4
MA 136,208,96
TR 192,36,32768
MA 136,212,112
s_add_u32 m0, s49, 69632
TR 194,36,36864
MA 168,212,116
DM 12,12,53,0
MA 168,208,100
MA 200,208,104
TR 196,36,40960
MA 200,212,120
TR 198,36,45056
MA 232,212,124
DM 13,12,53,1024
MA 232,208,108
WL 4
MA 236,216,108
TR 200,37,32768
MA 236,220,124
TR 202,37,36864
MA 204,220,120
DM 14,12,53,2048
MA 204,216,104
MA 172,216,100
TR 204,37,40960
MA 172,220,116
TR 206,37,45056
MA 140,220,112
DM 15,12,53,3072
MA 140,216,96
s_add_u32 s53, s53, 229376
WL 4
MA 144,192,96
TR 208,38,32768
MA 144,196,112
TR 210,38,36864
MA 176,196,116
XL 64,6,4,51,0
MA 176,192,100
MA 208,192,104
TR 212,38,40960
MA 208,196,120
TR 214,38,45056
MA 240,196,124
XL 68,6,4,51,128
MA 240,192,108
WL 4
MA 244,200,108
TR 216,39,32768
MA 244,204,124
TR 218,39,36864
MA 212,204,120
XL 72,7,4,51,0
MA 212,200,104
MA 180,200,100
TR 220,39,40960
MA 180,204,116
TR 222,39,45056
MA 148,204,112
XL 76,7,4,51,128
MA 148,200,96
s_add_u32 s51, s51, 4096
WL 4
MA 152,208,96
MA 152,212,112
MA 184,212,116
XL 80,6,4,51,0
MA 184,208,100
s_waitcnt vmcnt(40) lgkmcnt(0)
s_barrier
MA 216,208,104
TR 192,24,0
MA 216,212,120
TR 194,24,4096
MA 248,212,124
XL 84,6,4,51,128
TR 196,24,8192
MA 248,208,108
TR 198,24,12288
MA 252,216,108
TR 200,25,0
MA 252,220,124
TR 202,25,4096
MA 220,220,120
XL 88,7,4,51,0
MA 220,216,104
MA 188,216,100
TR 204,25,8192
MA 188,220,116
TR 206,25,12288
MA 156,220,112
XL 92,7,4,51,128
MA 156,216,96
s_add_u32 s51, s51, 12288
s_waitcnt vmcnt(35) lgkmcnt(4)
MA 128,192,0
TR 208,26,0
MA 128,196,16
s_add_u32 m0, s49, 98304
TR 210,26,4096
MA 160,196,20
DM 12,12,53,0
MA 160,192,4
MA 192,192,8
TR 212,26,8192
MA 192,196,24
TR 214,26,12288
MA 224,196,28
DM 13,12,53,1024
MA 224,192,12
WL 4
MA 228,200,12
TR 216,27,0
MA 228,204,28
TR 218,27,4096
MA 196,204,24
DM 14,12,53,2048
MA 196,200,8
MA 164,200,4
TR 220,27,8192
MA 164,204,20
TR 222,27,12288
MA 132,204,16
DM 15,12,53,3072
MA 132,200,0
s_add_u32 s53, s53, 32768
WL 4
MA 136,208,0
TR 192,28,0
MA 136,212,16
s_add_u32 m0, s49, 102400
TR 194,28,4096
MA 168,212,20
DM 12,12,53,0
MA 168,208,4
MA 200,208,8
TR 196,28,8192
MA 200,212,24
TR 198,28,12288
MA 232,212,28
DM 13,12,53,1024
MA 232,208,12
WL 4
MA 236,216,12
TR 200,29,0
MA 236,220,28
TR 202,29,4096
MA 204,220,24
DM 14,12,53,2048
MA 204,216,8
MA 172,216,4
TR 204,29,8192
MA 172,220,20
TR 206,29,12288
MA 140,220,16
DM 15,12,53,3072
MA 140,216,0
s_add_u32 s53, s53, 229376
WL 4
MA 144,192,0
TR 208,30,0
MA 144,196,16
TR 210,30,4096
MA 176,196,20
XL 96,6,4,51,0
MA 176,192,4
MA 208,192,8
TR 212,30,8192
MA 208,196,24
TR 214,30,12288
MA 240,196,28
XL 100,6,4,51,128
MA 240,192,12
WL 4
MA 244,200,12
TR 216,31,0
MA 244,204,28
TR 218,31,4096
MA 212,204,24
XL 104,7,4,51,0
MA 212,200,8
MA 180,200,4
TR 220,31,8192
MA 180,204,20
TR 222,31,12288
MA 148,204,16
XL 108,7,4,51,128
MA 148,200,0
s_add_u32 s51, s51, 4096
WL 4
MA 152,208,0
MA 152,212,16
MA 184,212,20
XL 112,6,4,51,0
MA 184,208,4
s_lshl_b32 s60, s54, 1
s_waitcnt vmcnt(38) lgkmcnt(0)
s_barrier
MA 216,208,8
TR 192,24,32768
MA 216,212,24
TR 194,24,36864
MA 248,212,28
XL 116,6,4,51,128
TR 196,24,40960
MA 248,208,12
TR 198,24,45056
s_add_u32 s60, s60, s73
MA 252,216,12
TR 200,25,32768
MA 252,220,28
TR 202,25,36864
MA 220,220,24
XL 120,7,4,51,0
MA 220,216,8
s_mul_i32 s60, s60, 131072
MA 188,216,4
TR 204,25,40960
MA 188,220,20
TR 206,25,45056
MA 156,220,16
XL 124,7,4,51,128
MA 156,216,0
s_add_u32 s51, s51, 12288
s_lshl_b32 s65, s94, 12
s_waitcnt vmcnt(33) lgkmcnt(4)
MA 128,192,32
TR 208,26,32768
MA 128,196,48
s_add_u32 m0, s48, 0
TR 210,26,36864
MA 160,196,52
DM 8,20,52,0
MA 160,192,36
s_add_u32 s60, s60, s65
MA 192,192,40
TR 212,26,40960
MA 192,196,56
TR 214,26,45056
MA 224,196,60
MA 224,192,44
s_lshl_b32 s65, s72, 8
WL 4
MA 228,200,44
TR 216,27,32768
MA 228,204,60
TR 218,27,36864
MA 196,204,56
DM 9,20,52,1024
MA 196,200,40
s_add_u32 s60, s60, s65
MA 164,200,36
TR 220,27,40960
MA 164,204,52
TR 222,27,45056
MA 132,204,48
MA 132,200,32
s_add_u32 s60, s60, 0
WL 4
MA 136,208,32
TR 192,28,32768
MA 136,212,48
TR 194,28,36864
MA 168,212,52
DM 10,20,52,2048
MA 168,208,36
buffer_load_dwordx4 v[64:67], v5, s[4:7], s60 offen offset:0 sc1
MA 200,208,40
TR 196,28,40960
MA 200,212,56
TR 198,28,45056
MA 232,212,60
MA 232,208,44
buffer_load_dwordx4 v[68:71], v5, s[4:7], s60 offen offset:128 sc1
WL 4
MA 236,216,44
TR 200,29,32768
MA 236,220,60
TR 202,29,36864
MA 204,220,56
DM 11,20,52,3072
MA 204,216,40
s_add_u32 s60, s60, 4096
MA 172,216,36
TR 204,29,40960
MA 172,220,52
TR 206,29,45056
MA 140,220,48
MA 140,216,32
buffer_load_dwordx4 v[72:75], v5, s[4:7], s60 offen offset:0 sc1
WL 4
MA 144,192,32
TR 208,30,32768
MA 144,196,48
s_add_u32 m0, s48, 16384
TR 210,30,36864
s_lshl_b32 s88, s48, 2
MA 176,196,52
DM 16,24,52,0
MA 176,192,36
buffer_load_dwordx4 v[76:79], v5, s[4:7], s60 offen offset:128 sc1
MA 208,192,40
TR 212,30,40960
MA 208,196,56
TR 214,30,45056
s_add_u32 s88, s88, 98304
MA 240,196,60
MA 240,192,44
s_add_u32 s60, s60, 4096
WL 4
MA 244,200,44
TR 216,31,32768
MA 244,204,60
TR 218,31,36864
v_lshl_add_u32 v52, v0, 4, s88
MA 212,204,56
DM 4,24,52,1024
MA 212,200,40
buffer_load_dwordx4 v[80:83], v5, s[4:7], s60 offen offset:0 sc1
MA 180,200,36
TR 220,31,40960
MA 180,204,52
TR 222,31,45056
s_xor_b32 s88, s48, 8192
MA 148,204,48
MA 148,200,32
buffer_load_dwordx4 v[84:87], v5, s[4:7], s60 offen offset:128 sc1
WL 4
MA 152,208,32
MA 152,212,48
s_lshl_b32 s88, s88, 2
MA 184,212,52
DM 16,24,52,2048
MA 184,208,36
s_add_u32 s60, s60, 4096
s_waitcnt vmcnt(37) lgkmcnt(0)
s_barrier
MA 216,208,40
TR 192,32,0
MA 216,212,56
TR 194,32,4096
s_add_u32 s88, s88, 98304
MA 248,212,60
TR 196,32,8192
MA 248,208,44
TR 198,32,12288
buffer_load_dwordx4 v[88:91], v5, s[4:7], s60 offen offset:0 sc1
MA 252,216,44
TR 200,33,0
MA 252,220,60
TR 202,33,4096
v_lshl_add_u32 v53, v0, 4, s88
MA 220,220,56
DM 4,24,52,3072
MA 220,216,40
s_add_u32 s52, s52, 16384
buffer_load_dwordx4 v[92:95], v5, s[4:7], s60 offen offset:128 sc1
MA 188,216,36
TR 204,33,8192
MA 188,220,52
TR 206,33,12288
MA 156,220,48
MA 156,216,32
s_add_u32 s60, s60, 4096
s_waitcnt vmcnt(32) lgkmcnt(4)
MA 128,192,64
TR 208,34,0
MA 128,196,80
s_add_u32 m0, s48, 32768
TR 210,34,4096
MA 160,196,84
DM 8,20,52,0
MA 160,192,68
MA 192,192,72
TR 212,34,8192
MA 192,196,88
TR 214,34,12288
MA 224,196,92
MA 224,192,76
WL 4
MA 228,200,76
TR 216,35,0
MA 228,204,92
TR 218,35,4096
MA 196,204,88
DM 9,20,52,1024
MA 196,200,72
MA 164,200,68
TR 220,35,8192
MA 164,204,84
TR 222,35,12288
MA 132,204,80
MA 132,200,64
WL 4
MA 136,208,64
TR 192,36,0
MA 136,212,80
TR 194,36,4096
MA 168,212,84
DM 10,20,52,2048
MA 168,208,68
MA 200,208,72
TR 196,36,8192
MA 200,212,88
TR 198,36,12288
MA 232,212,92
MA 232,208,76
WL 4
MA 236,216,76
TR 200,37,0
MA 236,220,92
TR 202,37,4096
MA 204,220,88
DM 11,20,52,3072
MA 204,216,72
MA 172,216,68
TR 204,37,8192
MA 172,220,84
TR 206,37,12288
MA 140,220,80
MA 140,216,64
WL 4
MA 144,192,64
TR 208,38,0
MA 144,196,80
s_add_u32 m0, s48, 49152
TR 210,38,4096
MA 176,196,84
DM 16,24,52,0
MA 176,192,68
v_xor_b32 v24, 0, v1
s_lshr_b32 s81, s82, 1
MA 208,192,72
TR 212,38,8192
MA 208,196,88
TR 214,38,12288
MA 240,196,92
MA 240,192,76
v_xor_b32 v25, 32, v1
s_mul_i32 s81, s81, 7168
WL 4
MA 244,200,76
TR 216,39,0
MA 244,204,92
TR 218,39,4096
MA 212,204,88
DM 4,24,52,1024
MA 212,200,72
v_xor_b32 v26, 64, v1
s_and_b32 s65, s82, 1
MA 180,200,68
TR 220,39,8192
MA 180,204,84
TR 222,39,12288
MA 148,204,80
MA 148,200,64
v_xor_b32 v27, 96, v1
s_mul_i32 s65, s65, 2048
WL 4
MA 152,208,64
MA 152,212,80
MA 184,212,84
DM 16,24,52,2048
MA 184,208,68
v_xor_b32 v28, 128, v1
s_add_u32 s81, s81, s65
s_waitcnt vmcnt(31) lgkmcnt(0)
s_barrier
MA 216,208,72
TR 192,32,32768
MA 216,212,88
TR 194,32,36864
MA 248,212,92
TR 196,32,40960
MA 248,208,76
TR 198,32,45056
v_xor_b32 v29, 160, v1
s_add_u32 s81, s81, 3072
MA 252,216,76
TR 200,33,32768
MA 252,220,92
TR 202,33,36864
MA 220,220,88
DM 4,24,52,3072
MA 220,216,72
s_add_u32 s52, s52, 16384
v_xor_b32 v30, 192, v1
MA 188,216,68
TR 204,33,40960
MA 188,220,84
TR 206,33,45056
MA 156,220,80
MA 156,216,64
v_xor_b32 v31, 224, v1
s_waitcnt vmcnt(24) lgkmcnt(4)
MA 192,192,104
TR 208,34,32768
MA 192,196,120
s_add_u32 m0, s48, 65536
TR 210,34,36864
MA 224,196,124
DM 8,20,52,0
TR 212,34,40960
MA 224,192,108
TR 214,34,45056
v_xor_b32 v40, 0, v3
WL 4
MA 228,200,108
TR 216,35,32768
MA 228,204,124
TR 218,35,36864
MA 196,204,120
TR 220,35,40960
MA 196,200,104
TR 222,35,45056
v_xor_b32 v41, 64, v3
WL 4
MA 200,208,104
TR 224,36,32768
MA 200,212,120
TR 226,36,36864
MA 232,212,124
DM 9,20,52,1024
TR 228,36,40960
MA 232,208,108
TR 230,36,45056
v_xor_b32 v42, 128, v3
WL 4
MA 236,216,108
TR 232,37,32768
MA 236,220,124
TR 234,37,36864
MA 204,220,120
TR 236,37,40960
MA 204,216,104
TR 238,37,45056
v_xor_b32 v43, 192, v3
buffer_load_dword v61, v60, s[84:87], s77 offen
WL 4
MA 208,224,104
TR 240,38,32768
MA 208,228,120
TR 242,38,36864
MA 240,228,124
DM 10,20,52,2048
TR 244,38,40960
MA 240,224,108
TR 246,38,45056
WL 4
MA 244,232,108
TR 248,39,32768
MA 244,236,124
TR 250,39,36864
MA 212,236,120
TR 252,39,40960
MA 212,232,104
TR 254,39,45056
WL 4
MA 216,240,104
MA 216,244,120
MA 248,244,124
DM 11,20,52,3072
MA 248,240,108
WL 0
MA 252,248,108
MA 252,252,124
MA 220,252,120
MA 220,248,104
WV 14
s_barrier
MA 128,192,96
MA 128,196,112
s_add_u32 m0, s48, 81920
ds_write_b128 v52, v[192:195] offset:0
MA 160,196,116
DM 16,24,52,0
MA 160,192,100
ds_write_b128 v52, v[196:199] offset:1024
MA 164,200,100
MA 164,204,116
ds_write_b128 v52, v[200:203] offset:2048
MA 132,204,112
MA 132,200,96
ds_write_b128 v52, v[204:207] offset:3072
MA 136,208,96
MA 136,212,112
ds_write_b128 v52, v[208:211] offset:4096
MA 168,212,116
DM 4,24,52,1024
MA 168,208,100
ds_write_b128 v52, v[212:215] offset:5120
MA 172,216,100
ds_read_b128 a[192:195], v40 offset:0
MA 172,220,116
ds_write_b128 v52, v[216:219] offset:6144
MA 140,220,112
ds_read_b128 a[196:199], v41 offset:0
MA 140,216,96
ds_write_b128 v52, v[220:223] offset:7168
MA 144,224,96
MA 144,228,112
ds_write_b128 v52, v[224:227] offset:8192
MA 176,228,116
DM 16,24,52,2048
MA 176,224,100
ds_write_b128 v52, v[228:231] offset:9216
MA 180,232,100
ds_read_b128 a[200:203], v42 offset:0
MA 180,236,116
ds_write_b128 v52, v[232:235] offset:10240
MA 148,236,112
ds_read_b128 a[204:207], v43 offset:0
MA 148,232,96
ds_write_b128 v52, v[236:239] offset:11264
MA 152,240,96
MA 152,244,112
ds_write_b128 v52, v[240:243] offset:12288
MA 184,244,116
DM 4,24,52,3072
MA 184,240,100
s_add_u32 s52, s52, 16384
ds_write_b128 v52, v[244:247] offset:13312
MA 188,248,100
MA 188,252,116
ds_write_b128 v52, v[248:251] offset:14336
MA 156,252,112
MA 156,248,96
ds_write_b128 v52, v[252:255] offset:15360
WL 0
s_barrier
ds_read_b128 v[192:195], v53 offset:0
ds_read_b128 v[196:199], v53 offset:1024
ds_read_b128 v[200:203], v53 offset:2048
ds_read_b128 v[204:207], v53 offset:3072
ds_read_b128 v[208:211], v53 offset:4096
ds_read_b128 v[212:215], v53 offset:5120
ds_read_b128 v[216:219], v53 offset:6144
ds_read_b128 v[220:223], v53 offset:7168
ds_read_b128 v[224:227], v53 offset:8192
ds_read_b128 v[228:231], v53 offset:9216
ds_read_b128 v[232:235], v53 offset:10240
ds_read_b128 v[236:239], v53 offset:11264
ds_read_b128 v[240:243], v53 offset:12288
ds_read_b128 v[244:247], v53 offset:13312
ds_read_b128 v[248:251], v53 offset:14336
ds_read_b128 v[252:255], v53 offset:15360
WL 15
v_pk_add_f32 v[128:129], v[128:129], v[192:193]
v_pk_add_f32 v[130:131], v[130:131], v[194:195]
WL 14
v_pk_add_f32 v[132:133], v[132:133], v[196:197]
v_pk_add_f32 v[134:135], v[134:135], v[198:199]
WL 13
v_pk_add_f32 v[136:137], v[136:137], v[200:201]
v_pk_add_f32 v[138:139], v[138:139], v[202:203]
WL 12
v_pk_add_f32 v[140:141], v[140:141], v[204:205]
v_pk_add_f32 v[142:143], v[142:143], v[206:207]
WL 11
v_pk_add_f32 v[144:145], v[144:145], v[208:209]
v_pk_add_f32 v[146:147], v[146:147], v[210:211]
WL 10
v_pk_add_f32 v[148:149], v[148:149], v[212:213]
v_pk_add_f32 v[150:151], v[150:151], v[214:215]
WL 9
v_pk_add_f32 v[152:153], v[152:153], v[216:217]
v_pk_add_f32 v[154:155], v[154:155], v[218:219]
WL 8
v_pk_add_f32 v[156:157], v[156:157], v[220:221]
v_pk_add_f32 v[158:159], v[158:159], v[222:223]
WL 7
v_pk_add_f32 v[160:161], v[160:161], v[224:225]
v_pk_add_f32 v[162:163], v[162:163], v[226:227]
WL 6
v_pk_add_f32 v[164:165], v[164:165], v[228:229]
v_pk_add_f32 v[166:167], v[166:167], v[230:231]
WL 5
v_pk_add_f32 v[168:169], v[168:169], v[232:233]
v_pk_add_f32 v[170:171], v[170:171], v[234:235]
WL 4
v_pk_add_f32 v[172:173], v[172:173], v[236:237]
v_pk_add_f32 v[174:175], v[174:175], v[238:239]
WL 3
v_pk_add_f32 v[176:177], v[176:177], v[240:241]
v_pk_add_f32 v[178:179], v[178:179], v[242:243]
WL 2
v_pk_add_f32 v[180:181], v[180:181], v[244:245]
v_pk_add_f32 v[182:183], v[182:183], v[246:247]
WL 1
v_pk_add_f32 v[184:185], v[184:185], v[248:249]
v_pk_add_f32 v[186:187], v[186:187], v[250:251]
WL 0
v_pk_add_f32 v[188:189], v[188:189], v[252:253]
v_pk_add_f32 v[190:191], v[190:191], v[254:255]
s_barrier
v_mov_b32 v50, 0
v_mov_b32 v51, 0
v_mov_b32 v52, 0
v_mov_b32 v53, 0
v_mov_b32 v54, 0
v_mov_b32 v55, 0
v_mov_b32 v56, 0
v_mov_b32 v57, 0
v_lshlrev_b32 v192, 16, v64
v_and_b32 v193, 0xffff0000, v64
v_pk_add_f32 v[128:129], v[128:129], v[192:193]
v_cvt_pk_bf16_f32 v96, v128, v129
v_pk_add_f32 v[50:51], v[50:51], v[128:129]
v_pk_fma_f32 v[52:53], v[128:129], v[128:129], v[52:53]
v_lshlrev_b32 v194, 16, v65
v_and_b32 v195, 0xffff0000, v65
v_pk_add_f32 v[130:131], v[130:131], v[194:195]
v_cvt_pk_bf16_f32 v97, v130, v131
v_pk_add_f32 v[50:51], v[50:51], v[130:131]
v_pk_fma_f32 v[52:53], v[130:131], v[130:131], v[52:53]
v_lshlrev_b32 v192, 16, v66
v_and_b32 v193, 0xffff0000, v66
v_pk_add_f32 v[132:133], v[132:133], v[192:193]
v_cvt_pk_bf16_f32 v98, v132, v133
v_pk_add_f32 v[50:51], v[50:51], v[132:133]
v_pk_fma_f32 v[52:53], v[132:133], v[132:133], v[52:53]
v_lshlrev_b32 v194, 16, v67
v_and_b32 v195, 0xffff0000, v67
v_pk_add_f32 v[134:135], v[134:135], v[194:195]
v_cvt_pk_bf16_f32 v99, v134, v135
v_pk_add_f32 v[50:51], v[50:51], v[134:135]
v_pk_fma_f32 v[52:53], v[134:135], v[134:135], v[52:53]
v_lshlrev_b32 v192, 16, v68
v_and_b32 v193, 0xffff0000, v68
v_pk_add_f32 v[160:161], v[160:161], v[192:193]
v_cvt_pk_bf16_f32 v100, v160, v161
v_pk_add_f32 v[54:55], v[54:55], v[160:161]
v_pk_fma_f32 v[56:57], v[160:161], v[160:161], v[56:57]
v_lshlrev_b32 v194, 16, v69
v_and_b32 v195, 0xffff0000, v69
v_pk_add_f32 v[162:163], v[162:163], v[194:195]
v_cvt_pk_bf16_f32 v101, v162, v163
v_pk_add_f32 v[54:55], v[54:55], v[162:163]
v_pk_fma_f32 v[56:57], v[162:163], v[162:163], v[56:57]
v_lshlrev_b32 v192, 16, v70
v_and_b32 v193, 0xffff0000, v70
v_pk_add_f32 v[164:165], v[164:165], v[192:193]
v_cvt_pk_bf16_f32 v102, v164, v165
v_pk_add_f32 v[54:55], v[54:55], v[164:165]
v_pk_fma_f32 v[56:57], v[164:165], v[164:165], v[56:57]
v_lshlrev_b32 v194, 16, v71
v_and_b32 v195, 0xffff0000, v71
v_pk_add_f32 v[166:167], v[166:167], v[194:195]
v_cvt_pk_bf16_f32 v103, v166, v167
v_pk_add_f32 v[54:55], v[54:55], v[166:167]
v_pk_fma_f32 v[56:57], v[166:167], v[166:167], v[56:57]
v_lshlrev_b32 v192, 16, v72
v_and_b32 v193, 0xffff0000, v72
v_pk_add_f32 v[136:137], v[136:137], v[192:193]
v_cvt_pk_bf16_f32 v104, v136, v137
v_pk_add_f32 v[50:51], v[50:51], v[136:137]
v_pk_fma_f32 v[52:53], v[136:137], v[136:137], v[52:53]
v_lshlrev_b32 v194, 16, v73
v_and_b32 v195, 0xffff0000, v73
v_pk_add_f32 v[138:139], v[138:139], v[194:195]
v_cvt_pk_bf16_f32 v105, v138, v139
v_pk_add_f32 v[50:51], v[50:51], v[138:139]
v_pk_fma_f32 v[52:53], v[138:139], v[138:139], v[52:53]
v_lshlrev_b32 v192, 16, v74
v_and_b32 v193, 0xffff0000, v74
v_pk_add_f32 v[140:141], v[140:141], v[192:193]
v_cvt_pk_bf16_f32 v106, v140, v141
v_pk_add_f32 v[50:51], v[50:51], v[140:141]
v_pk_fma_f32 v[52:53], v[140:141], v[140:141], v[52:53]
v_lshlrev_b32 v194, 16, v75
v_and_b32 v195, 0xffff0000, v75
v_pk_add_f32 v[142:143], v[142:143], v[194:195]
v_cvt_pk_bf16_f32 v107, v142, v143
v_pk_add_f32 v[50:51], v[50:51], v[142:143]
v_pk_fma_f32 v[52:53], v[142:143], v[142:143], v[52:53]
v_lshlrev_b32 v192, 16, v76
v_and_b32 v193, 0xffff0000, v76
v_pk_add_f32 v[168:169], v[168:169], v[192:193]
v_cvt_pk_bf16_f32 v108, v168, v169
v_pk_add_f32 v[54:55], v[54:55], v[168:169]
v_pk_fma_f32 v[56:57], v[168:169], v[168:169], v[56:57]
v_lshlrev_b32 v194, 16, v77
v_and_b32 v195, 0xffff0000, v77
v_pk_add_f32 v[170:171], v[170:171], v[194:195]
v_cvt_pk_bf16_f32 v109, v170, v171
v_pk_add_f32 v[54:55], v[54:55], v[170:171]
v_pk_fma_f32 v[56:57], v[170:171], v[170:171], v[56:57]
v_lshlrev_b32 v192, 16, v78
v_and_b32 v193, 0xffff0000, v78
v_pk_add_f32 v[172:173], v[172:173], v[192:193]
v_cvt_pk_bf16_f32 v110, v172, v173
v_pk_add_f32 v[54:55], v[54:55], v[172:173]
v_pk_fma_f32 v[56:57], v[172:173], v[172:173], v[56:57]
v_lshlrev_b32 v194, 16, v79
v_and_b32 v195, 0xffff0000, v79
v_pk_add_f32 v[174:175], v[174:175], v[194:195]
v_cvt_pk_bf16_f32 v111, v174, v175
v_pk_add_f32 v[54:55], v[54:55], v[174:175]
v_pk_fma_f32 v[56:57], v[174:175], v[174:175], v[56:57]
v_lshlrev_b32 v192, 16, v80
v_and_b32 v193, 0xffff0000, v80
v_pk_add_f32 v[144:145], v[144:145], v[192:193]
v_cvt_pk_bf16_f32 v112, v144, v145
v_pk_add_f32 v[50:51], v[50:51], v[144:145]
v_pk_fma_f32 v[52:53], v[144:145], v[144:145], v[52:53]
v_lshlrev_b32 v194, 16, v81
v_and_b32 v195, 0xffff0000, v81
v_pk_add_f32 v[146:147], v[146:147], v[194:195]
v_cvt_pk_bf16_f32 v113, v146, v147
v_pk_add_f32 v[50:51], v[50:51], v[146:147]
v_pk_fma_f32 v[52:53], v[146:147], v[146:147], v[52:53]
v_lshlrev_b32 v192, 16, v82
v_and_b32 v193, 0xffff0000, v82
v_pk_add_f32 v[148:149], v[148:149], v[192:193]
v_cvt_pk_bf16_f32 v114, v148, v149
v_pk_add_f32 v[50:51], v[50:51], v[148:149]
v_pk_fma_f32 v[52:53], v[148:149], v[148:149], v[52:53]
v_lshlrev_b32 v194, 16, v83
v_and_b32 v195, 0xffff0000, v83
v_pk_add_f32 v[150:151], v[150:151], v[194:195]
v_cvt_pk_bf16_f32 v115, v150, v151
v_pk_add_f32 v[50:51], v[50:51], v[150:151]
v_pk_fma_f32 v[52:53], v[150:151], v[150:151], v[52:53]
v_lshlrev_b32 v192, 16, v84
v_and_b32 v193, 0xffff0000, v84
v_pk_add_f32 v[176:177], v[176:177], v[192:193]
v_cvt_pk_bf16_f32 v116, v176, v177
v_pk_add_f32 v[54:55], v[54:55], v[176:177]
v_pk_fma_f32 v[56:57], v[176:177], v[176:177], v[56:57]
v_lshlrev_b32 v194, 16, v85
v_and_b32 v195, 0xffff0000, v85
v_pk_add_f32 v[178:179], v[178:179], v[194:195]
v_cvt_pk_bf16_f32 v117, v178, v179
v_pk_add_f32 v[54:55], v[54:55], v[178:179]
v_pk_fma_f32 v[56:57], v[178:179], v[178:179], v[56:57]
v_lshlrev_b32 v192, 16, v86
v_and_b32 v193, 0xffff0000, v86
v_pk_add_f32 v[180:181], v[180:181], v[192:193]
v_cvt_pk_bf16_f32 v118, v180, v181
v_pk_add_f32 v[54:55], v[54:55], v[180:181]
v_pk_fma_f32 v[56:57], v[180:181], v[180:181], v[56:57]
v_lshlrev_b32 v194, 16, v87
v_and_b32 v195, 0xffff0000, v87
v_pk_add_f32 v[182:183], v[182:183], v[194:195]
v_cvt_pk_bf16_f32 v119, v182, v183
v_pk_add_f32 v[54:55], v[54:55], v[182:183]
v_pk_fma_f32 v[56:57], v[182:183], v[182:183], v[56:57]
v_lshlrev_b32 v192, 16, v88
v_and_b32 v193, 0xffff0000, v88
v_pk_add_f32 v[152:153], v[152:153], v[192:193]
v_cvt_pk_bf16_f32 v120, v152, v153
v_pk_add_f32 v[50:51], v[50:51], v[152:153]
v_pk_fma_f32 v[52:53], v[152:153], v[152:153], v[52:53]
v_lshlrev_b32 v194, 16, v89
v_and_b32 v195, 0xffff0000, v89
v_pk_add_f32 v[154:155], v[154:155], v[194:195]
v_cvt_pk_bf16_f32 v121, v154, v155
v_pk_add_f32 v[50:51], v[50:51], v[154:155]
v_pk_fma_f32 v[52:53], v[154:155], v[154:155], v[52:53]
v_lshlrev_b32 v192, 16, v90
v_and_b32 v193, 0xffff0000, v90
v_pk_add_f32 v[156:157], v[156:157], v[192:193]
v_cvt_pk_bf16_f32 v122, v156, v157
v_pk_add_f32 v[50:51], v[50:51], v[156:157]
v_pk_fma_f32 v[52:53], v[156:157], v[156:157], v[52:53]
v_lshlrev_b32 v194, 16, v91
v_and_b32 v195, 0xffff0000, v91
v_pk_add_f32 v[158:159], v[158:159], v[194:195]
v_cvt_pk_bf16_f32 v123, v158, v159
v_pk_add_f32 v[50:51], v[50:51], v[158:159]
v_pk_fma_f32 v[52:53], v[158:159], v[158:159], v[52:53]
WV 17
v_lshlrev_b32 v192, 16, v92
v_and_b32 v193, 0xffff0000, v92
v_pk_add_f32 v[184:185], v[184:185], v[192:193]
v_cvt_pk_bf16_f32 v124, v184, v185
v_pk_add_f32 v[54:55], v[54:55], v[184:185]
v_pk_fma_f32 v[56:57], v[184:185], v[184:185], v[56:57]
v_lshlrev_b32 v194, 16, v93
v_and_b32 v195, 0xffff0000, v93
v_pk_add_f32 v[186:187], v[186:187], v[194:195]
v_cvt_pk_bf16_f32 v125, v186, v187
v_pk_add_f32 v[54:55], v[54:55], v[186:187]
v_pk_fma_f32 v[56:57], v[186:187], v[186:187], v[56:57]
v_lshlrev_b32 v192, 16, v94
v_and_b32 v193, 0xffff0000, v94
v_pk_add_f32 v[188:189], v[188:189], v[192:193]
v_cvt_pk_bf16_f32 v126, v188, v189
v_pk_add_f32 v[54:55], v[54:55], v[188:189]
v_pk_fma_f32 v[56:57], v[188:189], v[188:189], v[56:57]
v_lshlrev_b32 v194, 16, v95
v_and_b32 v195, 0xffff0000, v95
v_pk_add_f32 v[190:191], v[190:191], v[194:195]
v_cvt_pk_bf16_f32 v127, v190, v191
v_pk_add_f32 v[54:55], v[54:55], v[190:191]
v_pk_fma_f32 v[56:57], v[190:191], v[190:191], v[56:57]
v_add_f32 v50, v50, v51
v_add_f32 v51, v52, v53
v_add_f32 v54, v54, v55
v_add_f32 v55, v56, v57
v_mov_b32 v192, v50
v_mov_b32 v193, v51
v_mov_b32 v194, v54
v_mov_b32 v195, v55
v_permlane16_swap_b32 v50, v192
v_permlane16_swap_b32 v51, v193
v_permlane16_swap_b32 v54, v194
v_permlane16_swap_b32 v55, v195
v_add_f32 v50, v50, v192
v_add_f32 v51, v51, v193
v_add_f32 v54, v54, v194
v_add_f32 v55, v55, v195
v_mov_b32 v192, v50
v_mov_b32 v193, v51
v_mov_b32 v194, v54
v_mov_b32 v195, v55
v_permlane32_swap_b32 v50, v192
v_permlane32_swap_b32 v51, v193
v_permlane32_swap_b32 v54, v194
v_permlane32_swap_b32 v55, v195
v_add_f32 v50, v50, v192
v_add_f32 v51, v51, v193
v_add_f32 v54, v54, v194
v_add_f32 v55, v55, v195
s_lshl_b32 s60, s54, 3
s_add_u32 s60, s60, s55
s_lshl_b32 s60, s60, 10
s_lshl_b32 s62, s73, 9
s_add_u32 s60, s60, s62
s_lshl_b32 s62, s72, 8
s_add_u32 s60, s60, s62
s_add_u32 s60, s60, 20971520
v_and_b32 v192, 15, v0
v_lshlrev_b32 v192, 3, v192
v_lshl_add_u32 v192, v19, 29, v192
buffer_store_dwordx2 v[50:51], v192, s[4:7], s60 offen sc1
buffer_store_dwordx2 v[54:55], v192, s[4:7], s60 offen offset:128 sc1
v_mov_b32 v48, 0x3f803f80
v_accvgpr_write_b32 a240, v48
v_accvgpr_write_b32 a241, v48
v_accvgpr_write_b32 a242, v48
v_accvgpr_write_b32 a243, v48
MZ 128,192,128
ds_read_b128 a[224:227], v40 offset:4096
MA 128,196,132
ds_read_b128 a[228:231], v41 offset:4096
MA 128,200,136
ds_read_b128 a[232:235], v42 offset:4096
s_add_u32 m0, s48, 98304
s_nop 0
DM 8,20,52,0
MA 128,204,140
ds_read_b128 a[236:239], v43 offset:4096
MZ 136,204,156
MA 136,200,152
v_xor_b32 v32, 65536, v1
v_xor_b32 v33, 65568, v1
MA 136,196,148
DM 9,20,52,1024
MA 136,192,144
MZ 144,192,160
MA 144,196,164
v_xor_b32 v34, 65600, v1
v_xor_b32 v35, 65632, v1
MA 144,200,168
DM 10,20,52,2048
MA 144,204,172
MZ 152,204,188
MA 152,200,184
v_xor_b32 v36, 65664, v1
v_xor_b32 v37, 65696, v1
MA 152,196,180
DM 11,20,52,3072
MA 152,192,176
WL 0
MZ 132,224,128
ds_read_b128 a[192:195], v40 offset:8192
MA 132,228,132
ds_read_b128 a[196:199], v41 offset:8192
v_xor_b32 v38, 65728, v1
v_xor_b32 v39, 65760, v1
MA 132,232,136
ds_read_b128 a[200:203], v42 offset:8192
s_add_u32 m0, s48, 114688
s_nop 0
DM 16,24,52,0
MA 132,236,140
ds_read_b128 a[204:207], v43 offset:8192
MZ 140,236,156
MA 140,232,152
v_xor_b32 v44, 65536, v3
v_xor_b32 v45, 65600, v3
MA 140,228,148
DM 4,24,52,1024
MA 140,224,144
MZ 148,224,160
MA 148,228,164
v_xor_b32 v46, 65664, v3
v_xor_b32 v47, 65728, v3
MA 148,232,168
DM 16,24,52,2048
MA 148,236,172
MZ 156,236,188
MA 156,232,184
MA 156,228,180
DM 4,24,52,3072
s_add_u32 s52, s52, 16384
MA 156,224,176
v_max3_f32 v52, v128, v129, v130
v_max3_f32 v53, v136, v137, v138
v_max3_f32 v54, v144, v145, v146
v_max3_f32 v55, v152, v153, v154
v_max3_f32 v52, v52, v131, v132
v_max3_f32 v53, v53, v139, v140
v_max3_f32 v54, v54, v147, v148
s_nop 0
v_max3_f32 v55, v55, v155, v156
v_max3_f32 v52, v52, v133, v134
v_max3_f32 v53, v53, v141, v142
v_max3_f32 v54, v54, v149, v150
v_max3_f32 v55, v55, v157, v158
v_max_f32 v52, v52, v135
v_max_f32 v53, v53, v143
v_max_f32 v54, v54, v151
v_max_f32 v55, v55, v159
v_mov_b32 v208, v52
v_mov_b32 v209, v53
v_mov_b32 v210, v54
v_mov_b32 v211, v55
v_permlane16_swap_b32 v52, v208
v_permlane16_swap_b32 v53, v209
v_permlane16_swap_b32 v54, v210
v_permlane16_swap_b32 v55, v211
v_max_f32 v52, v52, v208
v_max_f32 v53, v53, v209
v_max_f32 v54, v54, v210
v_max_f32 v55, v55, v211
v_mov_b32 v208, v52
v_mov_b32 v209, v53
v_mov_b32 v210, v54
v_mov_b32 v211, v55
v_permlane32_swap_b32 v52, v208
v_permlane32_swap_b32 v53, v209
v_permlane32_swap_b32 v54, v210
v_permlane32_swap_b32 v55, v211
v_max_f32 v52, v52, v208
v_max_f32 v53, v53, v209
v_max_f32 v54, v54, v210
v_max_f32 v55, v55, v211
v_sub_f32 v192, 0, v52
v_sub_f32 v196, 0, v53
v_sub_f32 v200, 0, v54
v_sub_f32 v204, 0, v55
v_sub_f32 v193, 0, v52
v_sub_f32 v197, 0, v53
v_sub_f32 v201, 0, v54
v_sub_f32 v205, 0, v55
v_sub_f32 v194, 0, v52
v_sub_f32 v198, 0, v53
v_sub_f32 v202, 0, v54
v_sub_f32 v206, 0, v55
v_sub_f32 v195, 0, v52
v_sub_f32 v199, 0, v53
v_sub_f32 v203, 0, v54
v_sub_f32 v207, 0, v55
WV 8
s_barrier
buffer_atomic_add v21, v18, s[4:7], s78 offen offset:256
WL 0
v_mfma_f32_16x16x32_bf16 v[160:163], a[192:195], a[128:131], v[192:195]
v_sub_f32 v128, v128, v52
v_sub_f32 v129, v129, v52
v_exp_f32 v128, v128
MA 160,196,132
ds_read_b128 a[224:227], v40 offset:12288
v_exp_f32 v129, v129
v_sub_f32 v130, v130, v52
MA 160,200,136
v_sub_f32 v131, v131, v52
v_exp_f32 v130, v130
v_exp_f32 v131, v131
MA 160,204,140
ds_read_b128 a[228:231], v41 offset:12288
s_lshl_b32 s89, s54, 1
v_sub_f32 v136, v136, v53
v_sub_f32 v137, v137, v53
v_exp_f32 v136, v136
v_mfma_f32_16x16x32_bf16 v[168:171], a[204:207], a[156:159], v[196:199]
v_exp_f32 v137, v137
v_sub_f32 v138, v138, v53
v_sub_f32 v139, v139, v53
v_exp_f32 v138, v138
MA 168,200,152
ds_read_b128 a[232:235], v42 offset:12288
s_add_u32 s89, s89, s73
v_exp_f32 v139, v139
v_sub_f32 v144, v144, v54
MA 168,196,148
v_sub_f32 v145, v145, v54
v_exp_f32 v144, v144
v_exp_f32 v145, v145
MA 168,192,144
ds_read_b128 a[236:239], v43 offset:12288
s_mul_i32 s89, s89, 131072
v_sub_f32 v146, v146, v54
v_sub_f32 v147, v147, v54
v_exp_f32 v146, v146
v_mfma_f32_16x16x32_bf16 v[176:179], a[192:195], a[160:163], v[200:203]
v_exp_f32 v147, v147
v_sub_f32 v152, v152, v55
v_sub_f32 v153, v153, v55
v_exp_f32 v152, v152
MA 176,196,164
buffer_load_dword v61, v60, s[28:31], s81 offen
s_add_u32 s81, s81, 1835008
s_lshl_b32 s65, s94, 12
v_exp_f32 v153, v153
v_sub_f32 v154, v154, v55
MA 176,200,168
v_sub_f32 v155, v155, v55
v_exp_f32 v154, v154
v_exp_f32 v155, v155
MA 176,204,172
s_add_u32 s89, s89, s65
v_sub_f32 v132, v132, v52
v_sub_f32 v133, v133, v52
v_exp_f32 v132, v132
v_cvt_pk_bf16_f32 v224, v128, v129
v_mfma_f32_16x16x32_bf16 v[184:187], a[204:207], a[188:191], v[204:207]
v_exp_f32 v133, v133
v_sub_f32 v134, v134, v52
v_sub_f32 v135, v135, v52
v_exp_f32 v134, v134
MA 184,200,184
s_lshl_b32 s65, s72, 8
v_exp_f32 v135, v135
v_sub_f32 v140, v140, v53
v_sub_f32 v141, v141, v53
v_cvt_pk_bf16_f32 v225, v130, v131
MA 184,196,180
v_exp_f32 v140, v140
v_exp_f32 v141, v141
v_sub_f32 v142, v142, v53
MA 184,192,176
s_add_u32 s89, s89, s65
v_sub_f32 v143, v143, v53
v_exp_f32 v142, v142
v_exp_f32 v143, v143
WL 0
v_mfma_f32_16x16x32_bf16 v[164:167], a[224:227], a[128:131], v[192:195]
v_sub_f32 v148, v148, v54
v_sub_f32 v149, v149, v54
v_exp_f32 v148, v148
v_cvt_pk_bf16_f32 v228, v136, v137
MA 164,228,132
s_add_u32 s89, s89, 56623104
v_exp_f32 v149, v149
v_sub_f32 v150, v150, v54
v_sub_f32 v151, v151, v54
MA 164,232,136
v_exp_f32 v150, v150
v_exp_f32 v151, v151
v_sub_f32 v156, v156, v55
MA 164,236,140
v_sub_f32 v157, v157, v55
v_exp_f32 v156, v156
v_cvt_pk_bf16_f32 v229, v138, v139
v_exp_f32 v157, v157
v_mfma_f32_16x16x32_bf16 v[172:175], a[236:239], a[156:159], v[196:199]
TR 208,24,16384
v_cvt_pk_bf16_f32 v232, v144, v145
v_cvt_pk_bf16_f32 v233, v146, v147
v_sub_f32 v158, v158, v55
v_cvt_pk_bf16_f32 v236, v152, v153
MA 172,232,152
TR 210,24,20480
v_cvt_pk_bf16_f32 v237, v154, v155
v_sub_f32 v159, v159, v55
v_cvt_pk_bf16_f32 v226, v132, v133
v_cvt_pk_bf16_f32 v227, v134, v135
MA 172,228,148
v_exp_f32 v158, v158
v_cvt_pk_bf16_f32 v230, v140, v141
v_cvt_pk_bf16_f32 v231, v142, v143
v_cvt_pk_bf16_f32 v234, v148, v149
MA 172,224,144
v_exp_f32 v159, v159
v_cvt_pk_bf16_f32 v235, v150, v151
v_cvt_pk_bf16_f32 v238, v156, v157
v_cvt_pk_bf16_f32 v239, v158, v159
v_mfma_f32_16x16x32_bf16 v[208:211], a[240:243], v[224:227], 0
TR 212,25,16384
v_mfma_f32_16x16x32_bf16 v[212:215], a[240:243], v[228:231], 0
TR 214,25,20480
v_mfma_f32_16x16x32_bf16 v[216:219], a[240:243], v[232:235], 0
TR 216,26,16384
v_mfma_f32_16x16x32_bf16 v[220:223], a[240:243], v[236:239], 0
TR 218,26,20480
v_mfma_f32_16x16x32_bf16 v[180:183], a[224:227], a[160:163], v[200:203]
buffer_load_dword v61, v60, s[28:31], s81 offen
MA 180,228,164
s_add_u32 s81, s81, 1835008
MA 180,232,168
MA 180,236,172
v_mfma_f32_16x16x32_bf16 v[188:191], a[236:239], a[188:191], v[204:207]
MA 188,232,184
MA 188,228,180
MA 188,224,176
WL 4
v_mfma_f32_16x16x32_bf16 a[0:3], a[208:211], v[224:227], 0
TR 220,27,16384
v_mov_b32 v48, v208
v_mov_b32 v49, v212
v_mfma_f32_16x16x32_bf16 a[32:35], a[208:211], v[228:231], 0
TR 222,27,20480
buffer_store_dwordx4 v[96:99], v5, s[4:7], s89 offen offset:0 sc1
v_mov_b32 v50, v216
v_mov_b32 v51, v220
v_mfma_f32_16x16x32_bf16 a[64:67], a[208:211], v[232:235], 0
v_exp_f32 v160, v160
v_mfma_f32_16x16x32_bf16 a[96:99], a[208:211], v[236:239], 0
v_exp_f32 v161, v161
WL 4
v_mfma_f32_16x16x32_bf16 a[100:103], a[212:215], v[236:239], 0
TR 208,28,16384
v_mfma_f32_16x16x32_bf16 a[68:71], a[212:215], v[232:235], 0
TR 210,28,20480
v_mfma_f32_16x16x32_bf16 a[36:39], a[212:215], v[228:231], 0
v_exp_f32 v162, v162
v_mfma_f32_16x16x32_bf16 a[4:7], a[212:215], v[224:227], 0
v_exp_f32 v163, v163
WL 4
v_mfma_f32_16x16x32_bf16 a[8:11], a[216:219], v[224:227], 0
TR 212,29,16384
v_mfma_f32_16x16x32_bf16 a[40:43], a[216:219], v[228:231], 0
TR 214,29,20480
v_mfma_f32_16x16x32_bf16 a[72:75], a[216:219], v[232:235], 0
v_exp_f32 v168, v168
v_mfma_f32_16x16x32_bf16 a[104:107], a[216:219], v[236:239], 0
v_exp_f32 v169, v169
WL 4
v_mfma_f32_16x16x32_bf16 a[108:111], a[220:223], v[236:239], 0
TR 216,30,16384
v_exp_f32 v170, v170
v_mfma_f32_16x16x32_bf16 a[76:79], a[220:223], v[232:235], 0
TR 218,30,20480
buffer_store_dwordx4 v[100:103], v5, s[4:7], s89 offen offset:128 sc1
s_add_u32 s89, s89, 4096
v_mfma_f32_16x16x32_bf16 a[44:47], a[220:223], v[228:231], 0
v_exp_f32 v171, v171
v_mfma_f32_16x16x32_bf16 a[12:15], a[220:223], v[224:227], 0
v_exp_f32 v176, v176
WL 4
v_mfma_f32_16x16x32_bf16 a[16:19], a[208:211], v[224:227], 0
TR 220,31,16384
v_mfma_f32_16x16x32_bf16 a[48:51], a[208:211], v[228:231], 0
TR 222,31,20480
v_mfma_f32_16x16x32_bf16 a[80:83], a[208:211], v[232:235], 0
v_exp_f32 v177, v177
v_mfma_f32_16x16x32_bf16 a[112:115], a[208:211], v[236:239], 0
v_exp_f32 v178, v178
s_barrier
WL 4
v_mfma_f32_16x16x32_bf16 a[116:119], a[212:215], v[236:239], 0
ds_read_b128 a[192:195], v40 offset:32768
v_exp_f32 v179, v179
v_mfma_f32_16x16x32_bf16 a[84:87], a[212:215], v[232:235], 0
v_exp_f32 v184, v184
v_mfma_f32_16x16x32_bf16 a[52:55], a[212:215], v[228:231], 0
ds_read_b128 a[196:199], v41 offset:32768
v_mfma_f32_16x16x32_bf16 a[20:23], a[212:215], v[224:227], 0
v_exp_f32 v185, v185
WL 4
v_mfma_f32_16x16x32_bf16 a[24:27], a[216:219], v[224:227], 0
ds_read_b128 a[200:203], v42 offset:32768
v_mfma_f32_16x16x32_bf16 a[56:59], a[216:219], v[228:231], 0
v_exp_f32 v186, v186
v_mfma_f32_16x16x32_bf16 a[88:91], a[216:219], v[232:235], 0
ds_read_b128 a[204:207], v43 offset:32768
v_mfma_f32_16x16x32_bf16 a[120:123], a[216:219], v[236:239], 0
v_exp_f32 v187, v187
WL 4
v_mfma_f32_16x16x32_bf16 a[124:127], a[220:223], v[236:239], 0
v_exp_f32 v164, v164
v_mfma_f32_16x16x32_bf16 a[92:95], a[220:223], v[232:235], 0
buffer_store_dwordx4 v[104:107], v5, s[4:7], s89 offen offset:0 sc1
v_mfma_f32_16x16x32_bf16 a[60:63], a[220:223], v[228:231], 0
v_exp_f32 v165, v165
v_mfma_f32_16x16x32_bf16 a[28:31], a[220:223], v[224:227], 0
v_exp_f32 v166, v166
WL 0
v_mfma_f32_16x16x32_bf16 v[128:131], a[192:195], a[128:131], v[192:195]
v_exp_f32 v167, v167
MA 128,196,132
ds_read_b128 a[224:227], v40 offset:36864
v_exp_f32 v172, v172
MA 128,200,136
v_exp_f32 v173, v173
MA 128,204,140
ds_read_b128 a[228:231], v41 offset:36864
v_cvt_pk_bf16_f32 v224, v160, v161
v_mfma_f32_16x16x32_bf16 v[136:139], a[204:207], a[156:159], v[196:199]
v_exp_f32 v174, v174
MA 136,200,152
ds_read_b128 a[232:235], v42 offset:36864
v_cvt_pk_bf16_f32 v225, v162, v163
MA 136,196,148
v_exp_f32 v175, v175
MA 136,192,144
ds_read_b128 a[236:239], v43 offset:36864
v_cvt_pk_bf16_f32 v228, v168, v169
v_mfma_f32_16x16x32_bf16 v[144:147], a[192:195], a[160:163], v[200:203]
v_exp_f32 v180, v180
MA 144,196,164
buffer_store_dwordx4 v[108:111], v5, s[4:7], s89 offen offset:128 sc1
s_add_u32 s89, s89, 4096
MA 144,200,168
v_exp_f32 v181, v181
MA 144,204,172
v_exp_f32 v182, v182
v_mfma_f32_16x16x32_bf16 v[152:155], a[204:207], a[188:191], v[204:207]
v_cvt_pk_bf16_f32 v229, v170, v171
v_cvt_pk_bf16_f32 v232, v176, v177
MA 152,200,184
v_exp_f32 v183, v183
MA 152,196,180
v_cvt_pk_bf16_f32 v233, v178, v179
v_cvt_pk_bf16_f32 v236, v184, v185
MA 152,192,176
v_exp_f32 v188, v188
v_cvt_pk_bf16_f32 v237, v186, v187
WL 0
v_mfma_f32_16x16x32_bf16 v[132:135], a[224:227], a[128:131], v[192:195]
v_exp_f32 v189, v189
MA 132,228,132
v_cvt_pk_bf16_f32 v226, v164, v165
v_cvt_pk_bf16_f32 v227, v166, v167
MA 132,232,136
v_exp_f32 v190, v190
MA 132,236,140
v_cvt_pk_bf16_f32 v230, v172, v173
v_cvt_pk_bf16_f32 v231, v174, v175
v_mfma_f32_16x16x32_bf16 v[140:143], a[236:239], a[156:159], v[196:199]
TR 208,24,24576
v_cvt_pk_bf16_f32 v234, v180, v181
MA 140,232,152
TR 210,24,28672
v_cvt_pk_bf16_f32 v235, v182, v183
MA 140,228,148
v_exp_f32 v191, v191
MA 140,224,144
v_cvt_pk_bf16_f32 v238, v188, v189
v_cvt_pk_bf16_f32 v239, v190, v191
v_mfma_f32_16x16x32_bf16 v[208:211], a[240:243], v[224:227], 0
TR 212,25,24576
v_mfma_f32_16x16x32_bf16 v[212:215], a[240:243], v[228:231], 0
TR 214,25,28672
v_mfma_f32_16x16x32_bf16 v[216:219], a[240:243], v[232:235], 0
buffer_load_dword v61, v60, s[28:31], s81 offen
v_mfma_f32_16x16x32_bf16 v[220:223], a[240:243], v[236:239], 0
s_add_u32 s81, s81, 1835008
v_mfma_f32_16x16x32_bf16 v[148:151], a[224:227], a[160:163], v[200:203]
TR 216,26,24576
MA 148,228,164
TR 218,26,28672
MA 148,232,168
MA 148,236,172
v_mfma_f32_16x16x32_bf16 v[156:159], a[236:239], a[188:191], v[204:207]
MA 156,232,184
MA 156,228,180
v_max3_f32 v56, v208, v212, v216
v_max_f32 v56, v56, v220
MA 156,224,176
v_cmp_lt_f32 vcc, 0x49800000, v56
s_nop 0
s_cbranch_vccnz t2_c11
t2_r12:
WL 4
v_mfma_f32_16x16x32_bf16 a[0:3], a[208:211], v[224:227], a[0:3]
TR 220,27,24576
v_add_f32 v48, v48, v208
v_add_f32 v49, v49, v212
v_mfma_f32_16x16x32_bf16 a[32:35], a[208:211], v[228:231], a[32:35]
TR 222,27,28672
buffer_store_dwordx4 v[112:115], v5, s[4:7], s89 offen offset:0 sc1
v_add_f32 v50, v50, v216
v_add_f32 v51, v51, v220
v_mfma_f32_16x16x32_bf16 a[64:67], a[208:211], v[232:235], a[64:67]
v_exp_f32 v128, v128
v_mfma_f32_16x16x32_bf16 a[96:99], a[208:211], v[236:239], a[96:99]
v_exp_f32 v129, v129
WL 4
v_mfma_f32_16x16x32_bf16 a[100:103], a[212:215], v[236:239], a[100:103]
TR 208,28,24576
v_mfma_f32_16x16x32_bf16 a[68:71], a[212:215], v[232:235], a[68:71]
TR 210,28,28672
v_exp_f32 v130, v130
v_mfma_f32_16x16x32_bf16 a[36:39], a[212:215], v[228:231], a[36:39]
v_exp_f32 v131, v131
v_mfma_f32_16x16x32_bf16 a[4:7], a[212:215], v[224:227], a[4:7]
v_exp_f32 v136, v136
WL 4
v_mfma_f32_16x16x32_bf16 a[8:11], a[216:219], v[224:227], a[8:11]
TR 212,29,24576
v_exp_f32 v137, v137
v_mfma_f32_16x16x32_bf16 a[40:43], a[216:219], v[228:231], a[40:43]
TR 214,29,28672
v_mfma_f32_16x16x32_bf16 a[72:75], a[216:219], v[232:235], a[72:75]
v_exp_f32 v138, v138
v_mfma_f32_16x16x32_bf16 a[104:107], a[216:219], v[236:239], a[104:107]
v_exp_f32 v139, v139
WL 4
v_mfma_f32_16x16x32_bf16 a[108:111], a[220:223], v[236:239], a[108:111]
TR 216,30,24576
v_exp_f32 v144, v144
v_mfma_f32_16x16x32_bf16 a[76:79], a[220:223], v[232:235], a[76:79]
TR 218,30,28672
buffer_store_dwordx4 v[116:119], v5, s[4:7], s89 offen offset:128 sc1
s_add_u32 s89, s89, 4096
v_mfma_f32_16x16x32_bf16 a[44:47], a[220:223], v[228:231], a[44:47]
v_exp_f32 v145, v145
v_mfma_f32_16x16x32_bf16 a[12:15], a[220:223], v[224:227], a[12:15]
v_exp_f32 v146, v146
WL 4
v_mfma_f32_16x16x32_bf16 a[16:19], a[208:211], v[224:227], a[16:19]
TR 220,31,24576
v_exp_f32 v147, v147
v_mfma_f32_16x16x32_bf16 a[48:51], a[208:211], v[228:231], a[48:51]
TR 222,31,28672
v_mfma_f32_16x16x32_bf16 a[80:83], a[208:211], v[232:235], a[80:83]
v_exp_f32 v152, v152
v_mfma_f32_16x16x32_bf16 a[112:115], a[208:211], v[236:239], a[112:115]
v_exp_f32 v153, v153
WL 4
v_mfma_f32_16x16x32_bf16 a[116:119], a[212:215], v[236:239], a[116:119]
ds_read_b128 a[192:195], v40 offset:40960
v_mfma_f32_16x16x32_bf16 a[84:87], a[212:215], v[232:235], a[84:87]
v_exp_f32 v154, v154
v_mfma_f32_16x16x32_bf16 a[52:55], a[212:215], v[228:231], a[52:55]
ds_read_b128 a[196:199], v41 offset:40960
v_exp_f32 v155, v155
v_mfma_f32_16x16x32_bf16 a[20:23], a[212:215], v[224:227], a[20:23]
v_exp_f32 v132, v132
WL 4
v_mfma_f32_16x16x32_bf16 a[24:27], a[216:219], v[224:227], a[24:27]
ds_read_b128 a[200:203], v42 offset:40960
v_mfma_f32_16x16x32_bf16 a[56:59], a[216:219], v[228:231], a[56:59]
buffer_store_dwordx4 v[120:123], v5, s[4:7], s89 offen offset:0 sc1
v_mfma_f32_16x16x32_bf16 a[88:91], a[216:219], v[232:235], a[88:91]
ds_read_b128 a[204:207], v43 offset:40960
v_exp_f32 v133, v133
v_mfma_f32_16x16x32_bf16 a[120:123], a[216:219], v[236:239], a[120:123]
v_exp_f32 v134, v134
WL 4
v_mfma_f32_16x16x32_bf16 a[124:127], a[220:223], v[236:239], a[124:127]
v_exp_f32 v135, v135
v_mfma_f32_16x16x32_bf16 a[92:95], a[220:223], v[232:235], a[92:95]
v_exp_f32 v140, v140
v_mfma_f32_16x16x32_bf16 a[60:63], a[220:223], v[228:231], a[60:63]
v_exp_f32 v141, v141
v_mfma_f32_16x16x32_bf16 a[28:31], a[220:223], v[224:227], a[28:31]
v_exp_f32 v142, v142
WL 0
v_mfma_f32_16x16x32_bf16 v[160:163], a[192:195], a[128:131], v[192:195]
v_exp_f32 v143, v143
v_cvt_pk_bf16_f32 v224, v128, v129
MA 160,196,132
ds_read_b128 a[224:227], v40 offset:45056
v_cvt_pk_bf16_f32 v225, v130, v131
MA 160,200,136
v_exp_f32 v148, v148
MA 160,204,140
ds_read_b128 a[228:231], v41 offset:45056
s_lshl_b32 s60, s54, 13
v_mfma_f32_16x16x32_bf16 v[168:171], a[204:207], a[156:159], v[196:199]
v_exp_f32 v149, v149
MA 168,200,152
ds_read_b128 a[232:235], v42 offset:45056
s_lshl_b32 s62, s73, 9
buffer_store_dwordx4 v[124:127], v5, s[4:7], s89 offen offset:128 sc1
s_add_u32 s89, s89, 4096
MA 168,196,148
v_exp_f32 v150, v150
MA 168,192,144
ds_read_b128 a[236:239], v43 offset:45056
s_add_u32 s60, s60, s62
v_cvt_pk_bf16_f32 v228, v136, v137
v_mfma_f32_16x16x32_bf16 v[176:179], a[192:195], a[160:163], v[200:203]
v_cvt_pk_bf16_f32 v229, v138, v139
v_cvt_pk_bf16_f32 v232, v144, v145
MA 176,196,164
s_lshl_b32 s62, s72, 8
v_exp_f32 v151, v151
MA 176,200,168
v_cvt_pk_bf16_f32 v233, v146, v147
v_cvt_pk_bf16_f32 v236, v152, v153
MA 176,204,172
buffer_load_dword v61, v60, s[84:87], s77 offen
s_add_u32 s60, s60, s62
v_mfma_f32_16x16x32_bf16 v[184:187], a[204:207], a[188:191], v[204:207]
v_exp_f32 v156, v156
MA 184,200,184
s_add_u32 s60, s60, 20971520
v_cvt_pk_bf16_f32 v237, v154, v155
v_cvt_pk_bf16_f32 v226, v132, v133
MA 184,196,180
v_exp_f32 v157, v157
MA 184,192,176
s_add_u32 s61, s60, 4096
v_cvt_pk_bf16_f32 v227, v134, v135
WL 0
v_mfma_f32_16x16x32_bf16 v[164:167], a[224:227], a[128:131], v[192:195]
v_exp_f32 v158, v158
MA 164,228,132
buffer_load_dword v17, v22, s[4:7], s78 offen offset:256 sc1
v_and_b32 v248, 15, v0
MA 164,232,136
v_cvt_pk_bf16_f32 v230, v140, v141
v_cvt_pk_bf16_f32 v231, v142, v143
MA 164,236,140
v_lshlrev_b32 v248, 3, v248
v_cvt_pk_bf16_f32 v234, v148, v149
v_mfma_f32_16x16x32_bf16 v[172:175], a[236:239], a[156:159], v[196:199]
TR 208,24,49152
v_cvt_pk_bf16_f32 v235, v150, v151
MA 172,232,152
TR 210,24,53248
v_lshl_add_u32 v248, v19, 10, v248
MA 172,228,148
v_exp_f32 v159, v159
MA 172,224,144
v_cvt_pk_bf16_f32 v238, v156, v157
v_cvt_pk_bf16_f32 v239, v158, v159
v_mfma_f32_16x16x32_bf16 v[208:211], a[240:243], v[224:227], 0
TR 212,25,49152
v_mfma_f32_16x16x32_bf16 v[212:215], a[240:243], v[228:231], 0
TR 214,25,53248
v_mfma_f32_16x16x32_bf16 v[216:219], a[240:243], v[232:235], 0
TR 216,26,49152
v_mfma_f32_16x16x32_bf16 v[220:223], a[240:243], v[236:239], 0
TR 218,26,53248
v_mfma_f32_16x16x32_bf16 v[180:183], a[224:227], a[160:163], v[200:203]
MA 180,228,164
MA 180,232,168
MA 180,236,172
v_mfma_f32_16x16x32_bf16 v[188:191], a[236:239], a[188:191], v[204:207]
MA 188,232,184
MA 188,228,180
v_max3_f32 v56, v208, v212, v216
v_max_f32 v56, v56, v220
MA 188,224,176
v_cmp_lt_f32 vcc, 0x49800000, v56
s_nop 0
s_cbranch_vccnz t2_c13
t2_r14:
WL 4
v_mfma_f32_16x16x32_bf16 a[0:3], a[208:211], v[224:227], a[0:3]
TR 220,27,49152
v_add_f32 v48, v48, v208
v_add_f32 v49, v49, v212
v_mfma_f32_16x16x32_bf16 a[32:35], a[208:211], v[228:231], a[32:35]
TR 222,27,53248
v_add_f32 v50, v50, v216
v_add_f32 v51, v51, v220
v_mfma_f32_16x16x32_bf16 a[64:67], a[208:211], v[232:235], a[64:67]
v_exp_f32 v160, v160
v_mfma_f32_16x16x32_bf16 a[96:99], a[208:211], v[236:239], a[96:99]
v_exp_f32 v161, v161
WL 4
v_mfma_f32_16x16x32_bf16 a[100:103], a[212:215], v[236:239], a[100:103]
TR 208,28,49152
v_exp_f32 v162, v162
v_mfma_f32_16x16x32_bf16 a[68:71], a[212:215], v[232:235], a[68:71]
TR 210,28,53248
v_mfma_f32_16x16x32_bf16 a[36:39], a[212:215], v[228:231], a[36:39]
v_exp_f32 v163, v163
v_mfma_f32_16x16x32_bf16 a[4:7], a[212:215], v[224:227], a[4:7]
v_exp_f32 v168, v168
WL 4
v_mfma_f32_16x16x32_bf16 a[8:11], a[216:219], v[224:227], a[8:11]
TR 212,29,49152
v_exp_f32 v169, v169
v_mfma_f32_16x16x32_bf16 a[40:43], a[216:219], v[228:231], a[40:43]
TR 214,29,53248
v_exp_f32 v170, v170
v_mfma_f32_16x16x32_bf16 a[72:75], a[216:219], v[232:235], a[72:75]
v_exp_f32 v171, v171
v_mfma_f32_16x16x32_bf16 a[104:107], a[216:219], v[236:239], a[104:107]
v_exp_f32 v176, v176
WL 4
v_mfma_f32_16x16x32_bf16 a[108:111], a[220:223], v[236:239], a[108:111]
TR 216,30,49152
v_exp_f32 v177, v177
v_mfma_f32_16x16x32_bf16 a[76:79], a[220:223], v[232:235], a[76:79]
TR 218,30,53248
v_mfma_f32_16x16x32_bf16 a[44:47], a[220:223], v[228:231], a[44:47]
v_exp_f32 v178, v178
v_mfma_f32_16x16x32_bf16 a[12:15], a[220:223], v[224:227], a[12:15]
v_exp_f32 v179, v179
WL 4
v_mfma_f32_16x16x32_bf16 a[16:19], a[208:211], v[224:227], a[16:19]
TR 220,31,49152
v_exp_f32 v184, v184
v_mfma_f32_16x16x32_bf16 a[48:51], a[208:211], v[228:231], a[48:51]
TR 222,31,53248
v_exp_f32 v185, v185
v_mfma_f32_16x16x32_bf16 a[80:83], a[208:211], v[232:235], a[80:83]
v_exp_f32 v186, v186
v_mfma_f32_16x16x32_bf16 a[112:115], a[208:211], v[236:239], a[112:115]
v_exp_f32 v187, v187
WV 0
v_cmp_gt_u32 s[68:69], 8, v17
s_nop 0
s_and_b64 s[68:69], s[68:69], s[74:75]
s_cbranch_scc1 t2_slow7
t2_back8:
s_barrier
WL 4
v_mfma_f32_16x16x32_bf16 a[116:119], a[212:215], v[236:239], a[116:119]
ds_read_b128 a[192:195], v44 offset:0
v_exp_f32 v164, v164
v_mfma_f32_16x16x32_bf16 a[84:87], a[212:215], v[232:235], a[84:87]
v_exp_f32 v165, v165
v_mfma_f32_16x16x32_bf16 a[52:55], a[212:215], v[228:231], a[52:55]
ds_read_b128 a[196:199], v45 offset:0
s_add_u32 m0, s48, 0
v_mfma_f32_16x16x32_bf16 a[20:23], a[212:215], v[224:227], a[20:23]
DM 8,20,52,0
WL 4
v_mfma_f32_16x16x32_bf16 a[24:27], a[216:219], v[224:227], a[24:27]
ds_read_b128 a[200:203], v46 offset:0
v_exp_f32 v166, v166
v_mfma_f32_16x16x32_bf16 a[56:59], a[216:219], v[228:231], a[56:59]
buffer_load_dwordx2 v[240:241], v248, s[4:7], s60 offen offset:0 sc1
v_mfma_f32_16x16x32_bf16 a[88:91], a[216:219], v[232:235], a[88:91]
ds_read_b128 a[204:207], v47 offset:0
v_mfma_f32_16x16x32_bf16 a[120:123], a[216:219], v[236:239], a[120:123]
DM 9,20,52,1024
WL 4
v_mfma_f32_16x16x32_bf16 a[124:127], a[220:223], v[236:239], a[124:127]
v_exp_f32 v167, v167
v_mfma_f32_16x16x32_bf16 a[92:95], a[220:223], v[232:235], a[92:95]
buffer_load_dwordx2 v[242:243], v248, s[4:7], s61 offen offset:0 sc1
v_mfma_f32_16x16x32_bf16 a[60:63], a[220:223], v[228:231], a[60:63]
v_exp_f32 v172, v172
v_mfma_f32_16x16x32_bf16 a[28:31], a[220:223], v[224:227], a[28:31]
DM 10,20,52,2048
v_exp_f32 v173, v173
WL 0
v_mfma_f32_16x16x32_bf16 v[128:131], a[192:195], a[128:131], v[192:195]
v_exp_f32 v174, v174
MA 128,196,132
ds_read_b128 a[224:227], v44 offset:4096
buffer_load_dwordx2 v[244:245], v248, s[4:7], s60 offen offset:128 sc1
MA 128,200,136
v_exp_f32 v175, v175
MA 128,204,140
ds_read_b128 a[228:231], v45 offset:4096
DM 11,20,52,3072
v_mfma_f32_16x16x32_bf16 v[136:139], a[204:207], a[156:159], v[196:199]
v_exp_f32 v180, v180
v_cvt_pk_bf16_f32 v224, v160, v161
MA 136,200,152
ds_read_b128 a[232:235], v46 offset:4096
buffer_load_dwordx2 v[246:247], v248, s[4:7], s61 offen offset:128 sc1
MA 136,196,148
s_add_u32 m0, s48, 16384
v_exp_f32 v181, v181
MA 136,192,144
ds_read_b128 a[236:239], v47 offset:4096
DM 16,24,52,0
v_mfma_f32_16x16x32_bf16 v[144:147], a[192:195], a[160:163], v[200:203]
v_cvt_pk_bf16_f32 v225, v162, v163
v_cvt_pk_bf16_f32 v228, v168, v169
MA 144,196,164
v_exp_f32 v182, v182
MA 144,200,168
v_cvt_pk_bf16_f32 v229, v170, v171
v_cvt_pk_bf16_f32 v232, v176, v177
MA 144,204,172
DM 4,24,52,1024
v_cvt_pk_bf16_f32 v233, v178, v179
v_mfma_f32_16x16x32_bf16 v[152:155], a[204:207], a[188:191], v[204:207]
v_exp_f32 v183, v183
MA 152,200,184
v_exp_f32 v188, v188
MA 152,196,180
v_cvt_pk_bf16_f32 v236, v184, v185
v_cvt_pk_bf16_f32 v237, v186, v187
MA 152,192,176
DM 16,24,52,2048
WL 0
v_mfma_f32_16x16x32_bf16 v[132:135], a[224:227], a[128:131], v[192:195]
v_exp_f32 v189, v189
v_cvt_pk_bf16_f32 v226, v164, v165
MA 132,228,132
v_cvt_pk_bf16_f32 v227, v166, v167
v_cvt_pk_bf16_f32 v230, v172, v173
MA 132,232,136
v_exp_f32 v190, v190
MA 132,236,140
DM 4,24,52,3072
s_add_u32 s52, s52, 16384
v_mfma_f32_16x16x32_bf16 v[140:143], a[236:239], a[156:159], v[196:199]
TR 208,24,57344
v_cvt_pk_bf16_f32 v231, v174, v175
MA 140,232,152
TR 210,24,61440
v_exp_f32 v191, v191
MA 140,228,148
v_cvt_pk_bf16_f32 v234, v180, v181
v_cvt_pk_bf16_f32 v235, v182, v183
MA 140,224,144
v_cvt_pk_bf16_f32 v238, v188, v189
v_cvt_pk_bf16_f32 v239, v190, v191
v_mfma_f32_16x16x32_bf16 v[208:211], a[240:243], v[224:227], 0
TR 212,25,57344
v_mfma_f32_16x16x32_bf16 v[212:215], a[240:243], v[228:231], 0
TR 214,25,61440
v_mfma_f32_16x16x32_bf16 v[216:219], a[240:243], v[232:235], 0
TR 216,26,57344
v_mfma_f32_16x16x32_bf16 v[220:223], a[240:243], v[236:239], 0
TR 218,26,61440
v_mfma_f32_16x16x32_bf16 v[148:151], a[224:227], a[160:163], v[200:203]
MA 148,228,164
MA 148,232,168
MA 148,236,172
v_mfma_f32_16x16x32_bf16 v[156:159], a[236:239], a[188:191], v[204:207]
MA 156,232,184
MA 156,228,180
v_max3_f32 v56, v208, v212, v216
v_max_f32 v56, v56, v220
MA 156,224,176
v_cmp_lt_f32 vcc, 0x49800000, v56
s_nop 0
s_cbranch_vccnz t2_c15
t2_r16:
s_lshl_b32 s60, s54, 1
s_add_u32 s60, s60, s73
s_mul_i32 s60, s60, 131072
s_lshl_b32 s65, s94, 12
s_add_u32 s60, s60, s65
s_lshl_b32 s65, s72, 8
s_add_u32 s60, s60, s65
s_add_u32 s60, s60, 12582912
WV 8
v_pk_add_f32 v[240:241], v[240:241], v[242:243]
WV 4
v_pk_add_f32 v[244:245], v[244:245], v[246:247]
v_mov_b32 v248, v240
v_mov_b32 v249, v241
v_mov_b32 v250, v244
v_mov_b32 v251, v245
v_permlane16_swap_b32 v240, v248
v_permlane16_swap_b32 v241, v249
v_permlane16_swap_b32 v244, v250
v_permlane16_swap_b32 v245, v251
v_add_f32 v240, v240, v248
v_add_f32 v241, v241, v249
v_add_f32 v244, v244, v250
v_add_f32 v245, v245, v251
v_mov_b32 v248, v240
v_mov_b32 v249, v241
v_mov_b32 v250, v244
v_mov_b32 v251, v245
v_permlane32_swap_b32 v240, v248
v_permlane32_swap_b32 v241, v249
v_permlane32_swap_b32 v244, v250
v_permlane32_swap_b32 v245, v251
v_add_f32 v240, v240, v248
v_add_f32 v241, v241, v249
v_add_f32 v244, v244, v250
v_add_f32 v245, v245, v251
v_mul_f32 v240, 0x3a800000, v240
v_mul_f32 v244, 0x3a800000, v244
v_mul_f32 v248, v240, v240
v_mul_f32 v249, v244, v244
v_mul_f32 v241, 0x3a800000, v241
v_mul_f32 v245, 0x3a800000, v245
v_sub_f32 v241, v241, v248
v_sub_f32 v245, v245, v249
v_max_f32 v241, 0, v241
v_max_f32 v245, 0, v245
v_cvt_pk_bf16_f32 v240, v240, v240
v_cvt_pk_bf16_f32 v244, v244, v244
v_lshlrev_b32 v240, 16, v240
v_lshlrev_b32 v244, 16, v244
v_cvt_pk_bf16_f32 v241, v241, v241
v_cvt_pk_bf16_f32 v245, v245, v245
v_lshlrev_b32 v241, 16, v241
v_lshlrev_b32 v245, 16, v245
v_add_f32 v241, 0x3727c5ac, v241
v_add_f32 v245, 0x3727c5ac, v245
v_cvt_pk_bf16_f32 v241, v241, v241
v_cvt_pk_bf16_f32 v245, v245, v245
v_lshlrev_b32 v241, 16, v241
v_lshlrev_b32 v245, 16, v245
v_sqrt_f32 v241, v241
v_sqrt_f32 v245, v245
v_cvt_pk_bf16_f32 v241, v241, v241
v_cvt_pk_bf16_f32 v245, v245, v245
v_lshlrev_b32 v241, 16, v241
v_lshlrev_b32 v245, 16, v245
v_rcp_f32 v241, v241
v_rcp_f32 v245, v245
v_mul_f32 v242, -v240, v241
v_mul_f32 v246, -v244, v245
v_mov_b32 v240, v241
v_mov_b32 v244, v245
v_lshlrev_b32 v248, 16, v96
v_and_b32 v249, 0xffff0000, v96
v_lshlrev_b32 v250, 16, v97
v_and_b32 v251, 0xffff0000, v97
v_lshlrev_b32 v252, 16, v98
v_and_b32 v253, 0xffff0000, v98
v_lshlrev_b32 v254, 16, v99
v_and_b32 v255, 0xffff0000, v99
v_pk_fma_f32 v[248:249], v[248:249], v[240:241], v[242:243] op_sel_hi:[1,0,0]
v_pk_fma_f32 v[250:251], v[250:251], v[240:241], v[242:243] op_sel_hi:[1,0,0]
v_pk_fma_f32 v[252:253], v[252:253], v[240:241], v[242:243] op_sel_hi:[1,0,0]
v_pk_fma_f32 v[254:255], v[254:255], v[240:241], v[242:243] op_sel_hi:[1,0,0]
v_cvt_pk_bf16_f32 v64, v248, v249
v_cvt_pk_bf16_f32 v65, v250, v251
v_cvt_pk_bf16_f32 v66, v252, v253
v_cvt_pk_bf16_f32 v67, v254, v255
v_lshlrev_b32 v248, 16, v100
v_and_b32 v249, 0xffff0000, v100
v_lshlrev_b32 v250, 16, v101
v_and_b32 v251, 0xffff0000, v101
v_lshlrev_b32 v252, 16, v102
v_and_b32 v253, 0xffff0000, v102
v_lshlrev_b32 v254, 16, v103
v_and_b32 v255, 0xffff0000, v103
v_pk_fma_f32 v[248:249], v[248:249], v[244:245], v[246:247] op_sel_hi:[1,0,0]
v_pk_fma_f32 v[250:251], v[250:251], v[244:245], v[246:247] op_sel_hi:[1,0,0]
v_pk_fma_f32 v[252:253], v[252:253], v[244:245], v[246:247] op_sel_hi:[1,0,0]
v_pk_fma_f32 v[254:255], v[254:255], v[244:245], v[246:247] op_sel_hi:[1,0,0]
v_cvt_pk_bf16_f32 v68, v248, v249
v_cvt_pk_bf16_f32 v69, v250, v251
v_cvt_pk_bf16_f32 v70, v252, v253
v_cvt_pk_bf16_f32 v71, v254, v255
v_lshlrev_b32 v248, 16, v104
v_and_b32 v249, 0xffff0000, v104
v_lshlrev_b32 v250, 16, v105
v_and_b32 v251, 0xffff0000, v105
v_lshlrev_b32 v252, 16, v106
v_and_b32 v253, 0xffff0000, v106
v_lshlrev_b32 v254, 16, v107
v_and_b32 v255, 0xffff0000, v107
v_pk_fma_f32 v[248:249], v[248:249], v[240:241], v[242:243] op_sel_hi:[1,0,0]
v_pk_fma_f32 v[250:251], v[250:251], v[240:241], v[242:243] op_sel_hi:[1,0,0]
v_pk_fma_f32 v[252:253], v[252:253], v[240:241], v[242:243] op_sel_hi:[1,0,0]
v_pk_fma_f32 v[254:255], v[254:255], v[240:241], v[242:243] op_sel_hi:[1,0,0]
v_cvt_pk_bf16_f32 v72, v248, v249
v_cvt_pk_bf16_f32 v73, v250, v251
v_cvt_pk_bf16_f32 v74, v252, v253
v_cvt_pk_bf16_f32 v75, v254, v255
v_lshlrev_b32 v248, 16, v108
v_and_b32 v249, 0xffff0000, v108
v_lshlrev_b32 v250, 16, v109
v_and_b32 v251, 0xffff0000, v109
v_lshlrev_b32 v252, 16, v110
v_and_b32 v253, 0xffff0000, v110
v_lshlrev_b32 v254, 16, v111
v_and_b32 v255, 0xffff0000, v111
v_pk_fma_f32 v[248:249], v[248:249], v[244:245], v[246:247] op_sel_hi:[1,0,0]
v_pk_fma_f32 v[250:251], v[250:251], v[244:245], v[246:247] op_sel_hi:[1,0,0]
v_pk_fma_f32 v[252:253], v[252:253], v[244:245], v[246:247] op_sel_hi:[1,0,0]
v_pk_fma_f32 v[254:255], v[254:255], v[244:245], v[246:247] op_sel_hi:[1,0,0]
v_cvt_pk_bf16_f32 v76, v248, v249
v_cvt_pk_bf16_f32 v77, v250, v251
v_cvt_pk_bf16_f32 v78, v252, v253
v_cvt_pk_bf16_f32 v79, v254, v255
v_lshlrev_b32 v248, 16, v112
v_and_b32 v249, 0xffff0000, v112
v_lshlrev_b32 v250, 16, v113
v_and_b32 v251, 0xffff0000, v113
v_lshlrev_b32 v252, 16, v114
v_and_b32 v253, 0xffff0000, v114
v_lshlrev_b32 v254, 16, v115
v_and_b32 v255, 0xffff0000, v115
v_pk_fma_f32 v[248:249], v[248:249], v[240:241], v[242:243] op_sel_hi:[1,0,0]
v_pk_fma_f32 v[250:251], v[250:251], v[240:241], v[242:243] op_sel_hi:[1,0,0]
v_pk_fma_f32 v[252:253], v[252:253], v[240:241], v[242:243] op_sel_hi:[1,0,0]
v_pk_fma_f32 v[254:255], v[254:255], v[240:241], v[242:243] op_sel_hi:[1,0,0]
v_cvt_pk_bf16_f32 v80, v248, v249
v_cvt_pk_bf16_f32 v81, v250, v251
v_cvt_pk_bf16_f32 v82, v252, v253
v_cvt_pk_bf16_f32 v83, v254, v255
v_lshlrev_b32 v248, 16, v116
v_and_b32 v249, 0xffff0000, v116
v_lshlrev_b32 v250, 16, v117
v_and_b32 v251, 0xffff0000, v117
v_lshlrev_b32 v252, 16, v118
v_and_b32 v253, 0xffff0000, v118
v_lshlrev_b32 v254, 16, v119
v_and_b32 v255, 0xffff0000, v119
v_pk_fma_f32 v[248:249], v[248:249], v[244:245], v[246:247] op_sel_hi:[1,0,0]
v_pk_fma_f32 v[250:251], v[250:251], v[244:245], v[246:247] op_sel_hi:[1,0,0]
v_pk_fma_f32 v[252:253], v[252:253], v[244:245], v[246:247] op_sel_hi:[1,0,0]
v_pk_fma_f32 v[254:255], v[254:255], v[244:245], v[246:247] op_sel_hi:[1,0,0]
v_cvt_pk_bf16_f32 v84, v248, v249
v_cvt_pk_bf16_f32 v85, v250, v251
v_cvt_pk_bf16_f32 v86, v252, v253
v_cvt_pk_bf16_f32 v87, v254, v255
v_lshlrev_b32 v248, 16, v120
v_and_b32 v249, 0xffff0000, v120
v_lshlrev_b32 v250, 16, v121
v_and_b32 v251, 0xffff0000, v121
v_lshlrev_b32 v252, 16, v122
v_and_b32 v253, 0xffff0000, v122
v_lshlrev_b32 v254, 16, v123
v_and_b32 v255, 0xffff0000, v123
v_pk_fma_f32 v[248:249], v[248:249], v[240:241], v[242:243] op_sel_hi:[1,0,0]
v_pk_fma_f32 v[250:251], v[250:251], v[240:241], v[242:243] op_sel_hi:[1,0,0]
v_pk_fma_f32 v[252:253], v[252:253], v[240:241], v[242:243] op_sel_hi:[1,0,0]
v_pk_fma_f32 v[254:255], v[254:255], v[240:241], v[242:243] op_sel_hi:[1,0,0]
v_cvt_pk_bf16_f32 v88, v248, v249
v_cvt_pk_bf16_f32 v89, v250, v251
v_cvt_pk_bf16_f32 v90, v252, v253
v_cvt_pk_bf16_f32 v91, v254, v255
v_lshlrev_b32 v248, 16, v124
v_and_b32 v249, 0xffff0000, v124
v_lshlrev_b32 v250, 16, v125
v_and_b32 v251, 0xffff0000, v125
v_lshlrev_b32 v252, 16, v126
v_and_b32 v253, 0xffff0000, v126
v_lshlrev_b32 v254, 16, v127
v_and_b32 v255, 0xffff0000, v127
v_pk_fma_f32 v[248:249], v[248:249], v[244:245], v[246:247] op_sel_hi:[1,0,0]
v_pk_fma_f32 v[250:251], v[250:251], v[244:245], v[246:247] op_sel_hi:[1,0,0]
v_pk_fma_f32 v[252:253], v[252:253], v[244:245], v[246:247] op_sel_hi:[1,0,0]
v_pk_fma_f32 v[254:255], v[254:255], v[244:245], v[246:247] op_sel_hi:[1,0,0]
v_cvt_pk_bf16_f32 v92, v248, v249
v_cvt_pk_bf16_f32 v93, v250, v251
v_cvt_pk_bf16_f32 v94, v252, v253
v_cvt_pk_bf16_f32 v95, v254, v255
WL 4
v_mfma_f32_16x16x32_bf16 a[0:3], a[208:211], v[224:227], a[0:3]
TR 220,27,57344
v_add_f32 v48, v48, v208
v_add_f32 v49, v49, v212
v_mfma_f32_16x16x32_bf16 a[32:35], a[208:211], v[228:231], a[32:35]
TR 222,27,61440
buffer_store_dwordx4 v[64:67], v5, s[4:7], s60 offen offset:0 sc1
v_add_f32 v50, v50, v216
v_add_f32 v51, v51, v220
v_mfma_f32_16x16x32_bf16 a[64:67], a[208:211], v[232:235], a[64:67]
v_exp_f32 v128, v128
v_mfma_f32_16x16x32_bf16 a[96:99], a[208:211], v[236:239], a[96:99]
v_exp_f32 v129, v129
WL 4
v_mfma_f32_16x16x32_bf16 a[100:103], a[212:215], v[236:239], a[100:103]
TR 208,28,57344
v_mfma_f32_16x16x32_bf16 a[68:71], a[212:215], v[232:235], a[68:71]
TR 210,28,61440
v_mfma_f32_16x16x32_bf16 a[36:39], a[212:215], v[228:231], a[36:39]
v_exp_f32 v130, v130
v_mfma_f32_16x16x32_bf16 a[4:7], a[212:215], v[224:227], a[4:7]
v_exp_f32 v131, v131
WL 4
v_mfma_f32_16x16x32_bf16 a[8:11], a[216:219], v[224:227], a[8:11]
TR 212,29,57344
v_mfma_f32_16x16x32_bf16 a[40:43], a[216:219], v[228:231], a[40:43]
TR 214,29,61440
v_mfma_f32_16x16x32_bf16 a[72:75], a[216:219], v[232:235], a[72:75]
v_exp_f32 v136, v136
v_mfma_f32_16x16x32_bf16 a[104:107], a[216:219], v[236:239], a[104:107]
v_exp_f32 v137, v137
WL 4
v_mfma_f32_16x16x32_bf16 a[108:111], a[220:223], v[236:239], a[108:111]
TR 216,30,57344
v_exp_f32 v138, v138
v_mfma_f32_16x16x32_bf16 a[76:79], a[220:223], v[232:235], a[76:79]
TR 218,30,61440
v_mfma_f32_16x16x32_bf16 a[44:47], a[220:223], v[228:231], a[44:47]
v_exp_f32 v139, v139
v_mfma_f32_16x16x32_bf16 a[12:15], a[220:223], v[224:227], a[12:15]
v_exp_f32 v144, v144
WL 4
v_mfma_f32_16x16x32_bf16 a[16:19], a[208:211], v[224:227], a[16:19]
TR 220,31,57344
v_mfma_f32_16x16x32_bf16 a[48:51], a[208:211], v[228:231], a[48:51]
TR 222,31,61440
buffer_store_dwordx4 v[68:71], v5, s[4:7], s60 offen offset:128 sc1
s_add_u32 s60, s60, 4096
v_mfma_f32_16x16x32_bf16 a[80:83], a[208:211], v[232:235], a[80:83]
v_exp_f32 v145, v145
v_mfma_f32_16x16x32_bf16 a[112:115], a[208:211], v[236:239], a[112:115]
v_exp_f32 v146, v146
WL 4
v_mfma_f32_16x16x32_bf16 a[116:119], a[212:215], v[236:239], a[116:119]
ds_read_b128 a[192:195], v44 offset:8192
v_mfma_f32_16x16x32_bf16 a[84:87], a[212:215], v[232:235], a[84:87]
v_exp_f32 v147, v147
v_mfma_f32_16x16x32_bf16 a[52:55], a[212:215], v[228:231], a[52:55]
ds_read_b128 a[196:199], v45 offset:8192
v_mfma_f32_16x16x32_bf16 a[20:23], a[212:215], v[224:227], a[20:23]
v_exp_f32 v152, v152
WL 4
v_mfma_f32_16x16x32_bf16 a[24:27], a[216:219], v[224:227], a[24:27]
ds_read_b128 a[200:203], v46 offset:8192
v_exp_f32 v153, v153
v_mfma_f32_16x16x32_bf16 a[56:59], a[216:219], v[228:231], a[56:59]
v_exp_f32 v154, v154
v_mfma_f32_16x16x32_bf16 a[88:91], a[216:219], v[232:235], a[88:91]
ds_read_b128 a[204:207], v47 offset:8192
v_mfma_f32_16x16x32_bf16 a[120:123], a[216:219], v[236:239], a[120:123]
v_exp_f32 v155, v155
WL 4
v_mfma_f32_16x16x32_bf16 a[124:127], a[220:223], v[236:239], a[124:127]
v_exp_f32 v132, v132
v_mfma_f32_16x16x32_bf16 a[92:95], a[220:223], v[232:235], a[92:95]
v_exp_f32 v133, v133
v_mfma_f32_16x16x32_bf16 a[60:63], a[220:223], v[228:231], a[60:63]
v_exp_f32 v134, v134
v_mfma_f32_16x16x32_bf16 a[28:31], a[220:223], v[224:227], a[28:31]
v_exp_f32 v135, v135
WL 0
v_mfma_f32_16x16x32_bf16 v[160:163], a[192:195], a[128:131], v[192:195]
v_exp_f32 v140, v140
MA 160,196,132
ds_read_b128 a[224:227], v44 offset:12288
buffer_store_dwordx4 v[72:75], v5, s[4:7], s60 offen offset:0 sc1
MA 160,200,136
v_exp_f32 v141, v141
MA 160,204,140
ds_read_b128 a[228:231], v45 offset:12288
v_cvt_pk_bf16_f32 v224, v128, v129
v_mfma_f32_16x16x32_bf16 v[168:171], a[204:207], a[156:159], v[196:199]
v_exp_f32 v142, v142
MA 168,200,152
ds_read_b128 a[232:235], v46 offset:12288
v_cvt_pk_bf16_f32 v225, v130, v131
MA 168,196,148
v_exp_f32 v143, v143
MA 168,192,144
ds_read_b128 a[236:239], v47 offset:12288
v_cvt_pk_bf16_f32 v228, v136, v137
v_mfma_f32_16x16x32_bf16 v[176:179], a[192:195], a[160:163], v[200:203]
v_exp_f32 v148, v148
MA 176,196,164
v_exp_f32 v149, v149
MA 176,200,168
v_exp_f32 v150, v150
MA 176,204,172
v_cvt_pk_bf16_f32 v229, v138, v139
v_exp_f32 v151, v151
v_mfma_f32_16x16x32_bf16 v[184:187], a[204:207], a[188:191], v[204:207]
v_cvt_pk_bf16_f32 v232, v144, v145
v_cvt_pk_bf16_f32 v233, v146, v147
MA 184,200,184
v_exp_f32 v156, v156
MA 184,196,180
v_cvt_pk_bf16_f32 v236, v152, v153
v_cvt_pk_bf16_f32 v237, v154, v155
MA 184,192,176
v_exp_f32 v157, v157
WL 0
v_mfma_f32_16x16x32_bf16 v[164:167], a[224:227], a[128:131], v[192:195]
v_cvt_pk_bf16_f32 v226, v132, v133
v_cvt_pk_bf16_f32 v227, v134, v135
MA 164,228,132
buffer_store_dwordx4 v[76:79], v5, s[4:7], s60 offen offset:128 sc1
s_add_u32 s60, s60, 4096
MA 164,232,136
v_exp_f32 v158, v158
MA 164,236,140
v_cvt_pk_bf16_f32 v230, v140, v141
v_cvt_pk_bf16_f32 v231, v142, v143
v_mfma_f32_16x16x32_bf16 v[172:175], a[236:239], a[156:159], v[196:199]
TR 208,32,16384
v_cvt_pk_bf16_f32 v234, v148, v149
MA 172,232,152
TR 210,32,20480
v_cvt_pk_bf16_f32 v235, v150, v151
MA 172,228,148
v_exp_f32 v159, v159
MA 172,224,144
v_cvt_pk_bf16_f32 v238, v156, v157
v_cvt_pk_bf16_f32 v239, v158, v159
v_mfma_f32_16x16x32_bf16 v[208:211], a[240:243], v[224:227], 0
TR 212,33,16384
v_mfma_f32_16x16x32_bf16 v[212:215], a[240:243], v[228:231], 0
TR 214,33,20480
v_mfma_f32_16x16x32_bf16 v[216:219], a[240:243], v[232:235], 0
TR 216,34,16384
v_mfma_f32_16x16x32_bf16 v[220:223], a[240:243], v[236:239], 0
TR 218,34,20480
v_mfma_f32_16x16x32_bf16 v[180:183], a[224:227], a[160:163], v[200:203]
MA 180,228,164
MA 180,232,168
MA 180,236,172
v_mfma_f32_16x16x32_bf16 v[188:191], a[236:239], a[188:191], v[204:207]
MA 188,232,184
MA 188,228,180
v_max3_f32 v56, v208, v212, v216
v_max_f32 v56, v56, v220
MA 188,224,176
v_cmp_lt_f32 vcc, 0x49800000, v56
s_nop 0
s_cbranch_vccnz t2_c17
t2_r18:
WL 4
v_mfma_f32_16x16x32_bf16 a[0:3], a[208:211], v[224:227], a[0:3]
TR 220,35,16384
v_add_f32 v48, v48, v208
v_add_f32 v49, v49, v212
v_mfma_f32_16x16x32_bf16 a[32:35], a[208:211], v[228:231], a[32:35]
TR 222,35,20480
buffer_store_dwordx4 v[80:83], v5, s[4:7], s60 offen offset:0 sc1
v_add_f32 v50, v50, v216
v_add_f32 v51, v51, v220
v_mfma_f32_16x16x32_bf16 a[64:67], a[208:211], v[232:235], a[64:67]
v_exp_f32 v160, v160
v_mfma_f32_16x16x32_bf16 a[96:99], a[208:211], v[236:239], a[96:99]
v_exp_f32 v161, v161
WL 4
v_mfma_f32_16x16x32_bf16 a[100:103], a[212:215], v[236:239], a[100:103]
TR 208,36,16384
v_exp_f32 v162, v162
v_mfma_f32_16x16x32_bf16 a[68:71], a[212:215], v[232:235], a[68:71]
TR 210,36,20480
v_mfma_f32_16x16x32_bf16 a[36:39], a[212:215], v[228:231], a[36:39]
v_exp_f32 v163, v163
v_mfma_f32_16x16x32_bf16 a[4:7], a[212:215], v[224:227], a[4:7]
v_exp_f32 v168, v168
WL 4
v_mfma_f32_16x16x32_bf16 a[8:11], a[216:219], v[224:227], a[8:11]
TR 212,37,16384
v_exp_f32 v169, v169
v_mfma_f32_16x16x32_bf16 a[40:43], a[216:219], v[228:231], a[40:43]
TR 214,37,20480
v_mfma_f32_16x16x32_bf16 a[72:75], a[216:219], v[232:235], a[72:75]
v_exp_f32 v170, v170
v_mfma_f32_16x16x32_bf16 a[104:107], a[216:219], v[236:239], a[104:107]
v_exp_f32 v171, v171
WL 4
v_mfma_f32_16x16x32_bf16 a[108:111], a[220:223], v[236:239], a[108:111]
TR 216,38,16384
v_exp_f32 v176, v176
v_mfma_f32_16x16x32_bf16 a[76:79], a[220:223], v[232:235], a[76:79]
TR 218,38,20480
v_exp_f32 v177, v177
v_mfma_f32_16x16x32_bf16 a[44:47], a[220:223], v[228:231], a[44:47]
v_exp_f32 v178, v178
v_mfma_f32_16x16x32_bf16 a[12:15], a[220:223], v[224:227], a[12:15]
v_exp_f32 v179, v179
WL 4
v_mfma_f32_16x16x32_bf16 a[16:19], a[208:211], v[224:227], a[16:19]
TR 220,39,16384
v_mfma_f32_16x16x32_bf16 a[48:51], a[208:211], v[228:231], a[48:51]
TR 222,39,20480
v_exp_f32 v184, v184
v_mfma_f32_16x16x32_bf16 a[80:83], a[208:211], v[232:235], a[80:83]
v_exp_f32 v185, v185
v_mfma_f32_16x16x32_bf16 a[112:115], a[208:211], v[236:239], a[112:115]
v_exp_f32 v186, v186
s_barrier
WL 4
v_mfma_f32_16x16x32_bf16 a[116:119], a[212:215], v[236:239], a[116:119]
ds_read_b128 a[192:195], v44 offset:32768
v_mfma_f32_16x16x32_bf16 a[84:87], a[212:215], v[232:235], a[84:87]
v_exp_f32 v187, v187
v_mfma_f32_16x16x32_bf16 a[52:55], a[212:215], v[228:231], a[52:55]
ds_read_b128 a[196:199], v45 offset:32768
s_add_u32 m0, s48, 32768
v_mfma_f32_16x16x32_bf16 a[20:23], a[212:215], v[224:227], a[20:23]
DM 8,20,52,0
WL 4
v_mfma_f32_16x16x32_bf16 a[24:27], a[216:219], v[224:227], a[24:27]
ds_read_b128 a[200:203], v46 offset:32768
v_exp_f32 v164, v164
v_mfma_f32_16x16x32_bf16 a[56:59], a[216:219], v[228:231], a[56:59]
v_exp_f32 v165, v165
v_mfma_f32_16x16x32_bf16 a[88:91], a[216:219], v[232:235], a[88:91]
ds_read_b128 a[204:207], v47 offset:32768
v_exp_f32 v166, v166
v_mfma_f32_16x16x32_bf16 a[120:123], a[216:219], v[236:239], a[120:123]
DM 9,20,52,1024
WL 4
v_mfma_f32_16x16x32_bf16 a[124:127], a[220:223], v[236:239], a[124:127]
v_exp_f32 v167, v167
v_mfma_f32_16x16x32_bf16 a[92:95], a[220:223], v[232:235], a[92:95]
v_exp_f32 v172, v172
v_mfma_f32_16x16x32_bf16 a[60:63], a[220:223], v[228:231], a[60:63]
v_exp_f32 v173, v173
v_mfma_f32_16x16x32_bf16 a[28:31], a[220:223], v[224:227], a[28:31]
DM 10,20,52,2048
v_cvt_pk_bf16_f32 v224, v160, v161
WL 0
v_mfma_f32_16x16x32_bf16 v[128:131], a[192:195], a[128:131], v[192:195]
v_exp_f32 v174, v174
MA 128,196,132
ds_read_b128 a[224:227], v44 offset:36864
v_cvt_pk_bf16_f32 v225, v162, v163
MA 128,200,136
v_exp_f32 v175, v175
MA 128,204,140
ds_read_b128 a[228:231], v45 offset:36864
DM 11,20,52,3072
v_mfma_f32_16x16x32_bf16 v[136:139], a[204:207], a[156:159], v[196:199]
v_exp_f32 v180, v180
v_cvt_pk_bf16_f32 v228, v168, v169
MA 136,200,152
ds_read_b128 a[232:235], v46 offset:36864
v_cvt_pk_bf16_f32 v229, v170, v171
MA 136,196,148
s_add_u32 m0, s48, 49152
v_exp_f32 v181, v181
MA 136,192,144
ds_read_b128 a[236:239], v47 offset:36864
DM 16,24,52,0
v_mfma_f32_16x16x32_bf16 v[144:147], a[192:195], a[160:163], v[200:203]
v_exp_f32 v182, v182
MA 144,196,164
v_exp_f32 v183, v183
MA 144,200,168
v_cvt_pk_bf16_f32 v232, v176, v177
v_cvt_pk_bf16_f32 v233, v178, v179
MA 144,204,172
DM 4,24,52,1024
v_mfma_f32_16x16x32_bf16 v[152:155], a[204:207], a[188:191], v[204:207]
v_exp_f32 v188, v188
MA 152,200,184
v_cvt_pk_bf16_f32 v236, v184, v185
v_cvt_pk_bf16_f32 v237, v186, v187
v_cvt_pk_bf16_f32 v226, v164, v165
MA 152,196,180
v_exp_f32 v189, v189
MA 152,192,176
DM 16,24,52,2048
WL 0
v_mfma_f32_16x16x32_bf16 v[132:135], a[224:227], a[128:131], v[192:195]
v_cvt_pk_bf16_f32 v227, v166, v167
v_cvt_pk_bf16_f32 v230, v172, v173
MA 132,228,132
v_exp_f32 v190, v190
MA 132,232,136
v_cvt_pk_bf16_f32 v231, v174, v175
v_cvt_pk_bf16_f32 v234, v180, v181
MA 132,236,140
DM 4,24,52,3072
s_add_u32 s52, s52, 16384
v_mfma_f32_16x16x32_bf16 v[140:143], a[236:239], a[156:159], v[196:199]
TR 208,32,24576
v_exp_f32 v191, v191
MA 140,232,152
TR 210,32,28672
v_cvt_pk_bf16_f32 v235, v182, v183
MA 140,228,148
v_cvt_pk_bf16_f32 v238, v188, v189
v_cvt_pk_bf16_f32 v239, v190, v191
MA 140,224,144
buffer_store_dwordx4 v[84:87], v5, s[4:7], s60 offen offset:128 sc1
s_add_u32 s60, s60, 4096
v_mfma_f32_16x16x32_bf16 v[208:211], a[240:243], v[224:227], 0
TR 212,33,24576
v_mfma_f32_16x16x32_bf16 v[212:215], a[240:243], v[228:231], 0
TR 214,33,28672
v_mfma_f32_16x16x32_bf16 v[216:219], a[240:243], v[232:235], 0
TR 216,34,24576
v_mfma_f32_16x16x32_bf16 v[220:223], a[240:243], v[236:239], 0
TR 218,34,28672
v_mfma_f32_16x16x32_bf16 v[148:151], a[224:227], a[160:163], v[200:203]
MA 148,228,164
MA 148,232,168
MA 148,236,172
v_mfma_f32_16x16x32_bf16 v[156:159], a[236:239], a[188:191], v[204:207]
MA 156,232,184
MA 156,228,180
v_max3_f32 v56, v208, v212, v216
v_max_f32 v56, v56, v220
MA 156,224,176
v_cmp_lt_f32 vcc, 0x49800000, v56
s_nop 0
s_cbranch_vccnz t2_c19
t2_r20:
WL 4
v_mfma_f32_16x16x32_bf16 a[0:3], a[208:211], v[224:227], a[0:3]
TR 220,35,24576
v_add_f32 v48, v48, v208
v_add_f32 v49, v49, v212
v_mfma_f32_16x16x32_bf16 a[32:35], a[208:211], v[228:231], a[32:35]
TR 222,35,28672
v_add_f32 v50, v50, v216
v_add_f32 v51, v51, v220
v_mfma_f32_16x16x32_bf16 a[64:67], a[208:211], v[232:235], a[64:67]
v_exp_f32 v128, v128
v_mfma_f32_16x16x32_bf16 a[96:99], a[208:211], v[236:239], a[96:99]
v_exp_f32 v129, v129
WL 4
v_mfma_f32_16x16x32_bf16 a[100:103], a[212:215], v[236:239], a[100:103]
TR 208,36,24576
v_mfma_f32_16x16x32_bf16 a[68:71], a[212:215], v[232:235], a[68:71]
TR 210,36,28672
v_mfma_f32_16x16x32_bf16 a[36:39], a[212:215], v[228:231], a[36:39]
v_exp_f32 v130, v130
v_mfma_f32_16x16x32_bf16 a[4:7], a[212:215], v[224:227], a[4:7]
buffer_store_dwordx4 v[88:91], v5, s[4:7], s60 offen offset:0 sc1
WL 4
v_mfma_f32_16x16x32_bf16 a[8:11], a[216:219], v[224:227], a[8:11]
TR 212,37,24576
v_exp_f32 v131, v131
v_mfma_f32_16x16x32_bf16 a[40:43], a[216:219], v[228:231], a[40:43]
TR 214,37,28672
v_mfma_f32_16x16x32_bf16 a[72:75], a[216:219], v[232:235], a[72:75]
v_exp_f32 v136, v136
v_mfma_f32_16x16x32_bf16 a[104:107], a[216:219], v[236:239], a[104:107]
v_exp_f32 v137, v137
WL 4
v_mfma_f32_16x16x32_bf16 a[108:111], a[220:223], v[236:239], a[108:111]
TR 216,38,24576
v_mfma_f32_16x16x32_bf16 a[76:79], a[220:223], v[232:235], a[76:79]
TR 218,38,28672
v_mfma_f32_16x16x32_bf16 a[44:47], a[220:223], v[228:231], a[44:47]
v_exp_f32 v138, v138
v_mfma_f32_16x16x32_bf16 a[12:15], a[220:223], v[224:227], a[12:15]
v_exp_f32 v139, v139
WL 4
v_mfma_f32_16x16x32_bf16 a[16:19], a[208:211], v[224:227], a[16:19]
TR 220,39,24576
v_exp_f32 v144, v144
v_mfma_f32_16x16x32_bf16 a[48:51], a[208:211], v[228:231], a[48:51]
TR 222,39,28672
v_mfma_f32_16x16x32_bf16 a[80:83], a[208:211], v[232:235], a[80:83]
v_exp_f32 v145, v145
v_mfma_f32_16x16x32_bf16 a[112:115], a[208:211], v[236:239], a[112:115]
v_exp_f32 v146, v146
WL 4
v_mfma_f32_16x16x32_bf16 a[116:119], a[212:215], v[236:239], a[116:119]
ds_read_b128 a[192:195], v44 offset:40960
v_mfma_f32_16x16x32_bf16 a[84:87], a[212:215], v[232:235], a[84:87]
v_exp_f32 v147, v147
v_mfma_f32_16x16x32_bf16 a[52:55], a[212:215], v[228:231], a[52:55]
ds_read_b128 a[196:199], v45 offset:40960
v_mfma_f32_16x16x32_bf16 a[20:23], a[212:215], v[224:227], a[20:23]
buffer_store_dwordx4 v[92:95], v5, s[4:7], s60 offen offset:128 sc1
s_add_u32 s60, s60, 4096
WL 4
v_mfma_f32_16x16x32_bf16 a[24:27], a[216:219], v[224:227], a[24:27]
ds_read_b128 a[200:203], v46 offset:40960
v_exp_f32 v152, v152
v_mfma_f32_16x16x32_bf16 a[56:59], a[216:219], v[228:231], a[56:59]
v_exp_f32 v153, v153
v_mfma_f32_16x16x32_bf16 a[88:91], a[216:219], v[232:235], a[88:91]
ds_read_b128 a[204:207], v47 offset:40960
v_mfma_f32_16x16x32_bf16 a[120:123], a[216:219], v[236:239], a[120:123]
v_exp_f32 v154, v154
WL 4
v_mfma_f32_16x16x32_bf16 a[124:127], a[220:223], v[236:239], a[124:127]
v_exp_f32 v155, v155
v_mfma_f32_16x16x32_bf16 a[92:95], a[220:223], v[232:235], a[92:95]
v_exp_f32 v132, v132
v_mfma_f32_16x16x32_bf16 a[60:63], a[220:223], v[228:231], a[60:63]
v_exp_f32 v133, v133
v_mfma_f32_16x16x32_bf16 a[28:31], a[220:223], v[224:227], a[28:31]
v_exp_f32 v134, v134
WL 0
v_mfma_f32_16x16x32_bf16 v[160:163], a[192:195], a[128:131], v[192:195]
v_exp_f32 v135, v135
MA 160,196,132
ds_read_b128 a[224:227], v44 offset:45056
v_cvt_pk_bf16_f32 v224, v128, v129
MA 160,200,136
v_exp_f32 v140, v140
MA 160,204,140
ds_read_b128 a[228:231], v45 offset:45056
v_cvt_pk_bf16_f32 v225, v130, v131
v_mfma_f32_16x16x32_bf16 v[168:171], a[204:207], a[156:159], v[196:199]
v_exp_f32 v141, v141
v_cvt_pk_bf16_f32 v228, v136, v137
MA 168,200,152
ds_read_b128 a[232:235], v46 offset:45056
v_cvt_pk_bf16_f32 v229, v138, v139
MA 168,196,148
v_exp_f32 v142, v142
MA 168,192,144
ds_read_b128 a[236:239], v47 offset:45056
v_cvt_pk_bf16_f32 v232, v144, v145
v_mfma_f32_16x16x32_bf16 v[176:179], a[192:195], a[160:163], v[200:203]
v_exp_f32 v143, v143
MA 176,196,164
v_exp_f32 v148, v148
MA 176,200,168
v_exp_f32 v149, v149
MA 176,204,172
buffer_load_dword v61, v60, s[84:87], s77 offen
v_mfma_f32_16x16x32_bf16 v[184:187], a[204:207], a[188:191], v[204:207]
v_exp_f32 v150, v150
MA 184,200,184
v_exp_f32 v151, v151
MA 184,196,180
v_cvt_pk_bf16_f32 v233, v146, v147
v_cvt_pk_bf16_f32 v236, v152, v153
MA 184,192,176
v_exp_f32 v156, v156
WL 0
v_mfma_f32_16x16x32_bf16 v[164:167], a[224:227], a[128:131], v[192:195]
v_cvt_pk_bf16_f32 v237, v154, v155
v_exp_f32 v157, v157
MA 164,228,132
v_cvt_pk_bf16_f32 v226, v132, v133
v_cvt_pk_bf16_f32 v227, v134, v135
MA 164,232,136
v_exp_f32 v158, v158
MA 164,236,140
v_cvt_pk_bf16_f32 v230, v140, v141
v_cvt_pk_bf16_f32 v231, v142, v143
v_mfma_f32_16x16x32_bf16 v[172:175], a[236:239], a[156:159], v[196:199]
TR 208,32,49152
v_cvt_pk_bf16_f32 v234, v148, v149
MA 172,232,152
TR 210,32,53248
v_cvt_pk_bf16_f32 v235, v150, v151
MA 172,228,148
v_exp_f32 v159, v159
MA 172,224,144
v_cvt_pk_bf16_f32 v238, v156, v157
v_cvt_pk_bf16_f32 v239, v158, v159
v_mfma_f32_16x16x32_bf16 v[208:211], a[240:243], v[224:227], 0
TR 212,33,49152
v_mfma_f32_16x16x32_bf16 v[212:215], a[240:243], v[228:231], 0
TR 214,33,53248
v_mfma_f32_16x16x32_bf16 v[216:219], a[240:243], v[232:235], 0
TR 216,34,49152
v_mfma_f32_16x16x32_bf16 v[220:223], a[240:243], v[236:239], 0
TR 218,34,53248
v_mfma_f32_16x16x32_bf16 v[180:183], a[224:227], a[160:163], v[200:203]
MA 180,228,164
MA 180,232,168
MA 180,236,172
v_mfma_f32_16x16x32_bf16 v[188:191], a[236:239], a[188:191], v[204:207]
MA 188,232,184
MA 188,228,180
v_max3_f32 v56, v208, v212, v216
v_max_f32 v56, v56, v220
MA 188,224,176
v_cmp_lt_f32 vcc, 0x49800000, v56
s_nop 0
s_cbranch_vccnz t2_c21
t2_r22:
WL 4
v_mfma_f32_16x16x32_bf16 a[0:3], a[208:211], v[224:227], a[0:3]
TR 220,35,49152
v_add_f32 v48, v48, v208
v_add_f32 v49, v49, v212
v_mfma_f32_16x16x32_bf16 a[32:35], a[208:211], v[228:231], a[32:35]
TR 222,35,53248
v_add_f32 v50, v50, v216
v_add_f32 v51, v51, v220
v_mfma_f32_16x16x32_bf16 a[64:67], a[208:211], v[232:235], a[64:67]
v_exp_f32 v160, v160
v_mfma_f32_16x16x32_bf16 a[96:99], a[208:211], v[236:239], a[96:99]
v_exp_f32 v161, v161
WL 4
v_mfma_f32_16x16x32_bf16 a[100:103], a[212:215], v[236:239], a[100:103]
TR 208,36,49152
v_exp_f32 v162, v162
v_mfma_f32_16x16x32_bf16 a[68:71], a[212:215], v[232:235], a[68:71]
TR 210,36,53248
v_mfma_f32_16x16x32_bf16 a[36:39], a[212:215], v[228:231], a[36:39]
v_exp_f32 v163, v163
v_mfma_f32_16x16x32_bf16 a[4:7], a[212:215], v[224:227], a[4:7]
v_exp_f32 v168, v168
WL 4
v_mfma_f32_16x16x32_bf16 a[8:11], a[216:219], v[224:227], a[8:11]
TR 212,37,49152
v_exp_f32 v169, v169
v_mfma_f32_16x16x32_bf16 a[40:43], a[216:219], v[228:231], a[40:43]
TR 214,37,53248
v_mfma_f32_16x16x32_bf16 a[72:75], a[216:219], v[232:235], a[72:75]
v_exp_f32 v170, v170
v_mfma_f32_16x16x32_bf16 a[104:107], a[216:219], v[236:239], a[104:107]
v_exp_f32 v171, v171
WL 4
v_mfma_f32_16x16x32_bf16 a[108:111], a[220:223], v[236:239], a[108:111]
TR 216,38,49152
v_exp_f32 v176, v176
v_mfma_f32_16x16x32_bf16 a[76:79], a[220:223], v[232:235], a[76:79]
TR 218,38,53248
v_exp_f32 v177, v177
v_mfma_f32_16x16x32_bf16 a[44:47], a[220:223], v[228:231], a[44:47]
v_exp_f32 v178, v178
v_mfma_f32_16x16x32_bf16 a[12:15], a[220:223], v[224:227], a[12:15]
v_exp_f32 v179, v179
WL 4
v_mfma_f32_16x16x32_bf16 a[16:19], a[208:211], v[224:227], a[16:19]
TR 220,39,49152
v_mfma_f32_16x16x32_bf16 a[48:51], a[208:211], v[228:231], a[48:51]
TR 222,39,53248
v_exp_f32 v184, v184
v_mfma_f32_16x16x32_bf16 a[80:83], a[208:211], v[232:235], a[80:83]
v_exp_f32 v185, v185
v_mfma_f32_16x16x32_bf16 a[112:115], a[208:211], v[236:239], a[112:115]
v_exp_f32 v186, v186
WV 1
s_barrier
buffer_atomic_add v21, v18, s[4:7], s79 offen offset:768
WL 4
v_mfma_f32_16x16x32_bf16 a[116:119], a[212:215], v[236:239], a[116:119]
ds_read_b128 a[192:195], v40 offset:0
v_mfma_f32_16x16x32_bf16 a[84:87], a[212:215], v[232:235], a[84:87]
v_exp_f32 v187, v187
v_mfma_f32_16x16x32_bf16 a[52:55], a[212:215], v[228:231], a[52:55]
ds_read_b128 a[196:199], v41 offset:0
s_add_u32 m0, s48, 65536
v_mfma_f32_16x16x32_bf16 a[20:23], a[212:215], v[224:227], a[20:23]
DM 8,20,52,0
WL 4
v_mfma_f32_16x16x32_bf16 a[24:27], a[216:219], v[224:227], a[24:27]
ds_read_b128 a[200:203], v42 offset:0
v_exp_f32 v164, v164
v_mfma_f32_16x16x32_bf16 a[56:59], a[216:219], v[228:231], a[56:59]
v_exp_f32 v165, v165
v_mfma_f32_16x16x32_bf16 a[88:91], a[216:219], v[232:235], a[88:91]
ds_read_b128 a[204:207], v43 offset:0
v_exp_f32 v166, v166
v_mfma_f32_16x16x32_bf16 a[120:123], a[216:219], v[236:239], a[120:123]
DM 9,20,52,1024
WL 4
v_mfma_f32_16x16x32_bf16 a[124:127], a[220:223], v[236:239], a[124:127]
v_exp_f32 v167, v167
v_mfma_f32_16x16x32_bf16 a[92:95], a[220:223], v[232:235], a[92:95]
v_exp_f32 v172, v172
v_mfma_f32_16x16x32_bf16 a[60:63], a[220:223], v[228:231], a[60:63]
v_exp_f32 v173, v173
v_mfma_f32_16x16x32_bf16 a[28:31], a[220:223], v[224:227], a[28:31]
DM 10,20,52,2048
v_cvt_pk_bf16_f32 v224, v160, v161
WL 0
v_mfma_f32_16x16x32_bf16 v[128:131], a[192:195], a[128:131], v[192:195]
v_exp_f32 v174, v174
MA 128,196,132
ds_read_b128 a[224:227], v40 offset:4096
v_cvt_pk_bf16_f32 v225, v162, v163
MA 128,200,136
v_exp_f32 v175, v175
MA 128,204,140
ds_read_b128 a[228:231], v41 offset:4096
DM 11,20,52,3072
v_mfma_f32_16x16x32_bf16 v[136:139], a[204:207], a[156:159], v[196:199]
v_exp_f32 v180, v180
v_cvt_pk_bf16_f32 v228, v168, v169
MA 136,200,152
ds_read_b128 a[232:235], v42 offset:4096
v_cvt_pk_bf16_f32 v229, v170, v171
MA 136,196,148
s_add_u32 m0, s48, 81920
v_exp_f32 v181, v181
MA 136,192,144
ds_read_b128 a[236:239], v43 offset:4096
DM 16,24,52,0
v_mfma_f32_16x16x32_bf16 v[144:147], a[192:195], a[160:163], v[200:203]
v_exp_f32 v182, v182
MA 144,196,164
v_exp_f32 v183, v183
MA 144,200,168
v_cvt_pk_bf16_f32 v232, v176, v177
v_cvt_pk_bf16_f32 v233, v178, v179
MA 144,204,172
DM 4,24,52,1024
v_mfma_f32_16x16x32_bf16 v[152:155], a[204:207], a[188:191], v[204:207]
v_exp_f32 v188, v188
MA 152,200,184
v_cvt_pk_bf16_f32 v236, v184, v185
v_cvt_pk_bf16_f32 v237, v186, v187
v_cvt_pk_bf16_f32 v226, v164, v165
MA 152,196,180
v_exp_f32 v189, v189
MA 152,192,176
DM 16,24,52,2048
WL 0
v_mfma_f32_16x16x32_bf16 v[132:135], a[224:227], a[128:131], v[192:195]
v_cvt_pk_bf16_f32 v227, v166, v167
v_cvt_pk_bf16_f32 v230, v172, v173
MA 132,228,132
v_exp_f32 v190, v190
MA 132,232,136
v_cvt_pk_bf16_f32 v231, v174, v175
v_cvt_pk_bf16_f32 v234, v180, v181
MA 132,236,140
DM 4,24,52,3072
s_add_u32 s52, s52, 16384
v_mfma_f32_16x16x32_bf16 v[140:143], a[236:239], a[156:159], v[196:199]
TR 208,32,57344
v_exp_f32 v191, v191
MA 140,232,152
TR 210,32,61440
v_cvt_pk_bf16_f32 v235, v182, v183
MA 140,228,148
v_cvt_pk_bf16_f32 v238, v188, v189
v_cvt_pk_bf16_f32 v239, v190, v191
MA 140,224,144
buffer_load_dword v61, v60, s[28:31], s81 offen
s_add_u32 s81, s81, 1835008
v_mfma_f32_16x16x32_bf16 v[208:211], a[240:243], v[224:227], 0
TR 212,33,57344
v_mfma_f32_16x16x32_bf16 v[212:215], a[240:243], v[228:231], 0
TR 214,33,61440
v_mfma_f32_16x16x32_bf16 v[216:219], a[240:243], v[232:235], 0
TR 216,34,57344
v_mfma_f32_16x16x32_bf16 v[220:223], a[240:243], v[236:239], 0
TR 218,34,61440
v_mfma_f32_16x16x32_bf16 v[148:151], a[224:227], a[160:163], v[200:203]
MA 148,228,164
MA 148,232,168
MA 148,236,172
v_mfma_f32_16x16x32_bf16 v[156:159], a[236:239], a[188:191], v[204:207]
MA 156,232,184
MA 156,228,180
v_max3_f32 v56, v208, v212, v216
v_max_f32 v56, v56, v220
MA 156,224,176
v_cmp_lt_f32 vcc, 0x49800000, v56
s_nop 0
s_cbranch_vccnz t2_c23
t2_r24:
WL 4
v_mfma_f32_16x16x32_bf16 a[0:3], a[208:211], v[224:227], a[0:3]
TR 220,35,57344
v_add_f32 v48, v48, v208
v_add_f32 v49, v49, v212
v_mfma_f32_16x16x32_bf16 a[32:35], a[208:211], v[228:231], a[32:35]
TR 222,35,61440
v_add_f32 v50, v50, v216
v_add_f32 v51, v51, v220
v_mfma_f32_16x16x32_bf16 a[64:67], a[208:211], v[232:235], a[64:67]
v_exp_f32 v128, v128
v_mfma_f32_16x16x32_bf16 a[96:99], a[208:211], v[236:239], a[96:99]
v_exp_f32 v129, v129
WL 4
v_mfma_f32_16x16x32_bf16 a[100:103], a[212:215], v[236:239], a[100:103]
TR 208,36,57344
v_mfma_f32_16x16x32_bf16 a[68:71], a[212:215], v[232:235], a[68:71]
TR 210,36,61440
s_mul_i32 s81, s82, 2048
v_mfma_f32_16x16x32_bf16 a[36:39], a[212:215], v[228:231], a[36:39]
v_exp_f32 v130, v130
v_mfma_f32_16x16x32_bf16 a[4:7], a[212:215], v[224:227], a[4:7]
v_exp_f32 v131, v131
WL 4
v_mfma_f32_16x16x32_bf16 a[8:11], a[216:219], v[224:227], a[8:11]
TR 212,37,57344
v_exp_f32 v136, v136
v_mfma_f32_16x16x32_bf16 a[40:43], a[216:219], v[228:231], a[40:43]
TR 214,37,61440
v_exp_f32 v137, v137
v_mfma_f32_16x16x32_bf16 a[72:75], a[216:219], v[232:235], a[72:75]
v_exp_f32 v138, v138
v_mfma_f32_16x16x32_bf16 a[104:107], a[216:219], v[236:239], a[104:107]
v_exp_f32 v139, v139
WL 4
v_mfma_f32_16x16x32_bf16 a[108:111], a[220:223], v[236:239], a[108:111]
TR 216,38,57344
v_mfma_f32_16x16x32_bf16 a[76:79], a[220:223], v[232:235], a[76:79]
TR 218,38,61440
v_exp_f32 v144, v144
v_mfma_f32_16x16x32_bf16 a[44:47], a[220:223], v[228:231], a[44:47]
v_exp_f32 v145, v145
v_mfma_f32_16x16x32_bf16 a[12:15], a[220:223], v[224:227], a[12:15]
v_exp_f32 v146, v146
WL 4
v_mfma_f32_16x16x32_bf16 a[16:19], a[208:211], v[224:227], a[16:19]
TR 220,39,57344
v_mfma_f32_16x16x32_bf16 a[48:51], a[208:211], v[228:231], a[48:51]
TR 222,39,61440
buffer_load_dword v61, v60, s[32:35], s81 offen
s_add_u32 s81, s81, 1048576
v_mfma_f32_16x16x32_bf16 a[80:83], a[208:211], v[232:235], a[80:83]
v_exp_f32 v147, v147
v_mfma_f32_16x16x32_bf16 a[112:115], a[208:211], v[236:239], a[112:115]
v_exp_f32 v152, v152
WL 4
v_mfma_f32_16x16x32_bf16 a[116:119], a[212:215], v[236:239], a[116:119]
ds_read_b128 a[192:195], v40 offset:8192
v_exp_f32 v153, v153
v_mfma_f32_16x16x32_bf16 a[84:87], a[212:215], v[232:235], a[84:87]
v_exp_f32 v154, v154
v_mfma_f32_16x16x32_bf16 a[52:55], a[212:215], v[228:231], a[52:55]
ds_read_b128 a[196:199], v41 offset:8192
v_mfma_f32_16x16x32_bf16 a[20:23], a[212:215], v[224:227], a[20:23]
v_exp_f32 v155, v155
WL 4
v_mfma_f32_16x16x32_bf16 a[24:27], a[216:219], v[224:227], a[24:27]
ds_read_b128 a[200:203], v42 offset:8192
v_exp_f32 v132, v132
v_mfma_f32_16x16x32_bf16 a[56:59], a[216:219], v[228:231], a[56:59]
v_exp_f32 v133, v133
v_mfma_f32_16x16x32_bf16 a[88:91], a[216:219], v[232:235], a[88:91]
ds_read_b128 a[204:207], v43 offset:8192
v_mfma_f32_16x16x32_bf16 a[120:123], a[216:219], v[236:239], a[120:123]
v_exp_f32 v134, v134
WL 4
v_mfma_f32_16x16x32_bf16 a[124:127], a[220:223], v[236:239], a[124:127]
v_exp_f32 v135, v135
v_mfma_f32_16x16x32_bf16 a[92:95], a[220:223], v[232:235], a[92:95]
v_exp_f32 v140, v140
v_mfma_f32_16x16x32_bf16 a[60:63], a[220:223], v[228:231], a[60:63]
v_exp_f32 v141, v141
v_mfma_f32_16x16x32_bf16 a[28:31], a[220:223], v[224:227], a[28:31]
v_exp_f32 v142, v142
v_cvt_pk_bf16_f32 v224, v128, v129
WL 0
v_mfma_f32_16x16x32_bf16 v[160:163], a[192:195], a[128:131], v[192:195]
v_exp_f32 v143, v143
MA 160,196,132
ds_read_b128 a[224:227], v40 offset:12288
v_cvt_pk_bf16_f32 v225, v130, v131
MA 160,200,136
v_exp_f32 v148, v148
MA 160,204,140
ds_read_b128 a[228:231], v41 offset:12288
s_lshl_b32 s51, s58, 2
v_cvt_pk_bf16_f32 v228, v136, v137
v_mfma_f32_16x16x32_bf16 v[168:171], a[204:207], a[156:159], v[196:199]
v_exp_f32 v149, v149
MA 168,200,152
ds_read_b128 a[232:235], v42 offset:12288
s_add_u32 s51, s51, s44
MA 168,196,148
v_exp_f32 v150, v150
MA 168,192,144
ds_read_b128 a[236:239], v43 offset:12288
s_mul_i32 s51, s51, 131072
v_cvt_pk_bf16_f32 v229, v138, v139
v_mfma_f32_16x16x32_bf16 v[176:179], a[192:195], a[160:163], v[200:203]
v_exp_f32 v151, v151
MA 176,196,164
s_add_u32 s51, s51, 12582912
v_cvt_pk_bf16_f32 v232, v144, v145
MA 176,200,168
v_cvt_pk_bf16_f32 v233, v146, v147
v_cvt_pk_bf16_f32 v236, v152, v153
MA 176,204,172
s_mul_i32 s53, s44, 114688
v_cvt_pk_bf16_f32 v237, v154, v155
v_mfma_f32_16x16x32_bf16 v[184:187], a[204:207], a[188:191], v[204:207]
v_exp_f32 v156, v156
MA 184,200,184
s_mul_i32 s62, s59, 256
v_exp_f32 v157, v157
MA 184,196,180
v_cvt_pk_bf16_f32 v226, v132, v133
v_cvt_pk_bf16_f32 v227, v134, v135
MA 184,192,176
s_add_u32 s53, s53, s62
v_cvt_pk_bf16_f32 v230, v140, v141
WL 0
v_mfma_f32_16x16x32_bf16 v[164:167], a[224:227], a[128:131], v[192:195]
v_exp_f32 v158, v158
MA 164,228,132
buffer_load_dword v61, v60, s[32:35], s81 offen
s_add_u32 s81, s81, 1048576
s_add_u32 s53, s53, 3072
MA 164,232,136
v_cvt_pk_bf16_f32 v231, v142, v143
v_cvt_pk_bf16_f32 v234, v148, v149
MA 164,236,140
s_mov_b32 s62, 7168
v_cvt_pk_bf16_f32 v235, v150, v151
v_mfma_f32_16x16x32_bf16 v[172:175], a[236:239], a[156:159], v[196:199]
TR 208,24,16384
v_cvt_pk_bf16_f32 v238, v156, v157
MA 172,232,152
TR 210,24,20480
v_mad_u32_u24 v12, v19, s62, v20
MA 172,228,148
v_exp_f32 v159, v159
MA 172,224,144
v_xor_b32 v13, 128, v12
v_cvt_pk_bf16_f32 v239, v158, v159
v_mfma_f32_16x16x32_bf16 v[208:211], a[240:243], v[224:227], 0
TR 212,25,16384
v_mfma_f32_16x16x32_bf16 v[212:215], a[240:243], v[228:231], 0
TR 214,25,20480
v_mfma_f32_16x16x32_bf16 v[216:219], a[240:243], v[232:235], 0
v_add_u32 v14, 55296, v12
v_mfma_f32_16x16x32_bf16 v[220:223], a[240:243], v[236:239], 0
TR 216,26,16384
v_mfma_f32_16x16x32_bf16 v[180:183], a[224:227], a[160:163], v[200:203]
TR 218,26,20480
MA 180,228,164
MA 180,232,168
MA 180,236,172
v_mfma_f32_16x16x32_bf16 v[188:191], a[236:239], a[188:191], v[204:207]
MA 188,232,184
MA 188,228,180
v_max3_f32 v56, v208, v212, v216
v_max_f32 v56, v56, v220
MA 188,224,176
v_cmp_lt_f32 vcc, 0x49800000, v56
s_nop 0
s_cbranch_vccnz t2_c25
t2_r26:
WL 4
v_mfma_f32_16x16x32_bf16 a[0:3], a[208:211], v[224:227], a[0:3]
TR 220,27,16384
v_add_f32 v48, v48, v208
v_add_f32 v49, v49, v212
v_mfma_f32_16x16x32_bf16 a[32:35], a[208:211], v[228:231], a[32:35]
TR 222,27,20480
v_add_f32 v50, v50, v216
v_add_f32 v51, v51, v220
v_mfma_f32_16x16x32_bf16 a[64:67], a[208:211], v[232:235], a[64:67]
v_exp_f32 v160, v160
v_mfma_f32_16x16x32_bf16 a[96:99], a[208:211], v[236:239], a[96:99]
v_exp_f32 v161, v161
WL 4
v_mfma_f32_16x16x32_bf16 a[100:103], a[212:215], v[236:239], a[100:103]
TR 208,28,16384
v_exp_f32 v162, v162
v_mfma_f32_16x16x32_bf16 a[68:71], a[212:215], v[232:235], a[68:71]
TR 210,28,20480
v_mfma_f32_16x16x32_bf16 a[36:39], a[212:215], v[228:231], a[36:39]
v_exp_f32 v163, v163
v_mfma_f32_16x16x32_bf16 a[4:7], a[212:215], v[224:227], a[4:7]
v_exp_f32 v168, v168
WL 4
v_mfma_f32_16x16x32_bf16 a[8:11], a[216:219], v[224:227], a[8:11]
TR 212,29,16384
v_exp_f32 v169, v169
v_mfma_f32_16x16x32_bf16 a[40:43], a[216:219], v[228:231], a[40:43]
TR 214,29,20480
v_mfma_f32_16x16x32_bf16 a[72:75], a[216:219], v[232:235], a[72:75]
v_exp_f32 v170, v170
v_mfma_f32_16x16x32_bf16 a[104:107], a[216:219], v[236:239], a[104:107]
v_exp_f32 v171, v171
WL 4
v_mfma_f32_16x16x32_bf16 a[108:111], a[220:223], v[236:239], a[108:111]
TR 216,30,16384
v_exp_f32 v176, v176
v_mfma_f32_16x16x32_bf16 a[76:79], a[220:223], v[232:235], a[76:79]
TR 218,30,20480
v_exp_f32 v177, v177
v_mfma_f32_16x16x32_bf16 a[44:47], a[220:223], v[228:231], a[44:47]
v_exp_f32 v178, v178
v_mfma_f32_16x16x32_bf16 a[12:15], a[220:223], v[224:227], a[12:15]
v_exp_f32 v179, v179
WL 4
v_mfma_f32_16x16x32_bf16 a[16:19], a[208:211], v[224:227], a[16:19]
TR 220,31,16384
v_exp_f32 v184, v184
v_mfma_f32_16x16x32_bf16 a[48:51], a[208:211], v[228:231], a[48:51]
TR 222,31,20480
v_mfma_f32_16x16x32_bf16 a[80:83], a[208:211], v[232:235], a[80:83]
v_exp_f32 v185, v185
v_mfma_f32_16x16x32_bf16 a[112:115], a[208:211], v[236:239], a[112:115]
v_exp_f32 v186, v186
s_barrier
WL 4
v_mfma_f32_16x16x32_bf16 a[116:119], a[212:215], v[236:239], a[116:119]
ds_read_b128 a[192:195], v40 offset:32768
v_exp_f32 v187, v187
v_mfma_f32_16x16x32_bf16 a[84:87], a[212:215], v[232:235], a[84:87]
v_exp_f32 v164, v164
v_mfma_f32_16x16x32_bf16 a[52:55], a[212:215], v[228:231], a[52:55]
ds_read_b128 a[196:199], v41 offset:32768
s_add_u32 m0, s48, 98304
v_mfma_f32_16x16x32_bf16 a[20:23], a[212:215], v[224:227], a[20:23]
DM 8,20,52,0
WL 4
v_mfma_f32_16x16x32_bf16 a[24:27], a[216:219], v[224:227], a[24:27]
ds_read_b128 a[200:203], v42 offset:32768
v_exp_f32 v165, v165
v_mfma_f32_16x16x32_bf16 a[56:59], a[216:219], v[228:231], a[56:59]
v_exp_f32 v166, v166
v_mfma_f32_16x16x32_bf16 a[88:91], a[216:219], v[232:235], a[88:91]
ds_read_b128 a[204:207], v43 offset:32768
v_mfma_f32_16x16x32_bf16 a[120:123], a[216:219], v[236:239], a[120:123]
DM 9,20,52,1024
WL 4
v_mfma_f32_16x16x32_bf16 a[124:127], a[220:223], v[236:239], a[124:127]
v_exp_f32 v167, v167
v_mfma_f32_16x16x32_bf16 a[92:95], a[220:223], v[232:235], a[92:95]
v_exp_f32 v172, v172
v_mfma_f32_16x16x32_bf16 a[60:63], a[220:223], v[228:231], a[60:63]
v_exp_f32 v173, v173
v_mfma_f32_16x16x32_bf16 a[28:31], a[220:223], v[224:227], a[28:31]
DM 10,20,52,2048
v_cvt_pk_bf16_f32 v224, v160, v161
WL 0
v_mfma_f32_16x16x32_bf16 v[128:131], a[192:195], a[128:131], v[192:195]
v_exp_f32 v174, v174
MA 128,196,132
ds_read_b128 a[224:227], v40 offset:36864
v_exp_f32 v175, v175
MA 128,200,136
v_exp_f32 v180, v180
MA 128,204,140
ds_read_b128 a[228:231], v41 offset:36864
DM 11,20,52,3072
v_add_u32 v15, 82944, v13
v_mfma_f32_16x16x32_bf16 v[136:139], a[204:207], a[156:159], v[196:199]
v_exp_f32 v181, v181
MA 136,200,152
ds_read_b128 a[232:235], v42 offset:36864
v_add_u32 v13, 27648, v13
MA 136,196,148
s_add_u32 m0, s48, 114688
v_cvt_pk_bf16_f32 v225, v162, v163
v_cvt_pk_bf16_f32 v228, v168, v169
MA 136,192,144
ds_read_b128 a[236:239], v43 offset:36864
DM 16,24,52,0
v_mfma_f32_16x16x32_bf16 v[144:147], a[192:195], a[160:163], v[200:203]
v_exp_f32 v182, v182
v_cvt_pk_bf16_f32 v229, v170, v171
MA 144,196,164
v_exp_f32 v183, v183
MA 144,200,168
v_cvt_pk_bf16_f32 v232, v176, v177
v_cvt_pk_bf16_f32 v233, v178, v179
MA 144,204,172
DM 4,24,52,1024
v_mfma_f32_16x16x32_bf16 v[152:155], a[204:207], a[188:191], v[204:207]
v_exp_f32 v188, v188
MA 152,200,184
v_cvt_pk_bf16_f32 v236, v184, v185
v_cvt_pk_bf16_f32 v237, v186, v187
MA 152,196,180
v_exp_f32 v189, v189
v_cvt_pk_bf16_f32 v226, v164, v165
MA 152,192,176
DM 16,24,52,2048
WL 0
v_mfma_f32_16x16x32_bf16 v[132:135], a[224:227], a[128:131], v[192:195]
v_cvt_pk_bf16_f32 v227, v166, v167
v_cvt_pk_bf16_f32 v230, v172, v173
MA 132,228,132
v_exp_f32 v190, v190
MA 132,232,136
v_cvt_pk_bf16_f32 v231, v174, v175
v_cvt_pk_bf16_f32 v234, v180, v181
MA 132,236,140
DM 4,24,52,3072
s_add_u32 s52, s52, 16384
v_mfma_f32_16x16x32_bf16 v[140:143], a[236:239], a[156:159], v[196:199]
TR 208,24,24576
v_cvt_pk_bf16_f32 v235, v182, v183
MA 140,232,152
TR 210,24,28672
v_exp_f32 v191, v191
MA 140,228,148
v_cvt_pk_bf16_f32 v238, v188, v189
v_cvt_pk_bf16_f32 v239, v190, v191
MA 140,224,144
buffer_load_dword v61, v60, s[32:35], s81 offen
s_add_u32 s81, s81, 1048576
v_mfma_f32_16x16x32_bf16 v[208:211], a[240:243], v[224:227], 0
TR 212,25,24576
v_mfma_f32_16x16x32_bf16 v[212:215], a[240:243], v[228:231], 0
TR 214,25,28672
v_mfma_f32_16x16x32_bf16 v[216:219], a[240:243], v[232:235], 0
TR 216,26,24576
v_mfma_f32_16x16x32_bf16 v[220:223], a[240:243], v[236:239], 0
TR 218,26,28672
v_mfma_f32_16x16x32_bf16 v[148:151], a[224:227], a[160:163], v[200:203]
MA 148,228,164
MA 148,232,168
MA 148,236,172
v_mfma_f32_16x16x32_bf16 v[156:159], a[236:239], a[188:191], v[204:207]
MA 156,232,184
MA 156,228,180
v_max3_f32 v56, v208, v212, v216
v_max_f32 v56, v56, v220
MA 156,224,176
v_cmp_lt_f32 vcc, 0x49800000, v56
s_nop 0
s_cbranch_vccnz t2_c27
t2_r28:
WL 4
v_mfma_f32_16x16x32_bf16 a[0:3], a[208:211], v[224:227], a[0:3]
TR 220,27,24576
v_add_f32 v48, v48, v208
v_add_f32 v49, v49, v212
v_mfma_f32_16x16x32_bf16 a[32:35], a[208:211], v[228:231], a[32:35]
TR 222,27,28672
v_add_f32 v50, v50, v216
v_add_f32 v51, v51, v220
v_mfma_f32_16x16x32_bf16 a[64:67], a[208:211], v[232:235], a[64:67]
v_exp_f32 v128, v128
v_mfma_f32_16x16x32_bf16 a[96:99], a[208:211], v[236:239], a[96:99]
v_exp_f32 v129, v129
WL 4
v_mfma_f32_16x16x32_bf16 a[100:103], a[212:215], v[236:239], a[100:103]
TR 208,28,24576
v_mfma_f32_16x16x32_bf16 a[68:71], a[212:215], v[232:235], a[68:71]
TR 210,28,28672
v_mfma_f32_16x16x32_bf16 a[36:39], a[212:215], v[228:231], a[36:39]
v_exp_f32 v130, v130
v_mfma_f32_16x16x32_bf16 a[4:7], a[212:215], v[224:227], a[4:7]
v_exp_f32 v131, v131
WL 4
v_mfma_f32_16x16x32_bf16 a[8:11], a[216:219], v[224:227], a[8:11]
TR 212,29,24576
v_mfma_f32_16x16x32_bf16 a[40:43], a[216:219], v[228:231], a[40:43]
TR 214,29,28672
v_exp_f32 v136, v136
v_mfma_f32_16x16x32_bf16 a[72:75], a[216:219], v[232:235], a[72:75]
v_exp_f32 v137, v137
v_mfma_f32_16x16x32_bf16 a[104:107], a[216:219], v[236:239], a[104:107]
v_exp_f32 v138, v138
WL 4
v_mfma_f32_16x16x32_bf16 a[108:111], a[220:223], v[236:239], a[108:111]
TR 216,30,24576
v_mfma_f32_16x16x32_bf16 a[76:79], a[220:223], v[232:235], a[76:79]
TR 218,30,28672
v_mfma_f32_16x16x32_bf16 a[44:47], a[220:223], v[228:231], a[44:47]
v_exp_f32 v139, v139
v_mfma_f32_16x16x32_bf16 a[12:15], a[220:223], v[224:227], a[12:15]
v_exp_f32 v144, v144
WL 4
v_mfma_f32_16x16x32_bf16 a[16:19], a[208:211], v[224:227], a[16:19]
TR 220,31,24576
v_mfma_f32_16x16x32_bf16 a[48:51], a[208:211], v[228:231], a[48:51]
TR 222,31,28672
v_exp_f32 v145, v145
v_mfma_f32_16x16x32_bf16 a[80:83], a[208:211], v[232:235], a[80:83]
v_exp_f32 v146, v146
v_mfma_f32_16x16x32_bf16 a[112:115], a[208:211], v[236:239], a[112:115]
v_exp_f32 v147, v147
WL 4
v_mfma_f32_16x16x32_bf16 a[116:119], a[212:215], v[236:239], a[116:119]
ds_read_b128 a[192:195], v40 offset:40960
v_mfma_f32_16x16x32_bf16 a[84:87], a[212:215], v[232:235], a[84:87]
buffer_load_dword v61, v60, s[32:35], s81 offen
s_add_u32 s81, s81, 1048576
v_mfma_f32_16x16x32_bf16 a[52:55], a[212:215], v[228:231], a[52:55]
ds_read_b128 a[196:199], v41 offset:40960
v_mfma_f32_16x16x32_bf16 a[20:23], a[212:215], v[224:227], a[20:23]
v_exp_f32 v152, v152
WL 4
v_mfma_f32_16x16x32_bf16 a[24:27], a[216:219], v[224:227], a[24:27]
ds_read_b128 a[200:203], v42 offset:40960
v_mfma_f32_16x16x32_bf16 a[56:59], a[216:219], v[228:231], a[56:59]
v_exp_f32 v153, v153
v_mfma_f32_16x16x32_bf16 a[88:91], a[216:219], v[232:235], a[88:91]
ds_read_b128 a[204:207], v43 offset:40960
v_mfma_f32_16x16x32_bf16 a[120:123], a[216:219], v[236:239], a[120:123]
v_exp_f32 v154, v154
WL 4
v_mfma_f32_16x16x32_bf16 a[124:127], a[220:223], v[236:239], a[124:127]
v_exp_f32 v155, v155
v_mfma_f32_16x16x32_bf16 a[92:95], a[220:223], v[232:235], a[92:95]
v_exp_f32 v132, v132
v_mfma_f32_16x16x32_bf16 a[60:63], a[220:223], v[228:231], a[60:63]
v_exp_f32 v133, v133
v_mfma_f32_16x16x32_bf16 a[28:31], a[220:223], v[224:227], a[28:31]
v_exp_f32 v134, v134
v_cvt_pk_bf16_f32 v224, v128, v129
WL 0
v_mfma_f32_16x16x32_bf16 v[160:163], a[192:195], a[128:131], v[192:195]
v_exp_f32 v135, v135
MA 160,196,132
ds_read_b128 a[224:227], v40 offset:45056
v_cvt_pk_bf16_f32 v225, v130, v131
MA 160,200,136
v_exp_f32 v140, v140
MA 160,204,140
ds_read_b128 a[228:231], v41 offset:45056
v_cvt_pk_bf16_f32 v228, v136, v137
v_mfma_f32_16x16x32_bf16 v[168:171], a[204:207], a[156:159], v[196:199]
v_exp_f32 v141, v141
MA 168,200,152
ds_read_b128 a[232:235], v42 offset:45056
v_cvt_pk_bf16_f32 v229, v138, v139
MA 168,196,148
v_exp_f32 v142, v142
v_cvt_pk_bf16_f32 v232, v144, v145
MA 168,192,144
ds_read_b128 a[236:239], v43 offset:45056
v_cvt_pk_bf16_f32 v233, v146, v147
v_mfma_f32_16x16x32_bf16 v[176:179], a[192:195], a[160:163], v[200:203]
v_exp_f32 v143, v143
MA 176,196,164
v_exp_f32 v148, v148
MA 176,200,168
v_exp_f32 v149, v149
MA 176,204,172
buffer_load_dword v61, v60, s[84:87], s77 offen
v_mfma_f32_16x16x32_bf16 v[184:187], a[204:207], a[188:191], v[204:207]
v_exp_f32 v150, v150
MA 184,200,184
v_exp_f32 v151, v151
MA 184,196,180
v_exp_f32 v156, v156
MA 184,192,176
v_cvt_pk_bf16_f32 v236, v152, v153
v_cvt_pk_bf16_f32 v237, v154, v155
WL 0
v_mfma_f32_16x16x32_bf16 v[164:167], a[224:227], a[128:131], v[192:195]
v_exp_f32 v157, v157
MA 164,228,132
v_cvt_pk_bf16_f32 v226, v132, v133
v_cvt_pk_bf16_f32 v227, v134, v135
v_cvt_pk_bf16_f32 v230, v140, v141
MA 164,232,136
v_exp_f32 v158, v158
MA 164,236,140
v_cvt_pk_bf16_f32 v231, v142, v143
v_cvt_pk_bf16_f32 v234, v148, v149
v_mfma_f32_16x16x32_bf16 v[172:175], a[236:239], a[156:159], v[196:199]
TR 208,24,49152
v_cvt_pk_bf16_f32 v235, v150, v151
MA 172,232,152
TR 210,24,53248
buffer_load_dword v61, v60, s[32:35], s81 offen
s_add_u32 s81, s81, 1048576
MA 172,228,148
v_exp_f32 v159, v159
MA 172,224,144
v_cvt_pk_bf16_f32 v238, v156, v157
v_cvt_pk_bf16_f32 v239, v158, v159
v_mfma_f32_16x16x32_bf16 v[208:211], a[240:243], v[224:227], 0
TR 212,25,49152
v_mfma_f32_16x16x32_bf16 v[212:215], a[240:243], v[228:231], 0
TR 214,25,53248
v_mfma_f32_16x16x32_bf16 v[216:219], a[240:243], v[232:235], 0
TR 216,26,49152
v_mfma_f32_16x16x32_bf16 v[220:223], a[240:243], v[236:239], 0
TR 218,26,53248
v_mfma_f32_16x16x32_bf16 v[180:183], a[224:227], a[160:163], v[200:203]
MA 180,228,164
MA 180,232,168
MA 180,236,172
v_mfma_f32_16x16x32_bf16 v[188:191], a[236:239], a[188:191], v[204:207]
MA 188,232,184
MA 188,228,180
v_max3_f32 v56, v208, v212, v216
v_max_f32 v56, v56, v220
MA 188,224,176
v_cmp_lt_f32 vcc, 0x49800000, v56
s_nop 0
s_cbranch_vccnz t2_c29
t2_r30:
WL 4
v_mfma_f32_16x16x32_bf16 a[0:3], a[208:211], v[224:227], a[0:3]
TR 220,27,49152
v_add_f32 v48, v48, v208
v_add_f32 v49, v49, v212
v_mfma_f32_16x16x32_bf16 a[32:35], a[208:211], v[228:231], a[32:35]
TR 222,27,53248
v_lshrrev_b32 v23, 3, v0
v_add_f32 v50, v50, v216
v_add_f32 v51, v51, v220
v_mfma_f32_16x16x32_bf16 a[64:67], a[208:211], v[232:235], a[64:67]
v_exp_f32 v160, v160
v_mfma_f32_16x16x32_bf16 a[96:99], a[208:211], v[236:239], a[96:99]
v_and_b32 v58, 7, v0
WL 4
v_mfma_f32_16x16x32_bf16 a[100:103], a[212:215], v[236:239], a[100:103]
TR 208,28,49152
v_exp_f32 v161, v161
v_mfma_f32_16x16x32_bf16 a[68:71], a[212:215], v[232:235], a[68:71]
TR 210,28,53248
v_xor_b32 v58, v23, v58
v_mfma_f32_16x16x32_bf16 a[36:39], a[212:215], v[228:231], a[36:39]
v_exp_f32 v162, v162
v_mfma_f32_16x16x32_bf16 a[4:7], a[212:215], v[224:227], a[4:7]
v_lshlrev_b32 v58, 4, v58
WL 4
v_mfma_f32_16x16x32_bf16 a[8:11], a[216:219], v[224:227], a[8:11]
TR 212,29,49152
v_exp_f32 v163, v163
v_mfma_f32_16x16x32_bf16 a[40:43], a[216:219], v[228:231], a[40:43]
TR 214,29,53248
v_lshl_add_u32 v58, v23, 11, v58
v_mfma_f32_16x16x32_bf16 a[72:75], a[216:219], v[232:235], a[72:75]
v_exp_f32 v168, v168
v_mfma_f32_16x16x32_bf16 a[104:107], a[216:219], v[236:239], a[104:107]
s_lshl_b32 s64, s58, 2
v_exp_f32 v169, v169
WL 4
v_mfma_f32_16x16x32_bf16 a[108:111], a[220:223], v[236:239], a[108:111]
TR 216,30,49152
v_mfma_f32_16x16x32_bf16 a[76:79], a[220:223], v[232:235], a[76:79]
TR 218,30,53248
s_add_u32 s64, s64, s44
v_mfma_f32_16x16x32_bf16 a[44:47], a[220:223], v[228:231], a[44:47]
v_exp_f32 v170, v170
v_mfma_f32_16x16x32_bf16 a[12:15], a[220:223], v[224:227], a[12:15]
s_lshl_b32 s64, s64, 17
v_exp_f32 v171, v171
WL 4
v_mfma_f32_16x16x32_bf16 a[16:19], a[208:211], v[224:227], a[16:19]
TR 220,31,49152
v_exp_f32 v176, v176
v_mfma_f32_16x16x32_bf16 a[48:51], a[208:211], v[228:231], a[48:51]
TR 222,31,53248
s_lshl_b32 s65, s96, 8
v_mfma_f32_16x16x32_bf16 a[80:83], a[208:211], v[232:235], a[80:83]
v_exp_f32 v177, v177
v_mfma_f32_16x16x32_bf16 a[112:115], a[208:211], v[236:239], a[112:115]
v_exp_f32 v178, v178
WV 15
s_barrier
WL 4
v_mfma_f32_16x16x32_bf16 a[116:119], a[212:215], v[236:239], a[116:119]
ds_read_b128 a[192:195], v44 offset:0
v_exp_f32 v179, v179
v_mfma_f32_16x16x32_bf16 a[84:87], a[212:215], v[232:235], a[84:87]
v_exp_f32 v184, v184
v_mfma_f32_16x16x32_bf16 a[52:55], a[212:215], v[228:231], a[52:55]
ds_read_b128 a[196:199], v45 offset:0
s_add_u32 m0, s48, 0
v_mfma_f32_16x16x32_bf16 a[20:23], a[212:215], v[224:227], a[20:23]
DM 12,28,53,0
WL 4
v_mfma_f32_16x16x32_bf16 a[24:27], a[216:219], v[224:227], a[24:27]
ds_read_b128 a[200:203], v46 offset:0
v_exp_f32 v185, v185
v_mfma_f32_16x16x32_bf16 a[56:59], a[216:219], v[228:231], a[56:59]
v_exp_f32 v186, v186
v_mfma_f32_16x16x32_bf16 a[88:91], a[216:219], v[232:235], a[88:91]
ds_read_b128 a[204:207], v47 offset:0
v_mfma_f32_16x16x32_bf16 a[120:123], a[216:219], v[236:239], a[120:123]
DM 13,28,53,1024
WL 4
v_mfma_f32_16x16x32_bf16 a[124:127], a[220:223], v[236:239], a[124:127]
v_exp_f32 v187, v187
v_mfma_f32_16x16x32_bf16 a[92:95], a[220:223], v[232:235], a[92:95]
v_exp_f32 v164, v164
v_mfma_f32_16x16x32_bf16 a[60:63], a[220:223], v[228:231], a[60:63]
v_exp_f32 v165, v165
v_mfma_f32_16x16x32_bf16 a[28:31], a[220:223], v[224:227], a[28:31]
DM 14,28,53,2048
v_cvt_pk_bf16_f32 v224, v160, v161
WL 0
v_mfma_f32_16x16x32_bf16 v[128:131], a[192:195], a[128:131], v[192:195]
v_exp_f32 v166, v166
MA 128,196,132
ds_read_b128 a[224:227], v44 offset:4096
v_cvt_pk_bf16_f32 v225, v162, v163
MA 128,200,136
v_exp_f32 v167, v167
MA 128,204,140
ds_read_b128 a[228:231], v45 offset:4096
DM 15,28,53,3072
s_add_u32 s53, s53, 458752
v_mfma_f32_16x16x32_bf16 v[136:139], a[204:207], a[156:159], v[196:199]
v_exp_f32 v172, v172
MA 136,200,152
ds_read_b128 a[232:235], v46 offset:4096
v_exp_f32 v173, v173
MA 136,196,148
v_exp_f32 v174, v174
MA 136,192,144
ds_read_b128 a[236:239], v47 offset:4096
v_cvt_pk_bf16_f32 v228, v168, v169
v_mfma_f32_16x16x32_bf16 v[144:147], a[192:195], a[160:163], v[200:203]
v_exp_f32 v175, v175
MA 144,196,164
v_exp_f32 v180, v180
MA 144,200,168
v_exp_f32 v181, v181
MA 144,204,172
v_exp_f32 v182, v182
v_mfma_f32_16x16x32_bf16 v[152:155], a[204:207], a[188:191], v[204:207]
v_cvt_pk_bf16_f32 v229, v170, v171
v_cvt_pk_bf16_f32 v232, v176, v177
MA 152,200,184
v_exp_f32 v183, v183
v_cvt_pk_bf16_f32 v233, v178, v179
MA 152,196,180
v_exp_f32 v188, v188
MA 152,192,176
v_cvt_pk_bf16_f32 v236, v184, v185
v_cvt_pk_bf16_f32 v237, v186, v187
WL 0
v_mfma_f32_16x16x32_bf16 v[132:135], a[224:227], a[128:131], v[192:195]
v_exp_f32 v189, v189
MA 132,228,132
v_cvt_pk_bf16_f32 v226, v164, v165
v_cvt_pk_bf16_f32 v227, v166, v167
MA 132,232,136
v_exp_f32 v190, v190
MA 132,236,140
v_cvt_pk_bf16_f32 v230, v172, v173
v_cvt_pk_bf16_f32 v231, v174, v175
v_cvt_pk_bf16_f32 v234, v180, v181
v_mfma_f32_16x16x32_bf16 v[140:143], a[236:239], a[156:159], v[196:199]
TR 208,24,57344
v_cvt_pk_bf16_f32 v235, v182, v183
MA 140,232,152
TR 210,24,61440
v_cvt_pk_bf16_f32 v238, v188, v189
MA 140,228,148
v_exp_f32 v191, v191
MA 140,224,144
s_add_u32 s64, s64, s65
v_cvt_pk_bf16_f32 v239, v190, v191
v_mfma_f32_16x16x32_bf16 v[208:211], a[240:243], v[224:227], 0
TR 212,25,57344
v_mfma_f32_16x16x32_bf16 v[212:215], a[240:243], v[228:231], 0
TR 214,25,61440
v_mfma_f32_16x16x32_bf16 v[216:219], a[240:243], v[232:235], 0
buffer_load_dword v61, v60, s[32:35], s81 offen
v_mfma_f32_16x16x32_bf16 v[220:223], a[240:243], v[236:239], 0
s_add_u32 s81, s81, 1048576
v_mfma_f32_16x16x32_bf16 v[148:151], a[224:227], a[160:163], v[200:203]
s_lshl_b32 s65, s97, 7
MA 148,228,164
s_add_u32 s64, s64, s65
MA 148,232,168
TR 216,26,57344
MA 148,236,172
TR 218,26,61440
v_mfma_f32_16x16x32_bf16 v[156:159], a[236:239], a[188:191], v[204:207]
MA 156,232,184
MA 156,228,180
v_max3_f32 v56, v208, v212, v216
v_max_f32 v56, v56, v220
MA 156,224,176
v_cmp_lt_f32 vcc, 0x49800000, v56
s_nop 0
s_cbranch_vccnz t2_c31
t2_r32:
WL 4
v_mfma_f32_16x16x32_bf16 a[0:3], a[208:211], v[224:227], a[0:3]
TR 220,27,57344
v_add_f32 v48, v48, v208
v_add_f32 v49, v49, v212
v_mfma_f32_16x16x32_bf16 a[32:35], a[208:211], v[228:231], a[32:35]
TR 222,27,61440
v_add_f32 v50, v50, v216
v_add_f32 v51, v51, v220
v_mfma_f32_16x16x32_bf16 a[64:67], a[208:211], v[232:235], a[64:67]
v_exp_f32 v128, v128
v_mfma_f32_16x16x32_bf16 a[96:99], a[208:211], v[236:239], a[96:99]
s_add_u32 m0, s49, 131072
v_exp_f32 v129, v129
WL 4
v_mfma_f32_16x16x32_bf16 a[100:103], a[212:215], v[236:239], a[100:103]
TR 208,28,57344
v_mfma_f32_16x16x32_bf16 a[68:71], a[212:215], v[232:235], a[68:71]
TR 210,28,61440
DM 58,36,64,0
s_add_u32 s64, s64, 16384
v_mfma_f32_16x16x32_bf16 a[36:39], a[212:215], v[228:231], a[36:39]
v_exp_f32 v130, v130
v_mfma_f32_16x16x32_bf16 a[4:7], a[212:215], v[224:227], a[4:7]
v_exp_f32 v131, v131
WL 4
v_mfma_f32_16x16x32_bf16 a[8:11], a[216:219], v[224:227], a[8:11]
TR 212,29,57344
v_exp_f32 v136, v136
v_mfma_f32_16x16x32_bf16 a[40:43], a[216:219], v[228:231], a[40:43]
TR 214,29,61440
v_exp_f32 v137, v137
v_mfma_f32_16x16x32_bf16 a[72:75], a[216:219], v[232:235], a[72:75]
v_exp_f32 v138, v138
v_mfma_f32_16x16x32_bf16 a[104:107], a[216:219], v[236:239], a[104:107]
s_add_u32 m0, s49, 132096
v_exp_f32 v139, v139
WL 4
v_mfma_f32_16x16x32_bf16 a[108:111], a[220:223], v[236:239], a[108:111]
TR 216,30,57344
v_exp_f32 v144, v144
v_mfma_f32_16x16x32_bf16 a[76:79], a[220:223], v[232:235], a[76:79]
TR 218,30,61440
DM 58,36,64,0
s_add_u32 s64, s64, 16384
v_mfma_f32_16x16x32_bf16 a[44:47], a[220:223], v[228:231], a[44:47]
v_exp_f32 v145, v145
v_mfma_f32_16x16x32_bf16 a[12:15], a[220:223], v[224:227], a[12:15]
v_exp_f32 v146, v146
WL 4
v_mfma_f32_16x16x32_bf16 a[16:19], a[208:211], v[224:227], a[16:19]
TR 220,31,57344
v_exp_f32 v147, v147
v_mfma_f32_16x16x32_bf16 a[48:51], a[208:211], v[228:231], a[48:51]
TR 222,31,61440
v_mfma_f32_16x16x32_bf16 a[80:83], a[208:211], v[232:235], a[80:83]
v_exp_f32 v152, v152
v_mfma_f32_16x16x32_bf16 a[112:115], a[208:211], v[236:239], a[112:115]
s_add_u32 m0, s49, 133120
v_exp_f32 v153, v153
WL 4
v_mfma_f32_16x16x32_bf16 a[116:119], a[212:215], v[236:239], a[116:119]
ds_read_b128 a[192:195], v44 offset:8192
v_mfma_f32_16x16x32_bf16 a[84:87], a[212:215], v[232:235], a[84:87]
DM 58,36,64,0
s_add_u32 s64, s64, 16384
v_mfma_f32_16x16x32_bf16 a[52:55], a[212:215], v[228:231], a[52:55]
ds_read_b128 a[196:199], v45 offset:8192
v_exp_f32 v154, v154
v_mfma_f32_16x16x32_bf16 a[20:23], a[212:215], v[224:227], a[20:23]
v_exp_f32 v155, v155
WL 4
v_mfma_f32_16x16x32_bf16 a[24:27], a[216:219], v[224:227], a[24:27]
ds_read_b128 a[200:203], v46 offset:8192
v_mfma_f32_16x16x32_bf16 a[56:59], a[216:219], v[228:231], a[56:59]
v_exp_f32 v132, v132
v_mfma_f32_16x16x32_bf16 a[88:91], a[216:219], v[232:235], a[88:91]
ds_read_b128 a[204:207], v47 offset:8192
v_exp_f32 v133, v133
v_mfma_f32_16x16x32_bf16 a[120:123], a[216:219], v[236:239], a[120:123]
s_add_u32 m0, s49, 134144
WL 4
v_mfma_f32_16x16x32_bf16 a[124:127], a[220:223], v[236:239], a[124:127]
v_exp_f32 v134, v134
v_mfma_f32_16x16x32_bf16 a[92:95], a[220:223], v[232:235], a[92:95]
DM 58,36,64,0
s_add_u32 s64, s64, 16384
v_mfma_f32_16x16x32_bf16 a[60:63], a[220:223], v[228:231], a[60:63]
v_exp_f32 v135, v135
v_mfma_f32_16x16x32_bf16 a[28:31], a[220:223], v[224:227], a[28:31]
v_exp_f32 v140, v140
WL 0
v_mfma_f32_16x16x32_bf16 v[160:163], a[192:195], a[128:131], v[192:195]
v_exp_f32 v141, v141
v_cvt_pk_bf16_f32 v224, v128, v129
MA 160,196,132
ds_read_b128 a[224:227], v44 offset:12288
buffer_load_dword v61, v60, s[32:35], s81 offen
s_add_u32 s81, s81, 1048576
MA 160,200,136
v_exp_f32 v142, v142
MA 160,204,140
ds_read_b128 a[228:231], v45 offset:12288
s_add_u32 m0, s49, 135168
v_mfma_f32_16x16x32_bf16 v[168:171], a[204:207], a[156:159], v[196:199]
v_exp_f32 v143, v143
MA 168,200,152
ds_read_b128 a[232:235], v46 offset:12288
DM 58,36,64,0
s_add_u32 s64, s64, 16384
MA 168,196,148
v_exp_f32 v148, v148
MA 168,192,144
ds_read_b128 a[236:239], v47 offset:12288
v_exp_f32 v149, v149
v_mfma_f32_16x16x32_bf16 v[176:179], a[192:195], a[160:163], v[200:203]
v_cvt_pk_bf16_f32 v225, v130, v131
v_cvt_pk_bf16_f32 v228, v136, v137
MA 176,196,164
v_exp_f32 v150, v150
MA 176,200,168
v_cvt_pk_bf16_f32 v229, v138, v139
v_cvt_pk_bf16_f32 v232, v144, v145
MA 176,204,172
s_add_u32 m0, s49, 136192
v_exp_f32 v151, v151
v_mfma_f32_16x16x32_bf16 v[184:187], a[204:207], a[188:191], v[204:207]
v_cvt_pk_bf16_f32 v233, v146, v147
v_cvt_pk_bf16_f32 v236, v152, v153
MA 184,200,184
DM 58,36,64,0
s_add_u32 s64, s64, 16384
MA 184,196,180
v_exp_f32 v156, v156
MA 184,192,176
v_cvt_pk_bf16_f32 v237, v154, v155
v_cvt_pk_bf16_f32 v226, v132, v133
WL 0
v_mfma_f32_16x16x32_bf16 v[164:167], a[224:227], a[128:131], v[192:195]
v_exp_f32 v157, v157
MA 164,228,132
v_cvt_pk_bf16_f32 v227, v134, v135
v_cvt_pk_bf16_f32 v230, v140, v141
MA 164,232,136
v_exp_f32 v158, v158
MA 164,236,140
s_add_u32 m0, s49, 137216
v_cvt_pk_bf16_f32 v231, v142, v143
v_cvt_pk_bf16_f32 v234, v148, v149
v_mfma_f32_16x16x32_bf16 v[172:175], a[236:239], a[156:159], v[196:199]
TR 208,32,16384
v_cvt_pk_bf16_f32 v235, v150, v151
MA 172,232,152
TR 210,32,20480
DM 58,36,64,0
s_add_u32 s64, s64, 16384
MA 172,228,148
v_exp_f32 v159, v159
MA 172,224,144
v_cvt_pk_bf16_f32 v238, v156, v157
v_cvt_pk_bf16_f32 v239, v158, v159
v_mfma_f32_16x16x32_bf16 v[208:211], a[240:243], v[224:227], 0
TR 212,33,16384
v_mfma_f32_16x16x32_bf16 v[212:215], a[240:243], v[228:231], 0
TR 214,33,20480
v_mfma_f32_16x16x32_bf16 v[216:219], a[240:243], v[232:235], 0
s_add_u32 m0, s49, 138240
v_mfma_f32_16x16x32_bf16 v[220:223], a[240:243], v[236:239], 0
TR 216,34,16384
v_mfma_f32_16x16x32_bf16 v[180:183], a[224:227], a[160:163], v[200:203]
TR 218,34,20480
MA 180,228,164
DM 58,36,64,0
MA 180,232,168
s_add_u32 s64, s64, 16384
MA 180,236,172
v_mfma_f32_16x16x32_bf16 v[188:191], a[236:239], a[188:191], v[204:207]
MA 188,232,184
MA 188,228,180
v_max3_f32 v56, v208, v212, v216
v_max_f32 v56, v56, v220
MA 188,224,176
v_cmp_lt_f32 vcc, 0x49800000, v56
s_nop 0
s_cbranch_vccnz t2_c33
t2_r34:
WL 4
v_mfma_f32_16x16x32_bf16 a[0:3], a[208:211], v[224:227], a[0:3]
TR 220,35,16384
v_add_f32 v48, v48, v208
v_add_f32 v49, v49, v212
v_mfma_f32_16x16x32_bf16 a[32:35], a[208:211], v[228:231], a[32:35]
TR 222,35,20480
v_add_f32 v50, v50, v216
v_add_f32 v51, v51, v220
v_mfma_f32_16x16x32_bf16 a[64:67], a[208:211], v[232:235], a[64:67]
v_exp_f32 v160, v160
v_mfma_f32_16x16x32_bf16 a[96:99], a[208:211], v[236:239], a[96:99]
v_exp_f32 v161, v161
WL 4
v_mfma_f32_16x16x32_bf16 a[100:103], a[212:215], v[236:239], a[100:103]
TR 208,36,16384
v_mfma_f32_16x16x32_bf16 a[68:71], a[212:215], v[232:235], a[68:71]
TR 210,36,20480
v_mfma_f32_16x16x32_bf16 a[36:39], a[212:215], v[228:231], a[36:39]
v_exp_f32 v162, v162
v_mfma_f32_16x16x32_bf16 a[4:7], a[212:215], v[224:227], a[4:7]
v_exp_f32 v163, v163
WL 4
v_mfma_f32_16x16x32_bf16 a[8:11], a[216:219], v[224:227], a[8:11]
TR 212,37,16384
v_exp_f32 v168, v168
v_mfma_f32_16x16x32_bf16 a[40:43], a[216:219], v[228:231], a[40:43]
TR 214,37,20480
v_mfma_f32_16x16x32_bf16 a[72:75], a[216:219], v[232:235], a[72:75]
v_exp_f32 v169, v169
v_mfma_f32_16x16x32_bf16 a[104:107], a[216:219], v[236:239], a[104:107]
v_exp_f32 v170, v170
WL 4
v_mfma_f32_16x16x32_bf16 a[108:111], a[220:223], v[236:239], a[108:111]
TR 216,38,16384
v_mfma_f32_16x16x32_bf16 a[76:79], a[220:223], v[232:235], a[76:79]
TR 218,38,20480
v_exp_f32 v171, v171
v_mfma_f32_16x16x32_bf16 a[44:47], a[220:223], v[228:231], a[44:47]
v_exp_f32 v176, v176
v_mfma_f32_16x16x32_bf16 a[12:15], a[220:223], v[224:227], a[12:15]
v_exp_f32 v177, v177
WL 4
v_mfma_f32_16x16x32_bf16 a[16:19], a[208:211], v[224:227], a[16:19]
TR 220,39,16384
v_mfma_f32_16x16x32_bf16 a[48:51], a[208:211], v[228:231], a[48:51]
TR 222,39,20480
v_mfma_f32_16x16x32_bf16 a[80:83], a[208:211], v[232:235], a[80:83]
v_exp_f32 v178, v178
v_mfma_f32_16x16x32_bf16 a[112:115], a[208:211], v[236:239], a[112:115]
v_exp_f32 v179, v179
WV 18
s_barrier
WL 4
v_mfma_f32_16x16x32_bf16 a[116:119], a[212:215], v[236:239], a[116:119]
ds_read_b128 a[192:195], v44 offset:32768
v_mfma_f32_16x16x32_bf16 a[84:87], a[212:215], v[232:235], a[84:87]
v_exp_f32 v184, v184
v_mfma_f32_16x16x32_bf16 a[52:55], a[212:215], v[228:231], a[52:55]
ds_read_b128 a[196:199], v45 offset:32768
s_add_u32 m0, s48, 32768
v_mfma_f32_16x16x32_bf16 a[20:23], a[212:215], v[224:227], a[20:23]
DM 12,28,53,0
WL 4
v_mfma_f32_16x16x32_bf16 a[24:27], a[216:219], v[224:227], a[24:27]
ds_read_b128 a[200:203], v46 offset:32768
v_exp_f32 v185, v185
v_mfma_f32_16x16x32_bf16 a[56:59], a[216:219], v[228:231], a[56:59]
v_exp_f32 v186, v186
v_mfma_f32_16x16x32_bf16 a[88:91], a[216:219], v[232:235], a[88:91]
ds_read_b128 a[204:207], v47 offset:32768
v_mfma_f32_16x16x32_bf16 a[120:123], a[216:219], v[236:239], a[120:123]
DM 13,28,53,1024
WL 4
v_mfma_f32_16x16x32_bf16 a[124:127], a[220:223], v[236:239], a[124:127]
v_exp_f32 v187, v187
v_mfma_f32_16x16x32_bf16 a[92:95], a[220:223], v[232:235], a[92:95]
v_exp_f32 v164, v164
v_mfma_f32_16x16x32_bf16 a[60:63], a[220:223], v[228:231], a[60:63]
v_exp_f32 v165, v165
v_mfma_f32_16x16x32_bf16 a[28:31], a[220:223], v[224:227], a[28:31]
DM 14,28,53,2048
v_cvt_pk_bf16_f32 v224, v160, v161
WL 0
v_mfma_f32_16x16x32_bf16 v[128:131], a[192:195], a[128:131], v[192:195]
v_exp_f32 v166, v166
MA 128,196,132
ds_read_b128 a[224:227], v44 offset:36864
v_cvt_pk_bf16_f32 v225, v162, v163
MA 128,200,136
v_exp_f32 v167, v167
MA 128,204,140
ds_read_b128 a[228:231], v45 offset:36864
DM 15,28,53,3072
s_add_u32 s53, s53, 458752
v_mfma_f32_16x16x32_bf16 v[136:139], a[204:207], a[156:159], v[196:199]
v_exp_f32 v172, v172
MA 136,200,152
ds_read_b128 a[232:235], v46 offset:36864
v_cvt_pk_bf16_f32 v228, v168, v169
MA 136,196,148
v_exp_f32 v173, v173
MA 136,192,144
ds_read_b128 a[236:239], v47 offset:36864
v_exp_f32 v174, v174
v_mfma_f32_16x16x32_bf16 v[144:147], a[192:195], a[160:163], v[200:203]
v_exp_f32 v175, v175
MA 144,196,164
v_exp_f32 v180, v180
MA 144,200,168
v_exp_f32 v181, v181
MA 144,204,172
v_exp_f32 v182, v182
v_mfma_f32_16x16x32_bf16 v[152:155], a[204:207], a[188:191], v[204:207]
v_cvt_pk_bf16_f32 v229, v170, v171
v_cvt_pk_bf16_f32 v232, v176, v177
MA 152,200,184
v_exp_f32 v183, v183
MA 152,196,180
v_cvt_pk_bf16_f32 v233, v178, v179
v_cvt_pk_bf16_f32 v236, v184, v185
MA 152,192,176
v_exp_f32 v188, v188
WL 0
v_mfma_f32_16x16x32_bf16 v[132:135], a[224:227], a[128:131], v[192:195]
v_cvt_pk_bf16_f32 v237, v186, v187
v_cvt_pk_bf16_f32 v226, v164, v165
MA 132,228,132
v_exp_f32 v189, v189
MA 132,232,136
v_cvt_pk_bf16_f32 v227, v166, v167
v_exp_f32 v190, v190
MA 132,236,140
v_cvt_pk_bf16_f32 v230, v172, v173
v_cvt_pk_bf16_f32 v231, v174, v175
v_mfma_f32_16x16x32_bf16 v[140:143], a[236:239], a[156:159], v[196:199]
TR 208,32,24576
v_cvt_pk_bf16_f32 v234, v180, v181
MA 140,232,152
TR 210,32,28672
v_cvt_pk_bf16_f32 v235, v182, v183
MA 140,228,148
v_exp_f32 v191, v191
MA 140,224,144
v_cvt_pk_bf16_f32 v238, v188, v189
v_cvt_pk_bf16_f32 v239, v190, v191
v_mfma_f32_16x16x32_bf16 v[208:211], a[240:243], v[224:227], 0
TR 212,33,24576
v_mfma_f32_16x16x32_bf16 v[212:215], a[240:243], v[228:231], 0
TR 214,33,28672
v_mfma_f32_16x16x32_bf16 v[216:219], a[240:243], v[232:235], 0
TR 216,34,24576
v_mfma_f32_16x16x32_bf16 v[220:223], a[240:243], v[236:239], 0
TR 218,34,28672
v_mfma_f32_16x16x32_bf16 v[148:151], a[224:227], a[160:163], v[200:203]
MA 148,228,164
MA 148,232,168
MA 148,236,172
v_mfma_f32_16x16x32_bf16 v[156:159], a[236:239], a[188:191], v[204:207]
MA 156,232,184
MA 156,228,180
v_max3_f32 v56, v208, v212, v216
v_max_f32 v56, v56, v220
MA 156,224,176
v_cmp_lt_f32 vcc, 0x49800000, v56
s_nop 0
s_cbranch_vccnz t2_c35
t2_r36:
WL 4
v_mfma_f32_16x16x32_bf16 a[0:3], a[208:211], v[224:227], a[0:3]
TR 220,35,24576
v_add_f32 v48, v48, v208
v_add_f32 v49, v49, v212
v_mfma_f32_16x16x32_bf16 a[32:35], a[208:211], v[228:231], a[32:35]
TR 222,35,28672
v_add_f32 v50, v50, v216
v_add_f32 v51, v51, v220
v_mfma_f32_16x16x32_bf16 a[64:67], a[208:211], v[232:235], a[64:67]
v_exp_f32 v128, v128
v_mfma_f32_16x16x32_bf16 a[96:99], a[208:211], v[236:239], a[96:99]
v_exp_f32 v129, v129
WL 4
v_mfma_f32_16x16x32_bf16 a[100:103], a[212:215], v[236:239], a[100:103]
TR 208,36,24576
v_mfma_f32_16x16x32_bf16 a[68:71], a[212:215], v[232:235], a[68:71]
TR 210,36,28672
v_mfma_f32_16x16x32_bf16 a[36:39], a[212:215], v[228:231], a[36:39]
v_exp_f32 v130, v130
v_mfma_f32_16x16x32_bf16 a[4:7], a[212:215], v[224:227], a[4:7]
v_exp_f32 v131, v131
WL 4
v_mfma_f32_16x16x32_bf16 a[8:11], a[216:219], v[224:227], a[8:11]
TR 212,37,24576
v_exp_f32 v136, v136
v_mfma_f32_16x16x32_bf16 a[40:43], a[216:219], v[228:231], a[40:43]
TR 214,37,28672
v_mfma_f32_16x16x32_bf16 a[72:75], a[216:219], v[232:235], a[72:75]
v_exp_f32 v137, v137
v_mfma_f32_16x16x32_bf16 a[104:107], a[216:219], v[236:239], a[104:107]
v_exp_f32 v138, v138
WL 4
v_mfma_f32_16x16x32_bf16 a[108:111], a[220:223], v[236:239], a[108:111]
TR 216,38,24576
v_exp_f32 v139, v139
v_mfma_f32_16x16x32_bf16 a[76:79], a[220:223], v[232:235], a[76:79]
TR 218,38,28672
v_mfma_f32_16x16x32_bf16 a[44:47], a[220:223], v[228:231], a[44:47]
v_exp_f32 v144, v144
v_mfma_f32_16x16x32_bf16 a[12:15], a[220:223], v[224:227], a[12:15]
v_exp_f32 v145, v145
WL 4
v_mfma_f32_16x16x32_bf16 a[16:19], a[208:211], v[224:227], a[16:19]
TR 220,39,24576
v_mfma_f32_16x16x32_bf16 a[48:51], a[208:211], v[228:231], a[48:51]
TR 222,39,28672
buffer_load_dword v17, v22, s[4:7], s80 offen offset:768 sc1
v_mfma_f32_16x16x32_bf16 a[80:83], a[208:211], v[232:235], a[80:83]
v_exp_f32 v146, v146
v_mfma_f32_16x16x32_bf16 a[112:115], a[208:211], v[236:239], a[112:115]
v_exp_f32 v147, v147
WL 4
v_mfma_f32_16x16x32_bf16 a[116:119], a[212:215], v[236:239], a[116:119]
ds_read_b128 a[192:195], v44 offset:40960
v_exp_f32 v152, v152
v_mfma_f32_16x16x32_bf16 a[84:87], a[212:215], v[232:235], a[84:87]
v_exp_f32 v153, v153
v_mfma_f32_16x16x32_bf16 a[52:55], a[212:215], v[228:231], a[52:55]
ds_read_b128 a[196:199], v45 offset:40960
v_mfma_f32_16x16x32_bf16 a[20:23], a[212:215], v[224:227], a[20:23]
v_exp_f32 v154, v154
WL 4
v_mfma_f32_16x16x32_bf16 a[24:27], a[216:219], v[224:227], a[24:27]
ds_read_b128 a[200:203], v46 offset:40960
v_mfma_f32_16x16x32_bf16 a[56:59], a[216:219], v[228:231], a[56:59]
v_exp_f32 v155, v155
v_mfma_f32_16x16x32_bf16 a[88:91], a[216:219], v[232:235], a[88:91]
ds_read_b128 a[204:207], v47 offset:40960
v_exp_f32 v132, v132
v_mfma_f32_16x16x32_bf16 a[120:123], a[216:219], v[236:239], a[120:123]
v_exp_f32 v133, v133
WL 4
v_mfma_f32_16x16x32_bf16 a[124:127], a[220:223], v[236:239], a[124:127]
v_exp_f32 v134, v134
v_mfma_f32_16x16x32_bf16 a[92:95], a[220:223], v[232:235], a[92:95]
v_exp_f32 v135, v135
v_mfma_f32_16x16x32_bf16 a[60:63], a[220:223], v[228:231], a[60:63]
v_exp_f32 v140, v140
v_mfma_f32_16x16x32_bf16 a[28:31], a[220:223], v[224:227], a[28:31]
v_exp_f32 v141, v141
WL 0
v_mfma_f32_16x16x32_bf16 v[160:163], a[192:195], a[128:131], v[192:195]
v_exp_f32 v142, v142
MA 160,196,132
ds_read_b128 a[224:227], v44 offset:45056
v_cvt_pk_bf16_f32 v224, v128, v129
MA 160,200,136
v_exp_f32 v143, v143
MA 160,204,140
ds_read_b128 a[228:231], v45 offset:45056
v_cvt_pk_bf16_f32 v225, v130, v131
v_mfma_f32_16x16x32_bf16 v[168:171], a[204:207], a[156:159], v[196:199]
v_exp_f32 v148, v148
MA 168,200,152
ds_read_b128 a[232:235], v46 offset:45056
v_cvt_pk_bf16_f32 v228, v136, v137
MA 168,196,148
v_exp_f32 v149, v149
v_cvt_pk_bf16_f32 v229, v138, v139
MA 168,192,144
ds_read_b128 a[236:239], v47 offset:45056
v_cvt_pk_bf16_f32 v232, v144, v145
v_mfma_f32_16x16x32_bf16 v[176:179], a[192:195], a[160:163], v[200:203]
v_exp_f32 v150, v150
MA 176,196,164
v_exp_f32 v151, v151
MA 176,200,168
v_cvt_pk_bf16_f32 v233, v146, v147
v_cvt_pk_bf16_f32 v236, v152, v153
MA 176,204,172
buffer_load_dword v61, v60, s[84:87], s77 offen
v_mfma_f32_16x16x32_bf16 v[184:187], a[204:207], a[188:191], v[204:207]
v_exp_f32 v156, v156
MA 184,200,184
v_xor_b32 v24, 0, v1
v_cvt_pk_bf16_f32 v237, v154, v155
MA 184,196,180
v_exp_f32 v157, v157
MA 184,192,176
v_xor_b32 v25, 32, v1
v_cvt_pk_bf16_f32 v226, v132, v133
WL 0
v_mfma_f32_16x16x32_bf16 v[164:167], a[224:227], a[128:131], v[192:195]
v_cvt_pk_bf16_f32 v227, v134, v135
v_cvt_pk_bf16_f32 v230, v140, v141
MA 164,228,132
v_xor_b32 v26, 64, v1
v_exp_f32 v158, v158
MA 164,232,136
v_cvt_pk_bf16_f32 v231, v142, v143
v_cvt_pk_bf16_f32 v234, v148, v149
MA 164,236,140
v_xor_b32 v27, 96, v1
v_cvt_pk_bf16_f32 v235, v150, v151
v_mfma_f32_16x16x32_bf16 v[172:175], a[236:239], a[156:159], v[196:199]
TR 208,32,49152
v_cvt_pk_bf16_f32 v238, v156, v157
MA 172,232,152
TR 210,32,53248
v_xor_b32 v28, 128, v1
MA 172,228,148
v_exp_f32 v159, v159
MA 172,224,144
v_xor_b32 v29, 160, v1
v_cvt_pk_bf16_f32 v239, v158, v159
v_mfma_f32_16x16x32_bf16 v[208:211], a[240:243], v[224:227], 0
TR 212,33,49152
v_mfma_f32_16x16x32_bf16 v[212:215], a[240:243], v[228:231], 0
TR 214,33,53248
v_mfma_f32_16x16x32_bf16 v[216:219], a[240:243], v[232:235], 0
v_xor_b32 v30, 192, v1
v_mfma_f32_16x16x32_bf16 v[220:223], a[240:243], v[236:239], 0
v_xor_b32 v31, 224, v1
v_mfma_f32_16x16x32_bf16 v[180:183], a[224:227], a[160:163], v[200:203]
TR 216,34,49152
MA 180,228,164
TR 218,34,53248
MA 180,232,168
MA 180,236,172
v_mfma_f32_16x16x32_bf16 v[188:191], a[236:239], a[188:191], v[204:207]
MA 188,232,184
MA 188,228,180
v_max3_f32 v56, v208, v212, v216
v_max_f32 v56, v56, v220
MA 188,224,176
v_cmp_lt_f32 vcc, 0x49800000, v56
s_nop 0
s_cbranch_vccnz t2_c37
t2_r38:
WL 4
v_mfma_f32_16x16x32_bf16 a[0:3], a[208:211], v[224:227], a[0:3]
TR 220,35,49152
v_add_f32 v48, v48, v208
v_add_f32 v49, v49, v212
v_mfma_f32_16x16x32_bf16 a[32:35], a[208:211], v[228:231], a[32:35]
TR 222,35,53248
v_add_f32 v50, v50, v216
v_add_f32 v51, v51, v220
v_mfma_f32_16x16x32_bf16 a[64:67], a[208:211], v[232:235], a[64:67]
v_exp_f32 v128, v160
v_mfma_f32_16x16x32_bf16 a[96:99], a[208:211], v[236:239], a[96:99]
v_exp_f32 v129, v161
WL 4
v_mfma_f32_16x16x32_bf16 a[100:103], a[212:215], v[236:239], a[100:103]
TR 208,36,49152
v_exp_f32 v130, v162
v_mfma_f32_16x16x32_bf16 a[68:71], a[212:215], v[232:235], a[68:71]
TR 210,36,53248
v_exp_f32 v131, v163
v_mfma_f32_16x16x32_bf16 a[36:39], a[212:215], v[228:231], a[36:39]
v_exp_f32 v136, v168
v_cvt_pk_bf16_f32 v240, v128, v129
v_mfma_f32_16x16x32_bf16 a[4:7], a[212:215], v[224:227], a[4:7]
v_exp_f32 v137, v169
v_cvt_pk_bf16_f32 v241, v130, v131
WL 4
v_mfma_f32_16x16x32_bf16 a[8:11], a[216:219], v[224:227], a[8:11]
TR 212,37,49152
v_exp_f32 v138, v170
v_mfma_f32_16x16x32_bf16 a[40:43], a[216:219], v[228:231], a[40:43]
TR 214,37,53248
v_exp_f32 v139, v171
v_mfma_f32_16x16x32_bf16 a[72:75], a[216:219], v[232:235], a[72:75]
v_exp_f32 v144, v176
v_mfma_f32_16x16x32_bf16 a[104:107], a[216:219], v[236:239], a[104:107]
v_exp_f32 v145, v177
v_cvt_pk_bf16_f32 v244, v136, v137
WL 4
v_mfma_f32_16x16x32_bf16 a[108:111], a[220:223], v[236:239], a[108:111]
TR 216,38,49152
v_exp_f32 v146, v178
v_mfma_f32_16x16x32_bf16 a[76:79], a[220:223], v[232:235], a[76:79]
TR 218,38,53248
v_exp_f32 v147, v179
v_mfma_f32_16x16x32_bf16 a[44:47], a[220:223], v[228:231], a[44:47]
v_exp_f32 v152, v184
v_mfma_f32_16x16x32_bf16 a[12:15], a[220:223], v[224:227], a[12:15]
v_exp_f32 v153, v185
v_cvt_pk_bf16_f32 v245, v138, v139
WL 4
v_mfma_f32_16x16x32_bf16 a[16:19], a[208:211], v[224:227], a[16:19]
TR 220,39,49152
v_exp_f32 v154, v186
v_mfma_f32_16x16x32_bf16 a[48:51], a[208:211], v[228:231], a[48:51]
TR 222,39,53248
v_exp_f32 v155, v187
v_mfma_f32_16x16x32_bf16 a[80:83], a[208:211], v[232:235], a[80:83]
v_exp_f32 v132, v164
v_mfma_f32_16x16x32_bf16 a[112:115], a[208:211], v[236:239], a[112:115]
v_exp_f32 v133, v165
v_cvt_pk_bf16_f32 v248, v144, v145
WV 1
v_cmp_gt_u32 s[68:69], 16, v17
s_nop 0
s_and_b64 s[68:69], s[68:69], s[74:75]
s_cbranch_scc1 t2_slow9
t2_back10:
s_barrier
WL 4
v_mfma_f32_16x16x32_bf16 a[116:119], a[212:215], v[236:239], a[116:119]
TR 208,32,57344
v_exp_f32 v134, v166
v_mfma_f32_16x16x32_bf16 a[84:87], a[212:215], v[232:235], a[84:87]
TR 210,32,61440
v_exp_f32 v135, v167
v_mfma_f32_16x16x32_bf16 a[52:55], a[212:215], v[228:231], a[52:55]
s_add_u32 m0, s48, 65536
v_exp_f32 v140, v172
v_mfma_f32_16x16x32_bf16 a[20:23], a[212:215], v[224:227], a[20:23]
DM 12,28,53,0
v_cvt_pk_bf16_f32 v249, v146, v147
WL 4
v_mfma_f32_16x16x32_bf16 a[24:27], a[216:219], v[224:227], a[24:27]
TR 212,33,57344
v_cvt_pk_bf16_f32 v252, v152, v153
v_mfma_f32_16x16x32_bf16 a[56:59], a[216:219], v[228:231], a[56:59]
TR 214,33,61440
DM 13,28,53,1024
v_mfma_f32_16x16x32_bf16 a[88:91], a[216:219], v[232:235], a[88:91]
v_exp_f32 v141, v173
v_exp_f32 v142, v174
v_mfma_f32_16x16x32_bf16 a[120:123], a[216:219], v[236:239], a[120:123]
DM 14,28,53,2048
v_cvt_pk_bf16_f32 v253, v154, v155
WL 4
v_mfma_f32_16x16x32_bf16 a[124:127], a[220:223], v[236:239], a[124:127]
TR 216,34,57344
v_cvt_pk_bf16_f32 v242, v132, v133
v_mfma_f32_16x16x32_bf16 a[92:95], a[220:223], v[232:235], a[92:95]
TR 218,34,61440
DM 15,28,53,3072
s_add_u32 s53, s53, 458752
v_mfma_f32_16x16x32_bf16 a[60:63], a[220:223], v[228:231], a[60:63]
v_exp_f32 v143, v175
v_exp_f32 v148, v180
v_mfma_f32_16x16x32_bf16 a[28:31], a[220:223], v[224:227], a[28:31]
v_exp_f32 v149, v181
v_cvt_pk_bf16_f32 v243, v134, v135
XL 128,5,4,51,0
v_exp_f32 v150, v182
XL 132,5,4,51,128
v_cvt_pk_bf16_f32 v246, v140, v141
XL 136,5,4,51,256
v_exp_f32 v151, v183
XL 140,5,4,51,384
s_add_u32 s51, s51, 4096
v_cvt_pk_bf16_f32 v247, v142, v143
XL 144,5,4,51,0
v_exp_f32 v156, v188
XL 148,5,4,51,128
v_cvt_pk_bf16_f32 v250, v148, v149
XL 152,5,4,51,256
v_exp_f32 v157, v189
XL 156,5,4,51,384
s_add_u32 s51, s51, 4096
v_cvt_pk_bf16_f32 v251, v150, v151
XL 160,5,4,51,0
v_exp_f32 v158, v190
XL 164,5,4,51,128
v_exp_f32 v159, v191
XL 168,5,4,51,256
v_cvt_pk_bf16_f32 v254, v156, v157
XL 172,5,4,51,384
s_add_u32 s51, s51, 4096
v_cvt_pk_bf16_f32 v255, v158, v159
v_mfma_f32_16x16x32_bf16 v[208:211], a[240:243], v[240:243], 0
v_mfma_f32_16x16x32_bf16 v[212:215], a[240:243], v[244:247], 0
v_mfma_f32_16x16x32_bf16 v[216:219], a[240:243], v[248:251], 0
v_mfma_f32_16x16x32_bf16 v[220:223], a[240:243], v[252:255], 0
s_nop 6
v_max3_f32 v56, v208, v212, v216
v_max_f32 v56, v56, v220
v_cmp_lt_f32 vcc, 0x49800000, v56
s_nop 0
s_cbranch_vccnz t2_c39
t2_r40:
WL 4
v_mfma_f32_16x16x32_bf16 a[0:3], a[208:211], v[240:243], a[0:3]
TR 220,35,57344
v_mfma_f32_16x16x32_bf16 a[32:35], a[208:211], v[244:247], a[32:35]
TR 222,35,61440
XL 176,5,4,51,0
v_mfma_f32_16x16x32_bf16 a[64:67], a[208:211], v[248:251], a[64:67]
v_mfma_f32_16x16x32_bf16 a[96:99], a[208:211], v[252:255], a[96:99]
XL 180,5,4,51,128
WL 4
v_mfma_f32_16x16x32_bf16 a[100:103], a[212:215], v[252:255], a[100:103]
TR 208,36,57344
v_mfma_f32_16x16x32_bf16 a[68:71], a[212:215], v[248:251], a[68:71]
TR 210,36,61440
XL 184,5,4,51,256
v_mfma_f32_16x16x32_bf16 a[36:39], a[212:215], v[244:247], a[36:39]
v_mfma_f32_16x16x32_bf16 a[4:7], a[212:215], v[240:243], a[4:7]
XL 188,5,4,51,384
s_add_u32 s51, s51, 4096
WL 4
v_mfma_f32_16x16x32_bf16 a[8:11], a[216:219], v[240:243], a[8:11]
TR 212,37,57344
v_mfma_f32_16x16x32_bf16 a[40:43], a[216:219], v[244:247], a[40:43]
TR 214,37,61440
XL 224,5,4,51,0
v_mfma_f32_16x16x32_bf16 a[72:75], a[216:219], v[248:251], a[72:75]
v_mfma_f32_16x16x32_bf16 a[104:107], a[216:219], v[252:255], a[104:107]
XL 228,5,4,51,128
WL 4
v_mfma_f32_16x16x32_bf16 a[108:111], a[220:223], v[252:255], a[108:111]
TR 216,38,57344
v_mfma_f32_16x16x32_bf16 a[76:79], a[220:223], v[248:251], a[76:79]
TR 218,38,61440
XL 232,5,4,51,256
v_mfma_f32_16x16x32_bf16 a[44:47], a[220:223], v[244:247], a[44:47]
v_mfma_f32_16x16x32_bf16 a[12:15], a[220:223], v[240:243], a[12:15]
XL 236,5,4,51,384
s_add_u32 s51, s51, 4096
WL 4
v_mfma_f32_16x16x32_bf16 a[16:19], a[208:211], v[240:243], a[16:19]
TR 220,39,57344
v_mfma_f32_16x16x32_bf16 a[48:51], a[208:211], v[244:247], a[48:51]
TR 222,39,61440
XL 240,5,4,51,0
v_mfma_f32_16x16x32_bf16 a[80:83], a[208:211], v[248:251], a[80:83]
v_mfma_f32_16x16x32_bf16 a[112:115], a[208:211], v[252:255], a[112:115]
XL 244,5,4,51,128
WL 4
v_mfma_f32_16x16x32_bf16 a[116:119], a[212:215], v[252:255], a[116:119]
v_mfma_f32_16x16x32_bf16 a[84:87], a[212:215], v[248:251], a[84:87]
XL 248,5,4,51,256
v_mfma_f32_16x16x32_bf16 a[52:55], a[212:215], v[244:247], a[52:55]
v_mfma_f32_16x16x32_bf16 a[20:23], a[212:215], v[240:243], a[20:23]
XL 252,5,4,51,384
s_add_u32 s51, s51, 4096
WL 0
s_barrier
v_mfma_f32_16x16x32_bf16 a[24:27], a[216:219], v[240:243], a[24:27]
TR 192,24,0
v_mfma_f32_16x16x32_bf16 a[56:59], a[216:219], v[244:247], a[56:59]
TR 194,24,4096
v_mfma_f32_16x16x32_bf16 a[88:91], a[216:219], v[248:251], a[88:91]
TR 196,24,8192
v_mfma_f32_16x16x32_bf16 a[120:123], a[216:219], v[252:255], a[120:123]
TR 198,24,12288
v_mfma_f32_16x16x32_bf16 a[124:127], a[220:223], v[252:255], a[124:127]
TR 200,25,0
v_mfma_f32_16x16x32_bf16 a[92:95], a[220:223], v[248:251], a[92:95]
TR 202,25,4096
v_mfma_f32_16x16x32_bf16 a[60:63], a[220:223], v[244:247], a[60:63]
TR 204,25,8192
v_mfma_f32_16x16x32_bf16 a[28:31], a[220:223], v[240:243], a[28:31]
TR 206,25,12288
v_add_f32 v208, v208, v48
v_add_f32 v212, v212, v49
v_add_f32 v216, v216, v50
v_add_f32 v220, v220, v51
v_rcp_f32 v208, v208
v_rcp_f32 v212, v212
v_rcp_f32 v216, v216
v_rcp_f32 v220, v220
s_lshl_b32 s83, s56, 2
s_add_u32 s83, s83, s44
s_lshl_b32 s83, s83, 19
s_lshl_b32 s62, s57, 14
s_add_u32 s83, s83, s62
s_add_u32 s83, s83, 25165824
v_accvgpr_read_b32 v128, a0
v_accvgpr_read_b32 v129, a1
v_accvgpr_read_b32 v130, a2
v_accvgpr_read_b32 v131, a3
v_accvgpr_read_b32 v132, a4
v_accvgpr_read_b32 v133, a5
v_accvgpr_read_b32 v134, a6
v_accvgpr_read_b32 v135, a7
v_pk_mul_f32 v[128:129], v[128:129], v[208:209] op_sel_hi:[1,0]
v_pk_mul_f32 v[130:131], v[130:131], v[208:209] op_sel_hi:[1,0]
v_pk_mul_f32 v[132:133], v[132:133], v[208:209] op_sel_hi:[1,0]
v_pk_mul_f32 v[134:135], v[134:135], v[208:209] op_sel_hi:[1,0]
v_cvt_pk_bf16_f32 v160, v128, v129
v_cvt_pk_bf16_f32 v161, v130, v131
v_cvt_pk_bf16_f32 v162, v132, v133
v_cvt_pk_bf16_f32 v163, v134, v135
buffer_store_dwordx4 v[160:163], v5, s[4:7], s83 offen offset:0 sc1
v_accvgpr_read_b32 v136, a32
v_accvgpr_read_b32 v137, a33
v_accvgpr_read_b32 v138, a34
v_accvgpr_read_b32 v139, a35
v_accvgpr_read_b32 v140, a36
v_accvgpr_read_b32 v141, a37
v_accvgpr_read_b32 v142, a38
v_accvgpr_read_b32 v143, a39
v_pk_mul_f32 v[136:137], v[136:137], v[212:213] op_sel_hi:[1,0]
v_pk_mul_f32 v[138:139], v[138:139], v[212:213] op_sel_hi:[1,0]
v_pk_mul_f32 v[140:141], v[140:141], v[212:213] op_sel_hi:[1,0]
v_pk_mul_f32 v[142:143], v[142:143], v[212:213] op_sel_hi:[1,0]
v_cvt_pk_bf16_f32 v164, v136, v137
v_cvt_pk_bf16_f32 v165, v138, v139
v_cvt_pk_bf16_f32 v166, v140, v141
v_cvt_pk_bf16_f32 v167, v142, v143
buffer_store_dwordx4 v[164:167], v5, s[4:7], s83 offen offset:128 sc1
v_accvgpr_read_b32 v128, a64
v_accvgpr_read_b32 v129, a65
v_accvgpr_read_b32 v130, a66
v_accvgpr_read_b32 v131, a67
v_accvgpr_read_b32 v132, a68
v_accvgpr_read_b32 v133, a69
v_accvgpr_read_b32 v134, a70
v_accvgpr_read_b32 v135, a71
v_pk_mul_f32 v[128:129], v[128:129], v[216:217] op_sel_hi:[1,0]
v_pk_mul_f32 v[130:131], v[130:131], v[216:217] op_sel_hi:[1,0]
v_pk_mul_f32 v[132:133], v[132:133], v[216:217] op_sel_hi:[1,0]
v_pk_mul_f32 v[134:135], v[134:135], v[216:217] op_sel_hi:[1,0]
v_cvt_pk_bf16_f32 v168, v128, v129
v_cvt_pk_bf16_f32 v169, v130, v131
v_cvt_pk_bf16_f32 v170, v132, v133
v_cvt_pk_bf16_f32 v171, v134, v135
buffer_store_dwordx4 v[168:171], v5, s[4:7], s83 offen offset:256 sc1
v_accvgpr_read_b32 v136, a96
v_accvgpr_read_b32 v137, a97
v_accvgpr_read_b32 v138, a98
v_accvgpr_read_b32 v139, a99
v_accvgpr_read_b32 v140, a100
v_accvgpr_read_b32 v141, a101
v_accvgpr_read_b32 v142, a102
v_accvgpr_read_b32 v143, a103
v_pk_mul_f32 v[136:137], v[136:137], v[220:221] op_sel_hi:[1,0]
v_pk_mul_f32 v[138:139], v[138:139], v[220:221] op_sel_hi:[1,0]
v_pk_mul_f32 v[140:141], v[140:141], v[220:221] op_sel_hi:[1,0]
v_pk_mul_f32 v[142:143], v[142:143], v[220:221] op_sel_hi:[1,0]
v_cvt_pk_bf16_f32 v172, v136, v137
v_cvt_pk_bf16_f32 v173, v138, v139
v_cvt_pk_bf16_f32 v174, v140, v141
v_cvt_pk_bf16_f32 v175, v142, v143
buffer_store_dwordx4 v[172:175], v5, s[4:7], s83 offen offset:384 sc1
s_add_u32 s83, s83, 4096
v_accvgpr_read_b32 v128, a8
v_accvgpr_read_b32 v129, a9
v_accvgpr_read_b32 v130, a10
v_accvgpr_read_b32 v131, a11
v_accvgpr_read_b32 v132, a12
v_accvgpr_read_b32 v133, a13
v_accvgpr_read_b32 v134, a14
v_accvgpr_read_b32 v135, a15
v_pk_mul_f32 v[128:129], v[128:129], v[208:209] op_sel_hi:[1,0]
v_pk_mul_f32 v[130:131], v[130:131], v[208:209] op_sel_hi:[1,0]
v_pk_mul_f32 v[132:133], v[132:133], v[208:209] op_sel_hi:[1,0]
v_pk_mul_f32 v[134:135], v[134:135], v[208:209] op_sel_hi:[1,0]
v_cvt_pk_bf16_f32 v160, v128, v129
v_cvt_pk_bf16_f32 v161, v130, v131
v_cvt_pk_bf16_f32 v162, v132, v133
v_cvt_pk_bf16_f32 v163, v134, v135
buffer_store_dwordx4 v[160:163], v5, s[4:7], s83 offen offset:0 sc1
v_accvgpr_read_b32 v136, a40
v_accvgpr_read_b32 v137, a41
v_accvgpr_read_b32 v138, a42
v_accvgpr_read_b32 v139, a43
v_accvgpr_read_b32 v140, a44
v_accvgpr_read_b32 v141, a45
v_accvgpr_read_b32 v142, a46
v_accvgpr_read_b32 v143, a47
v_pk_mul_f32 v[136:137], v[136:137], v[212:213] op_sel_hi:[1,0]
v_pk_mul_f32 v[138:139], v[138:139], v[212:213] op_sel_hi:[1,0]
v_pk_mul_f32 v[140:141], v[140:141], v[212:213] op_sel_hi:[1,0]
v_pk_mul_f32 v[142:143], v[142:143], v[212:213] op_sel_hi:[1,0]
v_cvt_pk_bf16_f32 v164, v136, v137
v_cvt_pk_bf16_f32 v165, v138, v139
v_cvt_pk_bf16_f32 v166, v140, v141
v_cvt_pk_bf16_f32 v167, v142, v143
buffer_store_dwordx4 v[164:167], v5, s[4:7], s83 offen offset:128 sc1
v_accvgpr_read_b32 v128, a72
v_accvgpr_read_b32 v129, a73
v_accvgpr_read_b32 v130, a74
v_accvgpr_read_b32 v131, a75
v_accvgpr_read_b32 v132, a76
v_accvgpr_read_b32 v133, a77
v_accvgpr_read_b32 v134, a78
v_accvgpr_read_b32 v135, a79
v_pk_mul_f32 v[128:129], v[128:129], v[216:217] op_sel_hi:[1,0]
v_pk_mul_f32 v[130:131], v[130:131], v[216:217] op_sel_hi:[1,0]
v_pk_mul_f32 v[132:133], v[132:133], v[216:217] op_sel_hi:[1,0]
v_pk_mul_f32 v[134:135], v[134:135], v[216:217] op_sel_hi:[1,0]
v_cvt_pk_bf16_f32 v168, v128, v129
v_cvt_pk_bf16_f32 v169, v130, v131
v_cvt_pk_bf16_f32 v170, v132, v133
v_cvt_pk_bf16_f32 v171, v134, v135
buffer_store_dwordx4 v[168:171], v5, s[4:7], s83 offen offset:256 sc1
v_accvgpr_read_b32 v136, a104
v_accvgpr_read_b32 v137, a105
v_accvgpr_read_b32 v138, a106
v_accvgpr_read_b32 v139, a107
v_accvgpr_read_b32 v140, a108
v_accvgpr_read_b32 v141, a109
v_accvgpr_read_b32 v142, a110
v_accvgpr_read_b32 v143, a111
v_pk_mul_f32 v[136:137], v[136:137], v[220:221] op_sel_hi:[1,0]
v_pk_mul_f32 v[138:139], v[138:139], v[220:221] op_sel_hi:[1,0]
v_pk_mul_f32 v[140:141], v[140:141], v[220:221] op_sel_hi:[1,0]
v_pk_mul_f32 v[142:143], v[142:143], v[220:221] op_sel_hi:[1,0]
v_cvt_pk_bf16_f32 v172, v136, v137
v_cvt_pk_bf16_f32 v173, v138, v139
v_cvt_pk_bf16_f32 v174, v140, v141
v_cvt_pk_bf16_f32 v175, v142, v143
buffer_store_dwordx4 v[172:175], v5, s[4:7], s83 offen offset:384 sc1
s_add_u32 s83, s83, 4096
v_accvgpr_read_b32 v128, a16
v_accvgpr_read_b32 v129, a17
v_accvgpr_read_b32 v130, a18
v_accvgpr_read_b32 v131, a19
v_accvgpr_read_b32 v132, a20
v_accvgpr_read_b32 v133, a21
v_accvgpr_read_b32 v134, a22
v_accvgpr_read_b32 v135, a23
v_pk_mul_f32 v[128:129], v[128:129], v[208:209] op_sel_hi:[1,0]
v_pk_mul_f32 v[130:131], v[130:131], v[208:209] op_sel_hi:[1,0]
v_pk_mul_f32 v[132:133], v[132:133], v[208:209] op_sel_hi:[1,0]
v_pk_mul_f32 v[134:135], v[134:135], v[208:209] op_sel_hi:[1,0]
v_cvt_pk_bf16_f32 v160, v128, v129
v_cvt_pk_bf16_f32 v161, v130, v131
v_cvt_pk_bf16_f32 v162, v132, v133
v_cvt_pk_bf16_f32 v163, v134, v135
buffer_store_dwordx4 v[160:163], v5, s[4:7], s83 offen offset:0 sc1
v_accvgpr_read_b32 v136, a48
v_accvgpr_read_b32 v137, a49
v_accvgpr_read_b32 v138, a50
v_accvgpr_read_b32 v139, a51
v_accvgpr_read_b32 v140, a52
v_accvgpr_read_b32 v141, a53
v_accvgpr_read_b32 v142, a54
v_accvgpr_read_b32 v143, a55
v_pk_mul_f32 v[136:137], v[136:137], v[212:213] op_sel_hi:[1,0]
v_pk_mul_f32 v[138:139], v[138:139], v[212:213] op_sel_hi:[1,0]
v_pk_mul_f32 v[140:141], v[140:141], v[212:213] op_sel_hi:[1,0]
v_pk_mul_f32 v[142:143], v[142:143], v[212:213] op_sel_hi:[1,0]
v_cvt_pk_bf16_f32 v164, v136, v137
v_cvt_pk_bf16_f32 v165, v138, v139
v_cvt_pk_bf16_f32 v166, v140, v141
v_cvt_pk_bf16_f32 v167, v142, v143
buffer_store_dwordx4 v[164:167], v5, s[4:7], s83 offen offset:128 sc1
v_accvgpr_read_b32 v128, a80
v_accvgpr_read_b32 v129, a81
v_accvgpr_read_b32 v130, a82
v_accvgpr_read_b32 v131, a83
v_accvgpr_read_b32 v132, a84
v_accvgpr_read_b32 v133, a85
v_accvgpr_read_b32 v134, a86
v_accvgpr_read_b32 v135, a87
v_pk_mul_f32 v[128:129], v[128:129], v[216:217] op_sel_hi:[1,0]
v_pk_mul_f32 v[130:131], v[130:131], v[216:217] op_sel_hi:[1,0]
v_pk_mul_f32 v[132:133], v[132:133], v[216:217] op_sel_hi:[1,0]
v_pk_mul_f32 v[134:135], v[134:135], v[216:217] op_sel_hi:[1,0]
v_cvt_pk_bf16_f32 v168, v128, v129
v_cvt_pk_bf16_f32 v169, v130, v131
v_cvt_pk_bf16_f32 v170, v132, v133
v_cvt_pk_bf16_f32 v171, v134, v135
buffer_store_dwordx4 v[168:171], v5, s[4:7], s83 offen offset:256 sc1
v_accvgpr_read_b32 v136, a112
v_accvgpr_read_b32 v137, a113
v_accvgpr_read_b32 v138, a114
v_accvgpr_read_b32 v139, a115
v_accvgpr_read_b32 v140, a116
v_accvgpr_read_b32 v141, a117
v_accvgpr_read_b32 v142, a118
v_accvgpr_read_b32 v143, a119
v_pk_mul_f32 v[136:137], v[136:137], v[220:221] op_sel_hi:[1,0]
v_pk_mul_f32 v[138:139], v[138:139], v[220:221] op_sel_hi:[1,0]
v_pk_mul_f32 v[140:141], v[140:141], v[220:221] op_sel_hi:[1,0]
v_pk_mul_f32 v[142:143], v[142:143], v[220:221] op_sel_hi:[1,0]
v_cvt_pk_bf16_f32 v172, v136, v137
v_cvt_pk_bf16_f32 v173, v138, v139
v_cvt_pk_bf16_f32 v174, v140, v141
v_cvt_pk_bf16_f32 v175, v142, v143
buffer_store_dwordx4 v[172:175], v5, s[4:7], s83 offen offset:384 sc1
s_add_u32 s83, s83, 4096
v_accvgpr_read_b32 v128, a24
v_accvgpr_read_b32 v129, a25
v_accvgpr_read_b32 v130, a26
v_accvgpr_read_b32 v131, a27
v_accvgpr_read_b32 v132, a28
v_accvgpr_read_b32 v133, a29
v_accvgpr_read_b32 v134, a30
v_accvgpr_read_b32 v135, a31
v_pk_mul_f32 v[128:129], v[128:129], v[208:209] op_sel_hi:[1,0]
v_pk_mul_f32 v[130:131], v[130:131], v[208:209] op_sel_hi:[1,0]
v_pk_mul_f32 v[132:133], v[132:133], v[208:209] op_sel_hi:[1,0]
v_pk_mul_f32 v[134:135], v[134:135], v[208:209] op_sel_hi:[1,0]
v_cvt_pk_bf16_f32 v160, v128, v129
v_cvt_pk_bf16_f32 v161, v130, v131
v_cvt_pk_bf16_f32 v162, v132, v133
v_cvt_pk_bf16_f32 v163, v134, v135
v_accvgpr_write_b32 a64, v160
v_accvgpr_write_b32 a65, v161
v_accvgpr_write_b32 a66, v162
v_accvgpr_write_b32 a67, v163
v_accvgpr_read_b32 v136, a56
v_accvgpr_read_b32 v137, a57
v_accvgpr_read_b32 v138, a58
v_accvgpr_read_b32 v139, a59
v_accvgpr_read_b32 v140, a60
v_accvgpr_read_b32 v141, a61
v_accvgpr_read_b32 v142, a62
v_accvgpr_read_b32 v143, a63
v_pk_mul_f32 v[136:137], v[136:137], v[212:213] op_sel_hi:[1,0]
v_pk_mul_f32 v[138:139], v[138:139], v[212:213] op_sel_hi:[1,0]
v_pk_mul_f32 v[140:141], v[140:141], v[212:213] op_sel_hi:[1,0]
v_pk_mul_f32 v[142:143], v[142:143], v[212:213] op_sel_hi:[1,0]
v_cvt_pk_bf16_f32 v164, v136, v137
v_cvt_pk_bf16_f32 v165, v138, v139
v_cvt_pk_bf16_f32 v166, v140, v141
v_cvt_pk_bf16_f32 v167, v142, v143
v_accvgpr_write_b32 a68, v164
v_accvgpr_write_b32 a69, v165
v_accvgpr_write_b32 a70, v166
v_accvgpr_write_b32 a71, v167
v_accvgpr_read_b32 v128, a88
v_accvgpr_read_b32 v129, a89
v_accvgpr_read_b32 v130, a90
v_accvgpr_read_b32 v131, a91
v_accvgpr_read_b32 v132, a92
v_accvgpr_read_b32 v133, a93
v_accvgpr_read_b32 v134, a94
v_accvgpr_read_b32 v135, a95
v_pk_mul_f32 v[128:129], v[128:129], v[216:217] op_sel_hi:[1,0]
v_pk_mul_f32 v[130:131], v[130:131], v[216:217] op_sel_hi:[1,0]
v_pk_mul_f32 v[132:133], v[132:133], v[216:217] op_sel_hi:[1,0]
v_pk_mul_f32 v[134:135], v[134:135], v[216:217] op_sel_hi:[1,0]
v_cvt_pk_bf16_f32 v168, v128, v129
v_cvt_pk_bf16_f32 v169, v130, v131
v_cvt_pk_bf16_f32 v170, v132, v133
v_cvt_pk_bf16_f32 v171, v134, v135
v_accvgpr_write_b32 a72, v168
v_accvgpr_write_b32 a73, v169
v_accvgpr_write_b32 a74, v170
v_accvgpr_write_b32 a75, v171
v_accvgpr_read_b32 v136, a120
v_accvgpr_read_b32 v137, a121
v_accvgpr_read_b32 v138, a122
v_accvgpr_read_b32 v139, a123
v_accvgpr_read_b32 v140, a124
v_accvgpr_read_b32 v141, a125
v_accvgpr_read_b32 v142, a126
v_accvgpr_read_b32 v143, a127
v_pk_mul_f32 v[136:137], v[136:137], v[220:221] op_sel_hi:[1,0]
v_pk_mul_f32 v[138:139], v[138:139], v[220:221] op_sel_hi:[1,0]
v_pk_mul_f32 v[140:141], v[140:141], v[220:221] op_sel_hi:[1,0]
v_pk_mul_f32 v[142:143], v[142:143], v[220:221] op_sel_hi:[1,0]
v_cvt_pk_bf16_f32 v172, v136, v137
v_cvt_pk_bf16_f32 v173, v138, v139
v_cvt_pk_bf16_f32 v174, v140, v141
v_cvt_pk_bf16_f32 v175, v142, v143
v_accvgpr_write_b32 a76, v172
v_accvgpr_write_b32 a77, v173
v_accvgpr_write_b32 a78, v174
v_accvgpr_write_b32 a79, v175
s_waitcnt vmcnt(28) lgkmcnt(4)
MZ 128,192,128
TR 208,26,0
MA 128,196,144
s_add_u32 m0, s48, 98304
TR 210,26,4096
MZ 160,196,148
DM 12,28,53,0
MA 160,192,132
v_xor_b32 v32, 65536, v1
MZ 192,192,136
TR 212,26,8192
MA 192,196,152
TR 214,26,12288
MZ 224,196,156
DM 13,28,53,1024
MA 224,192,140
v_xor_b32 v33, 65568, v1
WL 4
MZ 228,200,140
TR 216,27,0
MA 228,204,156
TR 218,27,4096
MZ 196,204,152
DM 14,28,53,2048
MA 196,200,136
v_xor_b32 v34, 65600, v1
MZ 164,200,132
TR 220,27,8192
MA 164,204,148
TR 222,27,12288
MZ 132,204,144
MA 132,200,128
v_xor_b32 v35, 65632, v1
WL 4
MZ 136,208,128
TR 192,28,0
MA 136,212,144
TR 194,28,4096
MZ 168,212,148
DM 15,28,53,3072
MA 168,208,132
s_add_u32 s53, s53, 458752
v_xor_b32 v36, 65664, v1
MZ 200,208,136
TR 196,28,8192
MA 200,212,152
TR 198,28,12288
MZ 232,212,156
XL 0,5,4,51,0
MA 232,208,140
v_xor_b32 v37, 65696, v1
WL 4
MZ 236,216,140
TR 200,29,0
MA 236,220,156
TR 202,29,4096
MZ 204,220,152
XL 4,5,4,51,128
MA 204,216,136
v_xor_b32 v38, 65728, v1
MZ 172,216,132
TR 204,29,8192
MA 172,220,148
TR 206,29,12288
MZ 140,220,144
MA 140,216,128
v_xor_b32 v39, 65760, v1
WL 4
MZ 144,192,128
TR 208,30,0
MA 144,196,144
TR 210,30,4096
MZ 176,196,148
XL 8,5,4,51,256
MA 176,192,132
s_lshl_b32 s50, s58, 2
MZ 208,192,136
TR 212,30,8192
MA 208,196,152
TR 214,30,12288
MZ 240,196,156
XL 12,5,4,51,384
MA 240,192,140
s_add_u32 s51, s51, 4096
s_add_u32 s50, s50, s44
WL 4
MZ 244,200,140
TR 216,31,0
MA 244,204,156
TR 218,31,4096
MZ 212,204,152
XL 16,5,4,51,0
MA 212,200,136
s_mul_i32 s50, s50, 458752
MZ 180,200,132
TR 220,31,8192
MA 180,204,148
TR 222,31,12288
MZ 148,204,144
MA 148,200,128
s_add_u32 s50, s50, 41943040
WL 4
MZ 152,208,128
MA 152,212,144
MZ 184,212,148
XL 20,5,4,51,128
MA 184,208,132
s_mul_i32 s52, s44, 32768
WL 0
s_barrier
MZ 216,208,136
TR 192,24,32768
MA 216,212,152
TR 194,24,36864
MZ 248,212,156
XL 24,5,4,51,256
TR 196,24,40960
MA 248,208,140
TR 198,24,45056
s_mul_i32 s62, s96, 256
MZ 252,216,140
TR 200,25,32768
MA 252,220,156
TR 202,25,36864
MZ 220,220,152
XL 28,5,4,51,384
MA 220,216,136
s_add_u32 s51, s51, 4096
s_add_u32 s52, s52, s62
MZ 188,216,132
TR 204,25,40960
MA 188,220,148
TR 206,25,45056
MZ 156,220,144
MA 156,216,128
s_mul_i32 s62, s97, 98304
s_waitcnt vmcnt(32) lgkmcnt(4)
MA 128,192,160
TR 208,26,32768
MA 128,196,176
s_add_u32 m0, s48, 0
TR 210,26,36864
MA 160,196,180
DM 12,28,53,0
MA 160,192,164
s_add_u32 s50, s50, s62
MA 192,192,168
TR 212,26,40960
MA 192,196,184
TR 214,26,45056
MA 224,196,188
DM 13,28,53,1024
MA 224,192,172
s_mul_i32 s62, s97, 1572864
WL 4
MA 228,200,172
TR 216,27,32768
MA 228,204,188
TR 218,27,36864
MA 196,204,184
DM 14,28,53,2048
MA 196,200,168
s_add_u32 s52, s52, s62
MA 164,200,164
TR 220,27,40960
MA 164,204,180
TR 222,27,45056
MA 132,204,176
buffer_store_dwordx4 a[64:67], v5, s[4:7], s83 offen offset:0 sc1
MA 132,200,160
s_mov_b32 s62, 2048
WL 4
MA 136,208,160
TR 192,28,32768
MA 136,212,176
TR 194,28,36864
MA 168,212,180
DM 15,28,53,3072
MA 168,208,164
s_add_u32 s53, s53, 458752
s_lshl_b32 s88, s97, 7
MA 200,208,168
TR 196,28,40960
MA 200,212,184
TR 198,28,45056
MA 232,212,188
XL 128,5,4,51,0
MA 232,208,172
v_xor_b32 v8, s88, v20
WL 4
MA 236,216,172
TR 200,29,32768
MA 236,220,188
TR 202,29,36864
MA 204,220,184
XL 132,5,4,51,128
MA 204,216,168
v_mad_u32_u24 v8, v19, s62, v8
MA 172,216,164
TR 204,29,40960
MA 172,220,180
TR 206,29,45056
MA 140,220,176
buffer_store_dwordx4 a[68:71], v5, s[4:7], s83 offen offset:128 sc1
MA 140,216,160
v_xor_b32 v9, 128, v8
WL 4
MA 144,192,160
TR 208,30,32768
MA 144,196,176
TR 210,30,36864
MA 176,196,180
XL 136,5,4,51,256
MA 176,192,164
v_add_u32 v10, 14336, v8
MA 208,192,168
TR 212,30,40960
MA 208,196,184
TR 214,30,45056
MA 240,196,188
XL 140,5,4,51,384
MA 240,192,172
s_add_u32 s51, s51, 4096
v_add_u32 v11, 21504, v9
WL 4
MA 244,200,172
TR 216,31,32768
MA 244,204,188
TR 218,31,36864
MA 212,204,184
XL 144,5,4,51,0
MA 212,200,168
v_add_u32 v9, 7168, v9
MA 180,200,164
TR 220,31,40960
MA 180,204,180
TR 222,31,45056
MA 148,204,176
buffer_store_dwordx4 a[72:75], v5, s[4:7], s83 offen offset:256 sc1
MA 148,200,160
WL 4
MA 152,208,160
MA 152,212,176
MA 184,212,180
XL 148,5,4,51,128
MA 184,208,164
WL 0
s_barrier
MA 216,208,168
TR 192,32,0
MA 216,212,184
TR 194,32,4096
MA 248,212,188
XL 152,5,4,51,256
TR 196,32,8192
MA 248,208,172
TR 198,32,12288
MA 252,216,172
TR 200,33,0
MA 252,220,188
TR 202,33,4096
MA 220,220,184
XL 156,5,4,51,384
MA 220,216,168
s_add_u32 s51, s51, 4096
MA 188,216,164
TR 204,33,8192
MA 188,220,180
TR 206,33,12288
MA 156,220,176
MA 156,216,160
s_waitcnt vmcnt(39) lgkmcnt(4)
MA 128,192,224
TR 208,34,0
MA 128,196,240
s_add_u32 m0, s48, 32768
TR 210,34,4096
MA 160,196,244
DM 12,28,53,0
MA 160,192,228
MA 192,192,232
TR 212,34,8192
MA 192,196,248
TR 214,34,12288
MA 224,196,252
DM 13,28,53,1024
MA 224,192,236
WL 4
MA 228,200,236
TR 216,35,0
MA 228,204,252
TR 218,35,4096
MA 196,204,248
DM 14,28,53,2048
MA 196,200,232
MA 164,200,228
TR 220,35,8192
MA 164,204,244
TR 222,35,12288
MA 132,204,240
buffer_store_dwordx4 a[76:79], v5, s[4:7], s83 offen offset:384 sc1
MA 132,200,224
s_add_u32 s83, s83, 4096
WL 4
MA 136,208,224
TR 192,36,0
MA 136,212,240
TR 194,36,4096
MA 168,212,244
DM 15,28,53,3072
MA 168,208,228
s_add_u32 s53, s53, 458752
MA 200,208,232
TR 196,36,8192
MA 200,212,248
TR 198,36,12288
MA 232,212,252
XL 160,5,4,51,0
MA 232,208,236
WL 4
MA 236,216,236
TR 200,37,0
MA 236,220,252
TR 202,37,4096
MA 204,220,248
XL 164,5,4,51,128
MA 204,216,232
MA 172,216,228
TR 204,37,8192
MA 172,220,244
TR 206,37,12288
MA 140,220,240
MA 140,216,224
WL 4
MA 144,192,224
TR 208,38,0
MA 144,196,240
TR 210,38,4096
MA 176,196,244
XL 168,5,4,51,256
MA 176,192,228
MA 208,192,232
TR 212,38,8192
MA 208,196,248
TR 214,38,12288
MA 240,196,252
XL 172,5,4,51,384
MA 240,192,236
s_add_u32 s51, s51, 4096
WL 4
MA 244,200,236
TR 216,39,0
MA 244,204,252
TR 218,39,4096
MA 212,204,248
XL 176,5,4,51,0
MA 212,200,232
MA 180,200,228
TR 220,39,8192
MA 180,204,244
TR 222,39,12288
MA 148,204,240
MA 148,200,224
WL 4
MA 152,208,224
MA 152,212,240
MA 184,212,244
XL 180,5,4,51,128
MA 184,208,228
s_waitcnt vmcnt(34) lgkmcnt(0)
s_barrier
MA 216,208,232
TR 192,32,32768
MA 216,212,248
TR 194,32,36864
MA 248,212,252
XL 184,5,4,51,256
TR 196,32,40960
MA 248,208,236
TR 198,32,45056
MA 252,216,236
TR 200,33,32768
MA 252,220,252
TR 202,33,36864
MA 220,220,248
XL 188,5,4,51,384
MA 220,216,232
s_add_u32 s51, s51, 4096
MA 188,216,228
TR 204,33,40960
MA 188,220,244
TR 206,33,45056
MA 156,220,240
MA 156,216,224
s_waitcnt vmcnt(28) lgkmcnt(4)
MA 128,192,0
TR 208,34,32768
MA 128,196,16
s_add_u32 m0, s48, 65536
TR 210,34,36864
MA 160,196,20
DM 12,28,53,0
MA 160,192,4
MA 192,192,8
TR 212,34,40960
MA 192,196,24
TR 214,34,45056
MA 224,196,28
DM 13,28,53,1024
MA 224,192,12
WL 4
MA 228,200,12
TR 216,35,32768
MA 228,204,28
TR 218,35,36864
MA 196,204,24
DM 14,28,53,2048
MA 196,200,8
MA 164,200,4
TR 220,35,40960
MA 164,204,20
TR 222,35,45056
MA 132,204,16
MA 132,200,0
buffer_load_dword v61, v60, s[84:87], s77 offen
WL 4
MA 136,208,0
TR 192,36,32768
MA 136,212,16
TR 194,36,36864
MA 168,212,20
DM 15,28,53,3072
MA 168,208,4
s_add_u32 s53, s53, 458752
MA 200,208,8
TR 196,36,40960
MA 200,212,24
TR 198,36,45056
MA 232,212,28
XL 224,5,4,51,0
MA 232,208,12
WL 4
MA 236,216,12
TR 200,37,32768
MA 236,220,28
TR 202,37,36864
MA 204,220,24
XL 228,5,4,51,128
MA 204,216,8
MA 172,216,4
TR 204,37,40960
MA 172,220,20
TR 206,37,45056
MA 140,220,16
MA 140,216,0
WL 4
MA 144,192,0
TR 208,38,32768
MA 144,196,16
TR 210,38,36864
MA 176,196,20
XL 232,5,4,51,256
MA 176,192,4
MA 208,192,8
TR 212,38,40960
MA 208,196,24
TR 214,38,45056
MA 240,196,28
XL 236,5,4,51,384
MA 240,192,12
s_add_u32 s51, s51, 4096
WL 4
MA 244,200,12
TR 216,39,32768
MA 244,204,28
TR 218,39,36864
MA 212,204,24
XL 240,5,4,51,0
MA 212,200,8
MA 180,200,4
TR 220,39,40960
MA 180,204,20
TR 222,39,45056
MA 148,204,16
MA 148,200,0
WL 4
MA 152,208,0
MA 152,212,16
MA 184,212,20
XL 244,5,4,51,128
MA 184,208,4
s_waitcnt vmcnt(20) lgkmcnt(0)
s_barrier
buffer_atomic_add v21, v18, s[4:7], s80 offen offset:1024
MA 216,208,8
TR 192,24,0
MA 216,212,24
TR 194,24,4096
MA 248,212,28
XL 248,5,4,51,256
TR 196,24,8192
MA 248,208,12
TR 198,24,12288
MA 252,216,12
TR 200,25,0
MA 252,220,28
TR 202,25,4096
MA 220,220,24
XL 252,5,4,51,384
MA 220,216,8
s_add_u32 s51, s51, 4096
MA 188,216,4
TR 204,25,8192
MA 188,220,20
TR 206,25,12288
MA 156,220,16
MA 156,216,0
s_mov_b32 s47, 1
t2_L33:
s_waitcnt vmcnt(25) lgkmcnt(4)
MA 128,192,128
TR 208,26,0
MA 128,196,144
s_add_u32 m0, s48, 98304
TR 210,26,4096
MA 160,196,148
DM 12,28,53,0
MA 160,192,132
MA 192,192,136
TR 212,26,8192
MA 192,196,152
TR 214,26,12288
MA 224,196,156
DM 13,28,53,1024
MA 224,192,140
WL 4
MA 228,200,140
TR 216,27,0
MA 228,204,156
TR 218,27,4096
MA 196,204,152
DM 14,28,53,2048
MA 196,200,136
MA 164,200,132
TR 220,27,8192
MA 164,204,148
TR 222,27,12288
MA 132,204,144
MA 132,200,128
WL 4
MA 136,208,128
TR 192,28,0
MA 136,212,144
TR 194,28,4096
MA 168,212,148
DM 15,28,53,3072
MA 168,208,132
s_add_u32 s53, s53, 458752
MA 200,208,136
TR 196,28,8192
MA 200,212,152
TR 198,28,12288
MA 232,212,156
XL 0,5,4,51,0
MA 232,208,140
WL 4
MA 236,216,140
TR 200,29,0
MA 236,220,156
TR 202,29,4096
MA 204,220,152
XL 4,5,4,51,128
MA 204,216,136
MA 172,216,132
TR 204,29,8192
MA 172,220,148
TR 206,29,12288
MA 140,220,144
MA 140,216,128
WL 4
MA 144,192,128
TR 208,30,0
MA 144,196,144
TR 210,30,4096
MA 176,196,148
XL 8,5,4,51,256
MA 176,192,132
MA 208,192,136
TR 212,30,8192
MA 208,196,152
TR 214,30,12288
MA 240,196,156
XL 12,5,4,51,384
MA 240,192,140
s_add_u32 s51, s51, 4096
WL 4
MA 244,200,140
TR 216,31,0
MA 244,204,156
TR 218,31,4096
MA 212,204,152
XL 16,5,4,51,0
MA 212,200,136
MA 180,200,132
TR 220,31,8192
MA 180,204,148
TR 222,31,12288
MA 148,204,144
MA 148,200,128
WL 4
MA 152,208,128
MA 152,212,144
MA 184,212,148
XL 20,5,4,51,128
MA 184,208,132
s_waitcnt vmcnt(31) lgkmcnt(0)
s_barrier
MA 216,208,136
TR 192,24,32768
MA 216,212,152
TR 194,24,36864
MA 248,212,156
XL 24,5,4,51,256
TR 196,24,40960
MA 248,208,140
TR 198,24,45056
MA 252,216,140
TR 200,25,32768
MA 252,220,156
TR 202,25,36864
MA 220,220,152
XL 28,5,4,51,384
MA 220,216,136
s_add_u32 s51, s51, 4096
MA 188,216,132
TR 204,25,40960
MA 188,220,148
TR 206,25,45056
MA 156,220,144
MA 156,216,128
s_waitcnt vmcnt(25) lgkmcnt(4)
MA 128,192,160
TR 208,26,32768
MA 128,196,176
s_add_u32 m0, s48, 0
TR 210,26,36864
MA 160,196,180
DM 12,28,53,0
MA 160,192,164
MA 192,192,168
TR 212,26,40960
MA 192,196,184
TR 214,26,45056
MA 224,196,188
DM 13,28,53,1024
MA 224,192,172
WL 4
MA 228,200,172
TR 216,27,32768
MA 228,204,188
TR 218,27,36864
MA 196,204,184
DM 14,28,53,2048
MA 196,200,168
MA 164,200,164
TR 220,27,40960
MA 164,204,180
TR 222,27,45056
MA 132,204,176
MA 132,200,160
WL 4
MA 136,208,160
TR 192,28,32768
MA 136,212,176
TR 194,28,36864
MA 168,212,180
DM 15,28,53,3072
MA 168,208,164
s_add_u32 s53, s53, 458752
MA 200,208,168
TR 196,28,40960
MA 200,212,184
TR 198,28,45056
MA 232,212,188
XL 128,5,4,51,0
MA 232,208,172
WL 4
MA 236,216,172
TR 200,29,32768
MA 236,220,188
TR 202,29,36864
MA 204,220,184
XL 132,5,4,51,128
MA 204,216,168
MA 172,216,164
TR 204,29,40960
MA 172,220,180
TR 206,29,45056
MA 140,220,176
MA 140,216,160
WL 4
MA 144,192,160
TR 208,30,32768
MA 144,196,176
TR 210,30,36864
MA 176,196,180
XL 136,5,4,51,256
MA 176,192,164
MA 208,192,168
TR 212,30,40960
MA 208,196,184
TR 214,30,45056
MA 240,196,188
XL 140,5,4,51,384
MA 240,192,172
s_add_u32 s51, s51, 4096
WL 4
MA 244,200,172
TR 216,31,32768
MA 244,204,188
TR 218,31,36864
MA 212,204,184
XL 144,5,4,51,0
MA 212,200,168
MA 180,200,164
TR 220,31,40960
MA 180,204,180
TR 222,31,45056
MA 148,204,176
MA 148,200,160
WL 4
MA 152,208,160
MA 152,212,176
MA 184,212,180
XL 148,5,4,51,128
MA 184,208,164
s_waitcnt vmcnt(30) lgkmcnt(0)
s_barrier
MA 216,208,168
TR 192,32,0
MA 216,212,184
TR 194,32,4096
MA 248,212,188
XL 152,5,4,51,256
TR 196,32,8192
MA 248,208,172
TR 198,32,12288
MA 252,216,172
TR 200,33,0
MA 252,220,188
TR 202,33,4096
MA 220,220,184
XL 156,5,4,51,384
MA 220,216,168
s_add_u32 s51, s51, 4096
MA 188,216,164
TR 204,33,8192
MA 188,220,180
TR 206,33,12288
MA 156,220,176
MA 156,216,160
s_waitcnt vmcnt(24) lgkmcnt(4)
MA 128,192,224
TR 208,34,0
MA 128,196,240
s_add_u32 m0, s48, 32768
TR 210,34,4096
MA 160,196,244
DM 12,28,53,0
MA 160,192,228
MA 192,192,232
TR 212,34,8192
MA 192,196,248
TR 214,34,12288
MA 224,196,252
DM 13,28,53,1024
MA 224,192,236
WL 4
MA 228,200,236
TR 216,35,0
MA 228,204,252
TR 218,35,4096
MA 196,204,248
DM 14,28,53,2048
MA 196,200,232
MA 164,200,228
TR 220,35,8192
MA 164,204,244
TR 222,35,12288
MA 132,204,240
MA 132,200,224
WL 4
MA 136,208,224
TR 192,36,0
MA 136,212,240
TR 194,36,4096
MA 168,212,244
DM 15,28,53,3072
MA 168,208,228
s_add_u32 s53, s53, 458752
MA 200,208,232
TR 196,36,8192
MA 200,212,248
TR 198,36,12288
MA 232,212,252
XL 160,5,4,51,0
MA 232,208,236
WL 4
MA 236,216,236
TR 200,37,0
MA 236,220,252
TR 202,37,4096
MA 204,220,248
XL 164,5,4,51,128
MA 204,216,232
MA 172,216,228
TR 204,37,8192
MA 172,220,244
TR 206,37,12288
MA 140,220,240
MA 140,216,224
WL 4
MA 144,192,224
TR 208,38,0
MA 144,196,240
TR 210,38,4096
MA 176,196,244
XL 168,5,4,51,256
MA 176,192,228
MA 208,192,232
TR 212,38,8192
MA 208,196,248
TR 214,38,12288
MA 240,196,252
XL 172,5,4,51,384
MA 240,192,236
s_add_u32 s51, s51, 4096
WL 4
MA 244,200,236
TR 216,39,0
MA 244,204,252
TR 218,39,4096
MA 212,204,248
XL 176,5,4,51,0
MA 212,200,232
MA 180,200,228
TR 220,39,8192
MA 180,204,244
TR 222,39,12288
MA 148,204,240
MA 148,200,224
WL 4
MA 152,208,224
MA 152,212,240
MA 184,212,244
XL 180,5,4,51,128
MA 184,208,228
s_waitcnt vmcnt(30) lgkmcnt(0)
s_barrier
MA 216,208,232
TR 192,32,32768
MA 216,212,248
TR 194,32,36864
MA 248,212,252
XL 184,5,4,51,256
TR 196,32,40960
MA 248,208,236
TR 198,32,45056
MA 252,216,236
TR 200,33,32768
MA 252,220,252
TR 202,33,36864
MA 220,220,248
XL 188,5,4,51,384
MA 220,216,232
s_add_u32 s51, s51, 4096
MA 188,216,228
TR 204,33,40960
MA 188,220,244
TR 206,33,45056
MA 156,220,240
MA 156,216,224
s_waitcnt vmcnt(24) lgkmcnt(4)
MA 128,192,0
TR 208,34,32768
MA 128,196,16
s_add_u32 m0, s48, 65536
TR 210,34,36864
MA 160,196,20
DM 12,28,53,0
MA 160,192,4
MA 192,192,8
TR 212,34,40960
MA 192,196,24
TR 214,34,45056
MA 224,196,28
DM 13,28,53,1024
MA 224,192,12
WL 4
MA 228,200,12
TR 216,35,32768
MA 228,204,28
TR 218,35,36864
MA 196,204,24
DM 14,28,53,2048
MA 196,200,8
MA 164,200,4
TR 220,35,40960
MA 164,204,20
TR 222,35,45056
MA 132,204,16
MA 132,200,0
buffer_load_dword v61, v60, s[84:87], s77 offen
WL 4
MA 136,208,0
TR 192,36,32768
MA 136,212,16
TR 194,36,36864
MA 168,212,20
DM 15,28,53,3072
MA 168,208,4
s_add_u32 s53, s53, 458752
MA 200,208,8
TR 196,36,40960
MA 200,212,24
TR 198,36,45056
MA 232,212,28
XL 224,5,4,51,0
MA 232,208,12
WL 4
MA 236,216,12
TR 200,37,32768
MA 236,220,28
TR 202,37,36864
MA 204,220,24
XL 228,5,4,51,128
MA 204,216,8
MA 172,216,4
TR 204,37,40960
MA 172,220,20
TR 206,37,45056
MA 140,220,16
MA 140,216,0
WL 4
MA 144,192,0
TR 208,38,32768
MA 144,196,16
TR 210,38,36864
MA 176,196,20
XL 232,5,4,51,256
MA 176,192,4
MA 208,192,8
TR 212,38,40960
MA 208,196,24
TR 214,38,45056
MA 240,196,28
XL 236,5,4,51,384
MA 240,192,12
s_add_u32 s51, s51, 4096
WL 4
MA 244,200,12
TR 216,39,32768
MA 244,204,28
TR 218,39,36864
MA 212,204,24
XL 240,5,4,51,0
MA 212,200,8
MA 180,200,4
TR 220,39,40960
MA 180,204,20
TR 222,39,45056
MA 148,204,16
MA 148,200,0
WL 4
MA 152,208,0
MA 152,212,16
MA 184,212,20
XL 244,5,4,51,128
MA 184,208,4
s_waitcnt vmcnt(31) lgkmcnt(0)
s_barrier
MA 216,208,8
TR 192,24,0
MA 216,212,24
TR 194,24,4096
MA 248,212,28
XL 248,5,4,51,256
TR 196,24,8192
MA 248,208,12
TR 198,24,12288
MA 252,216,12
TR 200,25,0
MA 252,220,28
TR 202,25,4096
MA 220,220,24
XL 252,5,4,51,384
MA 220,216,8
s_add_u32 s51, s51, 4096
MA 188,216,4
TR 204,25,8192
MA 188,220,20
TR 206,25,12288
MA 156,220,16
MA 156,216,0
s_sub_u32 s47, s47, 1
s_cbranch_scc0 t2_L33
s_waitcnt vmcnt(25) lgkmcnt(4)
MA 128,192,128
TR 208,26,0
MA 128,196,144
s_add_u32 m0, s48, 98304
TR 210,26,4096
MA 160,196,148
DM 12,28,53,0
MA 160,192,132
MA 192,192,136
TR 212,26,8192
MA 192,196,152
TR 214,26,12288
MA 224,196,156
DM 13,28,53,1024
MA 224,192,140
WL 4
MA 228,200,140
TR 216,27,0
MA 228,204,156
TR 218,27,4096
MA 196,204,152
DM 14,28,53,2048
MA 196,200,136
MA 164,200,132
TR 220,27,8192
MA 164,204,148
TR 222,27,12288
MA 132,204,144
MA 132,200,128
WL 4
MA 136,208,128
TR 192,28,0
MA 136,212,144
TR 194,28,4096
MA 168,212,148
DM 15,28,53,3072
MA 168,208,132
s_add_u32 s53, s53, 458752
MA 200,208,136
TR 196,28,8192
MA 200,212,152
TR 198,28,12288
MA 232,212,156
XL 0,5,4,51,0
MA 232,208,140
WL 4
MA 236,216,140
TR 200,29,0
MA 236,220,156
TR 202,29,4096
MA 204,220,152
XL 4,5,4,51,128
MA 204,216,136
MA 172,216,132
TR 204,29,8192
MA 172,220,148
TR 206,29,12288
MA 140,220,144
MA 140,216,128
WL 4
MA 144,192,128
TR 208,30,0
MA 144,196,144
TR 210,30,4096
MA 176,196,148
XL 8,5,4,51,256
MA 176,192,132
MA 208,192,136
TR 212,30,8192
MA 208,196,152
TR 214,30,12288
MA 240,196,156
XL 12,5,4,51,384
MA 240,192,140
s_add_u32 s51, s51, 4096
WL 4
MA 244,200,140
TR 216,31,0
MA 244,204,156
TR 218,31,4096
MA 212,204,152
XL 16,5,4,51,0
MA 212,200,136
MA 180,200,132
TR 220,31,8192
MA 180,204,148
TR 222,31,12288
MA 148,204,144
MA 148,200,128
WL 4
MA 152,208,128
MA 152,212,144
MA 184,212,148
XL 20,5,4,51,128
MA 184,208,132
s_waitcnt vmcnt(31) lgkmcnt(0)
s_barrier
MA 216,208,136
TR 192,24,32768
MA 216,212,152
TR 194,24,36864
MA 248,212,156
XL 24,5,4,51,256
TR 196,24,40960
MA 248,208,140
TR 198,24,45056
MA 252,216,140
TR 200,25,32768
MA 252,220,156
TR 202,25,36864
MA 220,220,152
XL 28,5,4,51,384
MA 220,216,136
s_add_u32 s51, s51, 4096
MA 188,216,132
TR 204,25,40960
MA 188,220,148
TR 206,25,45056
MA 156,220,144
MA 156,216,128
s_waitcnt vmcnt(25) lgkmcnt(4)
MA 128,192,160
TR 208,26,32768
MA 128,196,176
s_add_u32 m0, s48, 0
TR 210,26,36864
MA 160,196,180
DM 8,32,52,0
MA 160,192,164
MA 192,192,168
TR 212,26,40960
MA 192,196,184
TR 214,26,45056
MA 224,196,188
MA 224,192,172
WL 4
MA 228,200,172
TR 216,27,32768
MA 228,204,188
TR 218,27,36864
MA 196,204,184
MA 196,200,168
MA 164,200,164
TR 220,27,40960
MA 164,204,180
TR 222,27,45056
MA 132,204,176
MA 132,200,160
WL 4
MA 136,208,160
TR 192,28,32768
MA 136,212,176
TR 194,28,36864
MA 168,212,180
DM 9,32,52,1024
MA 168,208,164
MA 200,208,168
TR 196,28,40960
MA 200,212,184
TR 198,28,45056
MA 232,212,188
MA 232,208,172
WL 4
MA 236,216,172
TR 200,29,32768
MA 236,220,188
TR 202,29,36864
MA 204,220,184
MA 204,216,168
MA 172,216,164
TR 204,29,40960
MA 172,220,180
TR 206,29,45056
MA 140,220,176
MA 140,216,160
WL 4
MA 144,192,160
TR 208,30,32768
MA 144,196,176
TR 210,30,36864
MA 176,196,180
DM 10,32,52,2048
MA 176,192,164
MA 208,192,168
TR 212,30,40960
MA 208,196,184
TR 214,30,45056
MA 240,196,188
MA 240,192,172
WL 4
MA 244,200,172
TR 216,31,32768
MA 244,204,188
TR 218,31,36864
MA 212,204,184
MA 212,200,168
MA 180,200,164
TR 220,31,40960
MA 180,204,180
TR 222,31,45056
MA 148,204,176
MA 148,200,160
WL 4
MA 152,208,160
MA 152,212,176
MA 184,212,180
DM 11,32,52,3072
MA 184,208,164
s_add_u32 s52, s52, 131072
s_waitcnt vmcnt(24) lgkmcnt(0)
s_barrier
MA 216,208,168
TR 192,32,0
MA 216,212,184
TR 194,32,4096
MA 248,212,188
TR 196,32,8192
MA 248,208,172
TR 198,32,12288
MA 252,216,172
TR 200,33,0
MA 252,220,188
TR 202,33,4096
MA 220,220,184
MA 220,216,168
MA 188,216,164
TR 204,33,8192
MA 188,220,180
TR 206,33,12288
MA 156,220,176
MA 156,216,160
s_waitcnt vmcnt(16) lgkmcnt(4)
MA 128,192,224
TR 208,34,0
MA 128,196,240
s_add_u32 m0, s48, 32768
TR 210,34,4096
MA 160,196,244
DM 8,32,52,0
MA 160,192,228
MA 192,192,232
TR 212,34,8192
MA 192,196,248
TR 214,34,12288
MA 224,196,252
MA 224,192,236
WL 4
MA 228,200,236
TR 216,35,0
MA 228,204,252
TR 218,35,4096
MA 196,204,248
MA 196,200,232
MA 164,200,228
TR 220,35,8192
MA 164,204,244
TR 222,35,12288
MA 132,204,240
MA 132,200,224
WL 4
MA 136,208,224
TR 192,36,0
MA 136,212,240
TR 194,36,4096
MA 168,212,244
DM 9,32,52,1024
MA 168,208,228
MA 200,208,232
TR 196,36,8192
MA 200,212,248
TR 198,36,12288
MA 232,212,252
MA 232,208,236
WL 4
MA 236,216,236
TR 200,37,0
MA 236,220,252
TR 202,37,4096
MA 204,220,248
MA 204,216,232
MA 172,216,228
TR 204,37,8192
MA 172,220,244
TR 206,37,12288
MA 140,220,240
MA 140,216,224
WL 4
MA 144,192,224
TR 208,38,0
MA 144,196,240
TR 210,38,4096
MA 176,196,244
DM 10,32,52,2048
MA 176,192,228
v_xor_b32 v24, 0, v1
MA 208,192,232
TR 212,38,8192
MA 208,196,248
TR 214,38,12288
MA 240,196,252
MA 240,192,236
v_xor_b32 v25, 32, v1
WL 4
MA 244,200,236
TR 216,39,0
MA 244,204,252
TR 218,39,4096
MA 212,204,248
MA 212,200,232
v_xor_b32 v26, 64, v1
MA 180,200,228
TR 220,39,8192
MA 180,204,244
TR 222,39,12288
MA 148,204,240
MA 148,200,224
v_xor_b32 v27, 96, v1
WL 4
MA 152,208,224
MA 152,212,240
MA 184,212,244
DM 11,32,52,3072
MA 184,208,228
s_add_u32 s52, s52, 131072
v_xor_b32 v28, 128, v1
s_waitcnt vmcnt(16) lgkmcnt(0)
s_barrier
MA 216,208,232
TR 192,32,32768
MA 216,212,248
TR 194,32,36864
MA 248,212,252
TR 196,32,40960
MA 248,208,236
TR 198,32,45056
v_xor_b32 v29, 160, v1
MA 252,216,236
TR 200,33,32768
MA 252,220,252
TR 202,33,36864
MA 220,220,248
MA 220,216,232
v_xor_b32 v30, 192, v1
MA 188,216,228
TR 204,33,40960
MA 188,220,244
TR 206,33,45056
MA 156,220,240
MA 156,216,224
v_xor_b32 v31, 224, v1
s_waitcnt vmcnt(8) lgkmcnt(4)
MA 128,192,0
TR 208,34,32768
MA 128,196,16
s_add_u32 m0, s48, 65536
TR 210,34,36864
MA 160,196,20
DM 8,32,52,0
MA 160,192,4
MA 192,192,8
TR 212,34,40960
MA 192,196,24
TR 214,34,45056
MA 224,196,28
MA 224,192,12
WL 4
MA 228,200,12
TR 216,35,32768
MA 228,204,28
TR 218,35,36864
MA 196,204,24
MA 196,200,8
MA 164,200,4
TR 220,35,40960
MA 164,204,20
TR 222,35,45056
MA 132,204,16
MA 132,200,0
buffer_load_dword v61, v60, s[84:87], s77 offen
WL 4
MA 136,208,0
TR 192,36,32768
MA 136,212,16
TR 194,36,36864
MA 168,212,20
DM 9,32,52,1024
MA 168,208,4
MA 200,208,8
TR 196,36,40960
MA 200,212,24
TR 198,36,45056
MA 232,212,28
MA 232,208,12
WL 4
MA 236,216,12
TR 200,37,32768
MA 236,220,28
TR 202,37,36864
MA 204,220,24
MA 204,216,8
MA 172,216,4
TR 204,37,40960
MA 172,220,20
TR 206,37,45056
MA 140,220,16
MA 140,216,0
WL 4
MA 144,192,0
TR 208,38,32768
MA 144,196,16
TR 210,38,36864
MA 176,196,20
DM 10,32,52,2048
MA 176,192,4
MA 208,192,8
TR 212,38,40960
MA 208,196,24
TR 214,38,45056
MA 240,196,28
MA 240,192,12
WL 4
MA 244,200,12
TR 216,39,32768
MA 244,204,28
TR 218,39,36864
MA 212,204,24
MA 212,200,8
MA 180,200,4
TR 220,39,40960
MA 180,204,20
TR 222,39,45056
MA 148,204,16
MA 148,200,0
WL 4
MA 152,208,0
MA 152,212,16
MA 184,212,20
DM 11,32,52,3072
MA 184,208,4
s_add_u32 s52, s52, 131072
s_waitcnt vmcnt(9) lgkmcnt(0)
s_barrier
MA 216,208,8
TR 192,28,0
MA 216,212,24
TR 194,28,4096
MA 248,212,28
TR 196,28,8192
MA 248,208,12
TR 198,28,12288
MA 252,216,12
TR 200,29,0
MA 252,220,28
TR 202,29,4096
MA 220,220,24
MA 220,216,8
MA 188,216,4
TR 204,29,8192
MA 188,220,20
TR 206,29,12288
MA 156,220,16
MA 156,216,0
v_mov_b32 v50, 0xc0135761
v_mov_b32 v51, 0xc0135761
v_mov_b32 v52, 0xbdd2d3e8
v_mov_b32 v53, 0xbdd2d3e8
s_lshl_b32 s60, s58, 2
s_add_u32 s60, s60, s44
s_mul_i32 s60, s60, 458752
s_mul_i32 s62, s59, 16384
s_add_u32 s60, s60, s62
s_add_u32 s60, s60, 42139648
v_pk_mul_f32 v[64:65], v[128:129], v[128:129]
v_pk_mul_f32 v[66:67], v[130:131], v[130:131]
v_pk_mul_f32 v[68:69], v[132:133], v[132:133]
v_pk_mul_f32 v[70:71], v[134:135], v[134:135]
v_pk_fma_f32 v[64:65], v[64:65], v[52:53], v[50:51]
v_pk_fma_f32 v[66:67], v[66:67], v[52:53], v[50:51]
v_pk_fma_f32 v[68:69], v[68:69], v[52:53], v[50:51]
v_pk_fma_f32 v[70:71], v[70:71], v[52:53], v[50:51]
v_pk_mul_f32 v[64:65], v[64:65], v[128:129]
v_pk_mul_f32 v[66:67], v[66:67], v[130:131]
v_pk_mul_f32 v[68:69], v[68:69], v[132:133]
v_pk_mul_f32 v[70:71], v[70:71], v[134:135]
v_exp_f32 v64, v64
v_pk_mul_f32 v[72:73], v[160:161], v[160:161]
v_exp_f32 v65, v65
v_pk_mul_f32 v[74:75], v[162:163], v[162:163]
v_exp_f32 v66, v66
v_pk_mul_f32 v[76:77], v[164:165], v[164:165]
v_exp_f32 v67, v67
v_pk_mul_f32 v[78:79], v[166:167], v[166:167]
v_exp_f32 v68, v68
v_pk_fma_f32 v[72:73], v[72:73], v[52:53], v[50:51]
v_exp_f32 v69, v69
v_pk_fma_f32 v[74:75], v[74:75], v[52:53], v[50:51]
v_exp_f32 v70, v70
v_pk_fma_f32 v[76:77], v[76:77], v[52:53], v[50:51]
v_exp_f32 v71, v71
v_pk_add_f32 v[64:65], v[64:65], 1.0 op_sel_hi:[1,0]
v_pk_add_f32 v[66:67], v[66:67], 1.0 op_sel_hi:[1,0]
v_pk_add_f32 v[68:69], v[68:69], 1.0 op_sel_hi:[1,0]
v_pk_add_f32 v[70:71], v[70:71], 1.0 op_sel_hi:[1,0]
v_rcp_f32 v64, v64
v_pk_fma_f32 v[78:79], v[78:79], v[52:53], v[50:51]
v_rcp_f32 v65, v65
v_pk_mul_f32 v[72:73], v[72:73], v[160:161]
v_rcp_f32 v66, v66
v_pk_mul_f32 v[74:75], v[74:75], v[162:163]
v_rcp_f32 v67, v67
v_pk_mul_f32 v[76:77], v[76:77], v[164:165]
v_rcp_f32 v68, v68
v_pk_mul_f32 v[78:79], v[78:79], v[166:167]
v_rcp_f32 v69, v69
v_rcp_f32 v70, v70
v_rcp_f32 v71, v71
v_pk_mul_f32 v[64:65], v[64:65], v[128:129]
v_exp_f32 v72, v72
v_pk_mul_f32 v[66:67], v[66:67], v[130:131]
v_exp_f32 v73, v73
v_pk_mul_f32 v[68:69], v[68:69], v[132:133]
v_exp_f32 v74, v74
v_pk_mul_f32 v[70:71], v[70:71], v[134:135]
v_exp_f32 v75, v75
v_cvt_pk_bf16_f32 v80, v64, v65
v_exp_f32 v76, v76
v_cvt_pk_bf16_f32 v81, v66, v67
v_exp_f32 v77, v77
v_cvt_pk_bf16_f32 v82, v68, v69
v_exp_f32 v78, v78
v_cvt_pk_bf16_f32 v83, v70, v71
v_exp_f32 v79, v79
buffer_store_dwordx4 v[80:83], v5, s[4:7], s60 offen offset:0 sc1
v_pk_add_f32 v[72:73], v[72:73], 1.0 op_sel_hi:[1,0]
v_pk_add_f32 v[74:75], v[74:75], 1.0 op_sel_hi:[1,0]
v_pk_add_f32 v[76:77], v[76:77], 1.0 op_sel_hi:[1,0]
v_pk_add_f32 v[78:79], v[78:79], 1.0 op_sel_hi:[1,0]
v_rcp_f32 v72, v72
v_pk_mul_f32 v[64:65], v[192:193], v[192:193]
v_rcp_f32 v73, v73
v_pk_mul_f32 v[66:67], v[194:195], v[194:195]
v_rcp_f32 v74, v74
v_pk_mul_f32 v[68:69], v[196:197], v[196:197]
v_rcp_f32 v75, v75
v_pk_mul_f32 v[70:71], v[198:199], v[198:199]
v_rcp_f32 v76, v76
v_pk_fma_f32 v[64:65], v[64:65], v[52:53], v[50:51]
v_rcp_f32 v77, v77
v_pk_fma_f32 v[66:67], v[66:67], v[52:53], v[50:51]
v_rcp_f32 v78, v78
v_pk_fma_f32 v[68:69], v[68:69], v[52:53], v[50:51]
v_rcp_f32 v79, v79
v_pk_mul_f32 v[72:73], v[72:73], v[160:161]
v_pk_mul_f32 v[74:75], v[74:75], v[162:163]
v_pk_mul_f32 v[76:77], v[76:77], v[164:165]
v_pk_mul_f32 v[78:79], v[78:79], v[166:167]
v_cvt_pk_bf16_f32 v84, v72, v73
v_cvt_pk_bf16_f32 v85, v74, v75
v_cvt_pk_bf16_f32 v86, v76, v77
v_cvt_pk_bf16_f32 v87, v78, v79
buffer_store_dwordx4 v[84:87], v5, s[4:7], s60 offen offset:128 sc1
v_pk_fma_f32 v[70:71], v[70:71], v[52:53], v[50:51]
v_pk_mul_f32 v[64:65], v[64:65], v[192:193]
v_pk_mul_f32 v[66:67], v[66:67], v[194:195]
v_pk_mul_f32 v[68:69], v[68:69], v[196:197]
v_pk_mul_f32 v[70:71], v[70:71], v[198:199]
v_exp_f32 v64, v64
v_pk_mul_f32 v[72:73], v[152:153], v[152:153]
v_exp_f32 v65, v65
v_pk_mul_f32 v[74:75], v[154:155], v[154:155]
v_exp_f32 v66, v66
v_pk_mul_f32 v[76:77], v[156:157], v[156:157]
v_exp_f32 v67, v67
v_pk_mul_f32 v[78:79], v[158:159], v[158:159]
v_exp_f32 v68, v68
v_pk_fma_f32 v[72:73], v[72:73], v[52:53], v[50:51]
v_exp_f32 v69, v69
v_pk_fma_f32 v[74:75], v[74:75], v[52:53], v[50:51]
v_exp_f32 v70, v70
v_pk_fma_f32 v[76:77], v[76:77], v[52:53], v[50:51]
v_exp_f32 v71, v71
v_pk_add_f32 v[64:65], v[64:65], 1.0 op_sel_hi:[1,0]
v_pk_add_f32 v[66:67], v[66:67], 1.0 op_sel_hi:[1,0]
v_pk_add_f32 v[68:69], v[68:69], 1.0 op_sel_hi:[1,0]
v_pk_add_f32 v[70:71], v[70:71], 1.0 op_sel_hi:[1,0]
v_rcp_f32 v64, v64
v_pk_fma_f32 v[78:79], v[78:79], v[52:53], v[50:51]
v_rcp_f32 v65, v65
v_pk_mul_f32 v[72:73], v[72:73], v[152:153]
v_rcp_f32 v66, v66
v_pk_mul_f32 v[74:75], v[74:75], v[154:155]
v_rcp_f32 v67, v67
v_pk_mul_f32 v[76:77], v[76:77], v[156:157]
v_rcp_f32 v68, v68
v_pk_mul_f32 v[78:79], v[78:79], v[158:159]
v_rcp_f32 v69, v69
v_rcp_f32 v70, v70
v_rcp_f32 v71, v71
v_pk_mul_f32 v[64:65], v[64:65], v[192:193]
v_exp_f32 v72, v72
v_pk_mul_f32 v[66:67], v[66:67], v[194:195]
v_exp_f32 v73, v73
v_pk_mul_f32 v[68:69], v[68:69], v[196:197]
v_exp_f32 v74, v74
v_pk_mul_f32 v[70:71], v[70:71], v[198:199]
v_exp_f32 v75, v75
v_cvt_pk_bf16_f32 v80, v64, v65
v_exp_f32 v76, v76
v_cvt_pk_bf16_f32 v81, v66, v67
v_exp_f32 v77, v77
v_cvt_pk_bf16_f32 v82, v68, v69
v_exp_f32 v78, v78
v_cvt_pk_bf16_f32 v83, v70, v71
v_exp_f32 v79, v79
buffer_store_dwordx4 v[80:83], v5, s[4:7], s60 offen offset:256 sc1
v_pk_add_f32 v[72:73], v[72:73], 1.0 op_sel_hi:[1,0]
v_pk_add_f32 v[74:75], v[74:75], 1.0 op_sel_hi:[1,0]
v_pk_add_f32 v[76:77], v[76:77], 1.0 op_sel_hi:[1,0]
v_pk_add_f32 v[78:79], v[78:79], 1.0 op_sel_hi:[1,0]
v_rcp_f32 v72, v72
v_pk_mul_f32 v[64:65], v[224:225], v[224:225]
v_rcp_f32 v73, v73
v_pk_mul_f32 v[66:67], v[226:227], v[226:227]
v_rcp_f32 v74, v74
v_pk_mul_f32 v[68:69], v[228:229], v[228:229]
v_rcp_f32 v75, v75
v_pk_mul_f32 v[70:71], v[230:231], v[230:231]
v_rcp_f32 v76, v76
v_pk_fma_f32 v[64:65], v[64:65], v[52:53], v[50:51]
v_rcp_f32 v77, v77
v_pk_fma_f32 v[66:67], v[66:67], v[52:53], v[50:51]
v_rcp_f32 v78, v78
v_pk_fma_f32 v[68:69], v[68:69], v[52:53], v[50:51]
v_rcp_f32 v79, v79
v_pk_mul_f32 v[72:73], v[72:73], v[152:153]
v_pk_mul_f32 v[74:75], v[74:75], v[154:155]
v_pk_mul_f32 v[76:77], v[76:77], v[156:157]
v_pk_mul_f32 v[78:79], v[78:79], v[158:159]
v_cvt_pk_bf16_f32 v84, v72, v73
v_cvt_pk_bf16_f32 v85, v74, v75
v_cvt_pk_bf16_f32 v86, v76, v77
v_cvt_pk_bf16_f32 v87, v78, v79
v_accvgpr_write_b32 a64, v84
v_accvgpr_write_b32 a65, v85
v_accvgpr_write_b32 a66, v86
v_accvgpr_write_b32 a67, v87
v_pk_fma_f32 v[70:71], v[70:71], v[52:53], v[50:51]
v_pk_mul_f32 v[64:65], v[64:65], v[224:225]
v_pk_mul_f32 v[66:67], v[66:67], v[226:227]
v_pk_mul_f32 v[68:69], v[68:69], v[228:229]
v_pk_mul_f32 v[70:71], v[70:71], v[230:231]
v_exp_f32 v64, v64
v_pk_mul_f32 v[72:73], v[136:137], v[136:137]
v_exp_f32 v65, v65
v_pk_mul_f32 v[74:75], v[138:139], v[138:139]
v_exp_f32 v66, v66
v_pk_mul_f32 v[76:77], v[140:141], v[140:141]
v_exp_f32 v67, v67
v_pk_mul_f32 v[78:79], v[142:143], v[142:143]
v_exp_f32 v68, v68
v_pk_fma_f32 v[72:73], v[72:73], v[52:53], v[50:51]
v_exp_f32 v69, v69
v_pk_fma_f32 v[74:75], v[74:75], v[52:53], v[50:51]
v_exp_f32 v70, v70
v_pk_fma_f32 v[76:77], v[76:77], v[52:53], v[50:51]
v_exp_f32 v71, v71
buffer_load_dword v17, v22, s[4:7], s80 offen offset:1536 sc1
v_pk_add_f32 v[64:65], v[64:65], 1.0 op_sel_hi:[1,0]
v_pk_add_f32 v[66:67], v[66:67], 1.0 op_sel_hi:[1,0]
v_pk_add_f32 v[68:69], v[68:69], 1.0 op_sel_hi:[1,0]
v_pk_add_f32 v[70:71], v[70:71], 1.0 op_sel_hi:[1,0]
v_rcp_f32 v64, v64
v_pk_fma_f32 v[78:79], v[78:79], v[52:53], v[50:51]
v_rcp_f32 v65, v65
v_pk_mul_f32 v[72:73], v[72:73], v[136:137]
v_rcp_f32 v66, v66
v_pk_mul_f32 v[74:75], v[74:75], v[138:139]
v_rcp_f32 v67, v67
v_pk_mul_f32 v[76:77], v[76:77], v[140:141]
v_rcp_f32 v68, v68
v_pk_mul_f32 v[78:79], v[78:79], v[142:143]
v_rcp_f32 v69, v69
v_rcp_f32 v70, v70
v_rcp_f32 v71, v71
v_pk_mul_f32 v[64:65], v[64:65], v[224:225]
v_exp_f32 v72, v72
v_pk_mul_f32 v[66:67], v[66:67], v[226:227]
v_exp_f32 v73, v73
v_pk_mul_f32 v[68:69], v[68:69], v[228:229]
v_exp_f32 v74, v74
v_pk_mul_f32 v[70:71], v[70:71], v[230:231]
v_exp_f32 v75, v75
v_cvt_pk_bf16_f32 v80, v64, v65
v_exp_f32 v76, v76
v_cvt_pk_bf16_f32 v81, v66, v67
v_exp_f32 v77, v77
v_cvt_pk_bf16_f32 v82, v68, v69
v_exp_f32 v78, v78
v_cvt_pk_bf16_f32 v83, v70, v71
v_exp_f32 v79, v79
buffer_store_dwordx4 v[80:83], v5, s[4:7], s60 offen offset:384 sc1
s_add_u32 s60, s60, 4096
v_pk_add_f32 v[72:73], v[72:73], 1.0 op_sel_hi:[1,0]
v_pk_add_f32 v[74:75], v[74:75], 1.0 op_sel_hi:[1,0]
v_pk_add_f32 v[76:77], v[76:77], 1.0 op_sel_hi:[1,0]
v_pk_add_f32 v[78:79], v[78:79], 1.0 op_sel_hi:[1,0]
v_rcp_f32 v72, v72
v_pk_mul_f32 v[64:65], v[168:169], v[168:169]
v_rcp_f32 v73, v73
v_pk_mul_f32 v[66:67], v[170:171], v[170:171]
v_rcp_f32 v74, v74
v_pk_mul_f32 v[68:69], v[172:173], v[172:173]
v_rcp_f32 v75, v75
v_pk_mul_f32 v[70:71], v[174:175], v[174:175]
v_rcp_f32 v76, v76
v_pk_fma_f32 v[64:65], v[64:65], v[52:53], v[50:51]
v_rcp_f32 v77, v77
v_pk_fma_f32 v[66:67], v[66:67], v[52:53], v[50:51]
v_rcp_f32 v78, v78
v_pk_fma_f32 v[68:69], v[68:69], v[52:53], v[50:51]
v_rcp_f32 v79, v79
v_pk_mul_f32 v[72:73], v[72:73], v[136:137]
v_pk_mul_f32 v[74:75], v[74:75], v[138:139]
v_pk_mul_f32 v[76:77], v[76:77], v[140:141]
v_pk_mul_f32 v[78:79], v[78:79], v[142:143]
v_cvt_pk_bf16_f32 v84, v72, v73
v_cvt_pk_bf16_f32 v85, v74, v75
v_cvt_pk_bf16_f32 v86, v76, v77
v_cvt_pk_bf16_f32 v87, v78, v79
buffer_store_dwordx4 v[84:87], v5, s[4:7], s60 offen offset:0 sc1
v_pk_fma_f32 v[70:71], v[70:71], v[52:53], v[50:51]
v_pk_mul_f32 v[64:65], v[64:65], v[168:169]
v_pk_mul_f32 v[66:67], v[66:67], v[170:171]
v_pk_mul_f32 v[68:69], v[68:69], v[172:173]
v_pk_mul_f32 v[70:71], v[70:71], v[174:175]
v_exp_f32 v64, v64
v_pk_mul_f32 v[72:73], v[184:185], v[184:185]
v_exp_f32 v65, v65
v_pk_mul_f32 v[74:75], v[186:187], v[186:187]
v_exp_f32 v66, v66
v_pk_mul_f32 v[76:77], v[188:189], v[188:189]
v_exp_f32 v67, v67
v_pk_mul_f32 v[78:79], v[190:191], v[190:191]
v_exp_f32 v68, v68
v_pk_fma_f32 v[72:73], v[72:73], v[52:53], v[50:51]
v_exp_f32 v69, v69
v_pk_fma_f32 v[74:75], v[74:75], v[52:53], v[50:51]
v_exp_f32 v70, v70
v_pk_fma_f32 v[76:77], v[76:77], v[52:53], v[50:51]
v_exp_f32 v71, v71
v_pk_add_f32 v[64:65], v[64:65], 1.0 op_sel_hi:[1,0]
v_pk_add_f32 v[66:67], v[66:67], 1.0 op_sel_hi:[1,0]
v_pk_add_f32 v[68:69], v[68:69], 1.0 op_sel_hi:[1,0]
v_pk_add_f32 v[70:71], v[70:71], 1.0 op_sel_hi:[1,0]
v_rcp_f32 v64, v64
v_pk_fma_f32 v[78:79], v[78:79], v[52:53], v[50:51]
v_rcp_f32 v65, v65
v_pk_mul_f32 v[72:73], v[72:73], v[184:185]
v_rcp_f32 v66, v66
v_pk_mul_f32 v[74:75], v[74:75], v[186:187]
v_rcp_f32 v67, v67
v_pk_mul_f32 v[76:77], v[76:77], v[188:189]
v_rcp_f32 v68, v68
v_pk_mul_f32 v[78:79], v[78:79], v[190:191]
v_rcp_f32 v69, v69
v_rcp_f32 v70, v70
v_rcp_f32 v71, v71
v_pk_mul_f32 v[64:65], v[64:65], v[168:169]
v_exp_f32 v72, v72
WV 2
v_cmp_gt_u32 s[68:69], 16, v17
s_nop 0
s_and_b64 s[68:69], s[68:69], s[74:75]
s_cbranch_scc1 t2_slow41
t2_back42:
s_barrier
XL 128,5,4,50,0
v_pk_mul_f32 v[66:67], v[66:67], v[170:171]
v_exp_f32 v73, v73
v_pk_mul_f32 v[68:69], v[68:69], v[172:173]
v_exp_f32 v74, v74
v_pk_mul_f32 v[70:71], v[70:71], v[174:175]
v_exp_f32 v75, v75
v_cvt_pk_bf16_f32 v80, v64, v65
v_exp_f32 v76, v76
v_cvt_pk_bf16_f32 v81, v66, v67
v_exp_f32 v77, v77
v_cvt_pk_bf16_f32 v82, v68, v69
v_exp_f32 v78, v78
v_cvt_pk_bf16_f32 v83, v70, v71
v_exp_f32 v79, v79
buffer_store_dwordx4 v[80:83], v5, s[4:7], s60 offen offset:128 sc1
XL 132,5,4,50,128
v_pk_add_f32 v[72:73], v[72:73], 1.0 op_sel_hi:[1,0]
v_pk_add_f32 v[74:75], v[74:75], 1.0 op_sel_hi:[1,0]
v_pk_add_f32 v[76:77], v[76:77], 1.0 op_sel_hi:[1,0]
v_pk_add_f32 v[78:79], v[78:79], 1.0 op_sel_hi:[1,0]
v_rcp_f32 v72, v72
v_pk_mul_f32 v[64:65], v[200:201], v[200:201]
v_rcp_f32 v73, v73
v_pk_mul_f32 v[66:67], v[202:203], v[202:203]
v_rcp_f32 v74, v74
v_pk_mul_f32 v[68:69], v[204:205], v[204:205]
v_rcp_f32 v75, v75
v_pk_mul_f32 v[70:71], v[206:207], v[206:207]
v_rcp_f32 v76, v76
v_pk_fma_f32 v[64:65], v[64:65], v[52:53], v[50:51]
v_rcp_f32 v77, v77
XL 136,5,4,50,256
v_pk_fma_f32 v[66:67], v[66:67], v[52:53], v[50:51]
v_rcp_f32 v78, v78
v_pk_fma_f32 v[68:69], v[68:69], v[52:53], v[50:51]
v_rcp_f32 v79, v79
v_pk_mul_f32 v[72:73], v[72:73], v[184:185]
v_pk_mul_f32 v[74:75], v[74:75], v[186:187]
v_pk_mul_f32 v[76:77], v[76:77], v[188:189]
v_pk_mul_f32 v[78:79], v[78:79], v[190:191]
v_cvt_pk_bf16_f32 v84, v72, v73
v_cvt_pk_bf16_f32 v85, v74, v75
v_cvt_pk_bf16_f32 v86, v76, v77
v_cvt_pk_bf16_f32 v87, v78, v79
v_accvgpr_write_b32 a68, v84
v_accvgpr_write_b32 a69, v85
v_accvgpr_write_b32 a70, v86
XL 140,5,4,50,384
s_add_u32 s50, s50, 4096
v_accvgpr_write_b32 a71, v87
v_pk_fma_f32 v[70:71], v[70:71], v[52:53], v[50:51]
v_pk_mul_f32 v[64:65], v[64:65], v[200:201]
v_pk_mul_f32 v[66:67], v[66:67], v[202:203]
v_pk_mul_f32 v[68:69], v[68:69], v[204:205]
v_pk_mul_f32 v[70:71], v[70:71], v[206:207]
v_exp_f32 v64, v64
v_pk_mul_f32 v[72:73], v[232:233], v[232:233]
v_exp_f32 v65, v65
v_pk_mul_f32 v[74:75], v[234:235], v[234:235]
v_exp_f32 v66, v66
v_pk_mul_f32 v[76:77], v[236:237], v[236:237]
v_exp_f32 v67, v67
v_pk_mul_f32 v[78:79], v[238:239], v[238:239]
v_exp_f32 v68, v68
XL 144,5,4,50,0
v_pk_fma_f32 v[72:73], v[72:73], v[52:53], v[50:51]
v_exp_f32 v69, v69
v_pk_fma_f32 v[74:75], v[74:75], v[52:53], v[50:51]
v_exp_f32 v70, v70
v_pk_fma_f32 v[76:77], v[76:77], v[52:53], v[50:51]
v_exp_f32 v71, v71
v_pk_add_f32 v[64:65], v[64:65], 1.0 op_sel_hi:[1,0]
v_pk_add_f32 v[66:67], v[66:67], 1.0 op_sel_hi:[1,0]
v_pk_add_f32 v[68:69], v[68:69], 1.0 op_sel_hi:[1,0]
v_pk_add_f32 v[70:71], v[70:71], 1.0 op_sel_hi:[1,0]
v_rcp_f32 v64, v64
v_pk_fma_f32 v[78:79], v[78:79], v[52:53], v[50:51]
v_rcp_f32 v65, v65
v_pk_mul_f32 v[72:73], v[72:73], v[232:233]
v_rcp_f32 v66, v66
XL 148,5,4,50,128
v_pk_mul_f32 v[74:75], v[74:75], v[234:235]
v_rcp_f32 v67, v67
v_pk_mul_f32 v[76:77], v[76:77], v[236:237]
v_rcp_f32 v68, v68
v_pk_mul_f32 v[78:79], v[78:79], v[238:239]
v_rcp_f32 v69, v69
v_rcp_f32 v70, v70
v_rcp_f32 v71, v71
v_pk_mul_f32 v[64:65], v[64:65], v[200:201]
v_exp_f32 v72, v72
v_pk_mul_f32 v[66:67], v[66:67], v[202:203]
v_exp_f32 v73, v73
v_pk_mul_f32 v[68:69], v[68:69], v[204:205]
v_exp_f32 v74, v74
v_pk_mul_f32 v[70:71], v[70:71], v[206:207]
XL 152,5,4,50,256
v_exp_f32 v75, v75
v_cvt_pk_bf16_f32 v80, v64, v65
v_exp_f32 v76, v76
v_cvt_pk_bf16_f32 v81, v66, v67
v_exp_f32 v77, v77
v_cvt_pk_bf16_f32 v82, v68, v69
v_exp_f32 v78, v78
v_cvt_pk_bf16_f32 v83, v70, v71
v_exp_f32 v79, v79
buffer_store_dwordx4 v[80:83], v5, s[4:7], s60 offen offset:256 sc1
v_pk_add_f32 v[72:73], v[72:73], 1.0 op_sel_hi:[1,0]
v_pk_add_f32 v[74:75], v[74:75], 1.0 op_sel_hi:[1,0]
v_pk_add_f32 v[76:77], v[76:77], 1.0 op_sel_hi:[1,0]
v_pk_add_f32 v[78:79], v[78:79], 1.0 op_sel_hi:[1,0]
v_rcp_f32 v72, v72
XL 156,5,4,50,384
s_add_u32 s50, s50, 4096
v_pk_mul_f32 v[64:65], v[144:145], v[144:145]
v_rcp_f32 v73, v73
v_pk_mul_f32 v[66:67], v[146:147], v[146:147]
v_rcp_f32 v74, v74
v_pk_mul_f32 v[68:69], v[148:149], v[148:149]
v_rcp_f32 v75, v75
v_pk_mul_f32 v[70:71], v[150:151], v[150:151]
v_rcp_f32 v76, v76
v_pk_fma_f32 v[64:65], v[64:65], v[52:53], v[50:51]
v_rcp_f32 v77, v77
v_pk_fma_f32 v[66:67], v[66:67], v[52:53], v[50:51]
v_rcp_f32 v78, v78
v_pk_fma_f32 v[68:69], v[68:69], v[52:53], v[50:51]
v_rcp_f32 v79, v79
v_pk_mul_f32 v[72:73], v[72:73], v[232:233]
XL 160,5,4,50,0
v_pk_mul_f32 v[74:75], v[74:75], v[234:235]
v_pk_mul_f32 v[76:77], v[76:77], v[236:237]
v_pk_mul_f32 v[78:79], v[78:79], v[238:239]
v_cvt_pk_bf16_f32 v84, v72, v73
v_cvt_pk_bf16_f32 v85, v74, v75
v_cvt_pk_bf16_f32 v86, v76, v77
v_cvt_pk_bf16_f32 v87, v78, v79
buffer_store_dwordx4 v[84:87], v5, s[4:7], s60 offen offset:384 sc1
s_add_u32 s60, s60, 4096
v_pk_fma_f32 v[70:71], v[70:71], v[52:53], v[50:51]
v_pk_mul_f32 v[64:65], v[64:65], v[144:145]
v_pk_mul_f32 v[66:67], v[66:67], v[146:147]
v_pk_mul_f32 v[68:69], v[68:69], v[148:149]
v_pk_mul_f32 v[70:71], v[70:71], v[150:151]
v_exp_f32 v64, v64
XL 164,5,4,50,128
v_pk_mul_f32 v[72:73], v[216:217], v[216:217]
v_exp_f32 v65, v65
v_pk_mul_f32 v[74:75], v[218:219], v[218:219]
v_exp_f32 v66, v66
v_pk_mul_f32 v[76:77], v[220:221], v[220:221]
v_exp_f32 v67, v67
v_pk_mul_f32 v[78:79], v[222:223], v[222:223]
v_exp_f32 v68, v68
v_pk_fma_f32 v[72:73], v[72:73], v[52:53], v[50:51]
v_exp_f32 v69, v69
v_pk_fma_f32 v[74:75], v[74:75], v[52:53], v[50:51]
v_exp_f32 v70, v70
v_pk_fma_f32 v[76:77], v[76:77], v[52:53], v[50:51]
v_exp_f32 v71, v71
v_pk_add_f32 v[64:65], v[64:65], 1.0 op_sel_hi:[1,0]
XL 168,5,4,50,256
v_pk_add_f32 v[66:67], v[66:67], 1.0 op_sel_hi:[1,0]
v_pk_add_f32 v[68:69], v[68:69], 1.0 op_sel_hi:[1,0]
v_pk_add_f32 v[70:71], v[70:71], 1.0 op_sel_hi:[1,0]
v_rcp_f32 v64, v64
v_pk_fma_f32 v[78:79], v[78:79], v[52:53], v[50:51]
v_rcp_f32 v65, v65
v_pk_mul_f32 v[72:73], v[72:73], v[216:217]
v_rcp_f32 v66, v66
v_pk_mul_f32 v[74:75], v[74:75], v[218:219]
v_rcp_f32 v67, v67
v_pk_mul_f32 v[76:77], v[76:77], v[220:221]
v_rcp_f32 v68, v68
v_pk_mul_f32 v[78:79], v[78:79], v[222:223]
v_rcp_f32 v69, v69
v_rcp_f32 v70, v70
XL 172,5,4,50,384
s_add_u32 s50, s50, 4096
v_rcp_f32 v71, v71
v_pk_mul_f32 v[64:65], v[64:65], v[144:145]
v_exp_f32 v72, v72
v_pk_mul_f32 v[66:67], v[66:67], v[146:147]
v_exp_f32 v73, v73
v_pk_mul_f32 v[68:69], v[68:69], v[148:149]
v_exp_f32 v74, v74
v_pk_mul_f32 v[70:71], v[70:71], v[150:151]
v_exp_f32 v75, v75
v_cvt_pk_bf16_f32 v80, v64, v65
v_exp_f32 v76, v76
v_cvt_pk_bf16_f32 v81, v66, v67
v_exp_f32 v77, v77
v_cvt_pk_bf16_f32 v82, v68, v69
v_exp_f32 v78, v78
XL 176,5,4,50,0
v_cvt_pk_bf16_f32 v83, v70, v71
v_exp_f32 v79, v79
buffer_store_dwordx4 v[80:83], v5, s[4:7], s60 offen offset:0 sc1
v_pk_add_f32 v[72:73], v[72:73], 1.0 op_sel_hi:[1,0]
v_pk_add_f32 v[74:75], v[74:75], 1.0 op_sel_hi:[1,0]
v_pk_add_f32 v[76:77], v[76:77], 1.0 op_sel_hi:[1,0]
v_pk_add_f32 v[78:79], v[78:79], 1.0 op_sel_hi:[1,0]
v_rcp_f32 v72, v72
v_pk_mul_f32 v[64:65], v[176:177], v[176:177]
v_rcp_f32 v73, v73
v_pk_mul_f32 v[66:67], v[178:179], v[178:179]
v_rcp_f32 v74, v74
v_pk_mul_f32 v[68:69], v[180:181], v[180:181]
v_rcp_f32 v75, v75
v_pk_mul_f32 v[70:71], v[182:183], v[182:183]
XL 180,5,4,50,128
v_rcp_f32 v76, v76
v_pk_fma_f32 v[64:65], v[64:65], v[52:53], v[50:51]
v_rcp_f32 v77, v77
v_pk_fma_f32 v[66:67], v[66:67], v[52:53], v[50:51]
v_rcp_f32 v78, v78
v_pk_fma_f32 v[68:69], v[68:69], v[52:53], v[50:51]
v_rcp_f32 v79, v79
v_pk_mul_f32 v[72:73], v[72:73], v[216:217]
v_pk_mul_f32 v[74:75], v[74:75], v[218:219]
v_pk_mul_f32 v[76:77], v[76:77], v[220:221]
v_pk_mul_f32 v[78:79], v[78:79], v[222:223]
v_cvt_pk_bf16_f32 v84, v72, v73
v_cvt_pk_bf16_f32 v85, v74, v75
v_cvt_pk_bf16_f32 v86, v76, v77
v_cvt_pk_bf16_f32 v87, v78, v79
XL 184,5,4,50,256
v_accvgpr_write_b32 a72, v84
v_accvgpr_write_b32 a73, v85
v_accvgpr_write_b32 a74, v86
v_accvgpr_write_b32 a75, v87
v_pk_fma_f32 v[70:71], v[70:71], v[52:53], v[50:51]
v_pk_mul_f32 v[64:65], v[64:65], v[176:177]
v_pk_mul_f32 v[66:67], v[66:67], v[178:179]
v_pk_mul_f32 v[68:69], v[68:69], v[180:181]
v_pk_mul_f32 v[70:71], v[70:71], v[182:183]
v_exp_f32 v64, v64
v_pk_mul_f32 v[72:73], v[208:209], v[208:209]
v_exp_f32 v65, v65
v_pk_mul_f32 v[74:75], v[210:211], v[210:211]
v_exp_f32 v66, v66
v_pk_mul_f32 v[76:77], v[212:213], v[212:213]
XL 188,5,4,50,384
s_add_u32 s50, s50, 4096
v_exp_f32 v67, v67
v_pk_mul_f32 v[78:79], v[214:215], v[214:215]
v_exp_f32 v68, v68
v_pk_fma_f32 v[72:73], v[72:73], v[52:53], v[50:51]
v_exp_f32 v69, v69
v_pk_fma_f32 v[74:75], v[74:75], v[52:53], v[50:51]
v_exp_f32 v70, v70
v_pk_fma_f32 v[76:77], v[76:77], v[52:53], v[50:51]
v_exp_f32 v71, v71
v_pk_add_f32 v[64:65], v[64:65], 1.0 op_sel_hi:[1,0]
v_pk_add_f32 v[66:67], v[66:67], 1.0 op_sel_hi:[1,0]
v_pk_add_f32 v[68:69], v[68:69], 1.0 op_sel_hi:[1,0]
v_pk_add_f32 v[70:71], v[70:71], 1.0 op_sel_hi:[1,0]
v_rcp_f32 v64, v64
v_pk_fma_f32 v[78:79], v[78:79], v[52:53], v[50:51]
XL 0,5,4,50,0
v_rcp_f32 v65, v65
v_pk_mul_f32 v[72:73], v[72:73], v[208:209]
v_rcp_f32 v66, v66
v_pk_mul_f32 v[74:75], v[74:75], v[210:211]
v_rcp_f32 v67, v67
v_pk_mul_f32 v[76:77], v[76:77], v[212:213]
v_rcp_f32 v68, v68
v_pk_mul_f32 v[78:79], v[78:79], v[214:215]
v_rcp_f32 v69, v69
v_rcp_f32 v70, v70
v_rcp_f32 v71, v71
v_pk_mul_f32 v[64:65], v[64:65], v[176:177]
v_exp_f32 v72, v72
v_pk_mul_f32 v[66:67], v[66:67], v[178:179]
v_exp_f32 v73, v73
XL 4,5,4,50,128
v_pk_mul_f32 v[68:69], v[68:69], v[180:181]
v_exp_f32 v74, v74
v_pk_mul_f32 v[70:71], v[70:71], v[182:183]
v_exp_f32 v75, v75
v_cvt_pk_bf16_f32 v80, v64, v65
v_exp_f32 v76, v76
v_cvt_pk_bf16_f32 v81, v66, v67
v_exp_f32 v77, v77
v_cvt_pk_bf16_f32 v82, v68, v69
v_exp_f32 v78, v78
v_cvt_pk_bf16_f32 v83, v70, v71
v_exp_f32 v79, v79
buffer_store_dwordx4 v[80:83], v5, s[4:7], s60 offen offset:128 sc1
v_pk_add_f32 v[72:73], v[72:73], 1.0 op_sel_hi:[1,0]
v_pk_add_f32 v[74:75], v[74:75], 1.0 op_sel_hi:[1,0]
XL 8,5,4,50,256
v_pk_add_f32 v[76:77], v[76:77], 1.0 op_sel_hi:[1,0]
v_pk_add_f32 v[78:79], v[78:79], 1.0 op_sel_hi:[1,0]
v_rcp_f32 v72, v72
v_pk_mul_f32 v[64:65], v[240:241], v[240:241]
v_rcp_f32 v73, v73
v_pk_mul_f32 v[66:67], v[242:243], v[242:243]
v_rcp_f32 v74, v74
v_pk_mul_f32 v[68:69], v[244:245], v[244:245]
v_rcp_f32 v75, v75
v_pk_mul_f32 v[70:71], v[246:247], v[246:247]
v_rcp_f32 v76, v76
v_pk_fma_f32 v[64:65], v[64:65], v[52:53], v[50:51]
v_rcp_f32 v77, v77
v_pk_fma_f32 v[66:67], v[66:67], v[52:53], v[50:51]
v_rcp_f32 v78, v78
XL 12,5,4,50,384
s_add_u32 s50, s50, 4096
v_pk_fma_f32 v[68:69], v[68:69], v[52:53], v[50:51]
v_rcp_f32 v79, v79
v_pk_mul_f32 v[72:73], v[72:73], v[208:209]
v_pk_mul_f32 v[74:75], v[74:75], v[210:211]
v_pk_mul_f32 v[76:77], v[76:77], v[212:213]
v_pk_mul_f32 v[78:79], v[78:79], v[214:215]
v_cvt_pk_bf16_f32 v84, v72, v73
v_cvt_pk_bf16_f32 v85, v74, v75
v_cvt_pk_bf16_f32 v86, v76, v77
v_cvt_pk_bf16_f32 v87, v78, v79
buffer_store_dwordx4 v[84:87], v5, s[4:7], s60 offen offset:256 sc1
v_pk_fma_f32 v[70:71], v[70:71], v[52:53], v[50:51]
v_pk_mul_f32 v[64:65], v[64:65], v[240:241]
v_pk_mul_f32 v[66:67], v[66:67], v[242:243]
v_pk_mul_f32 v[68:69], v[68:69], v[244:245]
XL 16,5,4,50,0
v_pk_mul_f32 v[70:71], v[70:71], v[246:247]
v_exp_f32 v64, v64
v_pk_mul_f32 v[72:73], v[248:249], v[248:249]
v_exp_f32 v65, v65
v_pk_mul_f32 v[74:75], v[250:251], v[250:251]
v_exp_f32 v66, v66
v_pk_mul_f32 v[76:77], v[252:253], v[252:253]
v_exp_f32 v67, v67
v_pk_mul_f32 v[78:79], v[254:255], v[254:255]
v_exp_f32 v68, v68
v_pk_fma_f32 v[72:73], v[72:73], v[52:53], v[50:51]
v_exp_f32 v69, v69
v_pk_fma_f32 v[74:75], v[74:75], v[52:53], v[50:51]
v_exp_f32 v70, v70
v_pk_fma_f32 v[76:77], v[76:77], v[52:53], v[50:51]
XL 20,5,4,50,128
v_exp_f32 v71, v71
v_pk_add_f32 v[64:65], v[64:65], 1.0 op_sel_hi:[1,0]
v_pk_add_f32 v[66:67], v[66:67], 1.0 op_sel_hi:[1,0]
v_pk_add_f32 v[68:69], v[68:69], 1.0 op_sel_hi:[1,0]
v_pk_add_f32 v[70:71], v[70:71], 1.0 op_sel_hi:[1,0]
v_rcp_f32 v64, v64
v_pk_fma_f32 v[78:79], v[78:79], v[52:53], v[50:51]
v_rcp_f32 v65, v65
v_pk_mul_f32 v[72:73], v[72:73], v[248:249]
v_rcp_f32 v66, v66
v_pk_mul_f32 v[74:75], v[74:75], v[250:251]
v_rcp_f32 v67, v67
v_pk_mul_f32 v[76:77], v[76:77], v[252:253]
v_rcp_f32 v68, v68
v_pk_mul_f32 v[78:79], v[78:79], v[254:255]
XL 24,5,4,50,256
v_rcp_f32 v69, v69
v_rcp_f32 v70, v70
v_rcp_f32 v71, v71
v_pk_mul_f32 v[64:65], v[64:65], v[240:241]
v_exp_f32 v72, v72
v_pk_mul_f32 v[66:67], v[66:67], v[242:243]
v_exp_f32 v73, v73
v_pk_mul_f32 v[68:69], v[68:69], v[244:245]
v_exp_f32 v74, v74
v_pk_mul_f32 v[70:71], v[70:71], v[246:247]
v_exp_f32 v75, v75
v_cvt_pk_bf16_f32 v80, v64, v65
v_exp_f32 v76, v76
v_cvt_pk_bf16_f32 v81, v66, v67
v_exp_f32 v77, v77
XL 28,5,4,50,384
s_add_u32 s50, s50, 4096
v_cvt_pk_bf16_f32 v82, v68, v69
v_exp_f32 v78, v78
v_cvt_pk_bf16_f32 v83, v70, v71
v_exp_f32 v79, v79
buffer_store_dwordx4 v[80:83], v5, s[4:7], s60 offen offset:384 sc1
s_add_u32 s60, s60, 4096
v_pk_add_f32 v[72:73], v[72:73], 1.0 op_sel_hi:[1,0]
v_pk_add_f32 v[74:75], v[74:75], 1.0 op_sel_hi:[1,0]
v_pk_add_f32 v[76:77], v[76:77], 1.0 op_sel_hi:[1,0]
v_pk_add_f32 v[78:79], v[78:79], 1.0 op_sel_hi:[1,0]
v_rcp_f32 v72, v72
v_rcp_f32 v73, v73
v_rcp_f32 v74, v74
v_rcp_f32 v75, v75
v_rcp_f32 v76, v76
v_rcp_f32 v77, v77
v_rcp_f32 v78, v78
v_rcp_f32 v79, v79
v_pk_mul_f32 v[72:73], v[72:73], v[248:249]
v_pk_mul_f32 v[74:75], v[74:75], v[250:251]
v_pk_mul_f32 v[76:77], v[76:77], v[252:253]
v_pk_mul_f32 v[78:79], v[78:79], v[254:255]
v_cvt_pk_bf16_f32 v84, v72, v73
v_cvt_pk_bf16_f32 v85, v74, v75
v_cvt_pk_bf16_f32 v86, v76, v77
v_cvt_pk_bf16_f32 v87, v78, v79
v_accvgpr_write_b32 a76, v84
v_accvgpr_write_b32 a77, v85
v_accvgpr_write_b32 a78, v86
v_accvgpr_write_b32 a79, v87
s_waitcnt vmcnt(21) lgkmcnt(4)
MZ 144,192,128
TR 208,30,0
MA 144,196,144
s_add_u32 m0, s48, 98304
TR 210,30,4096
MZ 176,196,148
DM 8,32,52,0
MA 176,192,132
v_xor_b32 v32, 65536, v1
MZ 208,192,136
TR 212,30,8192
MA 208,196,152
TR 214,30,12288
MZ 240,196,156
DM 9,32,52,1024
MA 240,192,140
v_xor_b32 v33, 65568, v1
WL 4
MZ 244,200,140
TR 216,31,0
MA 244,204,156
TR 218,31,4096
MZ 212,204,152
DM 10,32,52,2048
MA 212,200,136
v_xor_b32 v34, 65600, v1
MZ 180,200,132
TR 220,31,8192
MA 180,204,148
TR 222,31,12288
MZ 148,204,144
buffer_store_dwordx4 a[64:67], v5, s[4:7], s60 offen offset:0 sc1
MA 148,200,128
v_xor_b32 v35, 65632, v1
WL 4
MZ 152,208,128
TR 192,24,0
MA 152,212,144
TR 194,24,4096
MZ 184,212,148
DM 11,32,52,3072
MA 184,208,132
s_add_u32 s52, s52, 131072
v_xor_b32 v36, 65664, v1
MZ 216,208,136
TR 196,24,8192
MA 216,212,152
TR 198,24,12288
MZ 248,212,156
XL 32,5,4,50,0
MA 248,208,140
v_xor_b32 v37, 65696, v1
WL 4
MZ 252,216,140
TR 200,25,0
MA 252,220,156
TR 202,25,4096
MZ 220,220,152
XL 36,5,4,50,128
MA 220,216,136
v_xor_b32 v38, 65728, v1
MZ 188,216,132
TR 204,25,8192
MA 188,220,148
TR 206,25,12288
MZ 156,220,144
buffer_store_dwordx4 a[68:71], v5, s[4:7], s60 offen offset:128 sc1
MA 156,216,128
v_xor_b32 v39, 65760, v1
WL 4
MZ 128,192,128
TR 208,26,0
MA 128,196,144
TR 210,26,4096
MZ 160,196,148
XL 40,5,4,50,256
MA 160,192,132
MZ 192,192,136
TR 212,26,8192
MA 192,196,152
TR 214,26,12288
MZ 224,196,156
XL 44,5,4,50,384
MA 224,192,140
s_add_u32 s50, s50, 4096
WL 4
MZ 228,200,140
TR 216,27,0
MA 228,204,156
TR 218,27,4096
MZ 196,204,152
XL 48,5,4,50,0
MA 196,200,136
MZ 164,200,132
TR 220,27,8192
MA 164,204,148
TR 222,27,12288
MZ 132,204,144
buffer_store_dwordx4 a[72:75], v5, s[4:7], s60 offen offset:256 sc1
MA 132,200,128
WL 4
MZ 136,208,128
MA 136,212,144
MZ 168,212,148
XL 52,5,4,50,128
MA 168,208,132
WL 0
s_barrier
MZ 200,208,136
TR 192,28,32768
MA 200,212,152
TR 194,28,36864
MZ 232,212,156
XL 56,5,4,50,256
TR 196,28,40960
MA 232,208,140
TR 198,28,45056
MZ 236,216,140
TR 200,29,32768
MA 236,220,156
TR 202,29,36864
MZ 204,220,152
XL 60,5,4,50,384
MA 204,216,136
s_add_u32 s50, s50, 4096
MZ 172,216,132
TR 204,29,40960
MA 172,220,148
TR 206,29,45056
MZ 140,220,144
buffer_store_dwordx4 a[76:79], v5, s[4:7], s60 offen offset:384 sc1
MA 140,216,128
s_add_u32 s60, s60, 4096
s_waitcnt vmcnt(27) lgkmcnt(4)
MA 144,192,160
TR 208,30,32768
MA 144,196,176
s_add_u32 m0, s48, 0
TR 210,30,36864
MA 176,196,180
DM 8,32,52,0
MA 176,192,164
MA 208,192,168
TR 212,30,40960
MA 208,196,184
TR 214,30,45056
MA 240,196,188
DM 9,32,52,1024
MA 240,192,172
WL 4
MA 244,200,172
TR 216,31,32768
MA 244,204,188
TR 218,31,36864
MA 212,204,184
DM 10,32,52,2048
MA 212,200,168
MA 180,200,164
TR 220,31,40960
MA 180,204,180
TR 222,31,45056
MA 148,204,176
MA 148,200,160
WL 4
MA 152,208,160
TR 192,24,32768
MA 152,212,176
TR 194,24,36864
MA 184,212,180
DM 11,32,52,3072
MA 184,208,164
s_add_u32 s52, s52, 131072
MA 216,208,168
TR 196,24,40960
MA 216,212,184
TR 198,24,45056
MA 248,212,188
XL 128,5,4,50,0
MA 248,208,172
WL 4
MA 252,216,172
TR 200,25,32768
MA 252,220,188
TR 202,25,36864
MA 220,220,184
XL 132,5,4,50,128
MA 220,216,168
MA 188,216,164
TR 204,25,40960
MA 188,220,180
TR 206,25,45056
MA 156,220,176
MA 156,216,160
WL 4
MA 128,192,160
TR 208,26,32768
MA 128,196,176
TR 210,26,36864
MA 160,196,180
XL 136,5,4,50,256
MA 160,192,164
MA 192,192,168
TR 212,26,40960
MA 192,196,184
TR 214,26,45056
MA 224,196,188
XL 140,5,4,50,384
MA 224,192,172
s_add_u32 s50, s50, 4096
WL 4
MA 228,200,172
TR 216,27,32768
MA 228,204,188
TR 218,27,36864
MA 196,204,184
XL 144,5,4,50,0
MA 196,200,168
MA 164,200,164
TR 220,27,40960
MA 164,204,180
TR 222,27,45056
MA 132,204,176
MA 132,200,160
WL 4
MA 136,208,160
MA 136,212,176
MA 168,212,180
XL 148,5,4,50,128
MA 168,208,164
WL 0
s_barrier
MA 200,208,168
TR 192,36,0
MA 200,212,184
TR 194,36,4096
MA 232,212,188
XL 152,5,4,50,256
TR 196,36,8192
MA 232,208,172
TR 198,36,12288
MA 236,216,172
TR 200,37,0
MA 236,220,188
TR 202,37,4096
MA 204,220,184
XL 156,5,4,50,384
MA 204,216,168
s_add_u32 s50, s50, 4096
MA 172,216,164
TR 204,37,8192
MA 172,220,180
TR 206,37,12288
MA 140,220,176
MA 140,216,160
s_waitcnt vmcnt(29) lgkmcnt(4)
MA 144,192,0
TR 208,38,0
MA 144,196,16
s_add_u32 m0, s48, 32768
TR 210,38,4096
MA 176,196,20
DM 8,32,52,0
MA 176,192,4
MA 208,192,8
TR 212,38,8192
MA 208,196,24
TR 214,38,12288
MA 240,196,28
DM 9,32,52,1024
MA 240,192,12
WL 4
MA 244,200,12
TR 216,39,0
MA 244,204,28
TR 218,39,4096
MA 212,204,24
DM 10,32,52,2048
MA 212,200,8
MA 180,200,4
TR 220,39,8192
MA 180,204,20
TR 222,39,12288
MA 148,204,16
MA 148,200,0
WL 4
MA 152,208,0
TR 192,32,0
MA 152,212,16
TR 194,32,4096
MA 184,212,20
DM 11,32,52,3072
MA 184,208,4
s_add_u32 s52, s52, 131072
MA 216,208,8
TR 196,32,8192
MA 216,212,24
TR 198,32,12288
MA 248,212,28
XL 160,5,4,50,0
MA 248,208,12
WL 4
MA 252,216,12
TR 200,33,0
MA 252,220,28
TR 202,33,4096
MA 220,220,24
XL 164,5,4,50,128
MA 220,216,8
MA 188,216,4
TR 204,33,8192
MA 188,220,20
TR 206,33,12288
MA 156,220,16
MA 156,216,0
WL 4
MA 128,192,0
TR 208,34,0
MA 128,196,16
TR 210,34,4096
MA 160,196,20
XL 168,5,4,50,256
MA 160,192,4
MA 192,192,8
TR 212,34,8192
MA 192,196,24
TR 214,34,12288
MA 224,196,28
XL 172,5,4,50,384
MA 224,192,12
s_add_u32 s50, s50, 4096
WL 4
MA 228,200,12
TR 216,35,0
MA 228,204,28
TR 218,35,4096
MA 196,204,24
XL 176,5,4,50,0
MA 196,200,8
MA 164,200,4
TR 220,35,8192
MA 164,204,20
TR 222,35,12288
MA 132,204,16
MA 132,200,0
WL 4
MA 136,208,0
MA 136,212,16
MA 168,212,20
XL 180,5,4,50,128
MA 168,208,4
s_waitcnt vmcnt(33) lgkmcnt(0)
s_barrier
MA 200,208,8
TR 192,36,32768
MA 200,212,24
TR 194,36,36864
MA 232,212,28
XL 184,5,4,50,256
TR 196,36,40960
MA 232,208,12
TR 198,36,45056
MA 236,216,12
TR 200,37,32768
MA 236,220,28
TR 202,37,36864
MA 204,220,24
XL 188,5,4,50,384
MA 204,216,8
s_add_u32 s50, s50, 4096
MA 172,216,4
TR 204,37,40960
MA 172,220,20
TR 206,37,45056
MA 140,220,16
MA 140,216,0
s_waitcnt vmcnt(25) lgkmcnt(4)
MA 144,192,32
TR 208,38,32768
MA 144,196,48
s_add_u32 m0, s48, 65536
TR 210,38,36864
MA 176,196,52
DM 8,32,52,0
MA 176,192,36
MA 208,192,40
TR 212,38,40960
MA 208,196,56
TR 214,38,45056
MA 240,196,60
DM 9,32,52,1024
MA 240,192,44
WL 4
MA 244,200,44
TR 216,39,32768
MA 244,204,60
TR 218,39,36864
MA 212,204,56
DM 10,32,52,2048
MA 212,200,40
MA 180,200,36
TR 220,39,40960
MA 180,204,52
TR 222,39,45056
MA 148,204,48
MA 148,200,32
buffer_load_dword v61, v60, s[84:87], s77 offen
WL 4
MA 152,208,32
TR 192,32,32768
MA 152,212,48
TR 194,32,36864
MA 184,212,52
DM 11,32,52,3072
MA 184,208,36
s_add_u32 s52, s52, 131072
MA 216,208,40
TR 196,32,40960
MA 216,212,56
TR 198,32,45056
MA 248,212,60
XL 0,5,4,50,0
MA 248,208,44
WL 4
MA 252,216,44
TR 200,33,32768
MA 252,220,60
TR 202,33,36864
MA 220,220,56
XL 4,5,4,50,128
MA 220,216,40
MA 188,216,36
TR 204,33,40960
MA 188,220,52
TR 206,33,45056
MA 156,220,48
MA 156,216,32
WL 4
MA 128,192,32
TR 208,34,32768
MA 128,196,48
TR 210,34,36864
MA 160,196,52
XL 8,5,4,50,256
MA 160,192,36
MA 192,192,40
TR 212,34,40960
MA 192,196,56
TR 214,34,45056
MA 224,196,60
XL 12,5,4,50,384
MA 224,192,44
s_add_u32 s50, s50, 4096
WL 4
MA 228,200,44
TR 216,35,32768
MA 228,204,60
TR 218,35,36864
MA 196,204,56
XL 16,5,4,50,0
MA 196,200,40
MA 164,200,36
TR 220,35,40960
MA 164,204,52
TR 222,35,45056
MA 132,204,48
MA 132,200,32
WL 4
MA 136,208,32
MA 136,212,48
MA 168,212,52
XL 20,5,4,50,128
MA 168,208,36
s_waitcnt vmcnt(31) lgkmcnt(0)
s_barrier
buffer_atomic_add v21, v18, s[4:7], s80 offen offset:1792
MA 200,208,40
TR 192,28,0
MA 200,212,56
TR 194,28,4096
MA 232,212,60
XL 24,5,4,50,256
TR 196,28,8192
MA 232,208,44
TR 198,28,12288
MA 236,216,44
TR 200,29,0
MA 236,220,60
TR 202,29,4096
MA 204,220,56
XL 28,5,4,50,384
MA 204,216,40
s_add_u32 s50, s50, 4096
MA 172,216,36
TR 204,29,8192
MA 172,220,52
TR 206,29,12288
MA 140,220,48
MA 140,216,32
s_waitcnt vmcnt(26) lgkmcnt(4)
MA 144,192,128
TR 208,30,0
MA 144,196,144
s_add_u32 m0, s48, 98304
TR 210,30,4096
MA 176,196,148
DM 8,32,52,0
MA 176,192,132
MA 208,192,136
TR 212,30,8192
MA 208,196,152
TR 214,30,12288
MA 240,196,156
DM 9,32,52,1024
MA 240,192,140
WL 4
MA 244,200,140
TR 216,31,0
MA 244,204,156
TR 218,31,4096
MA 212,204,152
DM 10,32,52,2048
MA 212,200,136
MA 180,200,132
TR 220,31,8192
MA 180,204,148
TR 222,31,12288
MA 148,204,144
MA 148,200,128
WL 4
MA 152,208,128
TR 192,24,0
MA 152,212,144
TR 194,24,4096
MA 184,212,148
DM 11,32,52,3072
MA 184,208,132
s_add_u32 s52, s52, 131072
MA 216,208,136
TR 196,24,8192
MA 216,212,152
TR 198,24,12288
MA 248,212,156
XL 32,5,4,50,0
MA 248,208,140
WL 4
MA 252,216,140
TR 200,25,0
MA 252,220,156
TR 202,25,4096
MA 220,220,152
XL 36,5,4,50,128
MA 220,216,136
MA 188,216,132
TR 204,25,8192
MA 188,220,148
TR 206,25,12288
MA 156,220,144
MA 156,216,128
WL 4
MA 128,192,128
TR 208,26,0
MA 128,196,144
TR 210,26,4096
MA 160,196,148
XL 40,5,4,50,256
MA 160,192,132
MA 192,192,136
TR 212,26,8192
MA 192,196,152
TR 214,26,12288
MA 224,196,156
XL 44,5,4,50,384
MA 224,192,140
s_add_u32 s50, s50, 4096
WL 4
MA 228,200,140
TR 216,27,0
MA 228,204,156
TR 218,27,4096
MA 196,204,152
XL 48,5,4,50,0
MA 196,200,136
MA 164,200,132
TR 220,27,8192
MA 164,204,148
TR 222,27,12288
MA 132,204,144
MA 132,200,128
WL 4
MA 136,208,128
MA 136,212,144
MA 168,212,148
XL 52,5,4,50,128
MA 168,208,132
s_waitcnt vmcnt(32) lgkmcnt(0)
s_barrier
MA 200,208,136
TR 192,28,32768
MA 200,212,152
TR 194,28,36864
MA 232,212,156
XL 56,5,4,50,256
TR 196,28,40960
MA 232,208,140
TR 198,28,45056
MA 236,216,140
TR 200,29,32768
MA 236,220,156
TR 202,29,36864
MA 204,220,152
XL 60,5,4,50,384
MA 204,216,136
s_add_u32 s50, s50, 4096
MA 172,216,132
TR 204,29,40960
MA 172,220,148
TR 206,29,45056
MA 140,220,144
MA 140,216,128
s_waitcnt vmcnt(26) lgkmcnt(4)
MA 144,192,160
TR 208,30,32768
MA 144,196,176
s_add_u32 m0, s48, 0
TR 210,30,36864
MA 176,196,180
DM 8,32,52,0
MA 176,192,164
MA 208,192,168
TR 212,30,40960
MA 208,196,184
TR 214,30,45056
MA 240,196,188
DM 9,32,52,1024
MA 240,192,172
WL 4
MA 244,200,172
TR 216,31,32768
MA 244,204,188
TR 218,31,36864
MA 212,204,184
DM 10,32,52,2048
MA 212,200,168
MA 180,200,164
TR 220,31,40960
MA 180,204,180
TR 222,31,45056
MA 148,204,176
MA 148,200,160
WL 4
MA 152,208,160
TR 192,24,32768
MA 152,212,176
TR 194,24,36864
MA 184,212,180
DM 11,32,52,3072
MA 184,208,164
s_add_u32 s52, s52, 131072
MA 216,208,168
TR 196,24,40960
MA 216,212,184
TR 198,24,45056
MA 248,212,188
XL 128,5,4,50,0
MA 248,208,172
WL 4
MA 252,216,172
TR 200,25,32768
MA 252,220,188
TR 202,25,36864
MA 220,220,184
XL 132,5,4,50,128
MA 220,216,168
MA 188,216,164
TR 204,25,40960
MA 188,220,180
TR 206,25,45056
MA 156,220,176
MA 156,216,160
WL 4
MA 128,192,160
TR 208,26,32768
MA 128,196,176
TR 210,26,36864
MA 160,196,180
XL 136,5,4,50,256
MA 160,192,164
MA 192,192,168
TR 212,26,40960
MA 192,196,184
TR 214,26,45056
MA 224,196,188
XL 140,5,4,50,384
MA 224,192,172
s_add_u32 s50, s50, 4096
WL 4
MA 228,200,172
TR 216,27,32768
MA 228,204,188
TR 218,27,36864
MA 196,204,184
XL 144,5,4,50,0
MA 196,200,168
MA 164,200,164
TR 220,27,40960
MA 164,204,180
TR 222,27,45056
MA 132,204,176
MA 132,200,160
WL 4
MA 136,208,160
MA 136,212,176
MA 168,212,180
XL 148,5,4,50,128
MA 168,208,164
s_waitcnt vmcnt(31) lgkmcnt(0)
s_barrier
MA 200,208,168
TR 192,36,0
MA 200,212,184
TR 194,36,4096
MA 232,212,188
XL 152,5,4,50,256
TR 196,36,8192
MA 232,208,172
TR 198,36,12288
MA 236,216,172
TR 200,37,0
MA 236,220,188
TR 202,37,4096
MA 204,220,184
XL 156,5,4,50,384
MA 204,216,168
s_add_u32 s50, s50, 4096
MA 172,216,164
TR 204,37,8192
MA 172,220,180
TR 206,37,12288
MA 140,220,176
MA 140,216,160
s_waitcnt vmcnt(24) lgkmcnt(4)
MA 144,192,0
TR 208,38,0
MA 144,196,16
s_add_u32 m0, s48, 32768
TR 210,38,4096
MA 176,196,20
DM 8,32,52,0
MA 176,192,4
MA 208,192,8
TR 212,38,8192
MA 208,196,24
TR 214,38,12288
MA 240,196,28
DM 9,32,52,1024
MA 240,192,12
WL 4
MA 244,200,12
TR 216,39,0
MA 244,204,28
TR 218,39,4096
MA 212,204,24
DM 10,32,52,2048
MA 212,200,8
MA 180,200,4
TR 220,39,8192
MA 180,204,20
TR 222,39,12288
MA 148,204,16
MA 148,200,0
WL 4
MA 152,208,0
TR 192,32,0
MA 152,212,16
TR 194,32,4096
MA 184,212,20
DM 11,32,52,3072
MA 184,208,4
s_add_u32 s52, s52, 131072
MA 216,208,8
TR 196,32,8192
MA 216,212,24
TR 198,32,12288
MA 248,212,28
XL 160,5,4,50,0
MA 248,208,12
WL 4
MA 252,216,12
TR 200,33,0
MA 252,220,28
TR 202,33,4096
MA 220,220,24
XL 164,5,4,50,128
MA 220,216,8
MA 188,216,4
TR 204,33,8192
MA 188,220,20
TR 206,33,12288
MA 156,220,16
MA 156,216,0
WL 4
MA 128,192,0
TR 208,34,0
MA 128,196,16
TR 210,34,4096
MA 160,196,20
XL 168,5,4,50,256
MA 160,192,4
MA 192,192,8
TR 212,34,8192
MA 192,196,24
TR 214,34,12288
MA 224,196,28
XL 172,5,4,50,384
MA 224,192,12
s_add_u32 s50, s50, 4096
WL 4
MA 228,200,12
TR 216,35,0
MA 228,204,28
TR 218,35,4096
MA 196,204,24
XL 176,5,4,50,0
MA 196,200,8
MA 164,200,4
TR 220,35,8192
MA 164,204,20
TR 222,35,12288
MA 132,204,16
MA 132,200,0
WL 4
MA 136,208,0
MA 136,212,16
MA 168,212,20
XL 180,5,4,50,128
MA 168,208,4
s_waitcnt vmcnt(30) lgkmcnt(0)
s_barrier
MA 200,208,8
TR 192,36,32768
MA 200,212,24
TR 194,36,36864
MA 232,212,28
XL 184,5,4,50,256
TR 196,36,40960
MA 232,208,12
TR 198,36,45056
MA 236,216,12
TR 200,37,32768
MA 236,220,28
TR 202,37,36864
MA 204,220,24
XL 188,5,4,50,384
MA 204,216,8
s_add_u32 s50, s50, 4096
MA 172,216,4
TR 204,37,40960
MA 172,220,20
TR 206,37,45056
MA 140,220,16
MA 140,216,0
s_waitcnt vmcnt(24) lgkmcnt(4)
MA 144,192,32
TR 208,38,32768
MA 144,196,48
s_add_u32 m0, s48, 65536
TR 210,38,36864
MA 176,196,52
DM 8,32,52,0
MA 176,192,36
MA 208,192,40
TR 212,38,40960
MA 208,196,56
TR 214,38,45056
MA 240,196,60
DM 9,32,52,1024
MA 240,192,44
WL 4
MA 244,200,44
TR 216,39,32768
MA 244,204,60
TR 218,39,36864
MA 212,204,56
DM 10,32,52,2048
MA 212,200,40
MA 180,200,36
TR 220,39,40960
MA 180,204,52
TR 222,39,45056
MA 148,204,48
MA 148,200,32
buffer_load_dword v61, v60, s[84:87], s77 offen
WL 4
MA 152,208,32
TR 192,32,32768
MA 152,212,48
TR 194,32,36864
MA 184,212,52
DM 11,32,52,3072
MA 184,208,36
s_add_u32 s52, s52, 131072
MA 216,208,40
TR 196,32,40960
MA 216,212,56
TR 198,32,45056
MA 248,212,60
XL 0,5,4,50,0
MA 248,208,44
WL 4
MA 252,216,44
TR 200,33,32768
MA 252,220,60
TR 202,33,36864
MA 220,220,56
XL 4,5,4,50,128
MA 220,216,40
MA 188,216,36
TR 204,33,40960
MA 188,220,52
TR 206,33,45056
MA 156,220,48
MA 156,216,32
WL 4
MA 128,192,32
TR 208,34,32768
MA 128,196,48
TR 210,34,36864
MA 160,196,52
XL 8,5,4,50,256
MA 160,192,36
MA 192,192,40
TR 212,34,40960
MA 192,196,56
TR 214,34,45056
MA 224,196,60
XL 12,5,4,50,384
MA 224,192,44
s_add_u32 s50, s50, 4096
buffer_load_dword v17, v22, s[4:7], s80 offen offset:1792 sc1
WL 4
MA 228,200,44
TR 216,35,32768
MA 228,204,60
TR 218,35,36864
MA 196,204,56
XL 16,5,4,50,0
MA 196,200,40
MA 164,200,36
TR 220,35,40960
MA 164,204,52
TR 222,35,45056
MA 132,204,48
MA 132,200,32
WL 4
MA 136,208,32
MA 136,212,48
MA 168,212,52
XL 20,5,4,50,128
MA 168,208,36
s_waitcnt vmcnt(32) lgkmcnt(0)
s_barrier
MA 200,208,40
TR 192,28,0
MA 200,212,56
TR 194,28,4096
MA 232,212,60
XL 24,5,4,50,256
TR 196,28,8192
MA 232,208,44
TR 198,28,12288
MA 236,216,44
TR 200,29,0
MA 236,220,60
TR 202,29,4096
MA 204,220,56
XL 28,5,4,50,384
MA 204,216,40
s_add_u32 s50, s50, 4096
MA 172,216,36
TR 204,29,8192
MA 172,220,52
TR 206,29,12288
MA 140,220,48
MA 140,216,32
s_waitcnt vmcnt(26) lgkmcnt(4)
MA 144,192,128
TR 208,30,0
MA 144,196,144
s_add_u32 m0, s48, 98304
TR 210,30,4096
MA 176,196,148
DM 8,32,52,0
MA 176,192,132
s_mul_i32 s62, s97, 8
MA 208,192,136
TR 212,30,8192
MA 208,196,152
TR 214,30,12288
MA 240,196,156
DM 9,32,52,1024
MA 240,192,140
s_add_u32 s62, s62, 24
WL 4
MA 244,200,140
TR 216,31,0
MA 244,204,156
TR 218,31,4096
MA 212,204,152
DM 10,32,52,2048
MA 212,200,136
s_lshl_b32 s63, s62, 12
MA 180,200,132
TR 220,31,8192
MA 180,204,148
TR 222,31,12288
MA 148,204,144
MA 148,200,128
s_lshl_b32 s62, s62, 16
WL 4
MA 152,208,128
TR 192,24,0
MA 152,212,144
TR 194,24,4096
MA 184,212,148
DM 11,32,52,3072
MA 184,208,132
s_add_u32 s52, s52, 131072
MA 216,208,136
TR 196,24,8192
MA 216,212,152
TR 198,24,12288
MA 248,212,156
XL 32,5,4,50,0
MA 248,208,140
WL 4
MA 252,216,140
TR 200,25,0
MA 252,220,156
TR 202,25,4096
MA 220,220,152
XL 36,5,4,50,128
MA 220,216,136
MA 188,216,132
TR 204,25,8192
MA 188,220,148
TR 206,25,12288
MA 156,220,144
MA 156,216,128
WL 4
MA 128,192,128
TR 208,26,0
MA 128,196,144
TR 210,26,4096
MA 160,196,148
XL 40,5,4,50,256
MA 160,192,132
MA 192,192,136
TR 212,26,8192
MA 192,196,152
TR 214,26,12288
MA 224,196,156
XL 44,5,4,50,384
MA 224,192,140
s_add_u32 s50, s50, 4096
WL 4
MA 228,200,140
TR 216,27,0
MA 228,204,156
TR 218,27,4096
MA 196,204,152
XL 48,5,4,50,0
MA 196,200,136
MA 164,200,132
TR 220,27,8192
MA 164,204,148
TR 222,27,12288
MA 132,204,144
MA 132,200,128
WL 4
MA 136,208,128
MA 136,212,144
MA 168,212,148
XL 52,5,4,50,128
MA 168,208,132
WV 14
v_cmp_gt_u32 s[68:69], 16, v17
s_nop 0
s_and_b64 s[68:69], s[68:69], s[74:75]
s_cbranch_scc1 t2_slow43
t2_back44:
WL 0
s_barrier
MA 200,208,136
TR 192,28,32768
MA 200,212,152
TR 194,28,36864
MA 232,212,156
XL 56,5,4,50,256
TR 196,28,40960
MA 232,208,140
TR 198,28,45056
MA 236,216,140
TR 200,29,32768
MA 236,220,156
TR 202,29,36864
MA 204,220,152
XL 60,5,4,50,384
MA 204,216,136
s_add_u32 s50, s50, 4096
MA 172,216,132
TR 204,29,40960
MA 172,220,148
TR 206,29,45056
MA 140,220,144
MA 140,216,128
WL 4
MA 144,192,160
TR 208,30,32768
s_add_u32 s50, s50, s63
s_add_u32 s52, s52, s62
MA 144,196,176
s_add_u32 m0, s48, 0
TR 210,30,36864
MA 176,196,180
DM 8,32,52,0
MA 176,192,164
MA 208,192,168
TR 212,30,40960
MA 208,196,184
TR 214,30,45056
MA 240,196,188
DM 9,32,52,1024
MA 240,192,172
WL 4
MA 244,200,172
TR 216,31,32768
MA 244,204,188
TR 218,31,36864
MA 212,204,184
DM 10,32,52,2048
MA 212,200,168
MA 180,200,164
TR 220,31,40960
MA 180,204,180
TR 222,31,45056
MA 148,204,176
MA 148,200,160
WL 4
MA 152,208,160
TR 192,24,32768
MA 152,212,176
TR 194,24,36864
MA 184,212,180
DM 11,32,52,3072
MA 184,208,164
s_add_u32 s52, s52, 131072
MA 216,208,168
TR 196,24,40960
MA 216,212,184
TR 198,24,45056
MA 248,212,188
XL 128,5,4,50,0
MA 248,208,172
WL 4
MA 252,216,172
TR 200,25,32768
MA 252,220,188
TR 202,25,36864
MA 220,220,184
XL 132,5,4,50,128
MA 220,216,168
MA 188,216,164
TR 204,25,40960
MA 188,220,180
TR 206,25,45056
MA 156,220,176
MA 156,216,160
WL 4
MA 128,192,160
TR 208,26,32768
MA 128,196,176
TR 210,26,36864
MA 160,196,180
XL 136,5,4,50,256
MA 160,192,164
MA 192,192,168
TR 212,26,40960
MA 192,196,184
TR 214,26,45056
MA 224,196,188
XL 140,5,4,50,384
MA 224,192,172
s_add_u32 s50, s50, 4096
WL 4
MA 228,200,172
TR 216,27,32768
MA 228,204,188
TR 218,27,36864
MA 196,204,184
XL 144,5,4,50,0
MA 196,200,168
MA 164,200,164
TR 220,27,40960
MA 164,204,180
TR 222,27,45056
MA 132,204,176
MA 132,200,160
WL 4
MA 136,208,160
MA 136,212,176
MA 168,212,180
XL 148,5,4,50,128
MA 168,208,164
WL 0
s_barrier
MA 200,208,168
TR 192,36,0
MA 200,212,184
TR 194,36,4096
MA 232,212,188
XL 152,5,4,50,256
TR 196,36,8192
MA 232,208,172
TR 198,36,12288
MA 236,216,172
TR 200,37,0
MA 236,220,188
TR 202,37,4096
MA 204,220,184
XL 156,5,4,50,384
MA 204,216,168
s_add_u32 s50, s50, 4096
MA 172,216,164
TR 204,37,8192
MA 172,220,180
TR 206,37,12288
MA 140,220,176
MA 140,216,160
s_waitcnt vmcnt(24) lgkmcnt(4)
MA 144,192,0
TR 208,38,0
MA 144,196,16
s_add_u32 m0, s48, 32768
TR 210,38,4096
MA 176,196,20
DM 8,32,52,0
MA 176,192,4
MA 208,192,8
TR 212,38,8192
MA 208,196,24
TR 214,38,12288
MA 240,196,28
DM 9,32,52,1024
MA 240,192,12
WL 4
MA 244,200,12
TR 216,39,0
MA 244,204,28
TR 218,39,4096
MA 212,204,24
DM 10,32,52,2048
MA 212,200,8
MA 180,200,4
TR 220,39,8192
MA 180,204,20
TR 222,39,12288
MA 148,204,16
MA 148,200,0
WL 4
MA 152,208,0
TR 192,32,0
MA 152,212,16
TR 194,32,4096
MA 184,212,20
DM 11,32,52,3072
MA 184,208,4
s_add_u32 s52, s52, 131072
MA 216,208,8
TR 196,32,8192
MA 216,212,24
TR 198,32,12288
MA 248,212,28
XL 160,5,4,50,0
MA 248,208,12
WL 4
MA 252,216,12
TR 200,33,0
MA 252,220,28
TR 202,33,4096
MA 220,220,24
XL 164,5,4,50,128
MA 220,216,8
MA 188,216,4
TR 204,33,8192
MA 188,220,20
TR 206,33,12288
MA 156,220,16
MA 156,216,0
WL 4
MA 128,192,0
TR 208,34,0
MA 128,196,16
TR 210,34,4096
MA 160,196,20
XL 168,5,4,50,256
MA 160,192,4
MA 192,192,8
TR 212,34,8192
MA 192,196,24
TR 214,34,12288
MA 224,196,28
XL 172,5,4,50,384
MA 224,192,12
s_add_u32 s50, s50, 4096
WL 4
MA 228,200,12
TR 216,35,0
MA 228,204,28
TR 218,35,4096
MA 196,204,24
XL 176,5,4,50,0
MA 196,200,8
MA 164,200,4
TR 220,35,8192
MA 164,204,20
TR 222,35,12288
MA 132,204,16
MA 132,200,0
WL 4
MA 136,208,0
MA 136,212,16
MA 168,212,20
XL 180,5,4,50,128
MA 168,208,4
s_waitcnt vmcnt(30) lgkmcnt(0)
s_barrier
MA 200,208,8
TR 192,36,32768
MA 200,212,24
TR 194,36,36864
MA 232,212,28
XL 184,5,4,50,256
TR 196,36,40960
MA 232,208,12
TR 198,36,45056
MA 236,216,12
TR 200,37,32768
MA 236,220,28
TR 202,37,36864
MA 204,220,24
XL 188,5,4,50,384
MA 204,216,8
s_add_u32 s50, s50, 4096
MA 172,216,4
TR 204,37,40960
MA 172,220,20
TR 206,37,45056
MA 140,220,16
MA 140,216,0
s_waitcnt vmcnt(24) lgkmcnt(4)
MA 144,192,32
TR 208,38,32768
MA 144,196,48
s_add_u32 m0, s48, 65536
TR 210,38,36864
MA 176,196,52
DM 8,32,52,0
MA 176,192,36
MA 208,192,40
TR 212,38,40960
MA 208,196,56
TR 214,38,45056
MA 240,196,60
DM 9,32,52,1024
MA 240,192,44
WL 4
MA 244,200,44
TR 216,39,32768
MA 244,204,60
TR 218,39,36864
MA 212,204,56
DM 10,32,52,2048
MA 212,200,40
MA 180,200,36
TR 220,39,40960
MA 180,204,52
TR 222,39,45056
MA 148,204,48
MA 148,200,32
buffer_load_dword v61, v60, s[84:87], s77 offen
WL 4
MA 152,208,32
TR 192,32,32768
MA 152,212,48
TR 194,32,36864
MA 184,212,52
DM 11,32,52,3072
MA 184,208,36
s_add_u32 s52, s52, 131072
MA 216,208,40
TR 196,32,40960
MA 216,212,56
TR 198,32,45056
MA 248,212,60
XL 0,5,4,50,0
MA 248,208,44
WL 4
MA 252,216,44
TR 200,33,32768
MA 252,220,60
TR 202,33,36864
MA 220,220,56
XL 4,5,4,50,128
MA 220,216,40
MA 188,216,36
TR 204,33,40960
MA 188,220,52
TR 206,33,45056
MA 156,220,48
MA 156,216,32
WL 4
MA 128,192,32
TR 208,34,32768
MA 128,196,48
TR 210,34,36864
MA 160,196,52
XL 8,5,4,50,256
MA 160,192,36
MA 192,192,40
TR 212,34,40960
MA 192,196,56
TR 214,34,45056
MA 224,196,60
XL 12,5,4,50,384
MA 224,192,44
s_add_u32 s50, s50, 4096
WL 4
MA 228,200,44
TR 216,35,32768
MA 228,204,60
TR 218,35,36864
MA 196,204,56
XL 16,5,4,50,0
MA 196,200,40
MA 164,200,36
TR 220,35,40960
MA 164,204,52
TR 222,35,45056
MA 132,204,48
MA 132,200,32
WL 4
MA 136,208,32
MA 136,212,48
MA 168,212,52
XL 20,5,4,50,128
MA 168,208,36
s_waitcnt vmcnt(31) lgkmcnt(0)
s_barrier
MA 200,208,40
TR 192,28,0
MA 200,212,56
TR 194,28,4096
MA 232,212,60
XL 24,5,4,50,256
TR 196,28,8192
MA 232,208,44
TR 198,28,12288
MA 236,216,44
TR 200,29,0
MA 236,220,60
TR 202,29,4096
MA 204,220,56
XL 28,5,4,50,384
MA 204,216,40
s_add_u32 s50, s50, 4096
MA 172,216,36
TR 204,29,8192
MA 172,220,52
TR 206,29,12288
MA 140,220,48
MA 140,216,32
s_mov_b32 s47, 2
t2_L39:
s_waitcnt vmcnt(25) lgkmcnt(4)
MA 144,192,128
TR 208,30,0
MA 144,196,144
s_add_u32 m0, s48, 98304
TR 210,30,4096
MA 176,196,148
DM 8,32,52,0
MA 176,192,132
MA 208,192,136
TR 212,30,8192
MA 208,196,152
TR 214,30,12288
MA 240,196,156
DM 9,32,52,1024
MA 240,192,140
WL 4
MA 244,200,140
TR 216,31,0
MA 244,204,156
TR 218,31,4096
MA 212,204,152
DM 10,32,52,2048
MA 212,200,136
MA 180,200,132
TR 220,31,8192
MA 180,204,148
TR 222,31,12288
MA 148,204,144
MA 148,200,128
WL 4
MA 152,208,128
TR 192,24,0
MA 152,212,144
TR 194,24,4096
MA 184,212,148
DM 11,32,52,3072
MA 184,208,132
s_add_u32 s52, s52, 131072
MA 216,208,136
TR 196,24,8192
MA 216,212,152
TR 198,24,12288
MA 248,212,156
XL 32,5,4,50,0
MA 248,208,140
WL 4
MA 252,216,140
TR 200,25,0
MA 252,220,156
TR 202,25,4096
MA 220,220,152
XL 36,5,4,50,128
MA 220,216,136
MA 188,216,132
TR 204,25,8192
MA 188,220,148
TR 206,25,12288
MA 156,220,144
MA 156,216,128
WL 4
MA 128,192,128
TR 208,26,0
MA 128,196,144
TR 210,26,4096
MA 160,196,148
XL 40,5,4,50,256
MA 160,192,132
MA 192,192,136
TR 212,26,8192
MA 192,196,152
TR 214,26,12288
MA 224,196,156
XL 44,5,4,50,384
MA 224,192,140
s_add_u32 s50, s50, 4096
WL 4
MA 228,200,140
TR 216,27,0
MA 228,204,156
TR 218,27,4096
MA 196,204,152
XL 48,5,4,50,0
MA 196,200,136
MA 164,200,132
TR 220,27,8192
MA 164,204,148
TR 222,27,12288
MA 132,204,144
MA 132,200,128
WL 4
MA 136,208,128
MA 136,212,144
MA 168,212,148
XL 52,5,4,50,128
MA 168,208,132
s_waitcnt vmcnt(31) lgkmcnt(0)
s_barrier
MA 200,208,136
TR 192,28,32768
MA 200,212,152
TR 194,28,36864
MA 232,212,156
XL 56,5,4,50,256
TR 196,28,40960
MA 232,208,140
TR 198,28,45056
MA 236,216,140
TR 200,29,32768
MA 236,220,156
TR 202,29,36864
MA 204,220,152
XL 60,5,4,50,384
MA 204,216,136
s_add_u32 s50, s50, 4096
MA 172,216,132
TR 204,29,40960
MA 172,220,148
TR 206,29,45056
MA 140,220,144
MA 140,216,128
s_waitcnt vmcnt(25) lgkmcnt(4)
MA 144,192,160
TR 208,30,32768
MA 144,196,176
s_add_u32 m0, s48, 0
TR 210,30,36864
MA 176,196,180
DM 8,32,52,0
MA 176,192,164
MA 208,192,168
TR 212,30,40960
MA 208,196,184
TR 214,30,45056
MA 240,196,188
DM 9,32,52,1024
MA 240,192,172
WL 4
MA 244,200,172
TR 216,31,32768
MA 244,204,188
TR 218,31,36864
MA 212,204,184
DM 10,32,52,2048
MA 212,200,168
MA 180,200,164
TR 220,31,40960
MA 180,204,180
TR 222,31,45056
MA 148,204,176
MA 148,200,160
WL 4
MA 152,208,160
TR 192,24,32768
MA 152,212,176
TR 194,24,36864
MA 184,212,180
DM 11,32,52,3072
MA 184,208,164
s_add_u32 s52, s52, 131072
MA 216,208,168
TR 196,24,40960
MA 216,212,184
TR 198,24,45056
MA 248,212,188
XL 128,5,4,50,0
MA 248,208,172
WL 4
MA 252,216,172
TR 200,25,32768
MA 252,220,188
TR 202,25,36864
MA 220,220,184
XL 132,5,4,50,128
MA 220,216,168
MA 188,216,164
TR 204,25,40960
MA 188,220,180
TR 206,25,45056
MA 156,220,176
MA 156,216,160
WL 4
MA 128,192,160
TR 208,26,32768
MA 128,196,176
TR 210,26,36864
MA 160,196,180
XL 136,5,4,50,256
MA 160,192,164
MA 192,192,168
TR 212,26,40960
MA 192,196,184
TR 214,26,45056
MA 224,196,188
XL 140,5,4,50,384
MA 224,192,172
s_add_u32 s50, s50, 4096
WL 4
MA 228,200,172
TR 216,27,32768
MA 228,204,188
TR 218,27,36864
MA 196,204,184
XL 144,5,4,50,0
MA 196,200,168
MA 164,200,164
TR 220,27,40960
MA 164,204,180
TR 222,27,45056
MA 132,204,176
MA 132,200,160
WL 4
MA 136,208,160
MA 136,212,176
MA 168,212,180
XL 148,5,4,50,128
MA 168,208,164
s_waitcnt vmcnt(30) lgkmcnt(0)
s_barrier
MA 200,208,168
TR 192,36,0
MA 200,212,184
TR 194,36,4096
MA 232,212,188
XL 152,5,4,50,256
TR 196,36,8192
MA 232,208,172
TR 198,36,12288
MA 236,216,172
TR 200,37,0
MA 236,220,188
TR 202,37,4096
MA 204,220,184
XL 156,5,4,50,384
MA 204,216,168
s_add_u32 s50, s50, 4096
MA 172,216,164
TR 204,37,8192
MA 172,220,180
TR 206,37,12288
MA 140,220,176
MA 140,216,160
s_waitcnt vmcnt(24) lgkmcnt(4)
MA 144,192,0
TR 208,38,0
MA 144,196,16
s_add_u32 m0, s48, 32768
TR 210,38,4096
MA 176,196,20
DM 8,32,52,0
MA 176,192,4
MA 208,192,8
TR 212,38,8192
MA 208,196,24
TR 214,38,12288
MA 240,196,28
DM 9,32,52,1024
MA 240,192,12
WL 4
MA 244,200,12
TR 216,39,0
MA 244,204,28
TR 218,39,4096
MA 212,204,24
DM 10,32,52,2048
MA 212,200,8
MA 180,200,4
TR 220,39,8192
MA 180,204,20
TR 222,39,12288
MA 148,204,16
MA 148,200,0
WL 4
MA 152,208,0
TR 192,32,0
MA 152,212,16
TR 194,32,4096
MA 184,212,20
DM 11,32,52,3072
MA 184,208,4
s_add_u32 s52, s52, 131072
MA 216,208,8
TR 196,32,8192
MA 216,212,24
TR 198,32,12288
MA 248,212,28
XL 160,5,4,50,0
MA 248,208,12
WL 4
MA 252,216,12
TR 200,33,0
MA 252,220,28
TR 202,33,4096
MA 220,220,24
XL 164,5,4,50,128
MA 220,216,8
MA 188,216,4
TR 204,33,8192
MA 188,220,20
TR 206,33,12288
MA 156,220,16
MA 156,216,0
WL 4
MA 128,192,0
TR 208,34,0
MA 128,196,16
TR 210,34,4096
MA 160,196,20
XL 168,5,4,50,256
MA 160,192,4
MA 192,192,8
TR 212,34,8192
MA 192,196,24
TR 214,34,12288
MA 224,196,28
XL 172,5,4,50,384
MA 224,192,12
s_add_u32 s50, s50, 4096
WL 4
MA 228,200,12
TR 216,35,0
MA 228,204,28
TR 218,35,4096
MA 196,204,24
XL 176,5,4,50,0
MA 196,200,8
MA 164,200,4
TR 220,35,8192
MA 164,204,20
TR 222,35,12288
MA 132,204,16
MA 132,200,0
WL 4
MA 136,208,0
MA 136,212,16
MA 168,212,20
XL 180,5,4,50,128
MA 168,208,4
s_waitcnt vmcnt(30) lgkmcnt(0)
s_barrier
MA 200,208,8
TR 192,36,32768
MA 200,212,24
TR 194,36,36864
MA 232,212,28
XL 184,5,4,50,256
TR 196,36,40960
MA 232,208,12
TR 198,36,45056
MA 236,216,12
TR 200,37,32768
MA 236,220,28
TR 202,37,36864
MA 204,220,24
XL 188,5,4,50,384
MA 204,216,8
s_add_u32 s50, s50, 4096
MA 172,216,4
TR 204,37,40960
MA 172,220,20
TR 206,37,45056
MA 140,220,16
MA 140,216,0
s_waitcnt vmcnt(24) lgkmcnt(4)
MA 144,192,32
TR 208,38,32768
MA 144,196,48
s_add_u32 m0, s48, 65536
TR 210,38,36864
MA 176,196,52
DM 8,32,52,0
MA 176,192,36
MA 208,192,40
TR 212,38,40960
MA 208,196,56
TR 214,38,45056
MA 240,196,60
DM 9,32,52,1024
MA 240,192,44
WL 4
MA 244,200,44
TR 216,39,32768
MA 244,204,60
TR 218,39,36864
MA 212,204,56
DM 10,32,52,2048
MA 212,200,40
MA 180,200,36
TR 220,39,40960
MA 180,204,52
TR 222,39,45056
MA 148,204,48
MA 148,200,32
buffer_load_dword v61, v60, s[84:87], s77 offen
WL 4
MA 152,208,32
TR 192,32,32768
MA 152,212,48
TR 194,32,36864
MA 184,212,52
DM 11,32,52,3072
MA 184,208,36
s_add_u32 s52, s52, 131072
MA 216,208,40
TR 196,32,40960
MA 216,212,56
TR 198,32,45056
MA 248,212,60
XL 0,5,4,50,0
MA 248,208,44
WL 4
MA 252,216,44
TR 200,33,32768
MA 252,220,60
TR 202,33,36864
MA 220,220,56
XL 4,5,4,50,128
MA 220,216,40
MA 188,216,36
TR 204,33,40960
MA 188,220,52
TR 206,33,45056
MA 156,220,48
MA 156,216,32
WL 4
MA 128,192,32
TR 208,34,32768
MA 128,196,48
TR 210,34,36864
MA 160,196,52
XL 8,5,4,50,256
MA 160,192,36
MA 192,192,40
TR 212,34,40960
MA 192,196,56
TR 214,34,45056
MA 224,196,60
XL 12,5,4,50,384
MA 224,192,44
s_add_u32 s50, s50, 4096
WL 4
MA 228,200,44
TR 216,35,32768
MA 228,204,60
TR 218,35,36864
MA 196,204,56
XL 16,5,4,50,0
MA 196,200,40
MA 164,200,36
TR 220,35,40960
MA 164,204,52
TR 222,35,45056
MA 132,204,48
MA 132,200,32
WL 4
MA 136,208,32
MA 136,212,48
MA 168,212,52
XL 20,5,4,50,128
MA 168,208,36
s_waitcnt vmcnt(31) lgkmcnt(0)
s_barrier
MA 200,208,40
TR 192,28,0
MA 200,212,56
TR 194,28,4096
MA 232,212,60
XL 24,5,4,50,256
TR 196,28,8192
MA 232,208,44
TR 198,28,12288
MA 236,216,44
TR 200,29,0
MA 236,220,60
TR 202,29,4096
MA 204,220,56
XL 28,5,4,50,384
MA 204,216,40
s_add_u32 s50, s50, 4096
MA 172,216,36
TR 204,29,8192
MA 172,220,52
TR 206,29,12288
MA 140,220,48
MA 140,216,32
s_sub_u32 s47, s47, 1
s_cbranch_scc0 t2_L39
s_waitcnt vmcnt(25) lgkmcnt(4)
MA 144,192,128
TR 208,30,0
MA 144,196,144
s_add_u32 m0, s48, 98304
TR 210,30,4096
MA 176,196,148
DM 8,32,52,0
MA 176,192,132
s_lshl_b32 s83, s58, 2
s_add_u32 s83, s83, s44
s_lshl_b32 s83, s83, 17
MA 208,192,136
TR 212,30,8192
MA 208,196,152
TR 214,30,12288
MA 240,196,156
DM 9,32,52,1024
MA 240,192,140
s_lshl_b32 s65, s96, 14
s_add_u32 s83, s83, s65
s_add_u32 s83, s83, 4194304
WL 4
MA 244,200,140
TR 216,31,0
MA 244,204,156
TR 218,31,4096
MA 212,204,152
DM 10,32,52,2048
MA 212,200,136
s_xor_b32 s65, s97, 0
s_lshl_b32 s65, s65, 13
s_add_u32 s83, s83, s65
MA 180,200,132
TR 220,31,8192
MA 180,204,148
TR 222,31,12288
MA 148,204,144
MA 148,200,128
s_lshl_b32 s88, s58, 2
s_add_u32 s88, s88, s44
s_lshl_b32 s88, s88, 17
WL 4
MA 152,208,128
MA 152,212,144
MA 184,212,148
DM 11,32,52,3072
MA 184,208,132
s_add_u32 s52, s52, 131072
s_lshl_b32 s65, s96, 14
s_add_u32 s88, s88, s65
s_add_u32 s88, s88, 16777216
WV 25
s_barrier
MA 216,208,136
TR 192,28,32768
MA 216,212,152
TR 194,28,36864
MA 248,212,156
XL 32,5,4,50,0
TR 196,28,40960
MA 248,208,140
TR 198,28,45056
s_xor_b32 s65, s97, 0
s_lshl_b32 s65, s65, 13
s_add_u32 s88, s88, s65
WL 4
MA 252,216,140
TR 200,29,32768
MA 252,220,156
TR 202,29,36864
MA 220,220,152
XL 36,5,4,50,128
MA 220,216,136
s_lshl_b32 s89, s58, 2
s_add_u32 s89, s89, s44
s_lshl_b32 s89, s89, 17
MA 188,216,132
TR 204,29,40960
MA 188,220,148
TR 206,29,45056
MA 156,220,144
MA 156,216,128
s_lshl_b32 s65, s96, 14
s_add_u32 s89, s89, s65
s_add_u32 s89, s89, 8388608
s_waitcnt vmcnt(19) lgkmcnt(4)
MA 144,192,160
TR 208,30,32768
MA 144,196,176
TR 210,30,36864
MA 176,196,180
XL 40,5,4,50,256
MA 176,192,164
s_xor_b32 s65, s97, 0
s_lshl_b32 s65, s65, 13
s_add_u32 s89, s89, s65
MA 208,192,168
TR 212,30,40960
MA 208,196,184
TR 214,30,45056
MA 240,196,188
XL 44,5,4,50,384
MA 240,192,172
s_add_u32 s50, s50, 4096
s_lshl_b32 s78, s58, 3
s_add_u32 s78, s78, s96
s_lshl_b32 s78, s78, 8
WL 4
MA 244,200,172
TR 216,31,32768
MA 244,204,188
TR 218,31,36864
MA 212,204,184
XL 48,5,4,50,0
MA 212,200,168
s_add_u32 s78, s78, 22052864
s_lshl_b32 s98, s58, 3
s_add_u32 s98, s98, s96
MA 180,200,164
TR 220,31,40960
MA 180,204,180
TR 222,31,45056
MA 148,204,176
MA 148,200,160
s_lshl_b32 s98, s98, 8
s_add_u32 s98, s98, 22069248
v_add_u32 v59, 4096, v5
WL 4
MA 152,208,160
MA 152,212,176
MA 184,212,180
XL 52,5,4,50,128
MA 184,208,164
s_lshl_b32 s61, s58, 2
s_add_u32 s61, s61, s44
s_lshl_b32 s61, s61, 17
WV 18
s_barrier
MA 216,208,168
TR 192,36,0
MA 216,212,184
TR 194,36,4096
MA 248,212,188
XL 56,5,4,50,256
TR 196,36,8192
MA 248,208,172
TR 198,36,12288
s_lshl_b32 s65, s96, 8
s_add_u32 s61, s61, s65
s_lshl_b32 s65, s97, 7
WL 4
MA 252,216,172
TR 200,37,0
MA 252,220,188
TR 202,37,4096
MA 220,220,184
XL 60,5,4,50,384
MA 220,216,168
s_add_u32 s50, s50, 4096
s_add_u32 s61, s61, s65
v_lshrrev_b32 v1, 1, v19
v_and_b32 v2, 7, v0
MA 188,216,164
TR 204,37,8192
MA 188,220,180
TR 206,37,12288
MA 156,220,176
MA 156,216,160
v_xor_b32 v1, v1, v2
v_lshlrev_b32 v1, 4, v1
v_and_b32 v2, 1, v19
s_waitcnt vmcnt(12) lgkmcnt(4)
MA 144,192,0
TR 208,38,0
MA 144,196,16
TR 210,38,4096
MA 176,196,20
MA 176,192,4
v_lshl_add_u32 v1, v2, 3, v1
v_and_b32 v2, 15, v0
v_lshl_add_u32 v1, v2, 7, v1
MA 208,192,8
TR 212,38,8192
MA 208,196,24
TR 214,38,12288
MA 240,196,28
MA 240,192,12
s_add_u32 s65, s49, 131072
v_add_u32 v1, s65, v1
v_lshl_add_u32 v7, v0, 4, s65
WL 4
MA 244,200,12
TR 216,39,0
MA 244,204,28
TR 218,39,4096
MA 212,204,24
MA 212,200,8
v_xor_b32 v2, 32, v1
v_xor_b32 v3, 64, v1
v_xor_b32 v4, 96, v1
MA 180,200,4
TR 220,39,8192
MA 180,204,20
TR 222,39,12288
MA 148,204,16
MA 148,200,0
s_lshl_b32 s60, s58, 2
s_add_u32 s60, s60, s44
s_lshl_b32 s60, s60, 17
WL 4
MA 152,208,0
MA 152,212,16
MA 184,212,20
MA 184,208,4
s_lshl_b32 s65, s96, 14
s_add_u32 s60, s60, s65
s_add_u32 s60, s60, 56623104
WV 8
s_barrier
MA 216,208,8
TR 192,36,32768
MA 216,212,24
TR 194,36,36864
MA 248,212,28
TR 196,36,40960
MA 248,208,12
TR 198,36,45056
s_xor_b32 s65, s97, 0
s_lshl_b32 s65, s65, 13
s_add_u32 s60, s60, s65
WL 4
MA 252,216,12
TR 200,37,32768
MA 252,220,28
TR 202,37,36864
MA 220,220,24
MA 220,216,8
buffer_load_dwordx4 v[96:99], v5, s[4:7], s60 offen offset:0 sc1
buffer_load_dwordx4 v[100:103], v59, s[4:7], s60 offen offset:0 sc1
buffer_load_dwordx4 v[104:107], v5, s[4:7], s60 offen offset:128 sc1
MA 188,216,4
TR 204,37,40960
MA 188,220,20
TR 206,37,45056
MA 156,220,16
MA 156,216,0
buffer_load_dwordx4 v[108:111], v59, s[4:7], s60 offen offset:128 sc1
buffer_load_dwordx4 v[112:115], v5, s[4:7], s60 offen offset:256 sc1
buffer_load_dwordx4 v[116:119], v59, s[4:7], s60 offen offset:256 sc1
s_waitcnt vmcnt(6) lgkmcnt(4)
MA 144,192,32
TR 208,38,32768
MA 144,196,48
TR 210,38,36864
MA 176,196,52
MA 176,192,36
buffer_load_dwordx4 v[120:123], v5, s[4:7], s60 offen offset:384 sc1
buffer_load_dwordx4 v[124:127], v59, s[4:7], s60 offen offset:384 sc1
s_lshl_b32 s60, s58, 2
MA 208,192,40
TR 212,38,40960
MA 208,196,56
TR 214,38,45056
MA 240,196,60
MA 240,192,44
s_add_u32 s60, s60, s44
s_lshl_b32 s60, s60, 17
s_lshl_b32 s65, s96, 14
WL 4
MA 244,200,44
TR 216,39,32768
MA 244,204,60
TR 218,39,36864
MA 212,204,56
MA 212,200,40
s_add_u32 s60, s60, s65
s_add_u32 s60, s60, 8388608
s_xor_b32 s65, s97, 1
MA 180,200,36
TR 220,39,40960
MA 180,204,52
TR 222,39,45056
MA 148,204,48
MA 148,200,32
s_lshl_b32 s65, s65, 13
s_add_u32 s60, s60, s65
WL 4
MA 152,208,32
TR 192,24,0
MA 152,212,48
TR 194,24,4096
MA 184,212,52
MA 184,208,36
MA 216,208,40
TR 196,24,8192
MA 216,212,56
TR 198,24,12288
MA 248,212,60
MA 248,208,44
WL 4
MA 252,216,44
TR 200,25,0
MA 252,220,60
TR 202,25,4096
MA 220,220,56
MA 220,216,40
MA 188,216,36
TR 204,25,8192
MA 188,220,52
TR 206,25,12288
MA 156,220,48
MA 156,216,32
WL 4
MA 128,192,128
TR 208,26,0
MA 128,196,144
TR 210,26,4096
MA 160,196,148
v_cvt_pk_bf16_f32 v8, v144, v145
MA 160,192,132
v_cvt_pk_bf16_f32 v9, v146, v147
MA 192,192,136
TR 212,26,8192
v_cvt_pk_bf16_f32 v10, v148, v149
MA 192,196,152
TR 214,26,12288
v_cvt_pk_bf16_f32 v11, v150, v151
MA 224,196,156
buffer_store_dwordx4 v[8:11], v5, s[4:7], s60 offen offset:0 sc1
MA 224,192,140
v_cvt_pk_bf16_f32 v12, v176, v177
WL 4
MA 228,200,140
TR 216,27,0
v_cvt_pk_bf16_f32 v13, v178, v179
MA 228,204,156
TR 218,27,4096
v_cvt_pk_bf16_f32 v14, v180, v181
MA 196,204,152
v_cvt_pk_bf16_f32 v15, v182, v183
MA 196,200,136
buffer_store_dwordx4 v[12:15], v5, s[4:7], s60 offen offset:128 sc1
MA 164,200,132
TR 220,27,8192
v_cvt_pk_bf16_f32 v8, v208, v209
MA 164,204,148
TR 222,27,12288
v_cvt_pk_bf16_f32 v9, v210, v211
MA 132,204,144
v_cvt_pk_bf16_f32 v10, v212, v213
MA 132,200,128
v_cvt_pk_bf16_f32 v11, v214, v215
WL 4
MA 136,208,128
TR 192,24,32768
buffer_store_dwordx4 v[8:11], v5, s[4:7], s60 offen offset:256 sc1
MA 136,212,144
TR 194,24,36864
v_cvt_pk_bf16_f32 v12, v240, v241
MA 168,212,148
v_cvt_pk_bf16_f32 v13, v242, v243
MA 168,208,132
v_cvt_pk_bf16_f32 v14, v244, v245
MA 200,208,136
TR 196,24,40960
v_cvt_pk_bf16_f32 v15, v246, v247
MA 200,212,152
TR 198,24,45056
buffer_store_dwordx4 v[12:15], v5, s[4:7], s60 offen offset:384 sc1
MA 232,212,156
s_add_u32 s60, s60, 4096
MA 232,208,140
WL 4
MA 236,216,140
TR 200,25,32768
v_cvt_pk_bf16_f32 v8, v152, v153
MA 236,220,156
TR 202,25,36864
v_cvt_pk_bf16_f32 v9, v154, v155
MA 204,220,152
v_cvt_pk_bf16_f32 v10, v156, v157
MA 204,216,136
v_cvt_pk_bf16_f32 v11, v158, v159
MA 172,216,132
TR 204,25,40960
buffer_store_dwordx4 v[8:11], v5, s[4:7], s60 offen offset:0 sc1
MA 172,220,148
TR 206,25,45056
v_cvt_pk_bf16_f32 v12, v184, v185
MA 140,220,144
v_cvt_pk_bf16_f32 v13, v186, v187
MA 140,216,128
v_cvt_pk_bf16_f32 v14, v188, v189
WL 4
MA 128,192,160
TR 208,26,32768
v_cvt_pk_bf16_f32 v15, v190, v191
MA 128,196,176
TR 210,26,36864
buffer_store_dwordx4 v[12:15], v5, s[4:7], s60 offen offset:128 sc1
MA 160,196,180
v_cvt_pk_bf16_f32 v8, v216, v217
MA 160,192,164
v_cvt_pk_bf16_f32 v9, v218, v219
MA 192,192,168
TR 212,26,40960
v_cvt_pk_bf16_f32 v10, v220, v221
MA 192,196,184
TR 214,26,45056
v_cvt_pk_bf16_f32 v11, v222, v223
MA 224,196,188
buffer_store_dwordx4 v[8:11], v5, s[4:7], s60 offen offset:256 sc1
MA 224,192,172
v_cvt_pk_bf16_f32 v12, v248, v249
WL 4
MA 228,200,172
TR 216,27,32768
v_cvt_pk_bf16_f32 v13, v250, v251
MA 228,204,188
TR 218,27,36864
v_cvt_pk_bf16_f32 v14, v252, v253
MA 196,204,184
v_cvt_pk_bf16_f32 v15, v254, v255
MA 196,200,168
buffer_store_dwordx4 v[12:15], v5, s[4:7], s60 offen offset:384 sc1
MA 164,200,164
TR 220,27,40960
s_add_u32 s60, s60, 4096
MA 164,204,180
TR 222,27,45056
MA 132,204,176
MA 132,200,160
WL 4
MA 136,208,160
TR 192,32,0
MA 136,212,176
TR 194,32,4096
MA 168,212,180
MA 168,208,164
MA 200,208,168
TR 196,32,8192
MA 200,212,184
TR 198,32,12288
MA 232,212,188
MA 232,208,172
WL 4
MA 236,216,172
TR 200,33,0
MA 236,220,188
TR 202,33,4096
MA 204,220,184
MA 204,216,168
MA 172,216,164
TR 204,33,8192
MA 172,220,180
TR 206,33,12288
MA 140,220,176
MA 140,216,160
WL 4
MA 128,192,0
TR 208,34,0
MA 128,196,16
TR 210,34,4096
MA 160,196,20
MA 160,192,4
MA 192,192,8
TR 212,34,8192
MA 192,196,24
TR 214,34,12288
MA 224,196,28
MA 224,192,12
WL 4
MA 228,200,12
TR 216,35,0
MA 228,204,28
TR 218,35,4096
MA 196,204,24
MA 196,200,8
MA 164,200,4
TR 220,35,8192
MA 164,204,20
TR 222,35,12288
MA 132,204,16
MA 132,200,0
v_min_u32 v23, 1, v0
v_lshlrev_b32 v23, 31, v23
WV 0
buffer_atomic_add v21, v23, s[4:7], s98 offen
WL 4
MA 136,208,0
TR 192,32,32768
MA 136,212,16
TR 194,32,36864
MA 168,212,20
MA 168,208,4
MA 200,208,8
TR 196,32,40960
MA 200,212,24
TR 198,32,45056
MA 232,212,28
MA 232,208,12
WL 4
MA 236,216,12
TR 200,33,32768
MA 236,220,28
TR 202,33,36864
MA 204,220,24
MA 204,216,8
MA 172,216,4
TR 204,33,40960
MA 172,220,20
TR 206,33,45056
MA 140,220,16
MA 140,216,0
WL 4
MA 128,192,32
TR 208,34,32768
MA 128,196,48
TR 210,34,36864
MA 160,196,52
MA 160,192,36
MA 192,192,40
TR 212,34,40960
MA 192,196,56
TR 214,34,45056
MA 224,196,60
MA 224,192,44
WL 4
MA 228,200,44
TR 216,35,32768
MA 228,204,60
TR 218,35,36864
MA 196,204,56
MA 196,200,40
MA 164,200,36
TR 220,35,40960
MA 164,204,52
TR 222,35,45056
MA 132,204,48
MA 132,200,32
buffer_load_dword v17, v22, s[4:7], s98 offen offset:0 sc1
WL 4
MA 136,208,32
MA 136,212,48
MA 168,212,52
MA 168,208,36
MA 200,208,40
MA 200,212,56
MA 232,212,60
MA 232,208,44
WL 0
MA 236,216,44
MA 236,220,60
MA 204,220,56
MA 204,216,40
MA 172,216,36
MA 172,220,52
MA 140,220,48
MA 140,216,32
WV 0
v_cmp_gt_u32 s[68:69], 8, v17
s_nop 0
s_and_b64 s[68:69], s[68:69], s[74:75]
s_cbranch_scc1 t2_slow47
t2_back48:
s_barrier
buffer_load_dwordx4 v[24:27], v5, s[4:7], s89 offen offset:0 sc1
buffer_load_dwordx4 v[28:31], v59, s[4:7], s89 offen offset:0 sc1
buffer_load_dwordx4 v[32:35], v5, s[4:7], s89 offen offset:128 sc1
buffer_load_dwordx4 v[36:39], v59, s[4:7], s89 offen offset:128 sc1
buffer_load_dwordx4 v[40:43], v5, s[4:7], s89 offen offset:256 sc1
buffer_load_dwordx4 v[44:47], v59, s[4:7], s89 offen offset:256 sc1
buffer_load_dwordx4 v[8:11], v5, s[4:7], s89 offen offset:384 sc1
buffer_load_dwordx4 v[12:15], v59, s[4:7], s89 offen offset:384 sc1
buffer_load_dword v17, v22, s[4:7], s78 offen offset:0 sc1
ds_read_b64 v[64:65], v1 offset:0
ds_read_b64 v[66:67], v2 offset:0
ds_read_b64 v[68:69], v3 offset:0
ds_read_b64 v[70:71], v4 offset:0
ds_read_b64 v[72:73], v1 offset:2048
ds_read_b64 v[74:75], v2 offset:2048
ds_read_b64 v[76:77], v3 offset:2048
ds_read_b64 v[78:79], v4 offset:2048
ds_read_b64 v[80:81], v1 offset:4096
ds_read_b64 v[82:83], v2 offset:4096
ds_read_b64 v[84:85], v3 offset:4096
ds_read_b64 v[86:87], v4 offset:4096
ds_read_b64 v[88:89], v1 offset:6144
ds_read_b64 v[90:91], v2 offset:6144
ds_read_b64 v[92:93], v3 offset:6144
ds_read_b64 v[94:95], v4 offset:6144
v_mov_b32 v56, 0xbfb8aa3b
v_lshlrev_b32 v48, 16, v96
v_and_b32 v49, 0xffff0000, v96
v_lshlrev_b32 v50, 16, v97
v_and_b32 v51, 0xffff0000, v97
v_lshlrev_b32 v52, 16, v98
v_and_b32 v53, 0xffff0000, v98
v_lshlrev_b32 v54, 16, v99
v_and_b32 v55, 0xffff0000, v99
v_pk_add_f32 v[128:129], v[128:129], v[48:49]
v_pk_add_f32 v[130:131], v[130:131], v[50:51]
v_pk_add_f32 v[132:133], v[132:133], v[52:53]
v_pk_add_f32 v[134:135], v[134:135], v[54:55]
v_lshlrev_b32 v48, 16, v100
v_and_b32 v49, 0xffff0000, v100
v_lshlrev_b32 v50, 16, v101
v_and_b32 v51, 0xffff0000, v101
v_lshlrev_b32 v52, 16, v102
v_and_b32 v53, 0xffff0000, v102
v_lshlrev_b32 v54, 16, v103
v_and_b32 v55, 0xffff0000, v103
v_pk_add_f32 v[136:137], v[136:137], v[48:49]
v_pk_add_f32 v[138:139], v[138:139], v[50:51]
v_pk_add_f32 v[140:141], v[140:141], v[52:53]
v_pk_add_f32 v[142:143], v[142:143], v[54:55]
v_lshlrev_b32 v48, 16, v104
v_and_b32 v49, 0xffff0000, v104
v_lshlrev_b32 v50, 16, v105
v_and_b32 v51, 0xffff0000, v105
v_lshlrev_b32 v52, 16, v106
v_and_b32 v53, 0xffff0000, v106
v_lshlrev_b32 v54, 16, v107
v_and_b32 v55, 0xffff0000, v107
v_pk_add_f32 v[160:161], v[160:161], v[48:49]
v_pk_add_f32 v[162:163], v[162:163], v[50:51]
v_pk_add_f32 v[164:165], v[164:165], v[52:53]
v_pk_add_f32 v[166:167], v[166:167], v[54:55]
v_lshlrev_b32 v48, 16, v108
v_and_b32 v49, 0xffff0000, v108
v_lshlrev_b32 v50, 16, v109
v_and_b32 v51, 0xffff0000, v109
v_lshlrev_b32 v52, 16, v110
v_and_b32 v53, 0xffff0000, v110
v_lshlrev_b32 v54, 16, v111
v_and_b32 v55, 0xffff0000, v111
v_pk_add_f32 v[168:169], v[168:169], v[48:49]
v_pk_add_f32 v[170:171], v[170:171], v[50:51]
v_pk_add_f32 v[172:173], v[172:173], v[52:53]
v_pk_add_f32 v[174:175], v[174:175], v[54:55]
v_lshlrev_b32 v48, 16, v112
v_and_b32 v49, 0xffff0000, v112
v_lshlrev_b32 v50, 16, v113
v_and_b32 v51, 0xffff0000, v113
v_lshlrev_b32 v52, 16, v114
v_and_b32 v53, 0xffff0000, v114
v_lshlrev_b32 v54, 16, v115
v_and_b32 v55, 0xffff0000, v115
v_pk_add_f32 v[192:193], v[192:193], v[48:49]
v_pk_add_f32 v[194:195], v[194:195], v[50:51]
v_pk_add_f32 v[196:197], v[196:197], v[52:53]
v_pk_add_f32 v[198:199], v[198:199], v[54:55]
v_lshlrev_b32 v48, 16, v116
v_and_b32 v49, 0xffff0000, v116
v_lshlrev_b32 v50, 16, v117
v_and_b32 v51, 0xffff0000, v117
v_lshlrev_b32 v52, 16, v118
v_and_b32 v53, 0xffff0000, v118
v_lshlrev_b32 v54, 16, v119
v_and_b32 v55, 0xffff0000, v119
v_pk_add_f32 v[200:201], v[200:201], v[48:49]
v_pk_add_f32 v[202:203], v[202:203], v[50:51]
v_pk_add_f32 v[204:205], v[204:205], v[52:53]
v_pk_add_f32 v[206:207], v[206:207], v[54:55]
v_lshlrev_b32 v48, 16, v120
v_and_b32 v49, 0xffff0000, v120
v_lshlrev_b32 v50, 16, v121
v_and_b32 v51, 0xffff0000, v121
v_lshlrev_b32 v52, 16, v122
v_and_b32 v53, 0xffff0000, v122
v_lshlrev_b32 v54, 16, v123
v_and_b32 v55, 0xffff0000, v123
v_pk_add_f32 v[224:225], v[224:225], v[48:49]
v_pk_add_f32 v[226:227], v[226:227], v[50:51]
v_pk_add_f32 v[228:229], v[228:229], v[52:53]
v_pk_add_f32 v[230:231], v[230:231], v[54:55]
v_lshlrev_b32 v48, 16, v124
v_and_b32 v49, 0xffff0000, v124
v_lshlrev_b32 v50, 16, v125
v_and_b32 v51, 0xffff0000, v125
v_lshlrev_b32 v52, 16, v126
v_and_b32 v53, 0xffff0000, v126
v_lshlrev_b32 v54, 16, v127
v_and_b32 v55, 0xffff0000, v127
v_pk_add_f32 v[232:233], v[232:233], v[48:49]
v_pk_add_f32 v[234:235], v[234:235], v[50:51]
v_pk_add_f32 v[236:237], v[236:237], v[52:53]
v_pk_add_f32 v[238:239], v[238:239], v[54:55]
WV 8
v_lshlrev_b32 v48, 16, v24
v_and_b32 v49, 0xffff0000, v24
v_lshlrev_b32 v50, 16, v25
v_and_b32 v51, 0xffff0000, v25
v_lshlrev_b32 v52, 16, v26
v_and_b32 v53, 0xffff0000, v26
v_lshlrev_b32 v54, 16, v27
v_and_b32 v55, 0xffff0000, v27
v_pk_add_f32 v[128:129], v[128:129], v[48:49]
v_pk_add_f32 v[130:131], v[130:131], v[50:51]
v_pk_add_f32 v[132:133], v[132:133], v[52:53]
v_pk_add_f32 v[134:135], v[134:135], v[54:55]
v_pk_mul_f32 v[48:49], v[128:129], v[56:57] op_sel_hi:[1,0]
v_pk_mul_f32 v[50:51], v[130:131], v[56:57] op_sel_hi:[1,0]
v_pk_mul_f32 v[52:53], v[132:133], v[56:57] op_sel_hi:[1,0]
v_pk_mul_f32 v[54:55], v[134:135], v[56:57] op_sel_hi:[1,0]
v_exp_f32 v48, v48
WV 7
v_lshlrev_b32 v96, 16, v28
v_exp_f32 v49, v49
v_and_b32 v97, 0xffff0000, v28
v_exp_f32 v50, v50
v_lshlrev_b32 v98, 16, v29
v_exp_f32 v51, v51
v_and_b32 v99, 0xffff0000, v29
v_exp_f32 v52, v52
v_lshlrev_b32 v100, 16, v30
v_exp_f32 v53, v53
v_and_b32 v101, 0xffff0000, v30
v_exp_f32 v54, v54
v_lshlrev_b32 v102, 16, v31
v_exp_f32 v55, v55
v_pk_add_f32 v[48:49], v[48:49], 1.0 op_sel_hi:[1,0]
v_pk_add_f32 v[50:51], v[50:51], 1.0 op_sel_hi:[1,0]
v_pk_add_f32 v[52:53], v[52:53], 1.0 op_sel_hi:[1,0]
v_pk_add_f32 v[54:55], v[54:55], 1.0 op_sel_hi:[1,0]
v_rcp_f32 v48, v48
v_and_b32 v103, 0xffff0000, v31
v_rcp_f32 v49, v49
v_pk_add_f32 v[136:137], v[136:137], v[96:97]
v_rcp_f32 v50, v50
v_pk_add_f32 v[138:139], v[138:139], v[98:99]
v_rcp_f32 v51, v51
v_pk_add_f32 v[140:141], v[140:141], v[100:101]
v_rcp_f32 v52, v52
v_pk_add_f32 v[142:143], v[142:143], v[102:103]
v_rcp_f32 v53, v53
v_pk_mul_f32 v[96:97], v[136:137], v[56:57] op_sel_hi:[1,0]
v_rcp_f32 v54, v54
v_pk_mul_f32 v[98:99], v[138:139], v[56:57] op_sel_hi:[1,0]
v_rcp_f32 v55, v55
v_pk_mul_f32 v[128:129], v[128:129], v[48:49]
v_pk_mul_f32 v[130:131], v[130:131], v[50:51]
v_pk_mul_f32 v[132:133], v[132:133], v[52:53]
v_pk_mul_f32 v[134:135], v[134:135], v[54:55]
v_pk_mul_f32 v[100:101], v[140:141], v[56:57] op_sel_hi:[1,0]
v_pk_mul_f32 v[102:103], v[142:143], v[56:57] op_sel_hi:[1,0]
v_exp_f32 v96, v96
v_exp_f32 v97, v97
v_exp_f32 v98, v98
v_exp_f32 v99, v99
v_exp_f32 v100, v100
v_exp_f32 v101, v101
v_exp_f32 v102, v102
v_exp_f32 v103, v103
v_pk_add_f32 v[96:97], v[96:97], 1.0 op_sel_hi:[1,0]
v_pk_add_f32 v[98:99], v[98:99], 1.0 op_sel_hi:[1,0]
v_pk_add_f32 v[100:101], v[100:101], 1.0 op_sel_hi:[1,0]
v_pk_add_f32 v[102:103], v[102:103], 1.0 op_sel_hi:[1,0]
v_rcp_f32 v96, v96
v_rcp_f32 v97, v97
v_rcp_f32 v98, v98
v_rcp_f32 v99, v99
v_rcp_f32 v100, v100
v_rcp_f32 v101, v101
v_rcp_f32 v102, v102
v_rcp_f32 v103, v103
v_pk_mul_f32 v[136:137], v[136:137], v[96:97]
v_pk_mul_f32 v[138:139], v[138:139], v[98:99]
v_pk_mul_f32 v[140:141], v[140:141], v[100:101]
v_pk_mul_f32 v[142:143], v[142:143], v[102:103]
WV 0
v_cmp_gt_u32 s[68:69], 8, v17
s_nop 0
s_and_b64 s[68:69], s[68:69], s[74:75]
s_cbranch_scc1 t2_slow45
t2_back46:
s_barrier
buffer_load_dwordx4 v[144:147], v5, s[4:7], s83 offen offset:0 sc1
v_lshlrev_b32 v48, 16, v32
v_and_b32 v49, 0xffff0000, v32
v_lshlrev_b32 v50, 16, v33
v_and_b32 v51, 0xffff0000, v33
v_lshlrev_b32 v52, 16, v34
v_and_b32 v53, 0xffff0000, v34
v_lshlrev_b32 v54, 16, v35
v_and_b32 v55, 0xffff0000, v35
buffer_load_dwordx4 v[152:155], v59, s[4:7], s83 offen offset:0 sc1
v_pk_add_f32 v[160:161], v[160:161], v[48:49]
v_pk_add_f32 v[162:163], v[162:163], v[50:51]
v_pk_add_f32 v[164:165], v[164:165], v[52:53]
v_pk_add_f32 v[166:167], v[166:167], v[54:55]
v_pk_mul_f32 v[48:49], v[160:161], v[56:57] op_sel_hi:[1,0]
v_pk_mul_f32 v[50:51], v[162:163], v[56:57] op_sel_hi:[1,0]
v_pk_mul_f32 v[52:53], v[164:165], v[56:57] op_sel_hi:[1,0]
v_pk_mul_f32 v[54:55], v[166:167], v[56:57] op_sel_hi:[1,0]
buffer_load_dwordx4 v[176:179], v5, s[4:7], s83 offen offset:128 sc1
v_exp_f32 v48, v48
v_lshlrev_b32 v96, 16, v36
v_exp_f32 v49, v49
v_and_b32 v97, 0xffff0000, v36
v_exp_f32 v50, v50
v_lshlrev_b32 v98, 16, v37
v_exp_f32 v51, v51
v_and_b32 v99, 0xffff0000, v37
buffer_load_dwordx4 v[184:187], v59, s[4:7], s83 offen offset:128 sc1
v_exp_f32 v52, v52
v_lshlrev_b32 v100, 16, v38
v_exp_f32 v53, v53
v_and_b32 v101, 0xffff0000, v38
v_exp_f32 v54, v54
v_lshlrev_b32 v102, 16, v39
v_exp_f32 v55, v55
v_pk_add_f32 v[48:49], v[48:49], 1.0 op_sel_hi:[1,0]
buffer_load_dwordx4 v[208:211], v5, s[4:7], s83 offen offset:256 sc1
v_pk_add_f32 v[50:51], v[50:51], 1.0 op_sel_hi:[1,0]
v_pk_add_f32 v[52:53], v[52:53], 1.0 op_sel_hi:[1,0]
v_pk_add_f32 v[54:55], v[54:55], 1.0 op_sel_hi:[1,0]
v_rcp_f32 v48, v48
v_and_b32 v103, 0xffff0000, v39
v_rcp_f32 v49, v49
v_pk_add_f32 v[168:169], v[168:169], v[96:97]
v_rcp_f32 v50, v50
buffer_load_dwordx4 v[216:219], v59, s[4:7], s83 offen offset:256 sc1
v_pk_add_f32 v[170:171], v[170:171], v[98:99]
v_rcp_f32 v51, v51
v_pk_add_f32 v[172:173], v[172:173], v[100:101]
v_rcp_f32 v52, v52
v_pk_add_f32 v[174:175], v[174:175], v[102:103]
v_rcp_f32 v53, v53
v_pk_mul_f32 v[96:97], v[168:169], v[56:57] op_sel_hi:[1,0]
v_rcp_f32 v54, v54
buffer_load_dwordx4 v[240:243], v5, s[4:7], s83 offen offset:384 sc1
v_pk_mul_f32 v[98:99], v[170:171], v[56:57] op_sel_hi:[1,0]
v_rcp_f32 v55, v55
v_pk_mul_f32 v[160:161], v[160:161], v[48:49]
v_pk_mul_f32 v[162:163], v[162:163], v[50:51]
v_pk_mul_f32 v[164:165], v[164:165], v[52:53]
v_pk_mul_f32 v[166:167], v[166:167], v[54:55]
v_pk_mul_f32 v[100:101], v[172:173], v[56:57] op_sel_hi:[1,0]
v_pk_mul_f32 v[102:103], v[174:175], v[56:57] op_sel_hi:[1,0]
buffer_load_dwordx4 v[248:251], v59, s[4:7], s83 offen offset:384 sc1
v_exp_f32 v96, v96
v_lshlrev_b32 v48, 16, v40
v_exp_f32 v97, v97
v_and_b32 v49, 0xffff0000, v40
v_exp_f32 v98, v98
v_lshlrev_b32 v50, 16, v41
v_exp_f32 v99, v99
v_and_b32 v51, 0xffff0000, v41
buffer_load_dwordx4 v[148:151], v5, s[4:7], s88 offen offset:0 sc1
v_exp_f32 v100, v100
v_lshlrev_b32 v52, 16, v42
v_exp_f32 v101, v101
v_and_b32 v53, 0xffff0000, v42
v_exp_f32 v102, v102
v_lshlrev_b32 v54, 16, v43
v_exp_f32 v103, v103
v_pk_add_f32 v[96:97], v[96:97], 1.0 op_sel_hi:[1,0]
buffer_load_dwordx4 v[156:159], v59, s[4:7], s88 offen offset:0 sc1
v_pk_add_f32 v[98:99], v[98:99], 1.0 op_sel_hi:[1,0]
v_pk_add_f32 v[100:101], v[100:101], 1.0 op_sel_hi:[1,0]
v_pk_add_f32 v[102:103], v[102:103], 1.0 op_sel_hi:[1,0]
v_rcp_f32 v96, v96
v_and_b32 v55, 0xffff0000, v43
v_rcp_f32 v97, v97
v_pk_add_f32 v[192:193], v[192:193], v[48:49]
v_rcp_f32 v98, v98
buffer_load_dwordx4 v[180:183], v5, s[4:7], s88 offen offset:128 sc1
v_pk_add_f32 v[194:195], v[194:195], v[50:51]
v_rcp_f32 v99, v99
v_pk_add_f32 v[196:197], v[196:197], v[52:53]
v_rcp_f32 v100, v100
v_pk_add_f32 v[198:199], v[198:199], v[54:55]
v_rcp_f32 v101, v101
v_pk_mul_f32 v[48:49], v[192:193], v[56:57] op_sel_hi:[1,0]
v_rcp_f32 v102, v102
buffer_load_dwordx4 v[188:191], v59, s[4:7], s88 offen offset:128 sc1
v_pk_mul_f32 v[50:51], v[194:195], v[56:57] op_sel_hi:[1,0]
v_rcp_f32 v103, v103
v_pk_mul_f32 v[168:169], v[168:169], v[96:97]
v_pk_mul_f32 v[170:171], v[170:171], v[98:99]
v_pk_mul_f32 v[172:173], v[172:173], v[100:101]
v_pk_mul_f32 v[174:175], v[174:175], v[102:103]
v_pk_mul_f32 v[52:53], v[196:197], v[56:57] op_sel_hi:[1,0]
v_pk_mul_f32 v[54:55], v[198:199], v[56:57] op_sel_hi:[1,0]
buffer_load_dwordx4 v[212:215], v5, s[4:7], s88 offen offset:256 sc1
v_exp_f32 v48, v48
v_lshlrev_b32 v96, 16, v44
v_exp_f32 v49, v49
v_and_b32 v97, 0xffff0000, v44
v_exp_f32 v50, v50
v_lshlrev_b32 v98, 16, v45
v_exp_f32 v51, v51
v_and_b32 v99, 0xffff0000, v45
buffer_load_dwordx4 v[220:223], v59, s[4:7], s88 offen offset:256 sc1
v_exp_f32 v52, v52
v_lshlrev_b32 v100, 16, v46
v_exp_f32 v53, v53
v_and_b32 v101, 0xffff0000, v46
v_exp_f32 v54, v54
v_lshlrev_b32 v102, 16, v47
v_exp_f32 v55, v55
v_pk_add_f32 v[48:49], v[48:49], 1.0 op_sel_hi:[1,0]
buffer_load_dwordx4 v[244:247], v5, s[4:7], s88 offen offset:384 sc1
v_pk_add_f32 v[50:51], v[50:51], 1.0 op_sel_hi:[1,0]
v_pk_add_f32 v[52:53], v[52:53], 1.0 op_sel_hi:[1,0]
v_pk_add_f32 v[54:55], v[54:55], 1.0 op_sel_hi:[1,0]
v_rcp_f32 v48, v48
v_and_b32 v103, 0xffff0000, v47
v_rcp_f32 v49, v49
v_pk_add_f32 v[200:201], v[200:201], v[96:97]
v_rcp_f32 v50, v50
buffer_load_dwordx4 v[252:255], v59, s[4:7], s88 offen offset:384 sc1
v_pk_add_f32 v[202:203], v[202:203], v[98:99]
v_rcp_f32 v51, v51
v_pk_add_f32 v[204:205], v[204:205], v[100:101]
v_rcp_f32 v52, v52
v_pk_add_f32 v[206:207], v[206:207], v[102:103]
v_rcp_f32 v53, v53
v_pk_mul_f32 v[96:97], v[200:201], v[56:57] op_sel_hi:[1,0]
v_rcp_f32 v54, v54
v_pk_mul_f32 v[98:99], v[202:203], v[56:57] op_sel_hi:[1,0]
v_rcp_f32 v55, v55
v_pk_mul_f32 v[192:193], v[192:193], v[48:49]
v_pk_mul_f32 v[194:195], v[194:195], v[50:51]
v_pk_mul_f32 v[196:197], v[196:197], v[52:53]
v_pk_mul_f32 v[198:199], v[198:199], v[54:55]
v_pk_mul_f32 v[100:101], v[204:205], v[56:57] op_sel_hi:[1,0]
v_pk_mul_f32 v[102:103], v[206:207], v[56:57] op_sel_hi:[1,0]
v_exp_f32 v96, v96
v_lshlrev_b32 v48, 16, v8
v_exp_f32 v97, v97
v_and_b32 v49, 0xffff0000, v8
v_exp_f32 v98, v98
v_lshlrev_b32 v50, 16, v9
v_exp_f32 v99, v99
v_and_b32 v51, 0xffff0000, v9
v_exp_f32 v100, v100
v_lshlrev_b32 v52, 16, v10
v_exp_f32 v101, v101
v_and_b32 v53, 0xffff0000, v10
v_exp_f32 v102, v102
v_lshlrev_b32 v54, 16, v11
v_exp_f32 v103, v103
v_pk_add_f32 v[96:97], v[96:97], 1.0 op_sel_hi:[1,0]
v_pk_add_f32 v[98:99], v[98:99], 1.0 op_sel_hi:[1,0]
v_pk_add_f32 v[100:101], v[100:101], 1.0 op_sel_hi:[1,0]
v_pk_add_f32 v[102:103], v[102:103], 1.0 op_sel_hi:[1,0]
v_rcp_f32 v96, v96
v_and_b32 v55, 0xffff0000, v11
v_rcp_f32 v97, v97
v_pk_add_f32 v[224:225], v[224:225], v[48:49]
v_rcp_f32 v98, v98
v_pk_add_f32 v[226:227], v[226:227], v[50:51]
v_rcp_f32 v99, v99
v_pk_add_f32 v[228:229], v[228:229], v[52:53]
v_rcp_f32 v100, v100
v_pk_add_f32 v[230:231], v[230:231], v[54:55]
v_rcp_f32 v101, v101
v_pk_mul_f32 v[48:49], v[224:225], v[56:57] op_sel_hi:[1,0]
v_rcp_f32 v102, v102
v_pk_mul_f32 v[50:51], v[226:227], v[56:57] op_sel_hi:[1,0]
v_rcp_f32 v103, v103
v_pk_mul_f32 v[200:201], v[200:201], v[96:97]
v_pk_mul_f32 v[202:203], v[202:203], v[98:99]
v_pk_mul_f32 v[204:205], v[204:205], v[100:101]
v_pk_mul_f32 v[206:207], v[206:207], v[102:103]
v_pk_mul_f32 v[52:53], v[228:229], v[56:57] op_sel_hi:[1,0]
v_pk_mul_f32 v[54:55], v[230:231], v[56:57] op_sel_hi:[1,0]
v_exp_f32 v48, v48
v_lshlrev_b32 v96, 16, v12
v_exp_f32 v49, v49
v_and_b32 v97, 0xffff0000, v12
v_exp_f32 v50, v50
v_lshlrev_b32 v98, 16, v13
v_exp_f32 v51, v51
v_and_b32 v99, 0xffff0000, v13
v_exp_f32 v52, v52
v_lshlrev_b32 v100, 16, v14
v_exp_f32 v53, v53
v_and_b32 v101, 0xffff0000, v14
v_exp_f32 v54, v54
v_lshlrev_b32 v102, 16, v15
v_exp_f32 v55, v55
v_pk_add_f32 v[48:49], v[48:49], 1.0 op_sel_hi:[1,0]
v_pk_add_f32 v[50:51], v[50:51], 1.0 op_sel_hi:[1,0]
v_pk_add_f32 v[52:53], v[52:53], 1.0 op_sel_hi:[1,0]
v_pk_add_f32 v[54:55], v[54:55], 1.0 op_sel_hi:[1,0]
v_rcp_f32 v48, v48
v_and_b32 v103, 0xffff0000, v15
v_rcp_f32 v49, v49
v_pk_add_f32 v[232:233], v[232:233], v[96:97]
v_rcp_f32 v50, v50
v_pk_add_f32 v[234:235], v[234:235], v[98:99]
v_rcp_f32 v51, v51
v_pk_add_f32 v[236:237], v[236:237], v[100:101]
v_rcp_f32 v52, v52
v_pk_add_f32 v[238:239], v[238:239], v[102:103]
v_rcp_f32 v53, v53
v_pk_mul_f32 v[96:97], v[232:233], v[56:57] op_sel_hi:[1,0]
v_rcp_f32 v54, v54
v_pk_mul_f32 v[98:99], v[234:235], v[56:57] op_sel_hi:[1,0]
v_rcp_f32 v55, v55
v_pk_mul_f32 v[224:225], v[224:225], v[48:49]
v_pk_mul_f32 v[226:227], v[226:227], v[50:51]
v_pk_mul_f32 v[228:229], v[228:229], v[52:53]
v_pk_mul_f32 v[230:231], v[230:231], v[54:55]
v_pk_mul_f32 v[100:101], v[236:237], v[56:57] op_sel_hi:[1,0]
v_pk_mul_f32 v[102:103], v[238:239], v[56:57] op_sel_hi:[1,0]
v_exp_f32 v96, v96
v_exp_f32 v97, v97
v_exp_f32 v98, v98
v_exp_f32 v99, v99
v_exp_f32 v100, v100
v_exp_f32 v101, v101
v_exp_f32 v102, v102
v_exp_f32 v103, v103
v_pk_add_f32 v[96:97], v[96:97], 1.0 op_sel_hi:[1,0]
v_pk_add_f32 v[98:99], v[98:99], 1.0 op_sel_hi:[1,0]
v_pk_add_f32 v[100:101], v[100:101], 1.0 op_sel_hi:[1,0]
v_pk_add_f32 v[102:103], v[102:103], 1.0 op_sel_hi:[1,0]
v_rcp_f32 v96, v96
v_rcp_f32 v97, v97
v_rcp_f32 v98, v98
v_rcp_f32 v99, v99
v_rcp_f32 v100, v100
v_rcp_f32 v101, v101
v_rcp_f32 v102, v102
v_rcp_f32 v103, v103
v_pk_mul_f32 v[232:233], v[232:233], v[96:97]
v_pk_mul_f32 v[234:235], v[234:235], v[98:99]
v_pk_mul_f32 v[236:237], v[236:237], v[100:101]
v_pk_mul_f32 v[238:239], v[238:239], v[102:103]
WV 15
v_lshlrev_b32 v112, 16, v144
v_and_b32 v113, 0xffff0000, v144
v_lshlrev_b32 v114, 16, v145
v_and_b32 v115, 0xffff0000, v145
v_lshlrev_b32 v116, 16, v146
v_and_b32 v117, 0xffff0000, v146
v_lshlrev_b32 v118, 16, v147
v_and_b32 v119, 0xffff0000, v147
WV 7
v_lshlrev_b32 v120, 16, v148
v_and_b32 v121, 0xffff0000, v148
v_lshlrev_b32 v122, 16, v149
v_and_b32 v123, 0xffff0000, v149
v_lshlrev_b32 v124, 16, v150
v_and_b32 v125, 0xffff0000, v150
v_lshlrev_b32 v126, 16, v151
v_and_b32 v127, 0xffff0000, v151
v_pk_add_f32 v[144:145], v[112:113], v[120:121]
v_pk_add_f32 v[146:147], v[114:115], v[122:123]
v_pk_add_f32 v[148:149], v[116:117], v[124:125]
v_pk_add_f32 v[150:151], v[118:119], v[126:127]
WL 15
v_lshlrev_b32 v48, 16, v64
v_and_b32 v49, 0xffff0000, v64
v_lshlrev_b32 v50, 16, v65
v_and_b32 v51, 0xffff0000, v65
WL 14
v_lshlrev_b32 v52, 16, v66
v_and_b32 v53, 0xffff0000, v66
v_lshlrev_b32 v54, 16, v67
v_and_b32 v55, 0xffff0000, v67
v_pk_fma_f32 v[48:49], v[144:145], v[128:129], v[48:49]
v_pk_fma_f32 v[50:51], v[146:147], v[130:131], v[50:51]
v_pk_fma_f32 v[52:53], v[148:149], v[132:133], v[52:53]
v_pk_fma_f32 v[54:55], v[150:151], v[134:135], v[54:55]
v_cvt_pk_bf16_f32 v64, v48, v49
v_cvt_pk_bf16_f32 v65, v50, v51
v_cvt_pk_bf16_f32 v66, v52, v53
v_cvt_pk_bf16_f32 v67, v54, v55
ds_write_b64 v1, v[64:65] offset:0
ds_write_b64 v2, v[66:67] offset:0
v_lshlrev_b32 v112, 16, v152
v_and_b32 v113, 0xffff0000, v152
v_lshlrev_b32 v114, 16, v153
v_and_b32 v115, 0xffff0000, v153
v_lshlrev_b32 v116, 16, v154
v_and_b32 v117, 0xffff0000, v154
v_lshlrev_b32 v118, 16, v155
v_and_b32 v119, 0xffff0000, v155
WV 6
v_lshlrev_b32 v120, 16, v156
v_and_b32 v121, 0xffff0000, v156
v_lshlrev_b32 v122, 16, v157
v_and_b32 v123, 0xffff0000, v157
v_lshlrev_b32 v124, 16, v158
v_and_b32 v125, 0xffff0000, v158
v_lshlrev_b32 v126, 16, v159
v_and_b32 v127, 0xffff0000, v159
v_pk_add_f32 v[152:153], v[112:113], v[120:121]
v_pk_add_f32 v[154:155], v[114:115], v[122:123]
v_pk_add_f32 v[156:157], v[116:117], v[124:125]
v_pk_add_f32 v[158:159], v[118:119], v[126:127]
WL 15
v_lshlrev_b32 v96, 16, v68
v_and_b32 v97, 0xffff0000, v68
v_lshlrev_b32 v98, 16, v69
v_and_b32 v99, 0xffff0000, v69
WL 14
v_lshlrev_b32 v100, 16, v70
v_and_b32 v101, 0xffff0000, v70
v_lshlrev_b32 v102, 16, v71
v_and_b32 v103, 0xffff0000, v71
v_pk_fma_f32 v[96:97], v[152:153], v[136:137], v[96:97]
v_pk_fma_f32 v[98:99], v[154:155], v[138:139], v[98:99]
v_pk_fma_f32 v[100:101], v[156:157], v[140:141], v[100:101]
v_pk_fma_f32 v[102:103], v[158:159], v[142:143], v[102:103]
v_cvt_pk_bf16_f32 v68, v96, v97
v_cvt_pk_bf16_f32 v69, v98, v99
v_cvt_pk_bf16_f32 v70, v100, v101
v_cvt_pk_bf16_f32 v71, v102, v103
ds_write_b64 v3, v[68:69] offset:0
ds_write_b64 v4, v[70:71] offset:0
ds_read_b128 v[64:67], v7 offset:0
ds_read_b128 v[68:71], v7 offset:1024
v_lshlrev_b32 v112, 16, v176
v_and_b32 v113, 0xffff0000, v176
v_lshlrev_b32 v114, 16, v177
v_and_b32 v115, 0xffff0000, v177
v_lshlrev_b32 v116, 16, v178
v_and_b32 v117, 0xffff0000, v178
v_lshlrev_b32 v118, 16, v179
v_and_b32 v119, 0xffff0000, v179
WV 5
v_lshlrev_b32 v120, 16, v180
v_and_b32 v121, 0xffff0000, v180
v_lshlrev_b32 v122, 16, v181
v_and_b32 v123, 0xffff0000, v181
v_lshlrev_b32 v124, 16, v182
v_and_b32 v125, 0xffff0000, v182
v_lshlrev_b32 v126, 16, v183
v_and_b32 v127, 0xffff0000, v183
v_pk_add_f32 v[176:177], v[112:113], v[120:121]
v_pk_add_f32 v[178:179], v[114:115], v[122:123]
v_pk_add_f32 v[180:181], v[116:117], v[124:125]
v_pk_add_f32 v[182:183], v[118:119], v[126:127]
WL 15
v_lshlrev_b32 v48, 16, v72
v_and_b32 v49, 0xffff0000, v72
v_lshlrev_b32 v50, 16, v73
v_and_b32 v51, 0xffff0000, v73
v_lshlrev_b32 v52, 16, v74
v_and_b32 v53, 0xffff0000, v74
v_lshlrev_b32 v54, 16, v75
v_and_b32 v55, 0xffff0000, v75
v_pk_fma_f32 v[48:49], v[176:177], v[160:161], v[48:49]
v_pk_fma_f32 v[50:51], v[178:179], v[162:163], v[50:51]
v_pk_fma_f32 v[52:53], v[180:181], v[164:165], v[52:53]
v_pk_fma_f32 v[54:55], v[182:183], v[166:167], v[54:55]
v_cvt_pk_bf16_f32 v72, v48, v49
v_cvt_pk_bf16_f32 v73, v50, v51
v_cvt_pk_bf16_f32 v74, v52, v53
v_cvt_pk_bf16_f32 v75, v54, v55
ds_write_b64 v1, v[72:73] offset:2048
ds_write_b64 v2, v[74:75] offset:2048
WL 3
buffer_store_dwordx4 v[64:67], v58, s[40:43], s61 offen
s_add_u32 s61, s61, 16384
WL 2
buffer_store_dwordx4 v[68:71], v58, s[40:43], s61 offen
s_add_u32 s61, s61, 16384
v_lshlrev_b32 v112, 16, v184
v_and_b32 v113, 0xffff0000, v184
v_lshlrev_b32 v114, 16, v185
v_and_b32 v115, 0xffff0000, v185
v_lshlrev_b32 v116, 16, v186
v_and_b32 v117, 0xffff0000, v186
v_lshlrev_b32 v118, 16, v187
v_and_b32 v119, 0xffff0000, v187
WV 6
v_lshlrev_b32 v120, 16, v188
v_and_b32 v121, 0xffff0000, v188
v_lshlrev_b32 v122, 16, v189
v_and_b32 v123, 0xffff0000, v189
v_lshlrev_b32 v124, 16, v190
v_and_b32 v125, 0xffff0000, v190
v_lshlrev_b32 v126, 16, v191
v_and_b32 v127, 0xffff0000, v191
v_pk_add_f32 v[184:185], v[112:113], v[120:121]
v_pk_add_f32 v[186:187], v[114:115], v[122:123]
v_pk_add_f32 v[188:189], v[116:117], v[124:125]
v_pk_add_f32 v[190:191], v[118:119], v[126:127]
v_lshlrev_b32 v96, 16, v76
v_and_b32 v97, 0xffff0000, v76
v_lshlrev_b32 v98, 16, v77
v_and_b32 v99, 0xffff0000, v77
v_lshlrev_b32 v100, 16, v78
v_and_b32 v101, 0xffff0000, v78
v_lshlrev_b32 v102, 16, v79
v_and_b32 v103, 0xffff0000, v79
v_pk_fma_f32 v[96:97], v[184:185], v[168:169], v[96:97]
v_pk_fma_f32 v[98:99], v[186:187], v[170:171], v[98:99]
v_pk_fma_f32 v[100:101], v[188:189], v[172:173], v[100:101]
v_pk_fma_f32 v[102:103], v[190:191], v[174:175], v[102:103]
v_cvt_pk_bf16_f32 v76, v96, v97
v_cvt_pk_bf16_f32 v77, v98, v99
v_cvt_pk_bf16_f32 v78, v100, v101
v_cvt_pk_bf16_f32 v79, v102, v103
ds_write_b64 v3, v[76:77] offset:2048
ds_write_b64 v4, v[78:79] offset:2048
ds_read_b128 v[72:75], v7 offset:2048
ds_read_b128 v[76:79], v7 offset:3072
v_lshlrev_b32 v112, 16, v208
v_and_b32 v113, 0xffff0000, v208
v_lshlrev_b32 v114, 16, v209
v_and_b32 v115, 0xffff0000, v209
v_lshlrev_b32 v116, 16, v210
v_and_b32 v117, 0xffff0000, v210
v_lshlrev_b32 v118, 16, v211
v_and_b32 v119, 0xffff0000, v211
WV 5
v_lshlrev_b32 v120, 16, v212
v_and_b32 v121, 0xffff0000, v212
v_lshlrev_b32 v122, 16, v213
v_and_b32 v123, 0xffff0000, v213
v_lshlrev_b32 v124, 16, v214
v_and_b32 v125, 0xffff0000, v214
v_lshlrev_b32 v126, 16, v215
v_and_b32 v127, 0xffff0000, v215
v_pk_add_f32 v[208:209], v[112:113], v[120:121]
v_pk_add_f32 v[210:211], v[114:115], v[122:123]
v_pk_add_f32 v[212:213], v[116:117], v[124:125]
v_pk_add_f32 v[214:215], v[118:119], v[126:127]
v_lshlrev_b32 v48, 16, v80
v_and_b32 v49, 0xffff0000, v80
v_lshlrev_b32 v50, 16, v81
v_and_b32 v51, 0xffff0000, v81
v_lshlrev_b32 v52, 16, v82
v_and_b32 v53, 0xffff0000, v82
v_lshlrev_b32 v54, 16, v83
v_and_b32 v55, 0xffff0000, v83
v_pk_fma_f32 v[48:49], v[208:209], v[192:193], v[48:49]
v_pk_fma_f32 v[50:51], v[210:211], v[194:195], v[50:51]
v_pk_fma_f32 v[52:53], v[212:213], v[196:197], v[52:53]
v_pk_fma_f32 v[54:55], v[214:215], v[198:199], v[54:55]
v_cvt_pk_bf16_f32 v80, v48, v49
v_cvt_pk_bf16_f32 v81, v50, v51
v_cvt_pk_bf16_f32 v82, v52, v53
v_cvt_pk_bf16_f32 v83, v54, v55
ds_write_b64 v1, v[80:81] offset:4096
ds_write_b64 v2, v[82:83] offset:4096
WL 3
buffer_store_dwordx4 v[72:75], v58, s[40:43], s61 offen
s_add_u32 s61, s61, 16384
WL 2
buffer_store_dwordx4 v[76:79], v58, s[40:43], s61 offen
s_add_u32 s61, s61, 16384
v_lshlrev_b32 v112, 16, v216
v_and_b32 v113, 0xffff0000, v216
v_lshlrev_b32 v114, 16, v217
v_and_b32 v115, 0xffff0000, v217
v_lshlrev_b32 v116, 16, v218
v_and_b32 v117, 0xffff0000, v218
v_lshlrev_b32 v118, 16, v219
v_and_b32 v119, 0xffff0000, v219
WV 6
v_lshlrev_b32 v120, 16, v220
v_and_b32 v121, 0xffff0000, v220
v_lshlrev_b32 v122, 16, v221
v_and_b32 v123, 0xffff0000, v221
v_lshlrev_b32 v124, 16, v222
v_and_b32 v125, 0xffff0000, v222
v_lshlrev_b32 v126, 16, v223
v_and_b32 v127, 0xffff0000, v223
v_pk_add_f32 v[216:217], v[112:113], v[120:121]
v_pk_add_f32 v[218:219], v[114:115], v[122:123]
v_pk_add_f32 v[220:221], v[116:117], v[124:125]
v_pk_add_f32 v[222:223], v[118:119], v[126:127]
v_lshlrev_b32 v96, 16, v84
v_and_b32 v97, 0xffff0000, v84
v_lshlrev_b32 v98, 16, v85
v_and_b32 v99, 0xffff0000, v85
v_lshlrev_b32 v100, 16, v86
v_and_b32 v101, 0xffff0000, v86
v_lshlrev_b32 v102, 16, v87
v_and_b32 v103, 0xffff0000, v87
v_pk_fma_f32 v[96:97], v[216:217], v[200:201], v[96:97]
v_pk_fma_f32 v[98:99], v[218:219], v[202:203], v[98:99]
v_pk_fma_f32 v[100:101], v[220:221], v[204:205], v[100:101]
v_pk_fma_f32 v[102:103], v[222:223], v[206:207], v[102:103]
v_cvt_pk_bf16_f32 v84, v96, v97
v_cvt_pk_bf16_f32 v85, v98, v99
v_cvt_pk_bf16_f32 v86, v100, v101
v_cvt_pk_bf16_f32 v87, v102, v103
ds_write_b64 v3, v[84:85] offset:4096
ds_write_b64 v4, v[86:87] offset:4096
ds_read_b128 v[80:83], v7 offset:4096
ds_read_b128 v[84:87], v7 offset:5120
v_lshlrev_b32 v112, 16, v240
v_and_b32 v113, 0xffff0000, v240
v_lshlrev_b32 v114, 16, v241
v_and_b32 v115, 0xffff0000, v241
v_lshlrev_b32 v116, 16, v242
v_and_b32 v117, 0xffff0000, v242
v_lshlrev_b32 v118, 16, v243
v_and_b32 v119, 0xffff0000, v243
WV 5
v_lshlrev_b32 v120, 16, v244
v_and_b32 v121, 0xffff0000, v244
v_lshlrev_b32 v122, 16, v245
v_and_b32 v123, 0xffff0000, v245
v_lshlrev_b32 v124, 16, v246
v_and_b32 v125, 0xffff0000, v246
v_lshlrev_b32 v126, 16, v247
v_and_b32 v127, 0xffff0000, v247
v_pk_add_f32 v[240:241], v[112:113], v[120:121]
v_pk_add_f32 v[242:243], v[114:115], v[122:123]
v_pk_add_f32 v[244:245], v[116:117], v[124:125]
v_pk_add_f32 v[246:247], v[118:119], v[126:127]
v_lshlrev_b32 v48, 16, v88
v_and_b32 v49, 0xffff0000, v88
v_lshlrev_b32 v50, 16, v89
v_and_b32 v51, 0xffff0000, v89
v_lshlrev_b32 v52, 16, v90
v_and_b32 v53, 0xffff0000, v90
v_lshlrev_b32 v54, 16, v91
v_and_b32 v55, 0xffff0000, v91
v_pk_fma_f32 v[48:49], v[240:241], v[224:225], v[48:49]
v_pk_fma_f32 v[50:51], v[242:243], v[226:227], v[50:51]
v_pk_fma_f32 v[52:53], v[244:245], v[228:229], v[52:53]
v_pk_fma_f32 v[54:55], v[246:247], v[230:231], v[54:55]
v_cvt_pk_bf16_f32 v88, v48, v49
v_cvt_pk_bf16_f32 v89, v50, v51
v_cvt_pk_bf16_f32 v90, v52, v53
v_cvt_pk_bf16_f32 v91, v54, v55
ds_write_b64 v1, v[88:89] offset:6144
ds_write_b64 v2, v[90:91] offset:6144
WL 3
buffer_store_dwordx4 v[80:83], v58, s[40:43], s61 offen
s_add_u32 s61, s61, 16384
WL 2
buffer_store_dwordx4 v[84:87], v58, s[40:43], s61 offen
s_add_u32 s61, s61, 16384
v_lshlrev_b32 v112, 16, v248
v_and_b32 v113, 0xffff0000, v248
v_lshlrev_b32 v114, 16, v249
v_and_b32 v115, 0xffff0000, v249
v_lshlrev_b32 v116, 16, v250
v_and_b32 v117, 0xffff0000, v250
v_lshlrev_b32 v118, 16, v251
v_and_b32 v119, 0xffff0000, v251
WV 6
v_lshlrev_b32 v120, 16, v252
v_and_b32 v121, 0xffff0000, v252
v_lshlrev_b32 v122, 16, v253
v_and_b32 v123, 0xffff0000, v253
v_lshlrev_b32 v124, 16, v254
v_and_b32 v125, 0xffff0000, v254
v_lshlrev_b32 v126, 16, v255
v_and_b32 v127, 0xffff0000, v255
v_pk_add_f32 v[248:249], v[112:113], v[120:121]
v_pk_add_f32 v[250:251], v[114:115], v[122:123]
v_pk_add_f32 v[252:253], v[116:117], v[124:125]
v_pk_add_f32 v[254:255], v[118:119], v[126:127]
v_lshlrev_b32 v96, 16, v92
v_and_b32 v97, 0xffff0000, v92
v_lshlrev_b32 v98, 16, v93
v_and_b32 v99, 0xffff0000, v93
v_lshlrev_b32 v100, 16, v94
v_and_b32 v101, 0xffff0000, v94
v_lshlrev_b32 v102, 16, v95
v_and_b32 v103, 0xffff0000, v95
v_pk_fma_f32 v[96:97], v[248:249], v[232:233], v[96:97]
v_pk_fma_f32 v[98:99], v[250:251], v[234:235], v[98:99]
v_pk_fma_f32 v[100:101], v[252:253], v[236:237], v[100:101]
v_pk_fma_f32 v[102:103], v[254:255], v[238:239], v[102:103]
v_cvt_pk_bf16_f32 v92, v96, v97
v_cvt_pk_bf16_f32 v93, v98, v99
v_cvt_pk_bf16_f32 v94, v100, v101
v_cvt_pk_bf16_f32 v95, v102, v103
ds_write_b64 v3, v[92:93] offset:6144
ds_write_b64 v4, v[94:95] offset:6144
ds_read_b128 v[88:91], v7 offset:6144
ds_read_b128 v[92:95], v7 offset:7168
WL 1
buffer_store_dwordx4 v[88:91], v58, s[40:43], s61 offen
s_add_u32 s61, s61, 16384
WL 0
buffer_store_dwordx4 v[92:95], v58, s[40:43], s61 offen
s_add_u32 s61, s61, 16384
s_endpgm
t2_slow1:
s_mov_b32 s71, 0x20000
t2_slow1_r:
s_sleep 8
buffer_load_dword v17, v23, s[8:11], 0 offen offset:0 sc1
WV 0
v_cmp_gt_u32 s[68:69], 16, v17
s_sub_u32 s71, s71, 1
s_cbranch_scc1 t2_back2
s_nop 1
s_and_b64 s[68:69], s[68:69], s[74:75]
s_cbranch_scc1 t2_slow1_r
s_branch t2_back2
t2_slow3:
s_mov_b32 s71, 0x20000
t2_slow3_r:
s_sleep 8
buffer_load_dword v17, v23, s[8:11], 0 offen offset:0 sc1
WV 0
v_cmp_gt_u32 s[68:69], 16, v17
s_sub_u32 s71, s71, 1
s_cbranch_scc1 t2_back4
s_nop 1
s_and_b64 s[68:69], s[68:69], s[74:75]
s_cbranch_scc1 t2_slow3_r
s_branch t2_back4
t2_slow5:
s_mov_b32 s71, 0x20000
t2_slow5_r:
s_sleep 8
buffer_load_dword v17, v23, s[4:7], s76 offen offset:0 sc1
WV 0
v_cmp_gt_u32 s[68:69], 8, v17
s_sub_u32 s71, s71, 1
s_cbranch_scc1 t2_back6
s_nop 1
s_and_b64 s[68:69], s[68:69], s[74:75]
s_cbranch_scc1 t2_slow5_r
s_branch t2_back6
t2_slow7:
s_mov_b32 s71, 0x20000
t2_slow7_r:
s_sleep 8
buffer_load_dword v17, v22, s[4:7], s78 offen offset:256 sc1
WV 0
v_cmp_gt_u32 s[68:69], 8, v17
s_sub_u32 s71, s71, 1
s_cbranch_scc1 t2_back8
s_nop 1
s_and_b64 s[68:69], s[68:69], s[74:75]
s_cbranch_scc1 t2_slow7_r
s_branch t2_back8
t2_slow9:
s_mov_b32 s71, 0x20000
t2_slow9_r:
s_sleep 8
buffer_load_dword v17, v22, s[4:7], s80 offen offset:768 sc1
WV 0
v_cmp_gt_u32 s[68:69], 16, v17
s_sub_u32 s71, s71, 1
s_cbranch_scc1 t2_back10
s_nop 1
s_and_b64 s[68:69], s[68:69], s[74:75]
s_cbranch_scc1 t2_slow9_r
s_branch t2_back10
t2_rare_0:
WL 0
s_nop 7
s_nop 7
v_xor_b32 v208, 0, v3
v_add_u32 v208, s70, v208
ds_read_b128 a[192:195], v208 offset:0
v_xor_b32 v208, 64, v3
v_add_u32 v208, s70, v208
ds_read_b128 a[196:199], v208 offset:0
v_xor_b32 v208, 128, v3
v_add_u32 v208, s70, v208
ds_read_b128 a[200:203], v208 offset:0
v_xor_b32 v208, 192, v3
v_add_u32 v208, s70, v208
ds_read_b128 a[204:207], v208 offset:0
WL 0
v_mfma_f32_16x16x32_bf16 v[128:131], a[192:195], a[128:131], v[192:195]
MA 128,196,132
MA 128,200,136
MA 128,204,140
v_mfma_f32_16x16x32_bf16 v[136:139], a[192:195], a[144:147], v[196:199]
MA 136,196,148
MA 136,200,152
MA 136,204,156
v_mfma_f32_16x16x32_bf16 v[144:147], a[192:195], a[160:163], v[200:203]
MA 144,196,164
MA 144,200,168
MA 144,204,172
v_mfma_f32_16x16x32_bf16 v[152:155], a[192:195], a[176:179], v[204:207]
MA 152,196,180
MA 152,200,184
MA 152,204,188
s_nop 7
s_nop 7
v_xor_b32 v208, 0, v3
v_add_u32 v208, s70, v208
ds_read_b128 a[192:195], v208 offset:4096
v_xor_b32 v208, 64, v3
v_add_u32 v208, s70, v208
ds_read_b128 a[196:199], v208 offset:4096
v_xor_b32 v208, 128, v3
v_add_u32 v208, s70, v208
ds_read_b128 a[200:203], v208 offset:4096
v_xor_b32 v208, 192, v3
v_add_u32 v208, s70, v208
ds_read_b128 a[204:207], v208 offset:4096
WL 0
v_mfma_f32_16x16x32_bf16 v[132:135], a[192:195], a[128:131], v[192:195]
MA 132,196,132
MA 132,200,136
MA 132,204,140
v_mfma_f32_16x16x32_bf16 v[140:143], a[192:195], a[144:147], v[196:199]
MA 140,196,148
MA 140,200,152
MA 140,204,156
v_mfma_f32_16x16x32_bf16 v[148:151], a[192:195], a[160:163], v[200:203]
MA 148,196,164
MA 148,200,168
MA 148,204,172
v_mfma_f32_16x16x32_bf16 v[156:159], a[192:195], a[176:179], v[204:207]
MA 156,196,180
MA 156,200,184
MA 156,204,188
s_nop 7
s_nop 7
v_max3_f32 v208, v128, v129, v130
v_max3_f32 v208, v208, v131, v132
v_max3_f32 v208, v208, v133, v134
v_max_f32 v208, v208, v135
v_mov_b32 v209, v208
s_nop 1
v_permlane16_swap_b32 v208, v209
v_max_f32 v208, v208, v209
v_mov_b32 v209, v208
s_nop 1
v_permlane32_swap_b32 v208, v209
v_max_f32 v208, v208, v209
v_max_f32 v208, 0, v208
v_exp_f32 v52, -v208
v_sub_f32 v128, v128, v208
v_sub_f32 v129, v129, v208
v_sub_f32 v130, v130, v208
v_sub_f32 v131, v131, v208
v_sub_f32 v132, v132, v208
v_sub_f32 v133, v133, v208
v_sub_f32 v134, v134, v208
v_sub_f32 v135, v135, v208
v_sub_f32 v160, v160, v208
v_sub_f32 v161, v161, v208
v_sub_f32 v162, v162, v208
v_sub_f32 v163, v163, v208
v_sub_f32 v164, v164, v208
v_sub_f32 v165, v165, v208
v_sub_f32 v166, v166, v208
v_sub_f32 v167, v167, v208
v_sub_f32 v192, v192, v208
v_sub_f32 v193, v193, v208
v_sub_f32 v194, v194, v208
v_sub_f32 v195, v195, v208
v_mul_f32 v48, v48, v52
v_exp_f32 v128, v128
v_exp_f32 v129, v129
v_exp_f32 v130, v130
v_exp_f32 v131, v131
v_exp_f32 v132, v132
v_exp_f32 v133, v133
v_exp_f32 v134, v134
v_exp_f32 v135, v135
s_nop 0
v_cvt_pk_bf16_f32 v224, v128, v129
v_cvt_pk_bf16_f32 v225, v130, v131
v_cvt_pk_bf16_f32 v226, v132, v133
v_cvt_pk_bf16_f32 v227, v134, v135
v_max3_f32 v208, v136, v137, v138
v_max3_f32 v208, v208, v139, v140
v_max3_f32 v208, v208, v141, v142
v_max_f32 v208, v208, v143
v_mov_b32 v209, v208
s_nop 1
v_permlane16_swap_b32 v208, v209
v_max_f32 v208, v208, v209
v_mov_b32 v209, v208
s_nop 1
v_permlane32_swap_b32 v208, v209
v_max_f32 v208, v208, v209
v_max_f32 v208, 0, v208
v_exp_f32 v53, -v208
v_sub_f32 v136, v136, v208
v_sub_f32 v137, v137, v208
v_sub_f32 v138, v138, v208
v_sub_f32 v139, v139, v208
v_sub_f32 v140, v140, v208
v_sub_f32 v141, v141, v208
v_sub_f32 v142, v142, v208
v_sub_f32 v143, v143, v208
v_sub_f32 v168, v168, v208
v_sub_f32 v169, v169, v208
v_sub_f32 v170, v170, v208
v_sub_f32 v171, v171, v208
v_sub_f32 v172, v172, v208
v_sub_f32 v173, v173, v208
v_sub_f32 v174, v174, v208
v_sub_f32 v175, v175, v208
v_sub_f32 v196, v196, v208
v_sub_f32 v197, v197, v208
v_sub_f32 v198, v198, v208
v_sub_f32 v199, v199, v208
v_mul_f32 v49, v49, v53
v_exp_f32 v136, v136
v_exp_f32 v137, v137
v_exp_f32 v138, v138
v_exp_f32 v139, v139
v_exp_f32 v140, v140
v_exp_f32 v141, v141
v_exp_f32 v142, v142
v_exp_f32 v143, v143
s_nop 0
v_cvt_pk_bf16_f32 v228, v136, v137
v_cvt_pk_bf16_f32 v229, v138, v139
v_cvt_pk_bf16_f32 v230, v140, v141
v_cvt_pk_bf16_f32 v231, v142, v143
v_max3_f32 v208, v144, v145, v146
v_max3_f32 v208, v208, v147, v148
v_max3_f32 v208, v208, v149, v150
v_max_f32 v208, v208, v151
v_mov_b32 v209, v208
s_nop 1
v_permlane16_swap_b32 v208, v209
v_max_f32 v208, v208, v209
v_mov_b32 v209, v208
s_nop 1
v_permlane32_swap_b32 v208, v209
v_max_f32 v208, v208, v209
v_max_f32 v208, 0, v208
v_exp_f32 v54, -v208
v_sub_f32 v144, v144, v208
v_sub_f32 v145, v145, v208
v_sub_f32 v146, v146, v208
v_sub_f32 v147, v147, v208
v_sub_f32 v148, v148, v208
v_sub_f32 v149, v149, v208
v_sub_f32 v150, v150, v208
v_sub_f32 v151, v151, v208
v_sub_f32 v176, v176, v208
v_sub_f32 v177, v177, v208
v_sub_f32 v178, v178, v208
v_sub_f32 v179, v179, v208
v_sub_f32 v180, v180, v208
v_sub_f32 v181, v181, v208
v_sub_f32 v182, v182, v208
v_sub_f32 v183, v183, v208
v_sub_f32 v200, v200, v208
v_sub_f32 v201, v201, v208
v_sub_f32 v202, v202, v208
v_sub_f32 v203, v203, v208
v_mul_f32 v50, v50, v54
v_exp_f32 v144, v144
v_exp_f32 v145, v145
v_exp_f32 v146, v146
v_exp_f32 v147, v147
v_exp_f32 v148, v148
v_exp_f32 v149, v149
v_exp_f32 v150, v150
v_exp_f32 v151, v151
s_nop 0
v_cvt_pk_bf16_f32 v232, v144, v145
v_cvt_pk_bf16_f32 v233, v146, v147
v_cvt_pk_bf16_f32 v234, v148, v149
v_cvt_pk_bf16_f32 v235, v150, v151
v_max3_f32 v208, v152, v153, v154
v_max3_f32 v208, v208, v155, v156
v_max3_f32 v208, v208, v157, v158
v_max_f32 v208, v208, v159
v_mov_b32 v209, v208
s_nop 1
v_permlane16_swap_b32 v208, v209
v_max_f32 v208, v208, v209
v_mov_b32 v209, v208
s_nop 1
v_permlane32_swap_b32 v208, v209
v_max_f32 v208, v208, v209
v_max_f32 v208, 0, v208
v_exp_f32 v55, -v208
v_sub_f32 v152, v152, v208
v_sub_f32 v153, v153, v208
v_sub_f32 v154, v154, v208
v_sub_f32 v155, v155, v208
v_sub_f32 v156, v156, v208
v_sub_f32 v157, v157, v208
v_sub_f32 v158, v158, v208
v_sub_f32 v159, v159, v208
v_sub_f32 v184, v184, v208
v_sub_f32 v185, v185, v208
v_sub_f32 v186, v186, v208
v_sub_f32 v187, v187, v208
v_sub_f32 v188, v188, v208
v_sub_f32 v189, v189, v208
v_sub_f32 v190, v190, v208
v_sub_f32 v191, v191, v208
v_sub_f32 v204, v204, v208
v_sub_f32 v205, v205, v208
v_sub_f32 v206, v206, v208
v_sub_f32 v207, v207, v208
v_mul_f32 v51, v51, v55
v_exp_f32 v152, v152
v_exp_f32 v153, v153
v_exp_f32 v154, v154
v_exp_f32 v155, v155
v_exp_f32 v156, v156
v_exp_f32 v157, v157
v_exp_f32 v158, v158
v_exp_f32 v159, v159
s_nop 0
v_cvt_pk_bf16_f32 v236, v152, v153
v_cvt_pk_bf16_f32 v237, v154, v155
v_cvt_pk_bf16_f32 v238, v156, v157
v_cvt_pk_bf16_f32 v239, v158, v159
s_nop 1
s_mov_b32 s70, 1
s_branch t2_rare_o
t2_rare_1:
WL 0
s_nop 7
s_nop 7
v_xor_b32 v208, 0, v3
v_add_u32 v208, s70, v208
ds_read_b128 a[192:195], v208 offset:0
v_xor_b32 v208, 64, v3
v_add_u32 v208, s70, v208
ds_read_b128 a[196:199], v208 offset:0
v_xor_b32 v208, 128, v3
v_add_u32 v208, s70, v208
ds_read_b128 a[200:203], v208 offset:0
v_xor_b32 v208, 192, v3
v_add_u32 v208, s70, v208
ds_read_b128 a[204:207], v208 offset:0
WL 0
v_mfma_f32_16x16x32_bf16 v[160:163], a[192:195], a[128:131], v[192:195]
MA 160,196,132
MA 160,200,136
MA 160,204,140
v_mfma_f32_16x16x32_bf16 v[168:171], a[192:195], a[144:147], v[196:199]
MA 168,196,148
MA 168,200,152
MA 168,204,156
v_mfma_f32_16x16x32_bf16 v[176:179], a[192:195], a[160:163], v[200:203]
MA 176,196,164
MA 176,200,168
MA 176,204,172
v_mfma_f32_16x16x32_bf16 v[184:187], a[192:195], a[176:179], v[204:207]
MA 184,196,180
MA 184,200,184
MA 184,204,188
s_nop 7
s_nop 7
v_xor_b32 v208, 0, v3
v_add_u32 v208, s70, v208
ds_read_b128 a[192:195], v208 offset:4096
v_xor_b32 v208, 64, v3
v_add_u32 v208, s70, v208
ds_read_b128 a[196:199], v208 offset:4096
v_xor_b32 v208, 128, v3
v_add_u32 v208, s70, v208
ds_read_b128 a[200:203], v208 offset:4096
v_xor_b32 v208, 192, v3
v_add_u32 v208, s70, v208
ds_read_b128 a[204:207], v208 offset:4096
WL 0
v_mfma_f32_16x16x32_bf16 v[164:167], a[192:195], a[128:131], v[192:195]
MA 164,196,132
MA 164,200,136
MA 164,204,140
v_mfma_f32_16x16x32_bf16 v[172:175], a[192:195], a[144:147], v[196:199]
MA 172,196,148
MA 172,200,152
MA 172,204,156
v_mfma_f32_16x16x32_bf16 v[180:183], a[192:195], a[160:163], v[200:203]
MA 180,196,164
MA 180,200,168
MA 180,204,172
v_mfma_f32_16x16x32_bf16 v[188:191], a[192:195], a[176:179], v[204:207]
MA 188,196,180
MA 188,200,184
MA 188,204,188
s_nop 7
s_nop 7
v_max3_f32 v208, v160, v161, v162
v_max3_f32 v208, v208, v163, v164
v_max3_f32 v208, v208, v165, v166
v_max_f32 v208, v208, v167
v_mov_b32 v209, v208
s_nop 1
v_permlane16_swap_b32 v208, v209
v_max_f32 v208, v208, v209
v_mov_b32 v209, v208
s_nop 1
v_permlane32_swap_b32 v208, v209
v_max_f32 v208, v208, v209
v_max_f32 v208, 0, v208
v_exp_f32 v52, -v208
v_sub_f32 v160, v160, v208
v_sub_f32 v161, v161, v208
v_sub_f32 v162, v162, v208
v_sub_f32 v163, v163, v208
v_sub_f32 v164, v164, v208
v_sub_f32 v165, v165, v208
v_sub_f32 v166, v166, v208
v_sub_f32 v167, v167, v208
v_sub_f32 v128, v128, v208
v_sub_f32 v129, v129, v208
v_sub_f32 v130, v130, v208
v_sub_f32 v131, v131, v208
v_sub_f32 v132, v132, v208
v_sub_f32 v133, v133, v208
v_sub_f32 v134, v134, v208
v_sub_f32 v135, v135, v208
v_sub_f32 v192, v192, v208
v_sub_f32 v193, v193, v208
v_sub_f32 v194, v194, v208
v_sub_f32 v195, v195, v208
v_mul_f32 v48, v48, v52
v_exp_f32 v160, v160
v_exp_f32 v161, v161
v_exp_f32 v162, v162
v_exp_f32 v163, v163
v_exp_f32 v164, v164
v_exp_f32 v165, v165
v_exp_f32 v166, v166
v_exp_f32 v167, v167
s_nop 0
v_cvt_pk_bf16_f32 v224, v160, v161
v_cvt_pk_bf16_f32 v225, v162, v163
v_cvt_pk_bf16_f32 v226, v164, v165
v_cvt_pk_bf16_f32 v227, v166, v167
v_max3_f32 v208, v168, v169, v170
v_max3_f32 v208, v208, v171, v172
v_max3_f32 v208, v208, v173, v174
v_max_f32 v208, v208, v175
v_mov_b32 v209, v208
s_nop 1
v_permlane16_swap_b32 v208, v209
v_max_f32 v208, v208, v209
v_mov_b32 v209, v208
s_nop 1
v_permlane32_swap_b32 v208, v209
v_max_f32 v208, v208, v209
v_max_f32 v208, 0, v208
v_exp_f32 v53, -v208
v_sub_f32 v168, v168, v208
v_sub_f32 v169, v169, v208
v_sub_f32 v170, v170, v208
v_sub_f32 v171, v171, v208
v_sub_f32 v172, v172, v208
v_sub_f32 v173, v173, v208
v_sub_f32 v174, v174, v208
v_sub_f32 v175, v175, v208
v_sub_f32 v136, v136, v208
v_sub_f32 v137, v137, v208
v_sub_f32 v138, v138, v208
v_sub_f32 v139, v139, v208
v_sub_f32 v140, v140, v208
v_sub_f32 v141, v141, v208
v_sub_f32 v142, v142, v208
v_sub_f32 v143, v143, v208
v_sub_f32 v196, v196, v208
v_sub_f32 v197, v197, v208
v_sub_f32 v198, v198, v208
v_sub_f32 v199, v199, v208
v_mul_f32 v49, v49, v53
v_exp_f32 v168, v168
v_exp_f32 v169, v169
v_exp_f32 v170, v170
v_exp_f32 v171, v171
v_exp_f32 v172, v172
v_exp_f32 v173, v173
v_exp_f32 v174, v174
v_exp_f32 v175, v175
s_nop 0
v_cvt_pk_bf16_f32 v228, v168, v169
v_cvt_pk_bf16_f32 v229, v170, v171
v_cvt_pk_bf16_f32 v230, v172, v173
v_cvt_pk_bf16_f32 v231, v174, v175
v_max3_f32 v208, v176, v177, v178
v_max3_f32 v208, v208, v179, v180
v_max3_f32 v208, v208, v181, v182
v_max_f32 v208, v208, v183
v_mov_b32 v209, v208
s_nop 1
v_permlane16_swap_b32 v208, v209
v_max_f32 v208, v208, v209
v_mov_b32 v209, v208
s_nop 1
v_permlane32_swap_b32 v208, v209
v_max_f32 v208, v208, v209
v_max_f32 v208, 0, v208
v_exp_f32 v54, -v208
v_sub_f32 v176, v176, v208
v_sub_f32 v177, v177, v208
v_sub_f32 v178, v178, v208
v_sub_f32 v179, v179, v208
v_sub_f32 v180, v180, v208
v_sub_f32 v181, v181, v208
v_sub_f32 v182, v182, v208
v_sub_f32 v183, v183, v208
v_sub_f32 v144, v144, v208
v_sub_f32 v145, v145, v208
v_sub_f32 v146, v146, v208
v_sub_f32 v147, v147, v208
v_sub_f32 v148, v148, v208
v_sub_f32 v149, v149, v208
v_sub_f32 v150, v150, v208
v_sub_f32 v151, v151, v208
v_sub_f32 v200, v200, v208
v_sub_f32 v201, v201, v208
v_sub_f32 v202, v202, v208
v_sub_f32 v203, v203, v208
v_mul_f32 v50, v50, v54
v_exp_f32 v176, v176
v_exp_f32 v177, v177
v_exp_f32 v178, v178
v_exp_f32 v179, v179
v_exp_f32 v180, v180
v_exp_f32 v181, v181
v_exp_f32 v182, v182
v_exp_f32 v183, v183
s_nop 0
v_cvt_pk_bf16_f32 v232, v176, v177
v_cvt_pk_bf16_f32 v233, v178, v179
v_cvt_pk_bf16_f32 v234, v180, v181
v_cvt_pk_bf16_f32 v235, v182, v183
v_max3_f32 v208, v184, v185, v186
v_max3_f32 v208, v208, v187, v188
v_max3_f32 v208, v208, v189, v190
v_max_f32 v208, v208, v191
v_mov_b32 v209, v208
s_nop 1
v_permlane16_swap_b32 v208, v209
v_max_f32 v208, v208, v209
v_mov_b32 v209, v208
s_nop 1
v_permlane32_swap_b32 v208, v209
v_max_f32 v208, v208, v209
v_max_f32 v208, 0, v208
v_exp_f32 v55, -v208
v_sub_f32 v184, v184, v208
v_sub_f32 v185, v185, v208
v_sub_f32 v186, v186, v208
v_sub_f32 v187, v187, v208
v_sub_f32 v188, v188, v208
v_sub_f32 v189, v189, v208
v_sub_f32 v190, v190, v208
v_sub_f32 v191, v191, v208
v_sub_f32 v152, v152, v208
v_sub_f32 v153, v153, v208
v_sub_f32 v154, v154, v208
v_sub_f32 v155, v155, v208
v_sub_f32 v156, v156, v208
v_sub_f32 v157, v157, v208
v_sub_f32 v158, v158, v208
v_sub_f32 v159, v159, v208
v_sub_f32 v204, v204, v208
v_sub_f32 v205, v205, v208
v_sub_f32 v206, v206, v208
v_sub_f32 v207, v207, v208
v_mul_f32 v51, v51, v55
v_exp_f32 v184, v184
v_exp_f32 v185, v185
v_exp_f32 v186, v186
v_exp_f32 v187, v187
v_exp_f32 v188, v188
v_exp_f32 v189, v189
v_exp_f32 v190, v190
v_exp_f32 v191, v191
s_nop 0
v_cvt_pk_bf16_f32 v236, v184, v185
v_cvt_pk_bf16_f32 v237, v186, v187
v_cvt_pk_bf16_f32 v238, v188, v189
v_cvt_pk_bf16_f32 v239, v190, v191
s_nop 1
s_mov_b32 s70, 1
s_branch t2_rare_o
t2_rare_last:
WL 0
s_nop 7
s_nop 7
v_max3_f32 v208, v160, v161, v162
v_max3_f32 v208, v208, v163, v164
v_max3_f32 v208, v208, v165, v166
v_max_f32 v208, v208, v167
v_mov_b32 v209, v208
s_nop 1
v_permlane16_swap_b32 v208, v209
v_max_f32 v208, v208, v209
v_mov_b32 v209, v208
s_nop 1
v_permlane32_swap_b32 v208, v209
v_max_f32 v208, v208, v209
v_max_f32 v208, 0, v208
v_exp_f32 v52, -v208
v_sub_f32 v160, v160, v208
v_sub_f32 v161, v161, v208
v_sub_f32 v162, v162, v208
v_sub_f32 v163, v163, v208
v_sub_f32 v164, v164, v208
v_sub_f32 v165, v165, v208
v_sub_f32 v166, v166, v208
v_sub_f32 v167, v167, v208
v_mul_f32 v48, v48, v52
v_exp_f32 v160, v160
v_exp_f32 v161, v161
v_exp_f32 v162, v162
v_exp_f32 v163, v163
v_exp_f32 v164, v164
v_exp_f32 v165, v165
v_exp_f32 v166, v166
v_exp_f32 v167, v167
s_nop 0
v_cvt_pk_bf16_f32 v240, v160, v161
v_cvt_pk_bf16_f32 v241, v162, v163
v_cvt_pk_bf16_f32 v242, v164, v165
v_cvt_pk_bf16_f32 v243, v166, v167
v_max3_f32 v208, v168, v169, v170
v_max3_f32 v208, v208, v171, v172
v_max3_f32 v208, v208, v173, v174
v_max_f32 v208, v208, v175
v_mov_b32 v209, v208
s_nop 1
v_permlane16_swap_b32 v208, v209
v_max_f32 v208, v208, v209
v_mov_b32 v209, v208
s_nop 1
v_permlane32_swap_b32 v208, v209
v_max_f32 v208, v208, v209
v_max_f32 v208, 0, v208
v_exp_f32 v53, -v208
v_sub_f32 v168, v168, v208
v_sub_f32 v169, v169, v208
v_sub_f32 v170, v170, v208
v_sub_f32 v171, v171, v208
v_sub_f32 v172, v172, v208
v_sub_f32 v173, v173, v208
v_sub_f32 v174, v174, v208
v_sub_f32 v175, v175, v208
v_mul_f32 v49, v49, v53
v_exp_f32 v168, v168
v_exp_f32 v169, v169
v_exp_f32 v170, v170
v_exp_f32 v171, v171
v_exp_f32 v172, v172
v_exp_f32 v173, v173
v_exp_f32 v174, v174
v_exp_f32 v175, v175
s_nop 0
v_cvt_pk_bf16_f32 v244, v168, v169
v_cvt_pk_bf16_f32 v245, v170, v171
v_cvt_pk_bf16_f32 v246, v172, v173
v_cvt_pk_bf16_f32 v247, v174, v175
v_max3_f32 v208, v176, v177, v178
v_max3_f32 v208, v208, v179, v180
v_max3_f32 v208, v208, v181, v182
v_max_f32 v208, v208, v183
v_mov_b32 v209, v208
s_nop 1
v_permlane16_swap_b32 v208, v209
v_max_f32 v208, v208, v209
v_mov_b32 v209, v208
s_nop 1
v_permlane32_swap_b32 v208, v209
v_max_f32 v208, v208, v209
v_max_f32 v208, 0, v208
v_exp_f32 v54, -v208
v_sub_f32 v176, v176, v208
v_sub_f32 v177, v177, v208
v_sub_f32 v178, v178, v208
v_sub_f32 v179, v179, v208
v_sub_f32 v180, v180, v208
v_sub_f32 v181, v181, v208
v_sub_f32 v182, v182, v208
v_sub_f32 v183, v183, v208
v_mul_f32 v50, v50, v54
v_exp_f32 v176, v176
v_exp_f32 v177, v177
v_exp_f32 v178, v178
v_exp_f32 v179, v179
v_exp_f32 v180, v180
v_exp_f32 v181, v181
v_exp_f32 v182, v182
v_exp_f32 v183, v183
s_nop 0
v_cvt_pk_bf16_f32 v248, v176, v177
v_cvt_pk_bf16_f32 v249, v178, v179
v_cvt_pk_bf16_f32 v250, v180, v181
v_cvt_pk_bf16_f32 v251, v182, v183
v_max3_f32 v208, v184, v185, v186
v_max3_f32 v208, v208, v187, v188
v_max3_f32 v208, v208, v189, v190
v_max_f32 v208, v208, v191
v_mov_b32 v209, v208
s_nop 1
v_permlane16_swap_b32 v208, v209
v_max_f32 v208, v208, v209
v_mov_b32 v209, v208
s_nop 1
v_permlane32_swap_b32 v208, v209
v_max_f32 v208, v208, v209
v_max_f32 v208, 0, v208
v_exp_f32 v55, -v208
v_sub_f32 v184, v184, v208
v_sub_f32 v185, v185, v208
v_sub_f32 v186, v186, v208
v_sub_f32 v187, v187, v208
v_sub_f32 v188, v188, v208
v_sub_f32 v189, v189, v208
v_sub_f32 v190, v190, v208
v_sub_f32 v191, v191, v208
v_mul_f32 v51, v51, v55
v_exp_f32 v184, v184
v_exp_f32 v185, v185
v_exp_f32 v186, v186
v_exp_f32 v187, v187
v_exp_f32 v188, v188
v_exp_f32 v189, v189
v_exp_f32 v190, v190
v_exp_f32 v191, v191
s_nop 0
v_cvt_pk_bf16_f32 v252, v184, v185
v_cvt_pk_bf16_f32 v253, v186, v187
v_cvt_pk_bf16_f32 v254, v188, v189
v_cvt_pk_bf16_f32 v255, v190, v191
s_nop 1
s_mov_b32 s70, 0
s_branch t2_rare_o
t2_rare_o:
v_accvgpr_read_b32 v208, a0
v_accvgpr_read_b32 v209, a1
v_accvgpr_read_b32 v210, a2
v_accvgpr_read_b32 v211, a3
v_mul_f32 v208, v208, v52
v_mul_f32 v209, v209, v52
v_mul_f32 v210, v210, v52
v_mul_f32 v211, v211, v52
v_accvgpr_write_b32 a0, v208
v_accvgpr_write_b32 a1, v209
v_accvgpr_write_b32 a2, v210
v_accvgpr_write_b32 a3, v211
v_accvgpr_read_b32 v208, a4
v_accvgpr_read_b32 v209, a5
v_accvgpr_read_b32 v210, a6
v_accvgpr_read_b32 v211, a7
v_mul_f32 v208, v208, v52
v_mul_f32 v209, v209, v52
v_mul_f32 v210, v210, v52
v_mul_f32 v211, v211, v52
v_accvgpr_write_b32 a4, v208
v_accvgpr_write_b32 a5, v209
v_accvgpr_write_b32 a6, v210
v_accvgpr_write_b32 a7, v211
v_accvgpr_read_b32 v208, a8
v_accvgpr_read_b32 v209, a9
v_accvgpr_read_b32 v210, a10
v_accvgpr_read_b32 v211, a11
v_mul_f32 v208, v208, v52
v_mul_f32 v209, v209, v52
v_mul_f32 v210, v210, v52
v_mul_f32 v211, v211, v52
v_accvgpr_write_b32 a8, v208
v_accvgpr_write_b32 a9, v209
v_accvgpr_write_b32 a10, v210
v_accvgpr_write_b32 a11, v211
v_accvgpr_read_b32 v208, a12
v_accvgpr_read_b32 v209, a13
v_accvgpr_read_b32 v210, a14
v_accvgpr_read_b32 v211, a15
v_mul_f32 v208, v208, v52
v_mul_f32 v209, v209, v52
v_mul_f32 v210, v210, v52
v_mul_f32 v211, v211, v52
v_accvgpr_write_b32 a12, v208
v_accvgpr_write_b32 a13, v209
v_accvgpr_write_b32 a14, v210
v_accvgpr_write_b32 a15, v211
v_accvgpr_read_b32 v208, a16
v_accvgpr_read_b32 v209, a17
v_accvgpr_read_b32 v210, a18
v_accvgpr_read_b32 v211, a19
v_mul_f32 v208, v208, v52
v_mul_f32 v209, v209, v52
v_mul_f32 v210, v210, v52
v_mul_f32 v211, v211, v52
v_accvgpr_write_b32 a16, v208
v_accvgpr_write_b32 a17, v209
v_accvgpr_write_b32 a18, v210
v_accvgpr_write_b32 a19, v211
v_accvgpr_read_b32 v208, a20
v_accvgpr_read_b32 v209, a21
v_accvgpr_read_b32 v210, a22
v_accvgpr_read_b32 v211, a23
v_mul_f32 v208, v208, v52
v_mul_f32 v209, v209, v52
v_mul_f32 v210, v210, v52
v_mul_f32 v211, v211, v52
v_accvgpr_write_b32 a20, v208
v_accvgpr_write_b32 a21, v209
v_accvgpr_write_b32 a22, v210
v_accvgpr_write_b32 a23, v211
v_accvgpr_read_b32 v208, a24
v_accvgpr_read_b32 v209, a25
v_accvgpr_read_b32 v210, a26
v_accvgpr_read_b32 v211, a27
v_mul_f32 v208, v208, v52
v_mul_f32 v209, v209, v52
v_mul_f32 v210, v210, v52
v_mul_f32 v211, v211, v52
v_accvgpr_write_b32 a24, v208
v_accvgpr_write_b32 a25, v209
v_accvgpr_write_b32 a26, v210
v_accvgpr_write_b32 a27, v211
v_accvgpr_read_b32 v208, a28
v_accvgpr_read_b32 v209, a29
v_accvgpr_read_b32 v210, a30
v_accvgpr_read_b32 v211, a31
v_mul_f32 v208, v208, v52
v_mul_f32 v209, v209, v52
v_mul_f32 v210, v210, v52
v_mul_f32 v211, v211, v52
v_accvgpr_write_b32 a28, v208
v_accvgpr_write_b32 a29, v209
v_accvgpr_write_b32 a30, v210
v_accvgpr_write_b32 a31, v211
v_accvgpr_read_b32 v208, a32
v_accvgpr_read_b32 v209, a33
v_accvgpr_read_b32 v210, a34
v_accvgpr_read_b32 v211, a35
v_mul_f32 v208, v208, v53
v_mul_f32 v209, v209, v53
v_mul_f32 v210, v210, v53
v_mul_f32 v211, v211, v53
v_accvgpr_write_b32 a32, v208
v_accvgpr_write_b32 a33, v209
v_accvgpr_write_b32 a34, v210
v_accvgpr_write_b32 a35, v211
v_accvgpr_read_b32 v208, a36
v_accvgpr_read_b32 v209, a37
v_accvgpr_read_b32 v210, a38
v_accvgpr_read_b32 v211, a39
v_mul_f32 v208, v208, v53
v_mul_f32 v209, v209, v53
v_mul_f32 v210, v210, v53
v_mul_f32 v211, v211, v53
v_accvgpr_write_b32 a36, v208
v_accvgpr_write_b32 a37, v209
v_accvgpr_write_b32 a38, v210
v_accvgpr_write_b32 a39, v211
v_accvgpr_read_b32 v208, a40
v_accvgpr_read_b32 v209, a41
v_accvgpr_read_b32 v210, a42
v_accvgpr_read_b32 v211, a43
v_mul_f32 v208, v208, v53
v_mul_f32 v209, v209, v53
v_mul_f32 v210, v210, v53
v_mul_f32 v211, v211, v53
v_accvgpr_write_b32 a40, v208
v_accvgpr_write_b32 a41, v209
v_accvgpr_write_b32 a42, v210
v_accvgpr_write_b32 a43, v211
v_accvgpr_read_b32 v208, a44
v_accvgpr_read_b32 v209, a45
v_accvgpr_read_b32 v210, a46
v_accvgpr_read_b32 v211, a47
v_mul_f32 v208, v208, v53
v_mul_f32 v209, v209, v53
v_mul_f32 v210, v210, v53
v_mul_f32 v211, v211, v53
v_accvgpr_write_b32 a44, v208
v_accvgpr_write_b32 a45, v209
v_accvgpr_write_b32 a46, v210
v_accvgpr_write_b32 a47, v211
v_accvgpr_read_b32 v208, a48
v_accvgpr_read_b32 v209, a49
v_accvgpr_read_b32 v210, a50
v_accvgpr_read_b32 v211, a51
v_mul_f32 v208, v208, v53
v_mul_f32 v209, v209, v53
v_mul_f32 v210, v210, v53
v_mul_f32 v211, v211, v53
v_accvgpr_write_b32 a48, v208
v_accvgpr_write_b32 a49, v209
v_accvgpr_write_b32 a50, v210
v_accvgpr_write_b32 a51, v211
v_accvgpr_read_b32 v208, a52
v_accvgpr_read_b32 v209, a53
v_accvgpr_read_b32 v210, a54
v_accvgpr_read_b32 v211, a55
v_mul_f32 v208, v208, v53
v_mul_f32 v209, v209, v53
v_mul_f32 v210, v210, v53
v_mul_f32 v211, v211, v53
v_accvgpr_write_b32 a52, v208
v_accvgpr_write_b32 a53, v209
v_accvgpr_write_b32 a54, v210
v_accvgpr_write_b32 a55, v211
v_accvgpr_read_b32 v208, a56
v_accvgpr_read_b32 v209, a57
v_accvgpr_read_b32 v210, a58
v_accvgpr_read_b32 v211, a59
v_mul_f32 v208, v208, v53
v_mul_f32 v209, v209, v53
v_mul_f32 v210, v210, v53
v_mul_f32 v211, v211, v53
v_accvgpr_write_b32 a56, v208
v_accvgpr_write_b32 a57, v209
v_accvgpr_write_b32 a58, v210
v_accvgpr_write_b32 a59, v211
v_accvgpr_read_b32 v208, a60
v_accvgpr_read_b32 v209, a61
v_accvgpr_read_b32 v210, a62
v_accvgpr_read_b32 v211, a63
v_mul_f32 v208, v208, v53
v_mul_f32 v209, v209, v53
v_mul_f32 v210, v210, v53
v_mul_f32 v211, v211, v53
v_accvgpr_write_b32 a60, v208
v_accvgpr_write_b32 a61, v209
v_accvgpr_write_b32 a62, v210
v_accvgpr_write_b32 a63, v211
v_accvgpr_read_b32 v208, a64
v_accvgpr_read_b32 v209, a65
v_accvgpr_read_b32 v210, a66
v_accvgpr_read_b32 v211, a67
v_mul_f32 v208, v208, v54
v_mul_f32 v209, v209, v54
v_mul_f32 v210, v210, v54
v_mul_f32 v211, v211, v54
v_accvgpr_write_b32 a64, v208
v_accvgpr_write_b32 a65, v209
v_accvgpr_write_b32 a66, v210
v_accvgpr_write_b32 a67, v211
v_accvgpr_read_b32 v208, a68
v_accvgpr_read_b32 v209, a69
v_accvgpr_read_b32 v210, a70
v_accvgpr_read_b32 v211, a71
v_mul_f32 v208, v208, v54
v_mul_f32 v209, v209, v54
v_mul_f32 v210, v210, v54
v_mul_f32 v211, v211, v54
v_accvgpr_write_b32 a68, v208
v_accvgpr_write_b32 a69, v209
v_accvgpr_write_b32 a70, v210
v_accvgpr_write_b32 a71, v211
v_accvgpr_read_b32 v208, a72
v_accvgpr_read_b32 v209, a73
v_accvgpr_read_b32 v210, a74
v_accvgpr_read_b32 v211, a75
v_mul_f32 v208, v208, v54
v_mul_f32 v209, v209, v54
v_mul_f32 v210, v210, v54
v_mul_f32 v211, v211, v54
v_accvgpr_write_b32 a72, v208
v_accvgpr_write_b32 a73, v209
v_accvgpr_write_b32 a74, v210
v_accvgpr_write_b32 a75, v211
v_accvgpr_read_b32 v208, a76
v_accvgpr_read_b32 v209, a77
v_accvgpr_read_b32 v210, a78
v_accvgpr_read_b32 v211, a79
v_mul_f32 v208, v208, v54
v_mul_f32 v209, v209, v54
v_mul_f32 v210, v210, v54
v_mul_f32 v211, v211, v54
v_accvgpr_write_b32 a76, v208
v_accvgpr_write_b32 a77, v209
v_accvgpr_write_b32 a78, v210
v_accvgpr_write_b32 a79, v211
v_accvgpr_read_b32 v208, a80
v_accvgpr_read_b32 v209, a81
v_accvgpr_read_b32 v210, a82
v_accvgpr_read_b32 v211, a83
v_mul_f32 v208, v208, v54
v_mul_f32 v209, v209, v54
v_mul_f32 v210, v210, v54
v_mul_f32 v211, v211, v54
v_accvgpr_write_b32 a80, v208
v_accvgpr_write_b32 a81, v209
v_accvgpr_write_b32 a82, v210
v_accvgpr_write_b32 a83, v211
v_accvgpr_read_b32 v208, a84
v_accvgpr_read_b32 v209, a85
v_accvgpr_read_b32 v210, a86
v_accvgpr_read_b32 v211, a87
v_mul_f32 v208, v208, v54
v_mul_f32 v209, v209, v54
v_mul_f32 v210, v210, v54
v_mul_f32 v211, v211, v54
v_accvgpr_write_b32 a84, v208
v_accvgpr_write_b32 a85, v209
v_accvgpr_write_b32 a86, v210
v_accvgpr_write_b32 a87, v211
v_accvgpr_read_b32 v208, a88
v_accvgpr_read_b32 v209, a89
v_accvgpr_read_b32 v210, a90
v_accvgpr_read_b32 v211, a91
v_mul_f32 v208, v208, v54
v_mul_f32 v209, v209, v54
v_mul_f32 v210, v210, v54
v_mul_f32 v211, v211, v54
v_accvgpr_write_b32 a88, v208
v_accvgpr_write_b32 a89, v209
v_accvgpr_write_b32 a90, v210
v_accvgpr_write_b32 a91, v211
v_accvgpr_read_b32 v208, a92
v_accvgpr_read_b32 v209, a93
v_accvgpr_read_b32 v210, a94
v_accvgpr_read_b32 v211, a95
v_mul_f32 v208, v208, v54
v_mul_f32 v209, v209, v54
v_mul_f32 v210, v210, v54
v_mul_f32 v211, v211, v54
v_accvgpr_write_b32 a92, v208
v_accvgpr_write_b32 a93, v209
v_accvgpr_write_b32 a94, v210
v_accvgpr_write_b32 a95, v211
v_accvgpr_read_b32 v208, a96
v_accvgpr_read_b32 v209, a97
v_accvgpr_read_b32 v210, a98
v_accvgpr_read_b32 v211, a99
v_mul_f32 v208, v208, v55
v_mul_f32 v209, v209, v55
v_mul_f32 v210, v210, v55
v_mul_f32 v211, v211, v55
v_accvgpr_write_b32 a96, v208
v_accvgpr_write_b32 a97, v209
v_accvgpr_write_b32 a98, v210
v_accvgpr_write_b32 a99, v211
v_accvgpr_read_b32 v208, a100
v_accvgpr_read_b32 v209, a101
v_accvgpr_read_b32 v210, a102
v_accvgpr_read_b32 v211, a103
v_mul_f32 v208, v208, v55
v_mul_f32 v209, v209, v55
v_mul_f32 v210, v210, v55
v_mul_f32 v211, v211, v55
v_accvgpr_write_b32 a100, v208
v_accvgpr_write_b32 a101, v209
v_accvgpr_write_b32 a102, v210
v_accvgpr_write_b32 a103, v211
v_accvgpr_read_b32 v208, a104
v_accvgpr_read_b32 v209, a105
v_accvgpr_read_b32 v210, a106
v_accvgpr_read_b32 v211, a107
v_mul_f32 v208, v208, v55
v_mul_f32 v209, v209, v55
v_mul_f32 v210, v210, v55
v_mul_f32 v211, v211, v55
v_accvgpr_write_b32 a104, v208
v_accvgpr_write_b32 a105, v209
v_accvgpr_write_b32 a106, v210
v_accvgpr_write_b32 a107, v211
v_accvgpr_read_b32 v208, a108
v_accvgpr_read_b32 v209, a109
v_accvgpr_read_b32 v210, a110
v_accvgpr_read_b32 v211, a111
v_mul_f32 v208, v208, v55
v_mul_f32 v209, v209, v55
v_mul_f32 v210, v210, v55
v_mul_f32 v211, v211, v55
v_accvgpr_write_b32 a108, v208
v_accvgpr_write_b32 a109, v209
v_accvgpr_write_b32 a110, v210
v_accvgpr_write_b32 a111, v211
v_accvgpr_read_b32 v208, a112
v_accvgpr_read_b32 v209, a113
v_accvgpr_read_b32 v210, a114
v_accvgpr_read_b32 v211, a115
v_mul_f32 v208, v208, v55
v_mul_f32 v209, v209, v55
v_mul_f32 v210, v210, v55
v_mul_f32 v211, v211, v55
v_accvgpr_write_b32 a112, v208
v_accvgpr_write_b32 a113, v209
v_accvgpr_write_b32 a114, v210
v_accvgpr_write_b32 a115, v211
v_accvgpr_read_b32 v208, a116
v_accvgpr_read_b32 v209, a117
v_accvgpr_read_b32 v210, a118
v_accvgpr_read_b32 v211, a119
v_mul_f32 v208, v208, v55
v_mul_f32 v209, v209, v55
v_mul_f32 v210, v210, v55
v_mul_f32 v211, v211, v55
v_accvgpr_write_b32 a116, v208
v_accvgpr_write_b32 a117, v209
v_accvgpr_write_b32 a118, v210
v_accvgpr_write_b32 a119, v211
v_accvgpr_read_b32 v208, a120
v_accvgpr_read_b32 v209, a121
v_accvgpr_read_b32 v210, a122
v_accvgpr_read_b32 v211, a123
v_mul_f32 v208, v208, v55
v_mul_f32 v209, v209, v55
v_mul_f32 v210, v210, v55
v_mul_f32 v211, v211, v55
v_accvgpr_write_b32 a120, v208
v_accvgpr_write_b32 a121, v209
v_accvgpr_write_b32 a122, v210
v_accvgpr_write_b32 a123, v211
v_accvgpr_read_b32 v208, a124
v_accvgpr_read_b32 v209, a125
v_accvgpr_read_b32 v210, a126
v_accvgpr_read_b32 v211, a127
v_mul_f32 v208, v208, v55
v_mul_f32 v209, v209, v55
v_mul_f32 v210, v210, v55
v_mul_f32 v211, v211, v55
v_accvgpr_write_b32 a124, v208
v_accvgpr_write_b32 a125, v209
v_accvgpr_write_b32 a126, v210
v_accvgpr_write_b32 a127, v211
s_nop 1
s_cmp_eq_u32 s70, 0
s_cbranch_scc1 t2_rare_l
v_mfma_f32_16x16x32_bf16 v[208:211], a[240:243], v[224:227], 0
v_mfma_f32_16x16x32_bf16 v[212:215], a[240:243], v[228:231], 0
v_mfma_f32_16x16x32_bf16 v[216:219], a[240:243], v[232:235], 0
v_mfma_f32_16x16x32_bf16 v[220:223], a[240:243], v[236:239], 0
s_branch t2_rare_e
t2_rare_l:
v_mfma_f32_16x16x32_bf16 v[208:211], a[240:243], v[240:243], 0
v_mfma_f32_16x16x32_bf16 v[212:215], a[240:243], v[244:247], 0
v_mfma_f32_16x16x32_bf16 v[216:219], a[240:243], v[248:251], 0
v_mfma_f32_16x16x32_bf16 v[220:223], a[240:243], v[252:255], 0
t2_rare_e:
s_nop 7
s_nop 7
s_setpc_b64 s[66:67]
t2_c11:
s_mov_b32 s70, 8192
s_call_b64 s[66:67], t2_rare_1
s_branch t2_r12
t2_c13:
s_mov_b32 s70, 32768
s_call_b64 s[66:67], t2_rare_0
s_branch t2_r14
t2_c15:
s_mov_b32 s70, 40960
s_call_b64 s[66:67], t2_rare_1
s_branch t2_r16
t2_c17:
s_mov_b32 s70, 65536
s_call_b64 s[66:67], t2_rare_0
s_branch t2_r18
t2_c19:
s_mov_b32 s70, 73728
s_call_b64 s[66:67], t2_rare_1
s_branch t2_r20
t2_c21:
s_mov_b32 s70, 98304
s_call_b64 s[66:67], t2_rare_0
s_branch t2_r22
t2_c23:
s_mov_b32 s70, 106496
s_call_b64 s[66:67], t2_rare_1
s_branch t2_r24
t2_c25:
s_mov_b32 s70, 0
s_call_b64 s[66:67], t2_rare_0
s_branch t2_r26
t2_c27:
s_mov_b32 s70, 8192
s_call_b64 s[66:67], t2_rare_1
s_branch t2_r28
t2_c29:
s_mov_b32 s70, 32768
s_call_b64 s[66:67], t2_rare_0
s_branch t2_r30
t2_c31:
s_mov_b32 s70, 40960
s_call_b64 s[66:67], t2_rare_1
s_branch t2_r32
t2_c33:
s_mov_b32 s70, 65536
s_call_b64 s[66:67], t2_rare_0
s_branch t2_r34
t2_c35:
s_mov_b32 s70, 73728
s_call_b64 s[66:67], t2_rare_1
s_branch t2_r36
t2_c37:
s_mov_b32 s70, 98304
s_call_b64 s[66:67], t2_rare_0
s_branch t2_r38
t2_c39:
s_mov_b32 s70, 106496
s_call_b64 s[66:67], t2_rare_last
s_branch t2_r40
t2_slow41:
s_mov_b32 s71, 0x20000
t2_slow41_r:
s_sleep 8
buffer_load_dword v17, v22, s[4:7], s80 offen offset:1536 sc1
WV 0
v_cmp_gt_u32 s[68:69], 16, v17
s_sub_u32 s71, s71, 1
s_cbranch_scc1 t2_back42
s_nop 1
s_and_b64 s[68:69], s[68:69], s[74:75]
s_cbranch_scc1 t2_slow41_r
s_branch t2_back42
t2_slow43:
s_mov_b32 s71, 0x20000
t2_slow43_r:
s_sleep 8
buffer_load_dword v17, v22, s[4:7], s80 offen offset:1792 sc1
WV 0
v_cmp_gt_u32 s[68:69], 16, v17
s_sub_u32 s71, s71, 1
s_cbranch_scc1 t2_back44
s_nop 1
s_and_b64 s[68:69], s[68:69], s[74:75]
s_cbranch_scc1 t2_slow43_r
s_branch t2_back44
t2_slow45:
s_mov_b32 s71, 0x20000
t2_slow45_r:
s_sleep 1
buffer_load_dword v17, v22, s[4:7], s78 offen offset:0 sc1
WV 0
v_cmp_gt_u32 s[68:69], 8, v17
s_sub_u32 s71, s71, 1
s_cbranch_scc1 t2_back46
s_nop 1
s_and_b64 s[68:69], s[68:69], s[74:75]
s_cbranch_scc1 t2_slow45_r
s_branch t2_back46
t2_slow47:
s_mov_b32 s71, 0x20000
t2_slow47_r:
s_sleep 1
buffer_load_dword v17, v22, s[4:7], s98 offen offset:0 sc1
WV 0
v_cmp_gt_u32 s[68:69], 8, v17
s_sub_u32 s71, s71, 1
s_cbranch_scc1 t2_back48
s_nop 1
s_and_b64 s[68:69], s[68:69], s[74:75]
s_cbranch_scc1 t2_slow47_r
s_branch t2_back48
t2_end:
.section .rodata,"a"
.p2align 6
.amdhsa_kernel recurrent_scan__sliding_block_cached__mixer_s_mlp__prompt_kernel
  .amdhsa_next_free_vgpr 512
  .amdhsa_next_free_sgpr 100
  .amdhsa_accum_offset 256
  .amdhsa_group_segment_fixed_size 0
  .amdhsa_kernarg_size 104
  .amdhsa_user_sgpr_count 2
  .amdhsa_user_sgpr_kernarg_segment_ptr 1
  .amdhsa_system_sgpr_workgroup_id_x 1
.end_amdhsa_kernel
```
